```python
import torch

def _softmax(x, axis=-1):
    return torch.softmax(x, dim=axis)

def _gelu(x):
    return torch.nn.functional.gelu(x, approximate='tanh')

def _silu(x):
    return torch.nn.functional.silu(x)

def _sigmoid(x):
    return torch.sigmoid(x)

def _layernorm(x, axis=-1, eps=1e-05):
    m = x.mean(dim=axis, keepdim=True)
    v = x.var(dim=axis, keepdim=True, unbiased=False)
    return (x - m) / torch.sqrt(v + eps)

def _scatter_add(tgt, idx, src, axis=0):
    return tgt.clone().index_add_(axis, idx, src)

def _segment_sum(src, seg, n):
    out = torch.zeros((n,) + src.shape[1:], dtype=src.dtype)
    return out.index_add_(0, seg, src)

def _pad(x, pw):
    flat = tuple((v for pair in reversed(pw) for v in pair))
    return torch.nn.functional.pad(x, flat)
kernel_name = 'concat_heads__grouped_kv_mqa__memory_aug_recurrent_mem_tr__prompt'

def setup_inputs():

    _w = lambda a: (lambda t: t.to(torch.bfloat16) if t.is_floating_point() else t)(torch.as_tensor(a))

    def _A_setup():
        B, S, D, H = (1, 2048, 640, 32)
        Dh = D // H
        return {'x': _w((lambda *s: torch.randn(*s, dtype=torch.bfloat16) * 0.05)(B, S, D)), 'wq': _w((lambda *s: torch.randn(*s, dtype=torch.bfloat16) * 0.8)(D, H * Dh)), 'wk': _w((lambda *s: torch.randn(*s, dtype=torch.bfloat16) * 0.8)(D, Dh)), 'wv': _w((lambda *s: torch.randn(*s, dtype=torch.bfloat16) * 0.05)(D, Dh)), 'wo': _w((lambda *s: torch.randn(*s, dtype=torch.bfloat16) * 0.05)(H * Dh, D))}
    _A_in = _A_setup()

    def _B_setup():
        B, S, Dm = (1, 2048, 640)
        H, Dh = (32, 128)
        M, seg = (8, 32)
        seg = min(seg, S)
        S = S // seg * seg
        return {'x': _w((lambda *s: torch.randn(*s, dtype=torch.bfloat16) * 0.05)(B, S, Dm)), 'mem0': _w((lambda *s: torch.randn(*s, dtype=torch.bfloat16) * 0.4)(B, M, Dm)), 'Wq': _w((lambda *s: torch.randn(*s, dtype=torch.bfloat16) * 6.4)(Dm, H, Dh) * Dm ** (-0.5)), 'Wk': _w((lambda *s: torch.randn(*s, dtype=torch.bfloat16) * 6.4)(Dm, H, Dh) * Dm ** (-0.5)), 'Wv': _w((lambda *s: torch.randn(*s, dtype=torch.bfloat16) * 0.4)(Dm, H, Dh) * Dm ** (-0.5)), 'Wo': _w((lambda *s: torch.randn(*s, dtype=torch.bfloat16) * 0.4)(H, Dh, Dm) * (H * Dh) ** (-0.5)), 'seg_len': seg}
    _B_in = _B_setup()
    return {'A_x': _A_in['x'], 'A_wq': _A_in['wq'], 'A_wk': _A_in['wk'], 'A_wv': _A_in['wv'], 'A_wo': _A_in['wo'], 'B_x': _B_in['x'], 'B_mem0': _B_in['mem0'], 'B_Wq': _B_in['Wq'], 'B_Wk': _B_in['Wk'], 'B_Wv': _B_in['Wv'], 'B_Wo': _B_in['Wo'], 'B_seg_len': _B_in['seg_len']}

def reference(A_x, A_wq, A_wk, A_wv, A_wo, B_x, B_mem0, B_Wq, B_Wk, B_Wv, B_Wo, B_seg_len):

    def _A_ref(x, wq, wk, wv, wo):
        B, S, D = x.shape
        H = 32
        Dh = D // H
        q = (lambda x, *d: x.permute(*d))((x @ wq).reshape(B, S, H, Dh), 0, 2, 1, 3)
        k = x @ wk
        v = x @ wv
        scores = torch.einsum('bhqd,bkd->bhqk', q, k) * Dh ** (-0.5)
        p = _softmax(scores, axis=-1)
        o = torch.einsum('bhqk,bkd->bhqd', p, v)
        return (lambda x, *d: x.permute(*d))(o, 0, 2, 1, 3).reshape(B, S, H * Dh) @ wo

    def _B_ref(x, mem0, Wq, Wk, Wv, Wo, seg_len):
        B, S, Dm = x.shape
        H, Dh = (Wq.shape[1], Wq.shape[2])
        M = mem0.shape[1]
        scale = Dh ** (-0.5)
        n_seg = S // seg_len
        L = M + seg_len
        idx = torch.arange(L)
        mask = (idx[:, None] < M) | (idx[:, None] >= idx[None, :])
        mem = mem0
        outs = []
        for s in range(n_seg):
            xs = x[:, s * seg_len:(s + 1) * seg_len, :].clone()
            h = torch.concatenate([mem, xs], axis=1)
            q = torch.einsum('btd,dhe->bhte', h, Wq)
            k = torch.einsum('btd,dhe->bhte', h, Wk)
            v = torch.einsum('btd,dhe->bhte', h, Wv)
            scores = torch.einsum('bhqe,bhke->bhqk', q, k) * scale
            scores = torch.where(mask[None, None], scores, -1000000000.0)
            p = _softmax(scores, axis=-1)
            o = torch.einsum('bhqk,bhke->bhqe', p, v)
            o = torch.einsum('bhte,hed->btd', o, Wo)
            mem = o[:, :M, :].clone()
            outs.append(o[:, M:, :])
        return torch.concatenate(outs, axis=1)
    a = _A_ref(A_x, A_wq, A_wk, A_wv, A_wo)
    b = _B_ref(B_x, B_mem0, B_Wq, B_Wk, B_Wv, B_Wo, B_seg_len)
    return torch.concatenate([a, b], axis=-1)
```

```asm
; @launch grid=(256,1,1) block=(256,1,1) lds=163840
.amdgcn_target "amdgcn-amd-amdhsa--gfx950"
.text
.globl concat_heads__grouped_kv_mqa__memory_aug_recurrent_mem_tr__prompt_kernel
.p2align 8
.type concat_heads__grouped_kv_mqa__memory_aug_recurrent_mem_tr__prompt_kernel,@function
concat_heads__grouped_kv_mqa__memory_aug_recurrent_mem_tr__prompt_kernel:
    s_cmp_ge_u32 s2, 256
    s_cbranch_scc1 L_end
    s_load_dwordx4 s[8:11], s[0:1], 104
    v_lshrrev_b32 v1, 6, v0
    s_nop 0
    v_readfirstlane_b32 s4, v1
    s_getreg_b32 s87, hwreg(HW_REG_XCC_ID, 0, 4)
    s_min_u32 s12, s87, 7
    s_lshl_b32 s12, s12, 5
    s_lshr_b32 s13, s2, 3
    s_add_u32 s3, s12, s13
    s_mov_b32 s86, 0
    s_waitcnt lgkmcnt(0)
    s_add_u32 s6, s10, 0x3fffff
    s_addc_u32 s7, s11, 0
    s_and_b32 s6, s6, 0xffc00000
    s_mov_b32 s10, 1
L_dispatch:
    s_cmp_lt_u32 s3, 64
    s_cbranch_scc1 L_chain
    s_cmp_lg_u32 s3, 64
    s_cbranch_scc1 L_noprobe
    s_cmp_lg_u32 s4, 0
    s_cbranch_scc1 L_noprobe
    s_mov_b64 exec, 1
    v_mov_b32 v2, 0
    s_add_u32 s20, s6, 393216
    s_addc_u32 s21, s7, 0
    s_mov_b32 s22, -1
    s_mov_b32 s23, -1
    v_mov_b32 v1, 0
    global_store_dword v1, v2, s[20:21] sc1
    s_waitcnt vmcnt(0)
    s_memtime s[24:25]
    s_waitcnt lgkmcnt(0)
    global_load_dword v3, v1, s[20:21] sc1
    s_waitcnt vmcnt(0)
    s_memtime s[26:27]
    s_waitcnt lgkmcnt(0)
    s_sub_u32 s24, s26, s24
    s_min_u32 s22, s22, s24
    v_mov_b32 v1, 8192
    global_store_dword v1, v2, s[20:21] sc1
    s_waitcnt vmcnt(0)
    s_memtime s[24:25]
    s_waitcnt lgkmcnt(0)
    global_load_dword v3, v1, s[20:21] sc1
    s_waitcnt vmcnt(0)
    s_memtime s[26:27]
    s_waitcnt lgkmcnt(0)
    s_sub_u32 s24, s26, s24
    s_min_u32 s23, s23, s24
    v_mov_b32 v1, 17408
    global_store_dword v1, v2, s[20:21] sc1
    s_waitcnt vmcnt(0)
    s_memtime s[24:25]
    s_waitcnt lgkmcnt(0)
    global_load_dword v3, v1, s[20:21] sc1
    s_waitcnt vmcnt(0)
    s_memtime s[26:27]
    s_waitcnt lgkmcnt(0)
    s_sub_u32 s24, s26, s24
    s_min_u32 s22, s22, s24
    v_mov_b32 v1, 25600
    global_store_dword v1, v2, s[20:21] sc1
    s_waitcnt vmcnt(0)
    s_memtime s[24:25]
    s_waitcnt lgkmcnt(0)
    global_load_dword v3, v1, s[20:21] sc1
    s_waitcnt vmcnt(0)
    s_memtime s[26:27]
    s_waitcnt lgkmcnt(0)
    s_sub_u32 s24, s26, s24
    s_min_u32 s23, s23, s24
    v_mov_b32 v1, 34816
    global_store_dword v1, v2, s[20:21] sc1
    s_waitcnt vmcnt(0)
    s_memtime s[24:25]
    s_waitcnt lgkmcnt(0)
    global_load_dword v3, v1, s[20:21] sc1
    s_waitcnt vmcnt(0)
    s_memtime s[26:27]
    s_waitcnt lgkmcnt(0)
    s_sub_u32 s24, s26, s24
    s_min_u32 s22, s22, s24
    v_mov_b32 v1, 43008
    global_store_dword v1, v2, s[20:21] sc1
    s_waitcnt vmcnt(0)
    s_memtime s[24:25]
    s_waitcnt lgkmcnt(0)
    global_load_dword v3, v1, s[20:21] sc1
    s_waitcnt vmcnt(0)
    s_memtime s[26:27]
    s_waitcnt lgkmcnt(0)
    s_sub_u32 s24, s26, s24
    s_min_u32 s23, s23, s24
    v_mov_b32 v1, 52224
    global_store_dword v1, v2, s[20:21] sc1
    s_waitcnt vmcnt(0)
    s_memtime s[24:25]
    s_waitcnt lgkmcnt(0)
    global_load_dword v3, v1, s[20:21] sc1
    s_waitcnt vmcnt(0)
    s_memtime s[26:27]
    s_waitcnt lgkmcnt(0)
    s_sub_u32 s24, s26, s24
    s_min_u32 s22, s22, s24
    v_mov_b32 v1, 60416
    global_store_dword v1, v2, s[20:21] sc1
    s_waitcnt vmcnt(0)
    s_memtime s[24:25]
    s_waitcnt lgkmcnt(0)
    global_load_dword v3, v1, s[20:21] sc1
    s_waitcnt vmcnt(0)
    s_memtime s[26:27]
    s_waitcnt lgkmcnt(0)
    s_sub_u32 s24, s26, s24
    s_min_u32 s23, s23, s24
    s_cmp_lt_u32 s23, s22
    s_cselect_b32 s22, 2, 1
    s_lshr_b32 s23, s86, 1
    s_lshl_b32 s23, s23, 2
    v_mov_b32 v1, s23
    v_mov_b32 v2, s22
    global_store_dword v1, v2, s[8:9] offset:68 sc1
    s_waitcnt vmcnt(0)
    s_mov_b64 exec, -1
L_noprobe:
    s_or_b32 s96, s4, s86
    s_cbranch_scc1 L_ar_1
    v_mbcnt_lo_u32_b32 v14, -1, 0
    v_mbcnt_hi_u32_b32 v14, -1, v14
    s_lshl_b32 s96, s2, 8
    v_lshl_add_u32 v14, v14, 2, s96
    v_mov_b32 v15, 0
    global_store_dword v14, v15, s[6:7] sc1
L_ar_1:
    v_and_b32 v1, 63, v0
    v_and_b32 v2, 15, v0
    v_bfe_u32 v3, v0, 4, 2
    v_lshlrev_b32 v4, 4, v0
    v_lshlrev_b32 v5, 4, v1
    s_lshl_b32 s43, s4, 10
    s_mov_b32 s47, 0x05040100
    s_mov_b32 s48, 0x07060302
    v_lshrrev_b32 v12, 3, v0
    v_mul_u32_u24 v12, 1280, v12
    v_bfe_u32 v13, v0, 4, 3
    v_and_b32 v6, 7, v0
    v_xor_b32 v13, v13, v6
    v_lshl_add_u32 v6, v13, 4, v12
    v_lshrrev_b32 v12, 1, v2
    v_xor_b32 v12, v12, v3
    v_lshlrev_b32 v12, 4, v12
    v_lshl_add_u32 v7, v2, 7, v12
    v_xor_b32 v8, 64, v7
    s_cmp_lt_u32 s3, 128
    s_cbranch_scc1 L_r_qa
    s_cmp_lt_u32 s3, 160
    s_cbranch_scc1 L_r_k
    s_cmp_lt_u32 s3, 192
    s_cbranch_scc1 L_r_v
    s_sub_u32 s12, s3, 192
    s_lshr_b32 s40, s12, 5
    s_and_b32 s42, s12, 31
    s_cmp_lt_u32 s42, 20
    s_cbranch_scc1 L_orole
L_r_a:
    s_waitcnt vmcnt(0)
    s_or_b32 s96, s4, s86
    s_cbranch_scc1 L_ar_2
    s_and_b32 s96, s3, 31
    s_lshl_b32 s96, 1, s96
    s_lshl_b32 s97, s87, 3
    s_mov_b64 exec, 1
    v_mov_b32 v12, s97
    v_mov_b32 v14, s96
    v_mov_b32 v15, 0x100
    global_atomic_add_x2 v[14:15], v12, v[14:15], s[8:9] offset:128 sc0
    s_mov_b64 exec, -1
L_ar_2:
    s_cmp_lg_u32 s86, 0
    s_cbranch_scc1 L_vf_3
    s_cmp_lg_u32 s4, 0
    s_cbranch_scc1 L_vf_4
    s_mov_b64 exec, 0xffff
    v_mbcnt_lo_u32_b32 v18, -1, 0
    v_lshlrev_b32 v18, 3, v18
    s_mov_b32 s96, 1048576
L_vf_5:
    global_load_dwordx2 v[16:17], v18, s[8:9] offset:128 sc1
    s_sub_u32 s96, s96, 1
    s_cbranch_scc1 L_bail1
    s_waitcnt vmcnt(0)
    v_lshrrev_b32 v19, 8, v17
    s_nop 1
    v_add_u32_dpp v19, v19, v19 row_shr:1 row_mask:0xf bank_mask:0xf bound_ctrl:0
    s_nop 1
    v_add_u32_dpp v19, v19, v19 row_shr:2 row_mask:0xf bank_mask:0xf bound_ctrl:0
    s_nop 1
    v_add_u32_dpp v19, v19, v19 row_shr:4 row_mask:0xf bank_mask:0xf bound_ctrl:0
    s_nop 1
    v_add_u32_dpp v19, v19, v19 row_shr:8 row_mask:0xf bank_mask:0xf bound_ctrl:0
    s_nop 0
    v_readlane_b32 s97, v19, 15
    s_nop 0
    s_cmp_lt_u32 s97, 256
    s_cbranch_scc1 L_vf_5
    v_cmp_eq_u32 vcc, -1, v16
    s_nop 0
    s_mov_b32 s98, vcc_lo
    v_cmp_eq_u32 vcc, 0x2000, v17
    s_nop 0
    s_and_b32 s98, s98, vcc_lo
    s_mov_b32 s97, -1
    s_cmp_eq_u32 s98, 0xff
    s_cbranch_scc1 L_vf_6
    v_readlane_b32 s97, v19, s87
    v_readlane_b32 s98, v17, s87
    v_readlane_b32 s99, v15, 0
    s_lshr_b32 s98, s98, 8
    s_lshr_b32 s99, s99, 8
    s_sub_u32 s97, s97, s98
    s_add_u32 s97, s97, s99
    v_readlane_b32 s98, v19, 0
    v_readlane_b32 s99, v19, 1
    s_xor_b32 s98, s98, 32
    s_xor_b32 s99, s99, 64
    s_or_b32 s98, s98, s99
    s_cmp_eq_u32 s98, 0
    s_cselect_b32 s98, 0x10000, 0
    s_or_b32 s97, s97, s98
L_vf_6:
    v_mov_b32 v16, 122880
    v_mov_b32 v17, s97
    ds_write_b32 v16, v17
    s_waitcnt lgkmcnt(0)
    s_mov_b64 exec, -1
L_vf_4:
    s_barrier
    v_mov_b32 v16, 122880
    ds_read_b32 v17, v16
    s_waitcnt lgkmcnt(0)
    v_readfirstlane_b32 s97, v17
    s_barrier
    s_mov_b32 s86, 1
    s_cmp_lg_u32 s97, -1
    s_cbranch_scc1 L_redo
L_vf_3:
    s_branch L_queue
L_r_k:
    s_sub_u32 s42, s3, 128
    s_lshr_b32 s40, s42, 5
    s_and_b32 s42, s42, 31
    s_mov_b32 s11, 0
    s_load_dwordx2 s[52:53], s[0:1], 64
    s_load_dwordx2 s[36:37], s[0:1], 40
    s_lshl_b32 s13, s42, 8
    s_mov_b32 s14, 8192
    s_mul_i32 s12, s40, 40960
    s_mov_b32 s41, 64
    s_waitcnt lgkmcnt(0)
    s_add_u32 s36, s36, s12
    s_addc_u32 s37, s37, 0
    s_add_u32 s16, s52, s13
    s_addc_u32 s17, s53, 0
    s_and_b32 s17, s17, 0xffff
    s_sub_u32 s18, 5242880, s13
    s_mov_b32 s19, 0x20000
    s_lshl_b32 s12, s4, 6
    v_lshl_add_u32 v10, v2, 2, s12
    s_branch L_gload
L_r_v:
    s_sub_u32 s42, s3, 160
    s_lshr_b32 s40, s42, 5
    s_and_b32 s42, s42, 31
    s_mov_b32 s11, 1
    s_load_dwordx2 s[52:53], s[0:1], 72
    s_load_dwordx2 s[36:37], s[0:1], 40
    s_lshl_b32 s13, s42, 8
    s_mov_b32 s14, 8192
    s_mul_i32 s12, s40, 40960
    s_mov_b32 s41, 64
    s_waitcnt lgkmcnt(0)
    s_add_u32 s36, s36, s12
    s_addc_u32 s37, s37, 0
    s_add_u32 s16, s52, s13
    s_addc_u32 s17, s53, 0
    s_and_b32 s17, s17, 0xffff
    s_sub_u32 s18, 5242880, s13
    s_mov_b32 s19, 0x20000
    s_lshl_b32 s12, s4, 6
    v_lshl_add_u32 v10, v2, 2, s12
    s_branch L_gload
L_r_qa:
    s_sub_u32 s42, s3, 64
    s_lshr_b32 s40, s42, 5
    s_and_b32 s42, s42, 31
    s_mov_b32 s11, 2
    s_load_dwordx2 s[52:53], s[0:1], 56
    s_load_dwordx2 s[36:37], s[0:1], 40
    s_lshl_b32 s13, s42, 8
    s_mov_b32 s14, 8192
    s_mul_i32 s12, s40, 40960
    s_mov_b32 s41, 64
    s_waitcnt lgkmcnt(0)
    s_add_u32 s36, s36, s12
    s_addc_u32 s37, s37, 0
    s_add_u32 s16, s52, s13
    s_addc_u32 s17, s53, 0
    s_and_b32 s17, s17, 0xffff
    s_sub_u32 s18, 5242880, s13
    s_mov_b32 s19, 0x20000
    s_lshl_b32 s12, s4, 6
    v_lshl_add_u32 v10, v2, 2, s12
    s_branch L_gload
L_gload:
    s_mul_i32 s20, s14, 0
    s_mul_i32 s21, s14, 1
    s_mul_i32 s22, s14, 2
    s_mul_i32 s23, s14, 3
    s_mul_i32 s24, s14, 4
    s_mul_i32 s25, s14, 5
    s_mul_i32 s26, s14, 6
    s_mul_i32 s27, s14, 7
    s_mul_i32 s28, s14, 32
    s_mul_i32 s29, s14, 33
    s_mul_i32 s30, s14, 34
    s_mul_i32 s31, s14, 35
    s_mul_i32 s32, s14, 36
    s_mul_i32 s33, s14, 37
    s_mul_i32 s34, s14, 38
    s_mul_i32 s35, s14, 39
    s_lshl_b32 s12, s14, 3
    v_mul_lo_u32 v12, v3, s12
    v_add_u32 v10, v10, v12
    s_lshl_b32 s14, s14, 6
    buffer_load_dword v32, v10, s[16:19], s20 offen
    buffer_load_dword v33, v10, s[16:19], s21 offen
    buffer_load_dword v34, v10, s[16:19], s22 offen
    buffer_load_dword v35, v10, s[16:19], s23 offen
    buffer_load_dword v36, v10, s[16:19], s24 offen
    buffer_load_dword v37, v10, s[16:19], s25 offen
    buffer_load_dword v38, v10, s[16:19], s26 offen
    buffer_load_dword v39, v10, s[16:19], s27 offen
    buffer_load_dword v40, v10, s[16:19], s28 offen
    buffer_load_dword v41, v10, s[16:19], s29 offen
    buffer_load_dword v42, v10, s[16:19], s30 offen
    buffer_load_dword v43, v10, s[16:19], s31 offen
    buffer_load_dword v44, v10, s[16:19], s32 offen
    buffer_load_dword v45, v10, s[16:19], s33 offen
    buffer_load_dword v46, v10, s[16:19], s34 offen
    buffer_load_dword v47, v10, s[16:19], s35 offen
    v_add_u32 v10, s14, v10
    buffer_load_dword v48, v10, s[16:19], s20 offen
    buffer_load_dword v49, v10, s[16:19], s21 offen
    buffer_load_dword v50, v10, s[16:19], s22 offen
    buffer_load_dword v51, v10, s[16:19], s23 offen
    buffer_load_dword v52, v10, s[16:19], s24 offen
    buffer_load_dword v53, v10, s[16:19], s25 offen
    buffer_load_dword v54, v10, s[16:19], s26 offen
    buffer_load_dword v55, v10, s[16:19], s27 offen
    buffer_load_dword v56, v10, s[16:19], s28 offen
    buffer_load_dword v57, v10, s[16:19], s29 offen
    buffer_load_dword v58, v10, s[16:19], s30 offen
    buffer_load_dword v59, v10, s[16:19], s31 offen
    buffer_load_dword v60, v10, s[16:19], s32 offen
    buffer_load_dword v61, v10, s[16:19], s33 offen
    buffer_load_dword v62, v10, s[16:19], s34 offen
    buffer_load_dword v63, v10, s[16:19], s35 offen
    v_add_u32 v10, s14, v10
    buffer_load_dword v64, v10, s[16:19], s20 offen
    buffer_load_dword v65, v10, s[16:19], s21 offen
    buffer_load_dword v66, v10, s[16:19], s22 offen
    buffer_load_dword v67, v10, s[16:19], s23 offen
    buffer_load_dword v68, v10, s[16:19], s24 offen
    buffer_load_dword v69, v10, s[16:19], s25 offen
    buffer_load_dword v70, v10, s[16:19], s26 offen
    buffer_load_dword v71, v10, s[16:19], s27 offen
    buffer_load_dword v72, v10, s[16:19], s28 offen
    buffer_load_dword v73, v10, s[16:19], s29 offen
    buffer_load_dword v74, v10, s[16:19], s30 offen
    buffer_load_dword v75, v10, s[16:19], s31 offen
    buffer_load_dword v76, v10, s[16:19], s32 offen
    buffer_load_dword v77, v10, s[16:19], s33 offen
    buffer_load_dword v78, v10, s[16:19], s34 offen
    buffer_load_dword v79, v10, s[16:19], s35 offen
    v_add_u32 v10, s14, v10
    s_waitcnt vmcnt(32)
    v_perm_b32 v96, v33, v32, s47
    v_perm_b32 v104, v33, v32, s48
    v_perm_b32 v97, v35, v34, s47
    v_perm_b32 v105, v35, v34, s48
    v_perm_b32 v98, v37, v36, s47
    v_perm_b32 v106, v37, v36, s48
    v_perm_b32 v99, v39, v38, s47
    v_perm_b32 v107, v39, v38, s48
    v_perm_b32 v100, v41, v40, s47
    v_perm_b32 v108, v41, v40, s48
    v_perm_b32 v101, v43, v42, s47
    v_perm_b32 v109, v43, v42, s48
    v_perm_b32 v102, v45, v44, s47
    v_perm_b32 v110, v45, v44, s48
    v_perm_b32 v103, v47, v46, s47
    v_perm_b32 v111, v47, v46, s48
    buffer_load_dword v32, v10, s[16:19], s20 offen
    buffer_load_dword v33, v10, s[16:19], s21 offen
    buffer_load_dword v34, v10, s[16:19], s22 offen
    buffer_load_dword v35, v10, s[16:19], s23 offen
    buffer_load_dword v36, v10, s[16:19], s24 offen
    buffer_load_dword v37, v10, s[16:19], s25 offen
    buffer_load_dword v38, v10, s[16:19], s26 offen
    buffer_load_dword v39, v10, s[16:19], s27 offen
    buffer_load_dword v40, v10, s[16:19], s28 offen
    buffer_load_dword v41, v10, s[16:19], s29 offen
    buffer_load_dword v42, v10, s[16:19], s30 offen
    buffer_load_dword v43, v10, s[16:19], s31 offen
    buffer_load_dword v44, v10, s[16:19], s32 offen
    buffer_load_dword v45, v10, s[16:19], s33 offen
    buffer_load_dword v46, v10, s[16:19], s34 offen
    buffer_load_dword v47, v10, s[16:19], s35 offen
    v_add_u32 v10, s14, v10
    s_waitcnt vmcnt(32)
    v_perm_b32 v112, v49, v48, s47
    v_perm_b32 v120, v49, v48, s48
    v_perm_b32 v113, v51, v50, s47
    v_perm_b32 v121, v51, v50, s48
    v_perm_b32 v114, v53, v52, s47
    v_perm_b32 v122, v53, v52, s48
    v_perm_b32 v115, v55, v54, s47
    v_perm_b32 v123, v55, v54, s48
    v_perm_b32 v116, v57, v56, s47
    v_perm_b32 v124, v57, v56, s48
    v_perm_b32 v117, v59, v58, s47
    v_perm_b32 v125, v59, v58, s48
    v_perm_b32 v118, v61, v60, s47
    v_perm_b32 v126, v61, v60, s48
    v_perm_b32 v119, v63, v62, s47
    v_perm_b32 v127, v63, v62, s48
    buffer_load_dword v48, v10, s[16:19], s20 offen
    buffer_load_dword v49, v10, s[16:19], s21 offen
    buffer_load_dword v50, v10, s[16:19], s22 offen
    buffer_load_dword v51, v10, s[16:19], s23 offen
    buffer_load_dword v52, v10, s[16:19], s24 offen
    buffer_load_dword v53, v10, s[16:19], s25 offen
    buffer_load_dword v54, v10, s[16:19], s26 offen
    buffer_load_dword v55, v10, s[16:19], s27 offen
    buffer_load_dword v56, v10, s[16:19], s28 offen
    buffer_load_dword v57, v10, s[16:19], s29 offen
    buffer_load_dword v58, v10, s[16:19], s30 offen
    buffer_load_dword v59, v10, s[16:19], s31 offen
    buffer_load_dword v60, v10, s[16:19], s32 offen
    buffer_load_dword v61, v10, s[16:19], s33 offen
    buffer_load_dword v62, v10, s[16:19], s34 offen
    buffer_load_dword v63, v10, s[16:19], s35 offen
    v_add_u32 v10, s14, v10
    s_or_b32 s96, s4, s86
    s_cbranch_scc1 L_ar_7
    s_and_b32 s96, s3, 31
    s_lshl_b32 s96, 1, s96
    s_lshl_b32 s97, s87, 3
    s_mov_b64 exec, 1
    v_mov_b32 v12, s97
    v_mov_b32 v14, s96
    v_mov_b32 v15, 0x100
    global_atomic_add_x2 v[14:15], v12, v[14:15], s[8:9] offset:128 sc0
    s_mov_b64 exec, -1
L_ar_7:
    s_waitcnt vmcnt(32)
    v_perm_b32 v128, v65, v64, s47
    v_perm_b32 v136, v65, v64, s48
    v_perm_b32 v129, v67, v66, s47
    v_perm_b32 v137, v67, v66, s48
    v_perm_b32 v130, v69, v68, s47
    v_perm_b32 v138, v69, v68, s48
    v_perm_b32 v131, v71, v70, s47
    v_perm_b32 v139, v71, v70, s48
    v_perm_b32 v132, v73, v72, s47
    v_perm_b32 v140, v73, v72, s48
    v_perm_b32 v133, v75, v74, s47
    v_perm_b32 v141, v75, v74, s48
    v_perm_b32 v134, v77, v76, s47
    v_perm_b32 v142, v77, v76, s48
    v_perm_b32 v135, v79, v78, s47
    v_perm_b32 v143, v79, v78, s48
    buffer_load_dword v64, v10, s[16:19], s20 offen
    buffer_load_dword v65, v10, s[16:19], s21 offen
    buffer_load_dword v66, v10, s[16:19], s22 offen
    buffer_load_dword v67, v10, s[16:19], s23 offen
    buffer_load_dword v68, v10, s[16:19], s24 offen
    buffer_load_dword v69, v10, s[16:19], s25 offen
    buffer_load_dword v70, v10, s[16:19], s26 offen
    buffer_load_dword v71, v10, s[16:19], s27 offen
    buffer_load_dword v72, v10, s[16:19], s28 offen
    buffer_load_dword v73, v10, s[16:19], s29 offen
    buffer_load_dword v74, v10, s[16:19], s30 offen
    buffer_load_dword v75, v10, s[16:19], s31 offen
    buffer_load_dword v76, v10, s[16:19], s32 offen
    buffer_load_dword v77, v10, s[16:19], s33 offen
    buffer_load_dword v78, v10, s[16:19], s34 offen
    buffer_load_dword v79, v10, s[16:19], s35 offen
    v_add_u32 v10, s14, v10
    s_waitcnt vmcnt(32)
    v_perm_b32 v144, v33, v32, s47
    v_perm_b32 v152, v33, v32, s48
    v_perm_b32 v145, v35, v34, s47
    v_perm_b32 v153, v35, v34, s48
    v_perm_b32 v146, v37, v36, s47
    v_perm_b32 v154, v37, v36, s48
    v_perm_b32 v147, v39, v38, s47
    v_perm_b32 v155, v39, v38, s48
    v_perm_b32 v148, v41, v40, s47
    v_perm_b32 v156, v41, v40, s48
    v_perm_b32 v149, v43, v42, s47
    v_perm_b32 v157, v43, v42, s48
    v_perm_b32 v150, v45, v44, s47
    v_perm_b32 v158, v45, v44, s48
    v_perm_b32 v151, v47, v46, s47
    v_perm_b32 v159, v47, v46, s48
    buffer_load_dword v32, v10, s[16:19], s20 offen
    buffer_load_dword v33, v10, s[16:19], s21 offen
    buffer_load_dword v34, v10, s[16:19], s22 offen
    buffer_load_dword v35, v10, s[16:19], s23 offen
    buffer_load_dword v36, v10, s[16:19], s24 offen
    buffer_load_dword v37, v10, s[16:19], s25 offen
    buffer_load_dword v38, v10, s[16:19], s26 offen
    buffer_load_dword v39, v10, s[16:19], s27 offen
    buffer_load_dword v40, v10, s[16:19], s28 offen
    buffer_load_dword v41, v10, s[16:19], s29 offen
    buffer_load_dword v42, v10, s[16:19], s30 offen
    buffer_load_dword v43, v10, s[16:19], s31 offen
    buffer_load_dword v44, v10, s[16:19], s32 offen
    buffer_load_dword v45, v10, s[16:19], s33 offen
    buffer_load_dword v46, v10, s[16:19], s34 offen
    buffer_load_dword v47, v10, s[16:19], s35 offen
    v_add_u32 v10, s14, v10
    s_waitcnt vmcnt(32)
    v_perm_b32 v160, v49, v48, s47
    v_perm_b32 v168, v49, v48, s48
    v_perm_b32 v161, v51, v50, s47
    v_perm_b32 v169, v51, v50, s48
    v_perm_b32 v162, v53, v52, s47
    v_perm_b32 v170, v53, v52, s48
    v_perm_b32 v163, v55, v54, s47
    v_perm_b32 v171, v55, v54, s48
    v_perm_b32 v164, v57, v56, s47
    v_perm_b32 v172, v57, v56, s48
    v_perm_b32 v165, v59, v58, s47
    v_perm_b32 v173, v59, v58, s48
    v_perm_b32 v166, v61, v60, s47
    v_perm_b32 v174, v61, v60, s48
    v_perm_b32 v167, v63, v62, s47
    v_perm_b32 v175, v63, v62, s48
    buffer_load_dword v48, v10, s[16:19], s20 offen
    buffer_load_dword v49, v10, s[16:19], s21 offen
    buffer_load_dword v50, v10, s[16:19], s22 offen
    buffer_load_dword v51, v10, s[16:19], s23 offen
    buffer_load_dword v52, v10, s[16:19], s24 offen
    buffer_load_dword v53, v10, s[16:19], s25 offen
    buffer_load_dword v54, v10, s[16:19], s26 offen
    buffer_load_dword v55, v10, s[16:19], s27 offen
    buffer_load_dword v56, v10, s[16:19], s28 offen
    buffer_load_dword v57, v10, s[16:19], s29 offen
    buffer_load_dword v58, v10, s[16:19], s30 offen
    buffer_load_dword v59, v10, s[16:19], s31 offen
    buffer_load_dword v60, v10, s[16:19], s32 offen
    buffer_load_dword v61, v10, s[16:19], s33 offen
    buffer_load_dword v62, v10, s[16:19], s34 offen
    buffer_load_dword v63, v10, s[16:19], s35 offen
    v_add_u32 v10, s14, v10
    s_waitcnt vmcnt(32)
    v_perm_b32 v176, v65, v64, s47
    v_perm_b32 v184, v65, v64, s48
    v_perm_b32 v177, v67, v66, s47
    v_perm_b32 v185, v67, v66, s48
    v_perm_b32 v178, v69, v68, s47
    v_perm_b32 v186, v69, v68, s48
    v_perm_b32 v179, v71, v70, s47
    v_perm_b32 v187, v71, v70, s48
    v_perm_b32 v180, v73, v72, s47
    v_perm_b32 v188, v73, v72, s48
    v_perm_b32 v181, v75, v74, s47
    v_perm_b32 v189, v75, v74, s48
    v_perm_b32 v182, v77, v76, s47
    v_perm_b32 v190, v77, v76, s48
    v_perm_b32 v183, v79, v78, s47
    v_perm_b32 v191, v79, v78, s48
    buffer_load_dword v64, v10, s[16:19], s20 offen
    buffer_load_dword v65, v10, s[16:19], s21 offen
    buffer_load_dword v66, v10, s[16:19], s22 offen
    buffer_load_dword v67, v10, s[16:19], s23 offen
    buffer_load_dword v68, v10, s[16:19], s24 offen
    buffer_load_dword v69, v10, s[16:19], s25 offen
    buffer_load_dword v70, v10, s[16:19], s26 offen
    buffer_load_dword v71, v10, s[16:19], s27 offen
    buffer_load_dword v72, v10, s[16:19], s28 offen
    buffer_load_dword v73, v10, s[16:19], s29 offen
    buffer_load_dword v74, v10, s[16:19], s30 offen
    buffer_load_dword v75, v10, s[16:19], s31 offen
    buffer_load_dword v76, v10, s[16:19], s32 offen
    buffer_load_dword v77, v10, s[16:19], s33 offen
    buffer_load_dword v78, v10, s[16:19], s34 offen
    buffer_load_dword v79, v10, s[16:19], s35 offen
    v_add_u32 v10, s14, v10
    s_waitcnt vmcnt(32)
    v_perm_b32 v192, v33, v32, s47
    v_perm_b32 v200, v33, v32, s48
    v_perm_b32 v193, v35, v34, s47
    v_perm_b32 v201, v35, v34, s48
    v_perm_b32 v194, v37, v36, s47
    v_perm_b32 v202, v37, v36, s48
    v_perm_b32 v195, v39, v38, s47
    v_perm_b32 v203, v39, v38, s48
    v_perm_b32 v196, v41, v40, s47
    v_perm_b32 v204, v41, v40, s48
    v_perm_b32 v197, v43, v42, s47
    v_perm_b32 v205, v43, v42, s48
    v_perm_b32 v198, v45, v44, s47
    v_perm_b32 v206, v45, v44, s48
    v_perm_b32 v199, v47, v46, s47
    v_perm_b32 v207, v47, v46, s48
    buffer_load_dword v32, v10, s[16:19], s20 offen
    buffer_load_dword v33, v10, s[16:19], s21 offen
    buffer_load_dword v34, v10, s[16:19], s22 offen
    buffer_load_dword v35, v10, s[16:19], s23 offen
    buffer_load_dword v36, v10, s[16:19], s24 offen
    buffer_load_dword v37, v10, s[16:19], s25 offen
    buffer_load_dword v38, v10, s[16:19], s26 offen
    buffer_load_dword v39, v10, s[16:19], s27 offen
    buffer_load_dword v40, v10, s[16:19], s28 offen
    buffer_load_dword v41, v10, s[16:19], s29 offen
    buffer_load_dword v42, v10, s[16:19], s30 offen
    buffer_load_dword v43, v10, s[16:19], s31 offen
    buffer_load_dword v44, v10, s[16:19], s32 offen
    buffer_load_dword v45, v10, s[16:19], s33 offen
    buffer_load_dword v46, v10, s[16:19], s34 offen
    buffer_load_dword v47, v10, s[16:19], s35 offen
    s_waitcnt vmcnt(32)
    v_perm_b32 v208, v49, v48, s47
    v_perm_b32 v216, v49, v48, s48
    v_perm_b32 v209, v51, v50, s47
    v_perm_b32 v217, v51, v50, s48
    v_perm_b32 v210, v53, v52, s47
    v_perm_b32 v218, v53, v52, s48
    v_perm_b32 v211, v55, v54, s47
    v_perm_b32 v219, v55, v54, s48
    v_perm_b32 v212, v57, v56, s47
    v_perm_b32 v220, v57, v56, s48
    v_perm_b32 v213, v59, v58, s47
    v_perm_b32 v221, v59, v58, s48
    v_perm_b32 v214, v61, v60, s47
    v_perm_b32 v222, v61, v60, s48
    v_perm_b32 v215, v63, v62, s47
    v_perm_b32 v223, v63, v62, s48
    s_waitcnt vmcnt(16)
    v_perm_b32 v224, v65, v64, s47
    v_perm_b32 v232, v65, v64, s48
    v_perm_b32 v225, v67, v66, s47
    v_perm_b32 v233, v67, v66, s48
    v_perm_b32 v226, v69, v68, s47
    v_perm_b32 v234, v69, v68, s48
    v_perm_b32 v227, v71, v70, s47
    v_perm_b32 v235, v71, v70, s48
    v_perm_b32 v228, v73, v72, s47
    v_perm_b32 v236, v73, v72, s48
    v_perm_b32 v229, v75, v74, s47
    v_perm_b32 v237, v75, v74, s48
    v_perm_b32 v230, v77, v76, s47
    v_perm_b32 v238, v77, v76, s48
    v_perm_b32 v231, v79, v78, s47
    v_perm_b32 v239, v79, v78, s48
    s_waitcnt vmcnt(0)
    v_perm_b32 v240, v33, v32, s47
    v_perm_b32 v248, v33, v32, s48
    v_perm_b32 v241, v35, v34, s47
    v_perm_b32 v249, v35, v34, s48
    v_perm_b32 v242, v37, v36, s47
    v_perm_b32 v250, v37, v36, s48
    v_perm_b32 v243, v39, v38, s47
    v_perm_b32 v251, v39, v38, s48
    v_perm_b32 v244, v41, v40, s47
    v_perm_b32 v252, v41, v40, s48
    v_perm_b32 v245, v43, v42, s47
    v_perm_b32 v253, v43, v42, s48
    v_perm_b32 v246, v45, v44, s47
    v_perm_b32 v254, v45, v44, s48
    v_perm_b32 v247, v47, v46, s47
    v_perm_b32 v255, v47, v46, s48
    s_cmp_lg_u32 s86, 0
    s_cbranch_scc1 L_vf_8
    s_cmp_lg_u32 s4, 0
    s_cbranch_scc1 L_vf_9
    s_mov_b64 exec, 0xffff
    v_mbcnt_lo_u32_b32 v18, -1, 0
    v_lshlrev_b32 v18, 3, v18
    s_mov_b32 s96, 1048576
L_vf_10:
    global_load_dwordx2 v[16:17], v18, s[8:9] offset:128 sc1
    s_sub_u32 s96, s96, 1
    s_cbranch_scc1 L_bail1
    s_waitcnt vmcnt(0)
    v_lshrrev_b32 v19, 8, v17
    s_nop 1
    v_add_u32_dpp v19, v19, v19 row_shr:1 row_mask:0xf bank_mask:0xf bound_ctrl:0
    s_nop 1
    v_add_u32_dpp v19, v19, v19 row_shr:2 row_mask:0xf bank_mask:0xf bound_ctrl:0
    s_nop 1
    v_add_u32_dpp v19, v19, v19 row_shr:4 row_mask:0xf bank_mask:0xf bound_ctrl:0
    s_nop 1
    v_add_u32_dpp v19, v19, v19 row_shr:8 row_mask:0xf bank_mask:0xf bound_ctrl:0
    s_nop 0
    v_readlane_b32 s97, v19, 15
    s_nop 0
    s_cmp_lt_u32 s97, 256
    s_cbranch_scc1 L_vf_10
    v_cmp_eq_u32 vcc, -1, v16
    s_nop 0
    s_mov_b32 s98, vcc_lo
    v_cmp_eq_u32 vcc, 0x2000, v17
    s_nop 0
    s_and_b32 s98, s98, vcc_lo
    s_mov_b32 s97, -1
    s_cmp_eq_u32 s98, 0xff
    s_cbranch_scc1 L_vf_11
    v_readlane_b32 s97, v19, s87
    v_readlane_b32 s98, v17, s87
    v_readlane_b32 s99, v15, 0
    s_lshr_b32 s98, s98, 8
    s_lshr_b32 s99, s99, 8
    s_sub_u32 s97, s97, s98
    s_add_u32 s97, s97, s99
    v_readlane_b32 s98, v19, 0
    v_readlane_b32 s99, v19, 1
    s_xor_b32 s98, s98, 32
    s_xor_b32 s99, s99, 64
    s_or_b32 s98, s98, s99
    s_cmp_eq_u32 s98, 0
    s_cselect_b32 s98, 0x10000, 0
    s_or_b32 s97, s97, s98
L_vf_11:
    v_mov_b32 v16, 122880
    v_mov_b32 v17, s97
    ds_write_b32 v16, v17
    s_waitcnt lgkmcnt(0)
    s_mov_b64 exec, -1
L_vf_9:
    s_barrier
    v_mov_b32 v16, 122880
    ds_read_b32 v17, v16
    s_waitcnt lgkmcnt(0)
    v_readfirstlane_b32 s97, v17
    s_barrier
    s_mov_b32 s86, 1
    s_cmp_lg_u32 s97, -1
    s_cbranch_scc1 L_redo
L_vf_8:
    s_cmp_eq_u32 s11, 0
    s_cbranch_scc1 L_kloop
    s_cmp_eq_u32 s11, 1
    s_cbranch_scc1 L_vloop
    s_cmp_eq_u32 s11, 2
    s_cbranch_scc1 L_qa
    s_cmp_eq_u32 s11, 3
    s_cbranch_scc1 L_aq
    s_cmp_eq_u32 s11, 4
    s_cbranch_scc1 L_ao
    s_branch L_akv
L_kloop:
    s_lshr_b32 s15, s86, 1
    s_lshl_b32 s15, s15, 2
    v_mov_b32 v12, s15
    s_mov_b32 s15, 1048576
L_par_12:
    global_load_dword v13, v12, s[8:9] offset:68 sc1
    s_sub_u32 s15, s15, 1
    s_cbranch_scc1 L_bail2
    s_waitcnt vmcnt(0)
    v_readfirstlane_b32 s5, v13
    s_nop 0
    s_cmp_eq_u32 s5, 0
    s_cbranch_scc1 L_par_12
    s_sub_u32 s5, s5, 1
    s_add_u32 s12, s42, 0
    s_lshl_b32 s12, s12, 7
    s_add_u32 s44, s6, s12
    s_addc_u32 s45, s7, 0
    s_lshl_b32 s42, s42, 15
    s_add_u32 s42, s42, 0
    v_add_u32 v9, 4096, v4
L_kloop_g:
    s_mov_b32 s46, 0
    s_mov_b32 s58, 0
    s_add_u32 m0, s46, s43
    s_nop 0
    global_load_lds_dwordx4 v6, s[36:37] offset:0
    s_add_u32 m0, m0, 3968
    s_nop 0
    global_load_lds_dwordx4 v6, s[36:37] offset:128
    s_add_u32 m0, m0, 3968
    s_nop 0
    global_load_lds_dwordx4 v6, s[36:37] offset:256
    s_add_u32 m0, m0, 3968
    s_nop 0
    global_load_lds_dwordx4 v6, s[36:37] offset:384
    s_add_u32 m0, m0, 3968
    s_nop 0
    global_load_lds_dwordx4 v6, s[36:37] offset:512
    s_add_u32 m0, m0, 3968
    s_nop 0
    global_load_lds_dwordx4 v6, s[36:37] offset:640
    s_add_u32 m0, m0, 3968
    s_nop 0
    global_load_lds_dwordx4 v6, s[36:37] offset:768
    s_add_u32 m0, m0, 3968
    s_nop 0
    global_load_lds_dwordx4 v6, s[36:37] offset:896
    s_add_u32 m0, m0, 3968
    s_nop 0
    global_load_lds_dwordx4 v6, s[36:37] offset:1024
    s_add_u32 m0, m0, 3968
    s_nop 0
    global_load_lds_dwordx4 v6, s[36:37] offset:1152
    s_add_u32 s36, s36, 40960
    s_addc_u32 s37, s37, 0
    s_mov_b32 s46, 40960
    s_add_u32 m0, s46, s43
    s_nop 0
    global_load_lds_dwordx4 v6, s[36:37] offset:0
    s_add_u32 m0, m0, 3968
    s_nop 0
    global_load_lds_dwordx4 v6, s[36:37] offset:128
    s_add_u32 m0, m0, 3968
    s_nop 0
    global_load_lds_dwordx4 v6, s[36:37] offset:256
    s_add_u32 m0, m0, 3968
    s_nop 0
    global_load_lds_dwordx4 v6, s[36:37] offset:384
    s_add_u32 m0, m0, 3968
    s_nop 0
    global_load_lds_dwordx4 v6, s[36:37] offset:512
    s_add_u32 m0, m0, 3968
    s_nop 0
    global_load_lds_dwordx4 v6, s[36:37] offset:640
    s_add_u32 m0, m0, 3968
    s_nop 0
    global_load_lds_dwordx4 v6, s[36:37] offset:768
    s_add_u32 m0, m0, 3968
    s_nop 0
    global_load_lds_dwordx4 v6, s[36:37] offset:896
    s_add_u32 m0, m0, 3968
    s_nop 0
    global_load_lds_dwordx4 v6, s[36:37] offset:1024
    s_add_u32 m0, m0, 3968
    s_nop 0
    global_load_lds_dwordx4 v6, s[36:37] offset:1152
    s_add_u32 s36, s36, 40960
    s_addc_u32 s37, s37, 0
    s_waitcnt vmcnt(10)
L_kloop_g_top:
    s_waitcnt vmcnt(14)
    s_barrier
    s_add_u32 s46, s46, 40960
    s_cmp_eq_u32 s46, 122880
    s_cselect_b32 s46, 0, s46
    s_max_i32 s14, s40, 2
    s_sub_u32 s14, s14, 2
    s_cmp_lg_u32 s4, 0
    s_cbranch_scc1 L_sg_13
    s_mov_b64 exec, 1
    v_mov_b32 v12, 0
    v_mov_b32 v13, s14
    global_store_dword v12, v13, s[44:45] sc1
    s_mov_b64 exec, -1
L_sg_13:
    s_add_u32 s12, s40, 2
    s_cmp_lt_u32 s12, s41
    s_cselect_b32 s12, 0, 40960
    s_sub_u32 s36, s36, s12
    s_subb_u32 s37, s37, 0
    ds_read_b128 v[32:35], v7 offset:0
    ds_read_b128 v[36:39], v7 offset:2048
    ds_read_b128 v[40:43], v8 offset:0
    ds_read_b128 v[44:47], v8 offset:2048
    ds_read_b128 v[48:51], v7 offset:4096
    s_waitcnt lgkmcnt(4)
    v_mfma_f32_16x16x32_bf16 v[16:19], v[96:99], v[32:35], 0
    ds_read_b128 v[52:55], v7 offset:6144
    v_mfma_f32_16x16x32_bf16 v[24:27], v[104:107], v[32:35], 0
    s_add_u32 m0, s46, s43
    s_waitcnt lgkmcnt(4)
    v_mfma_f32_16x16x32_bf16 v[20:23], v[96:99], v[36:39], 0
    ds_read_b128 v[32:35], v8 offset:4096
    v_mfma_f32_16x16x32_bf16 v[28:31], v[104:107], v[36:39], 0
    global_load_lds_dwordx4 v6, s[36:37] offset:0
    s_waitcnt lgkmcnt(4)
    v_mfma_f32_16x16x32_bf16 v[16:19], v[100:103], v[40:43], v[16:19]
    ds_read_b128 v[36:39], v8 offset:6144
    v_mfma_f32_16x16x32_bf16 v[24:27], v[108:111], v[40:43], v[24:27]
    s_add_u32 m0, m0, 3968
    s_waitcnt lgkmcnt(4)
    v_mfma_f32_16x16x32_bf16 v[20:23], v[100:103], v[44:47], v[20:23]
    ds_read_b128 v[40:43], v7 offset:8192
    v_mfma_f32_16x16x32_bf16 v[28:31], v[108:111], v[44:47], v[28:31]
    global_load_lds_dwordx4 v6, s[36:37] offset:128
    s_waitcnt lgkmcnt(4)
    v_mfma_f32_16x16x32_bf16 v[16:19], v[112:115], v[48:51], v[16:19]
    ds_read_b128 v[44:47], v7 offset:10240
    v_mfma_f32_16x16x32_bf16 v[24:27], v[120:123], v[48:51], v[24:27]
    s_add_u32 m0, m0, 3968
    s_waitcnt lgkmcnt(4)
    v_mfma_f32_16x16x32_bf16 v[20:23], v[112:115], v[52:55], v[20:23]
    ds_read_b128 v[48:51], v8 offset:8192
    v_mfma_f32_16x16x32_bf16 v[28:31], v[120:123], v[52:55], v[28:31]
    global_load_lds_dwordx4 v6, s[36:37] offset:256
    s_waitcnt lgkmcnt(4)
    v_mfma_f32_16x16x32_bf16 v[16:19], v[116:119], v[32:35], v[16:19]
    ds_read_b128 v[52:55], v8 offset:10240
    v_mfma_f32_16x16x32_bf16 v[24:27], v[124:127], v[32:35], v[24:27]
    s_add_u32 m0, m0, 3968
    s_waitcnt lgkmcnt(4)
    v_mfma_f32_16x16x32_bf16 v[20:23], v[116:119], v[36:39], v[20:23]
    ds_read_b128 v[32:35], v7 offset:12288
    v_mfma_f32_16x16x32_bf16 v[28:31], v[124:127], v[36:39], v[28:31]
    global_load_lds_dwordx4 v6, s[36:37] offset:384
    s_waitcnt lgkmcnt(4)
    v_mfma_f32_16x16x32_bf16 v[16:19], v[128:131], v[40:43], v[16:19]
    ds_read_b128 v[36:39], v7 offset:14336
    v_mfma_f32_16x16x32_bf16 v[24:27], v[136:139], v[40:43], v[24:27]
    s_add_u32 m0, m0, 3968
    s_waitcnt lgkmcnt(4)
    v_mfma_f32_16x16x32_bf16 v[20:23], v[128:131], v[44:47], v[20:23]
    ds_read_b128 v[40:43], v8 offset:12288
    v_mfma_f32_16x16x32_bf16 v[28:31], v[136:139], v[44:47], v[28:31]
    global_load_lds_dwordx4 v6, s[36:37] offset:512
    s_waitcnt lgkmcnt(4)
    v_mfma_f32_16x16x32_bf16 v[16:19], v[132:135], v[48:51], v[16:19]
    ds_read_b128 v[44:47], v8 offset:14336
    v_mfma_f32_16x16x32_bf16 v[24:27], v[140:143], v[48:51], v[24:27]
    s_add_u32 m0, m0, 3968
    s_waitcnt lgkmcnt(4)
    v_mfma_f32_16x16x32_bf16 v[20:23], v[132:135], v[52:55], v[20:23]
    ds_read_b128 v[48:51], v7 offset:16384
    v_mfma_f32_16x16x32_bf16 v[28:31], v[140:143], v[52:55], v[28:31]
    global_load_lds_dwordx4 v6, s[36:37] offset:640
    s_waitcnt lgkmcnt(4)
    v_mfma_f32_16x16x32_bf16 v[16:19], v[144:147], v[32:35], v[16:19]
    ds_read_b128 v[52:55], v7 offset:18432
    v_mfma_f32_16x16x32_bf16 v[24:27], v[152:155], v[32:35], v[24:27]
    s_add_u32 m0, m0, 3968
    s_waitcnt lgkmcnt(4)
    v_mfma_f32_16x16x32_bf16 v[20:23], v[144:147], v[36:39], v[20:23]
    ds_read_b128 v[32:35], v8 offset:16384
    v_mfma_f32_16x16x32_bf16 v[28:31], v[152:155], v[36:39], v[28:31]
    global_load_lds_dwordx4 v6, s[36:37] offset:768
    s_waitcnt lgkmcnt(4)
    v_mfma_f32_16x16x32_bf16 v[16:19], v[148:151], v[40:43], v[16:19]
    ds_read_b128 v[36:39], v8 offset:18432
    v_mfma_f32_16x16x32_bf16 v[24:27], v[156:159], v[40:43], v[24:27]
    s_add_u32 m0, m0, 3968
    s_waitcnt lgkmcnt(4)
    v_mfma_f32_16x16x32_bf16 v[20:23], v[148:151], v[44:47], v[20:23]
    ds_read_b128 v[40:43], v7 offset:20480
    v_mfma_f32_16x16x32_bf16 v[28:31], v[156:159], v[44:47], v[28:31]
    global_load_lds_dwordx4 v6, s[36:37] offset:896
    s_waitcnt lgkmcnt(4)
    v_mfma_f32_16x16x32_bf16 v[16:19], v[160:163], v[48:51], v[16:19]
    ds_read_b128 v[44:47], v7 offset:22528
    v_mfma_f32_16x16x32_bf16 v[24:27], v[168:171], v[48:51], v[24:27]
    s_add_u32 m0, m0, 3968
    s_waitcnt lgkmcnt(4)
    v_mfma_f32_16x16x32_bf16 v[20:23], v[160:163], v[52:55], v[20:23]
    ds_read_b128 v[48:51], v8 offset:20480
    v_mfma_f32_16x16x32_bf16 v[28:31], v[168:171], v[52:55], v[28:31]
    global_load_lds_dwordx4 v6, s[36:37] offset:1024
    s_waitcnt lgkmcnt(4)
    v_mfma_f32_16x16x32_bf16 v[16:19], v[164:167], v[32:35], v[16:19]
    ds_read_b128 v[52:55], v8 offset:22528
    v_mfma_f32_16x16x32_bf16 v[24:27], v[172:175], v[32:35], v[24:27]
    s_add_u32 m0, m0, 3968
    s_waitcnt lgkmcnt(4)
    v_mfma_f32_16x16x32_bf16 v[20:23], v[164:167], v[36:39], v[20:23]
    ds_read_b128 v[32:35], v7 offset:24576
    v_mfma_f32_16x16x32_bf16 v[28:31], v[172:175], v[36:39], v[28:31]
    global_load_lds_dwordx4 v6, s[36:37] offset:1152
    s_waitcnt lgkmcnt(4)
    v_mfma_f32_16x16x32_bf16 v[16:19], v[176:179], v[40:43], v[16:19]
    ds_read_b128 v[36:39], v7 offset:26624
    v_mfma_f32_16x16x32_bf16 v[24:27], v[184:187], v[40:43], v[24:27]
    s_add_u32 s36, s36, 40960
    s_addc_u32 s37, s37, 0
    s_waitcnt lgkmcnt(4)
    v_mfma_f32_16x16x32_bf16 v[20:23], v[176:179], v[44:47], v[20:23]
    ds_read_b128 v[40:43], v8 offset:24576
    v_mfma_f32_16x16x32_bf16 v[28:31], v[184:187], v[44:47], v[28:31]
    s_waitcnt lgkmcnt(4)
    v_mfma_f32_16x16x32_bf16 v[16:19], v[180:183], v[48:51], v[16:19]
    ds_read_b128 v[44:47], v8 offset:26624
    v_mfma_f32_16x16x32_bf16 v[24:27], v[188:191], v[48:51], v[24:27]
    s_waitcnt lgkmcnt(4)
    v_mfma_f32_16x16x32_bf16 v[20:23], v[180:183], v[52:55], v[20:23]
    ds_read_b128 v[48:51], v7 offset:28672
    v_mfma_f32_16x16x32_bf16 v[28:31], v[188:191], v[52:55], v[28:31]
    s_waitcnt lgkmcnt(4)
    v_mfma_f32_16x16x32_bf16 v[16:19], v[192:195], v[32:35], v[16:19]
    ds_read_b128 v[52:55], v7 offset:30720
    v_mfma_f32_16x16x32_bf16 v[24:27], v[200:203], v[32:35], v[24:27]
    s_waitcnt lgkmcnt(4)
    v_mfma_f32_16x16x32_bf16 v[20:23], v[192:195], v[36:39], v[20:23]
    ds_read_b128 v[32:35], v8 offset:28672
    v_mfma_f32_16x16x32_bf16 v[28:31], v[200:203], v[36:39], v[28:31]
    s_waitcnt lgkmcnt(4)
    v_mfma_f32_16x16x32_bf16 v[16:19], v[196:199], v[40:43], v[16:19]
    ds_read_b128 v[36:39], v8 offset:30720
    v_mfma_f32_16x16x32_bf16 v[24:27], v[204:207], v[40:43], v[24:27]
    s_waitcnt lgkmcnt(4)
    v_mfma_f32_16x16x32_bf16 v[20:23], v[196:199], v[44:47], v[20:23]
    ds_read_b128 v[40:43], v7 offset:32768
    v_mfma_f32_16x16x32_bf16 v[28:31], v[204:207], v[44:47], v[28:31]
    s_waitcnt lgkmcnt(4)
    v_mfma_f32_16x16x32_bf16 v[16:19], v[208:211], v[48:51], v[16:19]
    ds_read_b128 v[44:47], v7 offset:34816
    v_mfma_f32_16x16x32_bf16 v[24:27], v[216:219], v[48:51], v[24:27]
    s_waitcnt lgkmcnt(4)
    v_mfma_f32_16x16x32_bf16 v[20:23], v[208:211], v[52:55], v[20:23]
    ds_read_b128 v[48:51], v8 offset:32768
    v_mfma_f32_16x16x32_bf16 v[28:31], v[216:219], v[52:55], v[28:31]
    s_waitcnt lgkmcnt(4)
    v_mfma_f32_16x16x32_bf16 v[16:19], v[212:215], v[32:35], v[16:19]
    ds_read_b128 v[52:55], v8 offset:34816
    v_mfma_f32_16x16x32_bf16 v[24:27], v[220:223], v[32:35], v[24:27]
    s_waitcnt lgkmcnt(4)
    v_mfma_f32_16x16x32_bf16 v[20:23], v[212:215], v[36:39], v[20:23]
    ds_read_b128 v[32:35], v7 offset:36864
    v_mfma_f32_16x16x32_bf16 v[28:31], v[220:223], v[36:39], v[28:31]
    s_waitcnt lgkmcnt(4)
    v_mfma_f32_16x16x32_bf16 v[16:19], v[224:227], v[40:43], v[16:19]
    ds_read_b128 v[36:39], v7 offset:38912
    v_mfma_f32_16x16x32_bf16 v[24:27], v[232:235], v[40:43], v[24:27]
    s_waitcnt lgkmcnt(4)
    v_mfma_f32_16x16x32_bf16 v[20:23], v[224:227], v[44:47], v[20:23]
    ds_read_b128 v[40:43], v8 offset:36864
    v_mfma_f32_16x16x32_bf16 v[28:31], v[232:235], v[44:47], v[28:31]
    s_waitcnt lgkmcnt(4)
    v_mfma_f32_16x16x32_bf16 v[16:19], v[228:231], v[48:51], v[16:19]
    ds_read_b128 v[44:47], v8 offset:38912
    v_mfma_f32_16x16x32_bf16 v[24:27], v[236:239], v[48:51], v[24:27]
    s_waitcnt lgkmcnt(4)
    v_mfma_f32_16x16x32_bf16 v[20:23], v[228:231], v[52:55], v[20:23]
    v_mfma_f32_16x16x32_bf16 v[28:31], v[236:239], v[52:55], v[28:31]
    s_waitcnt lgkmcnt(3)
    v_mfma_f32_16x16x32_bf16 v[16:19], v[240:243], v[32:35], v[16:19]
    v_mfma_f32_16x16x32_bf16 v[24:27], v[248:251], v[32:35], v[24:27]
    s_waitcnt lgkmcnt(2)
    v_mfma_f32_16x16x32_bf16 v[20:23], v[240:243], v[36:39], v[20:23]
    v_mfma_f32_16x16x32_bf16 v[28:31], v[248:251], v[36:39], v[28:31]
    s_waitcnt lgkmcnt(1)
    v_mfma_f32_16x16x32_bf16 v[16:19], v[244:247], v[40:43], v[16:19]
    v_mfma_f32_16x16x32_bf16 v[24:27], v[252:255], v[40:43], v[24:27]
    s_waitcnt lgkmcnt(0)
    v_mfma_f32_16x16x32_bf16 v[20:23], v[244:247], v[44:47], v[20:23]
    v_mfma_f32_16x16x32_bf16 v[28:31], v[252:255], v[44:47], v[28:31]
    s_lshr_b32 s12, s40, 1
    s_xor_b32 s12, s12, s5
    s_and_b32 s12, s12, 1
    s_lshl_b32 s12, s12, 13
    s_lshl_b32 s13, s40, 20
    s_add_u32 s12, s12, s13
    s_add_u32 s12, s12, s42
    s_add_u32 s12, s12, 8388608
    s_add_u32 s38, s6, s12
    s_addc_u32 s39, s7, 0
    v_cvt_pk_bf16_f32 v56, v16, v24
    v_cvt_pk_bf16_f32 v57, v17, v25
    v_cvt_pk_bf16_f32 v58, v18, v26
    v_cvt_pk_bf16_f32 v59, v19, v27
    global_store_dwordx4 v4, v[56:59], s[38:39] sc1
    v_cvt_pk_bf16_f32 v60, v20, v28
    v_cvt_pk_bf16_f32 v61, v21, v29
    v_cvt_pk_bf16_f32 v62, v22, v30
    v_cvt_pk_bf16_f32 v63, v23, v31
    global_store_dwordx4 v9, v[60:63], s[38:39] sc1
    s_cmp_eq_u32 s58, 81920
    s_cselect_b32 s12, 122880, 0
    s_sub_u32 s12, 40960, s12
    s_add_u32 s58, s58, s12
    v_add_u32 v7, s12, v7
    v_add_u32 v8, s12, v8
    s_add_u32 s40, s40, 1
    s_cmp_lt_u32 s40, s41
    s_cbranch_scc1 L_kloop_g_top
    s_waitcnt vmcnt(0)
    s_barrier
    v_subrev_u32 v7, s58, v7
    v_subrev_u32 v8, s58, v8
    s_cmp_lg_u32 s4, 0
    s_cbranch_scc1 L_sg_14
    s_mov_b64 exec, 1
    v_mov_b32 v12, 0
    v_mov_b32 v13, 64
    global_store_dword v12, v13, s[44:45] sc1
    s_mov_b64 exec, -1
L_sg_14:
    s_branch L_queue
L_vloop:
    s_lshr_b32 s15, s86, 1
    s_lshl_b32 s15, s15, 2
    v_mov_b32 v12, s15
    s_mov_b32 s15, 1048576
L_par_15:
    global_load_dword v13, v12, s[8:9] offset:68 sc1
    s_sub_u32 s15, s15, 1
    s_cbranch_scc1 L_bail2
    s_waitcnt vmcnt(0)
    v_readfirstlane_b32 s5, v13
    s_nop 0
    s_cmp_eq_u32 s5, 0
    s_cbranch_scc1 L_par_15
    s_sub_u32 s5, s5, 1
    s_add_u32 s12, s42, 32
    s_lshl_b32 s12, s12, 7
    s_add_u32 s44, s6, s12
    s_addc_u32 s45, s7, 0
    s_lshl_b32 s42, s42, 15
    s_add_u32 s42, s42, 16384
    v_add_u32 v9, 4096, v4
L_vloop_g:
    s_mov_b32 s46, 0
    s_mov_b32 s58, 0
    s_add_u32 m0, s46, s43
    s_nop 0
    global_load_lds_dwordx4 v6, s[36:37] offset:0
    s_add_u32 m0, m0, 3968
    s_nop 0
    global_load_lds_dwordx4 v6, s[36:37] offset:128
    s_add_u32 m0, m0, 3968
    s_nop 0
    global_load_lds_dwordx4 v6, s[36:37] offset:256
    s_add_u32 m0, m0, 3968
    s_nop 0
    global_load_lds_dwordx4 v6, s[36:37] offset:384
    s_add_u32 m0, m0, 3968
    s_nop 0
    global_load_lds_dwordx4 v6, s[36:37] offset:512
    s_add_u32 m0, m0, 3968
    s_nop 0
    global_load_lds_dwordx4 v6, s[36:37] offset:640
    s_add_u32 m0, m0, 3968
    s_nop 0
    global_load_lds_dwordx4 v6, s[36:37] offset:768
    s_add_u32 m0, m0, 3968
    s_nop 0
    global_load_lds_dwordx4 v6, s[36:37] offset:896
    s_add_u32 m0, m0, 3968
    s_nop 0
    global_load_lds_dwordx4 v6, s[36:37] offset:1024
    s_add_u32 m0, m0, 3968
    s_nop 0
    global_load_lds_dwordx4 v6, s[36:37] offset:1152
    s_add_u32 s36, s36, 40960
    s_addc_u32 s37, s37, 0
    s_mov_b32 s46, 40960
    s_add_u32 m0, s46, s43
    s_nop 0
    global_load_lds_dwordx4 v6, s[36:37] offset:0
    s_add_u32 m0, m0, 3968
    s_nop 0
    global_load_lds_dwordx4 v6, s[36:37] offset:128
    s_add_u32 m0, m0, 3968
    s_nop 0
    global_load_lds_dwordx4 v6, s[36:37] offset:256
    s_add_u32 m0, m0, 3968
    s_nop 0
    global_load_lds_dwordx4 v6, s[36:37] offset:384
    s_add_u32 m0, m0, 3968
    s_nop 0
    global_load_lds_dwordx4 v6, s[36:37] offset:512
    s_add_u32 m0, m0, 3968
    s_nop 0
    global_load_lds_dwordx4 v6, s[36:37] offset:640
    s_add_u32 m0, m0, 3968
    s_nop 0
    global_load_lds_dwordx4 v6, s[36:37] offset:768
    s_add_u32 m0, m0, 3968
    s_nop 0
    global_load_lds_dwordx4 v6, s[36:37] offset:896
    s_add_u32 m0, m0, 3968
    s_nop 0
    global_load_lds_dwordx4 v6, s[36:37] offset:1024
    s_add_u32 m0, m0, 3968
    s_nop 0
    global_load_lds_dwordx4 v6, s[36:37] offset:1152
    s_add_u32 s36, s36, 40960
    s_addc_u32 s37, s37, 0
    s_waitcnt vmcnt(10)
L_vloop_g_top:
    s_waitcnt vmcnt(14)
    s_barrier
    s_add_u32 s46, s46, 40960
    s_cmp_eq_u32 s46, 122880
    s_cselect_b32 s46, 0, s46
    s_max_i32 s14, s40, 2
    s_sub_u32 s14, s14, 2
    s_cmp_lg_u32 s4, 0
    s_cbranch_scc1 L_sg_16
    s_mov_b64 exec, 1
    v_mov_b32 v12, 0
    v_mov_b32 v13, s14
    global_store_dword v12, v13, s[44:45] sc1
    s_mov_b64 exec, -1
L_sg_16:
    s_add_u32 s12, s40, 2
    s_cmp_lt_u32 s12, s41
    s_cselect_b32 s12, 0, 40960
    s_sub_u32 s36, s36, s12
    s_subb_u32 s37, s37, 0
    ds_read_b128 v[32:35], v7 offset:0
    ds_read_b128 v[36:39], v7 offset:2048
    ds_read_b128 v[40:43], v8 offset:0
    ds_read_b128 v[44:47], v8 offset:2048
    ds_read_b128 v[48:51], v7 offset:4096
    s_waitcnt lgkmcnt(4)
    v_mfma_f32_16x16x32_bf16 v[16:19], v[32:35], v[96:99], 0
    ds_read_b128 v[52:55], v7 offset:6144
    v_mfma_f32_16x16x32_bf16 v[24:27], v[32:35], v[104:107], 0
    s_add_u32 m0, s46, s43
    s_waitcnt lgkmcnt(4)
    v_mfma_f32_16x16x32_bf16 v[20:23], v[36:39], v[96:99], 0
    ds_read_b128 v[32:35], v8 offset:4096
    v_mfma_f32_16x16x32_bf16 v[28:31], v[36:39], v[104:107], 0
    global_load_lds_dwordx4 v6, s[36:37] offset:0
    s_waitcnt lgkmcnt(4)
    v_mfma_f32_16x16x32_bf16 v[16:19], v[40:43], v[100:103], v[16:19]
    ds_read_b128 v[36:39], v8 offset:6144
    v_mfma_f32_16x16x32_bf16 v[24:27], v[40:43], v[108:111], v[24:27]
    s_add_u32 m0, m0, 3968
    s_waitcnt lgkmcnt(4)
    v_mfma_f32_16x16x32_bf16 v[20:23], v[44:47], v[100:103], v[20:23]
    ds_read_b128 v[40:43], v7 offset:8192
    v_mfma_f32_16x16x32_bf16 v[28:31], v[44:47], v[108:111], v[28:31]
    global_load_lds_dwordx4 v6, s[36:37] offset:128
    s_waitcnt lgkmcnt(4)
    v_mfma_f32_16x16x32_bf16 v[16:19], v[48:51], v[112:115], v[16:19]
    ds_read_b128 v[44:47], v7 offset:10240
    v_mfma_f32_16x16x32_bf16 v[24:27], v[48:51], v[120:123], v[24:27]
    s_add_u32 m0, m0, 3968
    s_waitcnt lgkmcnt(4)
    v_mfma_f32_16x16x32_bf16 v[20:23], v[52:55], v[112:115], v[20:23]
    ds_read_b128 v[48:51], v8 offset:8192
    v_mfma_f32_16x16x32_bf16 v[28:31], v[52:55], v[120:123], v[28:31]
    global_load_lds_dwordx4 v6, s[36:37] offset:256
    s_waitcnt lgkmcnt(4)
    v_mfma_f32_16x16x32_bf16 v[16:19], v[32:35], v[116:119], v[16:19]
    ds_read_b128 v[52:55], v8 offset:10240
    v_mfma_f32_16x16x32_bf16 v[24:27], v[32:35], v[124:127], v[24:27]
    s_add_u32 m0, m0, 3968
    s_waitcnt lgkmcnt(4)
    v_mfma_f32_16x16x32_bf16 v[20:23], v[36:39], v[116:119], v[20:23]
    ds_read_b128 v[32:35], v7 offset:12288
    v_mfma_f32_16x16x32_bf16 v[28:31], v[36:39], v[124:127], v[28:31]
    global_load_lds_dwordx4 v6, s[36:37] offset:384
    s_waitcnt lgkmcnt(4)
    v_mfma_f32_16x16x32_bf16 v[16:19], v[40:43], v[128:131], v[16:19]
    ds_read_b128 v[36:39], v7 offset:14336
    v_mfma_f32_16x16x32_bf16 v[24:27], v[40:43], v[136:139], v[24:27]
    s_add_u32 m0, m0, 3968
    s_waitcnt lgkmcnt(4)
    v_mfma_f32_16x16x32_bf16 v[20:23], v[44:47], v[128:131], v[20:23]
    ds_read_b128 v[40:43], v8 offset:12288
    v_mfma_f32_16x16x32_bf16 v[28:31], v[44:47], v[136:139], v[28:31]
    global_load_lds_dwordx4 v6, s[36:37] offset:512
    s_waitcnt lgkmcnt(4)
    v_mfma_f32_16x16x32_bf16 v[16:19], v[48:51], v[132:135], v[16:19]
    ds_read_b128 v[44:47], v8 offset:14336
    v_mfma_f32_16x16x32_bf16 v[24:27], v[48:51], v[140:143], v[24:27]
    s_add_u32 m0, m0, 3968
    s_waitcnt lgkmcnt(4)
    v_mfma_f32_16x16x32_bf16 v[20:23], v[52:55], v[132:135], v[20:23]
    ds_read_b128 v[48:51], v7 offset:16384
    v_mfma_f32_16x16x32_bf16 v[28:31], v[52:55], v[140:143], v[28:31]
    global_load_lds_dwordx4 v6, s[36:37] offset:640
    s_waitcnt lgkmcnt(4)
    v_mfma_f32_16x16x32_bf16 v[16:19], v[32:35], v[144:147], v[16:19]
    ds_read_b128 v[52:55], v7 offset:18432
    v_mfma_f32_16x16x32_bf16 v[24:27], v[32:35], v[152:155], v[24:27]
    s_add_u32 m0, m0, 3968
    s_waitcnt lgkmcnt(4)
    v_mfma_f32_16x16x32_bf16 v[20:23], v[36:39], v[144:147], v[20:23]
    ds_read_b128 v[32:35], v8 offset:16384
    v_mfma_f32_16x16x32_bf16 v[28:31], v[36:39], v[152:155], v[28:31]
    global_load_lds_dwordx4 v6, s[36:37] offset:768
    s_waitcnt lgkmcnt(4)
    v_mfma_f32_16x16x32_bf16 v[16:19], v[40:43], v[148:151], v[16:19]
    ds_read_b128 v[36:39], v8 offset:18432
    v_mfma_f32_16x16x32_bf16 v[24:27], v[40:43], v[156:159], v[24:27]
    s_add_u32 m0, m0, 3968
    s_waitcnt lgkmcnt(4)
    v_mfma_f32_16x16x32_bf16 v[20:23], v[44:47], v[148:151], v[20:23]
    ds_read_b128 v[40:43], v7 offset:20480
    v_mfma_f32_16x16x32_bf16 v[28:31], v[44:47], v[156:159], v[28:31]
    global_load_lds_dwordx4 v6, s[36:37] offset:896
    s_waitcnt lgkmcnt(4)
    v_mfma_f32_16x16x32_bf16 v[16:19], v[48:51], v[160:163], v[16:19]
    ds_read_b128 v[44:47], v7 offset:22528
    v_mfma_f32_16x16x32_bf16 v[24:27], v[48:51], v[168:171], v[24:27]
    s_add_u32 m0, m0, 3968
    s_waitcnt lgkmcnt(4)
    v_mfma_f32_16x16x32_bf16 v[20:23], v[52:55], v[160:163], v[20:23]
    ds_read_b128 v[48:51], v8 offset:20480
    v_mfma_f32_16x16x32_bf16 v[28:31], v[52:55], v[168:171], v[28:31]
    global_load_lds_dwordx4 v6, s[36:37] offset:1024
    s_waitcnt lgkmcnt(4)
    v_mfma_f32_16x16x32_bf16 v[16:19], v[32:35], v[164:167], v[16:19]
    ds_read_b128 v[52:55], v8 offset:22528
    v_mfma_f32_16x16x32_bf16 v[24:27], v[32:35], v[172:175], v[24:27]
    s_add_u32 m0, m0, 3968
    s_waitcnt lgkmcnt(4)
    v_mfma_f32_16x16x32_bf16 v[20:23], v[36:39], v[164:167], v[20:23]
    ds_read_b128 v[32:35], v7 offset:24576
    v_mfma_f32_16x16x32_bf16 v[28:31], v[36:39], v[172:175], v[28:31]
    global_load_lds_dwordx4 v6, s[36:37] offset:1152
    s_waitcnt lgkmcnt(4)
    v_mfma_f32_16x16x32_bf16 v[16:19], v[40:43], v[176:179], v[16:19]
    ds_read_b128 v[36:39], v7 offset:26624
    v_mfma_f32_16x16x32_bf16 v[24:27], v[40:43], v[184:187], v[24:27]
    s_add_u32 s36, s36, 40960
    s_addc_u32 s37, s37, 0
    s_waitcnt lgkmcnt(4)
    v_mfma_f32_16x16x32_bf16 v[20:23], v[44:47], v[176:179], v[20:23]
    ds_read_b128 v[40:43], v8 offset:24576
    v_mfma_f32_16x16x32_bf16 v[28:31], v[44:47], v[184:187], v[28:31]
    s_waitcnt lgkmcnt(4)
    v_mfma_f32_16x16x32_bf16 v[16:19], v[48:51], v[180:183], v[16:19]
    ds_read_b128 v[44:47], v8 offset:26624
    v_mfma_f32_16x16x32_bf16 v[24:27], v[48:51], v[188:191], v[24:27]
    s_waitcnt lgkmcnt(4)
    v_mfma_f32_16x16x32_bf16 v[20:23], v[52:55], v[180:183], v[20:23]
    ds_read_b128 v[48:51], v7 offset:28672
    v_mfma_f32_16x16x32_bf16 v[28:31], v[52:55], v[188:191], v[28:31]
    s_waitcnt lgkmcnt(4)
    v_mfma_f32_16x16x32_bf16 v[16:19], v[32:35], v[192:195], v[16:19]
    ds_read_b128 v[52:55], v7 offset:30720
    v_mfma_f32_16x16x32_bf16 v[24:27], v[32:35], v[200:203], v[24:27]
    s_waitcnt lgkmcnt(4)
    v_mfma_f32_16x16x32_bf16 v[20:23], v[36:39], v[192:195], v[20:23]
    ds_read_b128 v[32:35], v8 offset:28672
    v_mfma_f32_16x16x32_bf16 v[28:31], v[36:39], v[200:203], v[28:31]
    s_waitcnt lgkmcnt(4)
    v_mfma_f32_16x16x32_bf16 v[16:19], v[40:43], v[196:199], v[16:19]
    ds_read_b128 v[36:39], v8 offset:30720
    v_mfma_f32_16x16x32_bf16 v[24:27], v[40:43], v[204:207], v[24:27]
    s_waitcnt lgkmcnt(4)
    v_mfma_f32_16x16x32_bf16 v[20:23], v[44:47], v[196:199], v[20:23]
    ds_read_b128 v[40:43], v7 offset:32768
    v_mfma_f32_16x16x32_bf16 v[28:31], v[44:47], v[204:207], v[28:31]
    s_waitcnt lgkmcnt(4)
    v_mfma_f32_16x16x32_bf16 v[16:19], v[48:51], v[208:211], v[16:19]
    ds_read_b128 v[44:47], v7 offset:34816
    v_mfma_f32_16x16x32_bf16 v[24:27], v[48:51], v[216:219], v[24:27]
    s_waitcnt lgkmcnt(4)
    v_mfma_f32_16x16x32_bf16 v[20:23], v[52:55], v[208:211], v[20:23]
    ds_read_b128 v[48:51], v8 offset:32768
    v_mfma_f32_16x16x32_bf16 v[28:31], v[52:55], v[216:219], v[28:31]
    s_waitcnt lgkmcnt(4)
    v_mfma_f32_16x16x32_bf16 v[16:19], v[32:35], v[212:215], v[16:19]
    ds_read_b128 v[52:55], v8 offset:34816
    v_mfma_f32_16x16x32_bf16 v[24:27], v[32:35], v[220:223], v[24:27]
    s_waitcnt lgkmcnt(4)
    v_mfma_f32_16x16x32_bf16 v[20:23], v[36:39], v[212:215], v[20:23]
    ds_read_b128 v[32:35], v7 offset:36864
    v_mfma_f32_16x16x32_bf16 v[28:31], v[36:39], v[220:223], v[28:31]
    s_waitcnt lgkmcnt(4)
    v_mfma_f32_16x16x32_bf16 v[16:19], v[40:43], v[224:227], v[16:19]
    ds_read_b128 v[36:39], v7 offset:38912
    v_mfma_f32_16x16x32_bf16 v[24:27], v[40:43], v[232:235], v[24:27]
    s_waitcnt lgkmcnt(4)
    v_mfma_f32_16x16x32_bf16 v[20:23], v[44:47], v[224:227], v[20:23]
    ds_read_b128 v[40:43], v8 offset:36864
    v_mfma_f32_16x16x32_bf16 v[28:31], v[44:47], v[232:235], v[28:31]
    s_waitcnt lgkmcnt(4)
    v_mfma_f32_16x16x32_bf16 v[16:19], v[48:51], v[228:231], v[16:19]
    ds_read_b128 v[44:47], v8 offset:38912
    v_mfma_f32_16x16x32_bf16 v[24:27], v[48:51], v[236:239], v[24:27]
    s_waitcnt lgkmcnt(4)
    v_mfma_f32_16x16x32_bf16 v[20:23], v[52:55], v[228:231], v[20:23]
    v_mfma_f32_16x16x32_bf16 v[28:31], v[52:55], v[236:239], v[28:31]
    s_waitcnt lgkmcnt(3)
    v_mfma_f32_16x16x32_bf16 v[16:19], v[32:35], v[240:243], v[16:19]
    v_mfma_f32_16x16x32_bf16 v[24:27], v[32:35], v[248:251], v[24:27]
    s_waitcnt lgkmcnt(2)
    v_mfma_f32_16x16x32_bf16 v[20:23], v[36:39], v[240:243], v[20:23]
    v_mfma_f32_16x16x32_bf16 v[28:31], v[36:39], v[248:251], v[28:31]
    s_waitcnt lgkmcnt(1)
    v_mfma_f32_16x16x32_bf16 v[16:19], v[40:43], v[244:247], v[16:19]
    v_mfma_f32_16x16x32_bf16 v[24:27], v[40:43], v[252:255], v[24:27]
    s_waitcnt lgkmcnt(0)
    v_mfma_f32_16x16x32_bf16 v[20:23], v[44:47], v[244:247], v[20:23]
    v_mfma_f32_16x16x32_bf16 v[28:31], v[44:47], v[252:255], v[28:31]
    s_lshr_b32 s12, s40, 1
    s_xor_b32 s12, s12, s5
    s_and_b32 s12, s12, 1
    s_lshl_b32 s12, s12, 13
    s_lshl_b32 s13, s40, 20
    s_add_u32 s12, s12, s13
    s_add_u32 s12, s12, s42
    s_add_u32 s12, s12, 8388608
    s_add_u32 s38, s6, s12
    s_addc_u32 s39, s7, 0
    v_cvt_pk_bf16_f32 v56, v16, v17
    v_cvt_pk_bf16_f32 v57, v18, v19
    v_cvt_pk_bf16_f32 v58, v20, v21
    v_cvt_pk_bf16_f32 v59, v22, v23
    global_store_dwordx4 v4, v[56:59], s[38:39] sc1
    v_cvt_pk_bf16_f32 v60, v24, v25
    v_cvt_pk_bf16_f32 v61, v26, v27
    v_cvt_pk_bf16_f32 v62, v28, v29
    v_cvt_pk_bf16_f32 v63, v30, v31
    global_store_dwordx4 v9, v[60:63], s[38:39] sc1
    s_cmp_eq_u32 s58, 81920
    s_cselect_b32 s12, 122880, 0
    s_sub_u32 s12, 40960, s12
    s_add_u32 s58, s58, s12
    v_add_u32 v7, s12, v7
    v_add_u32 v8, s12, v8
    s_add_u32 s40, s40, 1
    s_cmp_lt_u32 s40, s41
    s_cbranch_scc1 L_vloop_g_top
    s_waitcnt vmcnt(0)
    s_barrier
    v_subrev_u32 v7, s58, v7
    v_subrev_u32 v8, s58, v8
    s_cmp_lg_u32 s4, 0
    s_cbranch_scc1 L_sg_17
    s_mov_b64 exec, 1
    v_mov_b32 v12, 0
    v_mov_b32 v13, 64
    global_store_dword v12, v13, s[44:45] sc1
    s_mov_b64 exec, -1
L_sg_17:
    s_branch L_queue
L_qa:
    s_lshr_b32 s15, s86, 1
    s_lshl_b32 s15, s15, 2
    v_mov_b32 v12, s15
    s_mov_b32 s15, 1048576
L_par_18:
    global_load_dword v13, v12, s[8:9] offset:68 sc1
    s_sub_u32 s15, s15, 1
    s_cbranch_scc1 L_bail2
    s_waitcnt vmcnt(0)
    v_readfirstlane_b32 s5, v13
    s_nop 0
    s_cmp_eq_u32 s5, 0
    s_cbranch_scc1 L_par_18
    s_sub_u32 s5, s5, 1
    s_add_u32 s12, s42, 64
    s_lshl_b32 s12, s12, 7
    s_add_u32 s44, s6, s12
    s_addc_u32 s45, s7, 0
    s_lshl_b32 s42, s42, 15
    s_mov_b32 s50, 0x3e0293ee
    s_mov_b32 s51, 0x3e0293ee
    s_mov_b32 s82, 0xf149f2ca
    s_mov_b32 s84, 0x3f803f80
    s_mov_b32 s85, 0x3f803f80
    s_and_b32 s12, s4, 1
    s_lshl_b32 s12, s12, 4
    v_add_u32 v12, s12, v2
    v_lshlrev_b32 v13, 2, v3
    v_sub_u32 v12, v12, v13
    v_cmp_le_i32 s[64:65], 0, v12
    v_cmp_le_i32 s[66:67], 1, v12
    v_cmp_le_i32 s[68:69], 2, v12
    v_cmp_le_i32 s[70:71], 3, v12
    v_cmp_le_i32 s[72:73], 16, v12
    v_cmp_le_i32 s[74:75], 17, v12
    v_cmp_le_i32 s[76:77], 18, v12
    v_cmp_le_i32 s[78:79], 19, v12
    v_lshrrev_b32 v12, 2, v2
    v_and_b32 v13, 1, v2
    v_lshl_add_u32 v12, v12, 1, v13
    v_mul_u32_u24 v12, 288, v12
    v_lshl_add_u32 v14, v3, 4, v12
    s_and_b32 s12, s4, 1
    s_lshl_b32 s13, s12, 12
    s_add_u32 s14, s13, 122880
    v_add_u32 v15, s14, v5
    s_lshr_b32 s12, s4, 1
    s_lshl_b32 s14, s12, 11
    v_add_u32 v10, s14, v5
    v_add_u32 v9, s13, v10
    s_lshl_b32 s14, s12, 10
    v_lshrrev_b32 v11, 1, v5
    v_add_u32 v11, s14, v11
    s_mov_b32 s46, 0
    s_mov_b32 s58, 0
    s_add_u32 s12, s40, 128
    s_lshl_b32 s12, s12, 7
    s_add_u32 s60, s6, s12
    s_addc_u32 s61, s7, 0
    s_add_u32 m0, s46, s43
    s_nop 0
    global_load_lds_dwordx4 v6, s[36:37] offset:0
    s_add_u32 m0, m0, 3968
    s_nop 0
    global_load_lds_dwordx4 v6, s[36:37] offset:128
    s_add_u32 m0, m0, 3968
    s_nop 0
    global_load_lds_dwordx4 v6, s[36:37] offset:256
    s_add_u32 m0, m0, 3968
    s_nop 0
    global_load_lds_dwordx4 v6, s[36:37] offset:384
    s_add_u32 m0, m0, 3968
    s_nop 0
    global_load_lds_dwordx4 v6, s[36:37] offset:512
    s_add_u32 m0, m0, 3968
    s_nop 0
    global_load_lds_dwordx4 v6, s[36:37] offset:640
    s_add_u32 m0, m0, 3968
    s_nop 0
    global_load_lds_dwordx4 v6, s[36:37] offset:768
    s_add_u32 m0, m0, 3968
    s_nop 0
    global_load_lds_dwordx4 v6, s[36:37] offset:896
    s_add_u32 m0, m0, 3968
    s_nop 0
    global_load_lds_dwordx4 v6, s[36:37] offset:1024
    s_add_u32 m0, m0, 3968
    s_nop 0
    global_load_lds_dwordx4 v6, s[36:37] offset:1152
    s_add_u32 s36, s36, 81920
    s_addc_u32 s37, s37, 0
    s_sub_u32 s56, s44, 8192
    s_subb_u32 s57, s45, 0
    s_cmp_lg_u32 s4, 0
    s_cbranch_scc1 L_wf_19
    s_mov_b64 exec, 3
    v_mul_u32_u24 v12, 4096, v1
    s_mov_b32 s15, 1048576
L_wf_20:
    global_load_dword v13, v12, s[56:57] sc1
    s_sub_u32 s15, s15, 1
    s_cbranch_scc1 L_bail14
    s_waitcnt vmcnt(0)
    v_cmp_gt_u32 vcc, 2, v13
    s_nop 0
    s_cbranch_vccnz L_wf_20
    s_mov_b64 exec, -1
L_wf_19:
    s_waitcnt vmcnt(0)
    s_barrier
L_qa_top:
    s_lshr_b32 s12, s40, 1
    s_xor_b32 s12, s12, s5
    s_and_b32 s12, s12, 1
    s_lshl_b32 s12, s12, 13
    s_lshl_b32 s13, s40, 20
    s_add_u32 s12, s12, s13
    s_add_u32 s12, s12, s42
    s_add_u32 s12, s12, 8388608
    s_add_u32 s54, s6, s12
    s_addc_u32 s55, s7, 0
    v_add_u32 v12, 4096, v5
    global_load_dwordx4 a[0:3], v5, s[54:55] offset:0 sc1
    global_load_dwordx4 a[4:7], v5, s[54:55] offset:1024 sc1
    global_load_dwordx4 a[8:11], v5, s[54:55] offset:2048 sc1
    global_load_dwordx4 a[12:15], v5, s[54:55] offset:3072 sc1
    global_load_dwordx4 a[16:19], v12, s[54:55] offset:0 sc1
    global_load_dwordx4 a[20:23], v12, s[54:55] offset:1024 sc1
    global_load_dwordx4 a[24:27], v12, s[54:55] offset:2048 sc1
    global_load_dwordx4 a[28:31], v12, s[54:55] offset:3072 sc1
    s_add_u32 s54, s54, 0x4000
    s_addc_u32 s55, s55, 0
    v_add_u32 v13, 4096, v10
    global_load_dwordx4 a[32:35], v10, s[54:55] offset:0 sc1
    global_load_dwordx4 a[36:39], v13, s[54:55] offset:0 sc1
    global_load_dwordx4 a[40:43], v10, s[54:55] offset:1024 sc1
    global_load_dwordx4 a[44:47], v13, s[54:55] offset:1024 sc1
    s_lshr_b32 s12, s40, 1
    s_xor_b32 s12, s12, s5
    s_and_b32 s12, s12, 1
    s_xor_b32 s12, s12, 1
    s_lshl_b32 s12, s12, 13
    s_lshl_b32 s13, s40, 20
    s_add_u32 s12, s12, s13
    s_add_u32 s12, s12, s42
    s_add_u32 s12, s12, 8388608
    s_add_u32 s38, s6, s12
    s_addc_u32 s39, s7, 0
    s_cmp_le_u32 s58, s40
    s_cbranch_scc1 L_qa_21
    s_lshr_b32 s12, s40, 2
    s_xor_b32 s12, s12, s5
    s_and_b32 s12, s12, 1
    s_lshl_b32 s12, s12, 13
    s_lshl_b32 s13, s40, 19
    s_add_u32 s12, s12, s13
    s_lshr_b32 s13, s42, 1
    s_add_u32 s12, s12, s13
    s_add_u32 s12, s12, 79691776
    s_add_u32 s56, s6, s12
    s_addc_u32 s57, s7, 0
    global_load_dwordx4 a[48:51], v14, s[56:57] offset:0 sc1
    global_load_dwordx4 a[52:55], v14, s[56:57] offset:64 sc1
    global_load_dwordx4 a[56:59], v14, s[56:57] offset:128 sc1
    global_load_dwordx4 a[60:63], v14, s[56:57] offset:192 sc1
    s_add_u32 s56, s56, 0x1000
    s_addc_u32 s57, s57, 0
    global_load_dwordx2 v[92:93], v11, s[56:57] offset:0 sc1
    global_load_dwordx2 v[94:95], v11, s[56:57] offset:512 sc1
L_qa_21:
    s_xor_b32 s46, s46, 40960
    s_add_u32 s12, s40, 2
    s_cmp_lt_u32 s12, s41
    s_cselect_b32 s12, 0, 81920
    s_sub_u32 s36, s36, s12
    s_subb_u32 s37, s37, 0
    ds_read_b128 v[32:35], v7 offset:0
    ds_read_b128 v[36:39], v7 offset:2048
    ds_read_b128 v[40:43], v8 offset:0
    ds_read_b128 v[44:47], v8 offset:2048
    ds_read_b128 v[48:51], v7 offset:4096
    s_waitcnt lgkmcnt(4)
    v_mfma_f32_16x16x32_bf16 v[16:19], v[96:99], v[32:35], 0
    ds_read_b128 v[52:55], v7 offset:6144
    v_mfma_f32_16x16x32_bf16 v[24:27], v[104:107], v[32:35], 0
    s_add_u32 m0, s46, s43
    s_waitcnt lgkmcnt(4)
    v_mfma_f32_16x16x32_bf16 v[20:23], v[96:99], v[36:39], 0
    ds_read_b128 v[32:35], v8 offset:4096
    v_mfma_f32_16x16x32_bf16 v[28:31], v[104:107], v[36:39], 0
    global_load_lds_dwordx4 v6, s[36:37] offset:0
    s_waitcnt lgkmcnt(4)
    v_mfma_f32_16x16x32_bf16 v[16:19], v[100:103], v[40:43], v[16:19]
    ds_read_b128 v[36:39], v8 offset:6144
    v_mfma_f32_16x16x32_bf16 v[24:27], v[108:111], v[40:43], v[24:27]
    s_add_u32 m0, m0, 3968
    s_waitcnt lgkmcnt(4)
    v_mfma_f32_16x16x32_bf16 v[20:23], v[100:103], v[44:47], v[20:23]
    ds_read_b128 v[40:43], v7 offset:8192
    v_mfma_f32_16x16x32_bf16 v[28:31], v[108:111], v[44:47], v[28:31]
    global_load_lds_dwordx4 v6, s[36:37] offset:128
    s_waitcnt lgkmcnt(4)
    v_mfma_f32_16x16x32_bf16 v[16:19], v[112:115], v[48:51], v[16:19]
    ds_read_b128 v[44:47], v7 offset:10240
    v_mfma_f32_16x16x32_bf16 v[24:27], v[120:123], v[48:51], v[24:27]
    s_add_u32 m0, m0, 3968
    s_waitcnt lgkmcnt(4)
    v_mfma_f32_16x16x32_bf16 v[20:23], v[112:115], v[52:55], v[20:23]
    ds_read_b128 v[48:51], v8 offset:8192
    v_mfma_f32_16x16x32_bf16 v[28:31], v[120:123], v[52:55], v[28:31]
    global_load_lds_dwordx4 v6, s[36:37] offset:256
    s_waitcnt lgkmcnt(4)
    v_mfma_f32_16x16x32_bf16 v[16:19], v[116:119], v[32:35], v[16:19]
    ds_read_b128 v[52:55], v8 offset:10240
    v_mfma_f32_16x16x32_bf16 v[24:27], v[124:127], v[32:35], v[24:27]
    s_add_u32 m0, m0, 3968
    s_waitcnt lgkmcnt(4)
    v_mfma_f32_16x16x32_bf16 v[20:23], v[116:119], v[36:39], v[20:23]
    ds_read_b128 v[32:35], v7 offset:12288
    v_mfma_f32_16x16x32_bf16 v[28:31], v[124:127], v[36:39], v[28:31]
    global_load_lds_dwordx4 v6, s[36:37] offset:384
    s_waitcnt lgkmcnt(4)
    v_mfma_f32_16x16x32_bf16 v[16:19], v[128:131], v[40:43], v[16:19]
    ds_read_b128 v[36:39], v7 offset:14336
    v_mfma_f32_16x16x32_bf16 v[24:27], v[136:139], v[40:43], v[24:27]
    s_add_u32 m0, m0, 3968
    s_waitcnt lgkmcnt(4)
    v_mfma_f32_16x16x32_bf16 v[20:23], v[128:131], v[44:47], v[20:23]
    ds_read_b128 v[40:43], v8 offset:12288
    v_mfma_f32_16x16x32_bf16 v[28:31], v[136:139], v[44:47], v[28:31]
    global_load_lds_dwordx4 v6, s[36:37] offset:512
    s_waitcnt lgkmcnt(4)
    v_mfma_f32_16x16x32_bf16 v[16:19], v[132:135], v[48:51], v[16:19]
    ds_read_b128 v[44:47], v8 offset:14336
    v_mfma_f32_16x16x32_bf16 v[24:27], v[140:143], v[48:51], v[24:27]
    s_add_u32 m0, m0, 3968
    s_waitcnt lgkmcnt(4)
    v_mfma_f32_16x16x32_bf16 v[20:23], v[132:135], v[52:55], v[20:23]
    ds_read_b128 v[48:51], v7 offset:16384
    v_mfma_f32_16x16x32_bf16 v[28:31], v[140:143], v[52:55], v[28:31]
    global_load_lds_dwordx4 v6, s[36:37] offset:640
    s_waitcnt lgkmcnt(4)
    v_mfma_f32_16x16x32_bf16 v[16:19], v[144:147], v[32:35], v[16:19]
    ds_read_b128 v[52:55], v7 offset:18432
    v_mfma_f32_16x16x32_bf16 v[24:27], v[152:155], v[32:35], v[24:27]
    s_add_u32 m0, m0, 3968
    s_waitcnt lgkmcnt(4)
    v_mfma_f32_16x16x32_bf16 v[20:23], v[144:147], v[36:39], v[20:23]
    ds_read_b128 v[32:35], v8 offset:16384
    v_mfma_f32_16x16x32_bf16 v[28:31], v[152:155], v[36:39], v[28:31]
    global_load_lds_dwordx4 v6, s[36:37] offset:768
    s_waitcnt lgkmcnt(4)
    v_mfma_f32_16x16x32_bf16 v[16:19], v[148:151], v[40:43], v[16:19]
    ds_read_b128 v[36:39], v8 offset:18432
    v_mfma_f32_16x16x32_bf16 v[24:27], v[156:159], v[40:43], v[24:27]
    s_add_u32 m0, m0, 3968
    s_waitcnt lgkmcnt(4)
    v_mfma_f32_16x16x32_bf16 v[20:23], v[148:151], v[44:47], v[20:23]
    ds_read_b128 v[40:43], v7 offset:20480
    v_mfma_f32_16x16x32_bf16 v[28:31], v[156:159], v[44:47], v[28:31]
    global_load_lds_dwordx4 v6, s[36:37] offset:896
    s_waitcnt lgkmcnt(4)
    v_mfma_f32_16x16x32_bf16 v[16:19], v[160:163], v[48:51], v[16:19]
    ds_read_b128 v[44:47], v7 offset:22528
    v_mfma_f32_16x16x32_bf16 v[24:27], v[168:171], v[48:51], v[24:27]
    s_add_u32 m0, m0, 3968
    s_waitcnt lgkmcnt(4)
    v_mfma_f32_16x16x32_bf16 v[20:23], v[160:163], v[52:55], v[20:23]
    ds_read_b128 v[48:51], v8 offset:20480
    v_mfma_f32_16x16x32_bf16 v[28:31], v[168:171], v[52:55], v[28:31]
    global_load_lds_dwordx4 v6, s[36:37] offset:1024
    s_waitcnt lgkmcnt(4)
    v_mfma_f32_16x16x32_bf16 v[16:19], v[164:167], v[32:35], v[16:19]
    ds_read_b128 v[52:55], v8 offset:22528
    v_mfma_f32_16x16x32_bf16 v[24:27], v[172:175], v[32:35], v[24:27]
    s_add_u32 m0, m0, 3968
    s_waitcnt lgkmcnt(4)
    v_mfma_f32_16x16x32_bf16 v[20:23], v[164:167], v[36:39], v[20:23]
    ds_read_b128 v[32:35], v7 offset:24576
    v_mfma_f32_16x16x32_bf16 v[28:31], v[172:175], v[36:39], v[28:31]
    global_load_lds_dwordx4 v6, s[36:37] offset:1152
    s_waitcnt lgkmcnt(4)
    v_mfma_f32_16x16x32_bf16 v[16:19], v[176:179], v[40:43], v[16:19]
    ds_read_b128 v[36:39], v7 offset:26624
    v_mfma_f32_16x16x32_bf16 v[24:27], v[184:187], v[40:43], v[24:27]
    s_add_u32 s36, s36, 81920
    s_addc_u32 s37, s37, 0
    s_waitcnt lgkmcnt(4)
    v_mfma_f32_16x16x32_bf16 v[20:23], v[176:179], v[44:47], v[20:23]
    ds_read_b128 v[40:43], v8 offset:24576
    v_mfma_f32_16x16x32_bf16 v[28:31], v[184:187], v[44:47], v[28:31]
    s_waitcnt lgkmcnt(4)
    v_mfma_f32_16x16x32_bf16 v[16:19], v[180:183], v[48:51], v[16:19]
    ds_read_b128 v[44:47], v8 offset:26624
    v_mfma_f32_16x16x32_bf16 v[24:27], v[188:191], v[48:51], v[24:27]
    s_waitcnt lgkmcnt(4)
    v_mfma_f32_16x16x32_bf16 v[20:23], v[180:183], v[52:55], v[20:23]
    ds_read_b128 v[48:51], v7 offset:28672
    v_mfma_f32_16x16x32_bf16 v[28:31], v[188:191], v[52:55], v[28:31]
    s_waitcnt lgkmcnt(4)
    v_mfma_f32_16x16x32_bf16 v[16:19], v[192:195], v[32:35], v[16:19]
    ds_read_b128 v[52:55], v7 offset:30720
    v_mfma_f32_16x16x32_bf16 v[24:27], v[200:203], v[32:35], v[24:27]
    s_waitcnt lgkmcnt(4)
    v_mfma_f32_16x16x32_bf16 v[20:23], v[192:195], v[36:39], v[20:23]
    ds_read_b128 v[32:35], v8 offset:28672
    v_mfma_f32_16x16x32_bf16 v[28:31], v[200:203], v[36:39], v[28:31]
    s_waitcnt lgkmcnt(4)
    v_mfma_f32_16x16x32_bf16 v[16:19], v[196:199], v[40:43], v[16:19]
    ds_read_b128 v[36:39], v8 offset:30720
    v_mfma_f32_16x16x32_bf16 v[24:27], v[204:207], v[40:43], v[24:27]
    s_waitcnt lgkmcnt(4)
    v_mfma_f32_16x16x32_bf16 v[20:23], v[196:199], v[44:47], v[20:23]
    ds_read_b128 v[40:43], v7 offset:32768
    v_mfma_f32_16x16x32_bf16 v[28:31], v[204:207], v[44:47], v[28:31]
    s_waitcnt lgkmcnt(4)
    v_mfma_f32_16x16x32_bf16 v[16:19], v[208:211], v[48:51], v[16:19]
    ds_read_b128 v[44:47], v7 offset:34816
    v_mfma_f32_16x16x32_bf16 v[24:27], v[216:219], v[48:51], v[24:27]
    s_waitcnt lgkmcnt(4)
    v_mfma_f32_16x16x32_bf16 v[20:23], v[208:211], v[52:55], v[20:23]
    ds_read_b128 v[48:51], v8 offset:32768
    v_mfma_f32_16x16x32_bf16 v[28:31], v[216:219], v[52:55], v[28:31]
    s_waitcnt lgkmcnt(4)
    v_mfma_f32_16x16x32_bf16 v[16:19], v[212:215], v[32:35], v[16:19]
    ds_read_b128 v[52:55], v8 offset:34816
    v_mfma_f32_16x16x32_bf16 v[24:27], v[220:223], v[32:35], v[24:27]
    s_waitcnt lgkmcnt(4)
    v_mfma_f32_16x16x32_bf16 v[20:23], v[212:215], v[36:39], v[20:23]
    ds_read_b128 v[32:35], v7 offset:36864
    v_mfma_f32_16x16x32_bf16 v[28:31], v[220:223], v[36:39], v[28:31]
    s_waitcnt lgkmcnt(4)
    v_mfma_f32_16x16x32_bf16 v[16:19], v[224:227], v[40:43], v[16:19]
    ds_read_b128 v[36:39], v7 offset:38912
    v_mfma_f32_16x16x32_bf16 v[24:27], v[232:235], v[40:43], v[24:27]
    s_waitcnt lgkmcnt(4)
    v_mfma_f32_16x16x32_bf16 v[20:23], v[224:227], v[44:47], v[20:23]
    ds_read_b128 v[40:43], v8 offset:36864
    v_mfma_f32_16x16x32_bf16 v[28:31], v[232:235], v[44:47], v[28:31]
    s_waitcnt lgkmcnt(4)
    v_mfma_f32_16x16x32_bf16 v[16:19], v[228:231], v[48:51], v[16:19]
    ds_read_b128 v[44:47], v8 offset:38912
    v_mfma_f32_16x16x32_bf16 v[24:27], v[236:239], v[48:51], v[24:27]
    s_waitcnt lgkmcnt(4)
    v_mfma_f32_16x16x32_bf16 v[20:23], v[228:231], v[52:55], v[20:23]
    v_mfma_f32_16x16x32_bf16 v[28:31], v[236:239], v[52:55], v[28:31]
    s_waitcnt lgkmcnt(3)
    v_mfma_f32_16x16x32_bf16 v[16:19], v[240:243], v[32:35], v[16:19]
    v_mfma_f32_16x16x32_bf16 v[24:27], v[248:251], v[32:35], v[24:27]
    s_waitcnt lgkmcnt(2)
    v_mfma_f32_16x16x32_bf16 v[20:23], v[240:243], v[36:39], v[20:23]
    v_mfma_f32_16x16x32_bf16 v[28:31], v[248:251], v[36:39], v[28:31]
    s_waitcnt lgkmcnt(1)
    v_mfma_f32_16x16x32_bf16 v[16:19], v[244:247], v[40:43], v[16:19]
    v_mfma_f32_16x16x32_bf16 v[24:27], v[252:255], v[40:43], v[24:27]
    s_waitcnt lgkmcnt(0)
    v_mfma_f32_16x16x32_bf16 v[20:23], v[244:247], v[44:47], v[20:23]
    v_mfma_f32_16x16x32_bf16 v[28:31], v[252:255], v[44:47], v[28:31]
    s_lshl_b32 s12, s46, 1
    s_sub_u32 s12, s12, 40960
    v_add_u32 v7, s12, v7
    v_add_u32 v8, s12, v8
    v_add_u32 v12, 122880, v4
    v_pk_mul_f32 v[16:17], v[16:17], s[50:51]
    v_pk_mul_f32 v[24:25], v[24:25], s[50:51]
    v_pk_mul_f32 v[18:19], v[18:19], s[50:51]
    v_pk_mul_f32 v[26:27], v[26:27], s[50:51]
    v_cvt_pk_bf16_f32 v56, v16, v24
    v_cvt_pk_bf16_f32 v57, v17, v25
    v_cvt_pk_bf16_f32 v58, v18, v26
    v_cvt_pk_bf16_f32 v59, v19, v27
    ds_write_b128 v12, v[56:59] offset:0
    v_pk_mul_f32 v[20:21], v[20:21], s[50:51]
    v_pk_mul_f32 v[28:29], v[28:29], s[50:51]
    v_pk_mul_f32 v[22:23], v[22:23], s[50:51]
    v_pk_mul_f32 v[30:31], v[30:31], s[50:51]
    v_cvt_pk_bf16_f32 v60, v20, v28
    v_cvt_pk_bf16_f32 v61, v21, v29
    v_cvt_pk_bf16_f32 v62, v22, v30
    v_cvt_pk_bf16_f32 v63, v23, v31
    ds_write_b128 v12, v[60:63] offset:4096
    s_waitcnt vmcnt(0) lgkmcnt(0)
    s_barrier
    s_cmp_lt_u32 s40, 2
    s_cbranch_scc1 L_qa_22
    s_cmp_lg_u32 s4, 0
    s_cbranch_scc1 L_sg_24
    s_mov_b64 exec, 1
    v_mov_b32 v12, 0
    v_mov_b32 v13, 1
    global_atomic_add v12, v13, s[60:61]
    s_mov_b64 exec, -1
L_sg_24:
L_qa_22:
    ds_read_b128 v[64:67], v15 offset:0
    ds_read_b128 v[68:71], v15 offset:1024
    ds_read_b128 v[72:75], v15 offset:2048
    ds_read_b128 v[76:79], v15 offset:3072
    s_cmp_gt_u32 s58, s40
    s_cbranch_scc1 L_qa_23
    s_mov_b64 exec, 3
    v_mul_u32_u24 v12, 4096, v1
    s_mov_b32 s15, 1048576
L_qa_25:
    global_load_dword v13, v12, s[44:45] sc1
    s_sub_u32 s15, s15, 1
    s_cbranch_scc1 L_bail9
    s_waitcnt vmcnt(0)
    v_readlane_b32 s12, v13, 0
    v_readlane_b32 s13, v13, 1
    s_nop 0
    s_min_u32 s58, s12, s13
    s_cmp_le_u32 s58, s40
    s_cbranch_scc1 L_qa_25
    s_mov_b64 exec, -1
    s_lshr_b32 s12, s40, 2
    s_xor_b32 s12, s12, s5
    s_and_b32 s12, s12, 1
    s_lshl_b32 s12, s12, 13
    s_lshl_b32 s13, s40, 19
    s_add_u32 s12, s12, s13
    s_lshr_b32 s13, s42, 1
    s_add_u32 s12, s12, s13
    s_add_u32 s12, s12, 79691776
    s_add_u32 s56, s6, s12
    s_addc_u32 s57, s7, 0
    global_load_dwordx4 a[48:51], v14, s[56:57] offset:0 sc1
    global_load_dwordx4 a[52:55], v14, s[56:57] offset:64 sc1
    global_load_dwordx4 a[56:59], v14, s[56:57] offset:128 sc1
    global_load_dwordx4 a[60:63], v14, s[56:57] offset:192 sc1
    s_add_u32 s56, s56, 0x1000
    s_addc_u32 s57, s57, 0
    global_load_dwordx2 v[92:93], v11, s[56:57] offset:0 sc1
    global_load_dwordx2 v[94:95], v11, s[56:57] offset:512 sc1
L_qa_23:
    s_waitcnt lgkmcnt(0)
    v_mfma_f32_16x16x32_bf16 v[16:19], a[0:3], v[64:67], 0
    v_mfma_f32_16x16x32_bf16 v[16:19], a[4:7], v[68:71], v[16:19]
    v_mfma_f32_16x16x32_bf16 v[16:19], a[8:11], v[72:75], v[16:19]
    v_mfma_f32_16x16x32_bf16 v[16:19], a[12:15], v[76:79], v[16:19]
    v_mfma_f32_16x16x32_bf16 v[20:23], a[16:19], v[64:67], 0
    v_mfma_f32_16x16x32_bf16 v[20:23], a[20:23], v[68:71], v[20:23]
    v_mfma_f32_16x16x32_bf16 v[20:23], a[24:27], v[72:75], v[20:23]
    v_mfma_f32_16x16x32_bf16 v[20:23], a[28:31], v[76:79], v[20:23]
    v_mov_b32 v80, s82
    s_nop 2
    v_cndmask_b32 v16, v80, v16, s[64:65]
    v_cndmask_b32 v17, v80, v17, s[66:67]
    v_cndmask_b32 v18, v80, v18, s[68:69]
    v_cndmask_b32 v19, v80, v19, s[70:71]
    v_cndmask_b32 v20, v80, v20, s[72:73]
    v_cndmask_b32 v21, v80, v21, s[74:75]
    v_cndmask_b32 v22, v80, v22, s[76:77]
    v_cndmask_b32 v23, v80, v23, s[78:79]
    v_max3_f32 v80, v16, v17, v18
    v_max3_f32 v80, v80, v19, v20
    v_max3_f32 v80, v80, v21, v22
    v_mov_b64 v[88:89], s[84:85]
    v_mov_b64 v[90:91], s[84:85]
    s_add_u32 s12, s40, 128
    s_lshl_b32 s12, s12, 7
    s_add_u32 s60, s6, s12
    s_addc_u32 s61, s7, 0
    s_waitcnt vmcnt(0)
    v_mfma_f32_16x16x32_bf16 v[24:27], a[48:51], v[64:67], 0
    v_mfma_f32_16x16x32_bf16 v[24:27], a[52:55], v[68:71], v[24:27]
    v_mfma_f32_16x16x32_bf16 v[24:27], a[56:59], v[72:75], v[24:27]
    v_mfma_f32_16x16x32_bf16 v[24:27], a[60:63], v[76:79], v[24:27]
    v_mov_b32 v48, v93
    v_mov_b32 v49, 0
    v_mov_b32 v50, v95
    v_mov_b32 v51, 0
    s_nop 3
    v_max3_f32 v80, v80, v23, v24
    v_max_f32 v80, v80, v25
    v_mov_b32 v81, v80
    s_nop 1
    v_permlane16_swap_b32 v80, v81
    v_max_f32 v80, v80, v81
    v_mov_b32 v81, v80
    s_nop 1
    v_permlane32_swap_b32 v80, v81
    v_max_f32 v80, v80, v81
    v_sub_f32 v16, v16, v80
    v_sub_f32 v17, v17, v80
    v_sub_f32 v18, v18, v80
    v_sub_f32 v19, v19, v80
    v_sub_f32 v20, v20, v80
    v_sub_f32 v21, v21, v80
    v_sub_f32 v22, v22, v80
    v_sub_f32 v23, v23, v80
    v_sub_f32 v24, v24, v80
    v_sub_f32 v25, v25, v80
    v_exp_f32 v16, v16
    v_exp_f32 v17, v17
    v_exp_f32 v18, v18
    v_exp_f32 v19, v19
    v_exp_f32 v20, v20
    v_exp_f32 v21, v21
    v_exp_f32 v22, v22
    v_exp_f32 v23, v23
    v_exp_f32 v24, v24
    v_exp_f32 v25, v25
    v_cvt_pk_bf16_f32 v28, v16, v17
    v_cvt_pk_bf16_f32 v29, v18, v19
    v_cvt_pk_bf16_f32 v30, v20, v21
    v_cvt_pk_bf16_f32 v31, v22, v23
    v_cvt_pk_bf16_f32 v82, v24, v25
    v_mov_b32 v83, 0
    v_mfma_f32_16x16x32_bf16 v[84:87], v[88:91], v[28:31], 0
    v_mfma_f32_16x16x32_bf16 v[32:35], a[32:35], v[28:31], 0
    v_mfma_f32_16x16x32_bf16 v[36:39], a[36:39], v[28:31], 0
    v_mfma_f32_16x16x32_bf16 v[40:43], a[40:43], v[28:31], 0
    v_mfma_f32_16x16x32_bf16 v[44:47], a[44:47], v[28:31], 0
    s_nop 1
    v_mfma_f32_16x16x16_bf16 v[84:87], v[88:89], v[82:83], v[84:87]
    v_mfma_f32_16x16x16_bf16 v[32:35], v[92:93], v[82:83], v[32:35]
    v_mfma_f32_16x16x16_bf16 v[36:39], v[48:49], v[82:83], v[36:39]
    v_mfma_f32_16x16x16_bf16 v[40:43], v[94:95], v[82:83], v[40:43]
    v_mfma_f32_16x16x16_bf16 v[44:47], v[50:51], v[82:83], v[44:47]
    s_nop 3
    v_rcp_f32 v80, v84
    s_nop 0
    v_pk_mul_f32 v[32:33], v[32:33], v[80:81] op_sel_hi:[1,0]
    v_pk_mul_f32 v[34:35], v[34:35], v[80:81] op_sel_hi:[1,0]
    v_pk_mul_f32 v[36:37], v[36:37], v[80:81] op_sel_hi:[1,0]
    v_pk_mul_f32 v[38:39], v[38:39], v[80:81] op_sel_hi:[1,0]
    v_cvt_pk_bf16_f32 v56, v32, v36
    v_cvt_pk_bf16_f32 v57, v33, v37
    v_cvt_pk_bf16_f32 v58, v34, v38
    v_cvt_pk_bf16_f32 v59, v35, v39
    global_store_dwordx4 v9, v[56:59], s[38:39] offset:0 sc1
    v_pk_mul_f32 v[40:41], v[40:41], v[80:81] op_sel_hi:[1,0]
    v_pk_mul_f32 v[42:43], v[42:43], v[80:81] op_sel_hi:[1,0]
    v_pk_mul_f32 v[44:45], v[44:45], v[80:81] op_sel_hi:[1,0]
    v_pk_mul_f32 v[46:47], v[46:47], v[80:81] op_sel_hi:[1,0]
    v_cvt_pk_bf16_f32 v60, v40, v44
    v_cvt_pk_bf16_f32 v61, v41, v45
    v_cvt_pk_bf16_f32 v62, v42, v46
    v_cvt_pk_bf16_f32 v63, v43, v47
    global_store_dwordx4 v9, v[60:63], s[38:39] offset:1024 sc1
    s_barrier
    s_add_u32 s40, s40, 2
    s_cmp_lt_u32 s40, s41
    s_cbranch_scc1 L_qa_top
    s_waitcnt vmcnt(0)
    s_barrier
    s_cmp_lg_u32 s4, 0
    s_cbranch_scc1 L_sg_26
    s_mov_b64 exec, 1
    v_mov_b32 v12, 0
    v_mov_b32 v13, 1
    global_atomic_add v12, v13, s[60:61]
    s_mov_b64 exec, -1
L_sg_26:
    s_waitcnt vmcnt(0)
    s_branch L_done
L_orole:
    s_load_dwordx2 s[52:53], s[0:1], 80
    s_load_dwordx2 s[36:37], s[0:1], 96
    s_mul_i32 s13, s4, 1310720
    s_lshl_b32 s12, s42, 6
    s_add_u32 s13, s13, s12
    s_mov_b32 s14, 1280
    s_waitcnt lgkmcnt(0)
    s_add_u32 s16, s52, s13
    s_addc_u32 s17, s53, 0
    s_and_b32 s17, s17, 0xffff
    s_sub_u32 s18, 5242880, s13
    s_mov_b32 s19, 0x20000
    v_lshlrev_b32 v10, 2, v2
    s_mul_i32 s20, s14, 0
    s_mul_i32 s21, s14, 1
    s_mul_i32 s22, s14, 2
    s_mul_i32 s23, s14, 3
    s_mul_i32 s24, s14, 4
    s_mul_i32 s25, s14, 5
    s_mul_i32 s26, s14, 6
    s_mul_i32 s27, s14, 7
    s_mul_i32 s28, s14, 32
    s_mul_i32 s29, s14, 33
    s_mul_i32 s30, s14, 34
    s_mul_i32 s31, s14, 35
    s_mul_i32 s32, s14, 36
    s_mul_i32 s33, s14, 37
    s_mul_i32 s34, s14, 38
    s_mul_i32 s35, s14, 39
    s_lshl_b32 s12, s14, 3
    v_mul_lo_u32 v12, v3, s12
    v_add_u32 v10, v10, v12
    buffer_load_dword v32, v10, s[16:19], s20 offen
    buffer_load_dword v33, v10, s[16:19], s21 offen
    buffer_load_dword v34, v10, s[16:19], s22 offen
    buffer_load_dword v35, v10, s[16:19], s23 offen
    buffer_load_dword v36, v10, s[16:19], s24 offen
    buffer_load_dword v37, v10, s[16:19], s25 offen
    buffer_load_dword v38, v10, s[16:19], s26 offen
    buffer_load_dword v39, v10, s[16:19], s27 offen
    buffer_load_dword v40, v10, s[16:19], s28 offen
    buffer_load_dword v41, v10, s[16:19], s29 offen
    buffer_load_dword v42, v10, s[16:19], s30 offen
    buffer_load_dword v43, v10, s[16:19], s31 offen
    buffer_load_dword v44, v10, s[16:19], s32 offen
    buffer_load_dword v45, v10, s[16:19], s33 offen
    buffer_load_dword v46, v10, s[16:19], s34 offen
    buffer_load_dword v47, v10, s[16:19], s35 offen
    v_add_u32 v10, 81920, v10
    buffer_load_dword v48, v10, s[16:19], s20 offen
    buffer_load_dword v49, v10, s[16:19], s21 offen
    buffer_load_dword v50, v10, s[16:19], s22 offen
    buffer_load_dword v51, v10, s[16:19], s23 offen
    buffer_load_dword v52, v10, s[16:19], s24 offen
    buffer_load_dword v53, v10, s[16:19], s25 offen
    buffer_load_dword v54, v10, s[16:19], s26 offen
    buffer_load_dword v55, v10, s[16:19], s27 offen
    buffer_load_dword v56, v10, s[16:19], s28 offen
    buffer_load_dword v57, v10, s[16:19], s29 offen
    buffer_load_dword v58, v10, s[16:19], s30 offen
    buffer_load_dword v59, v10, s[16:19], s31 offen
    buffer_load_dword v60, v10, s[16:19], s32 offen
    buffer_load_dword v61, v10, s[16:19], s33 offen
    buffer_load_dword v62, v10, s[16:19], s34 offen
    buffer_load_dword v63, v10, s[16:19], s35 offen
    v_add_u32 v10, 81920, v10
    buffer_load_dword v64, v10, s[16:19], s20 offen
    buffer_load_dword v65, v10, s[16:19], s21 offen
    buffer_load_dword v66, v10, s[16:19], s22 offen
    buffer_load_dword v67, v10, s[16:19], s23 offen
    buffer_load_dword v68, v10, s[16:19], s24 offen
    buffer_load_dword v69, v10, s[16:19], s25 offen
    buffer_load_dword v70, v10, s[16:19], s26 offen
    buffer_load_dword v71, v10, s[16:19], s27 offen
    buffer_load_dword v72, v10, s[16:19], s28 offen
    buffer_load_dword v73, v10, s[16:19], s29 offen
    buffer_load_dword v74, v10, s[16:19], s30 offen
    buffer_load_dword v75, v10, s[16:19], s31 offen
    buffer_load_dword v76, v10, s[16:19], s32 offen
    buffer_load_dword v77, v10, s[16:19], s33 offen
    buffer_load_dword v78, v10, s[16:19], s34 offen
    buffer_load_dword v79, v10, s[16:19], s35 offen
    v_add_u32 v10, 81920, v10
    s_waitcnt vmcnt(32)
    v_perm_b32 v80, v33, v32, s47
    v_accvgpr_write_b32 a0, v80
    v_perm_b32 v80, v33, v32, s48
    v_accvgpr_write_b32 a8, v80
    v_perm_b32 v81, v35, v34, s47
    v_accvgpr_write_b32 a1, v81
    v_perm_b32 v81, v35, v34, s48
    v_accvgpr_write_b32 a9, v81
    v_perm_b32 v82, v37, v36, s47
    v_accvgpr_write_b32 a2, v82
    v_perm_b32 v82, v37, v36, s48
    v_accvgpr_write_b32 a10, v82
    v_perm_b32 v83, v39, v38, s47
    v_accvgpr_write_b32 a3, v83
    v_perm_b32 v83, v39, v38, s48
    v_accvgpr_write_b32 a11, v83
    v_perm_b32 v80, v41, v40, s47
    v_accvgpr_write_b32 a4, v80
    v_perm_b32 v80, v41, v40, s48
    v_accvgpr_write_b32 a12, v80
    v_perm_b32 v81, v43, v42, s47
    v_accvgpr_write_b32 a5, v81
    v_perm_b32 v81, v43, v42, s48
    v_accvgpr_write_b32 a13, v81
    v_perm_b32 v82, v45, v44, s47
    v_accvgpr_write_b32 a6, v82
    v_perm_b32 v82, v45, v44, s48
    v_accvgpr_write_b32 a14, v82
    v_perm_b32 v83, v47, v46, s47
    v_accvgpr_write_b32 a7, v83
    v_perm_b32 v83, v47, v46, s48
    v_accvgpr_write_b32 a15, v83
    buffer_load_dword v32, v10, s[16:19], s20 offen
    buffer_load_dword v33, v10, s[16:19], s21 offen
    buffer_load_dword v34, v10, s[16:19], s22 offen
    buffer_load_dword v35, v10, s[16:19], s23 offen
    buffer_load_dword v36, v10, s[16:19], s24 offen
    buffer_load_dword v37, v10, s[16:19], s25 offen
    buffer_load_dword v38, v10, s[16:19], s26 offen
    buffer_load_dword v39, v10, s[16:19], s27 offen
    buffer_load_dword v40, v10, s[16:19], s28 offen
    buffer_load_dword v41, v10, s[16:19], s29 offen
    buffer_load_dword v42, v10, s[16:19], s30 offen
    buffer_load_dword v43, v10, s[16:19], s31 offen
    buffer_load_dword v44, v10, s[16:19], s32 offen
    buffer_load_dword v45, v10, s[16:19], s33 offen
    buffer_load_dword v46, v10, s[16:19], s34 offen
    buffer_load_dword v47, v10, s[16:19], s35 offen
    v_add_u32 v10, 81920, v10
    s_waitcnt vmcnt(32)
    v_perm_b32 v80, v49, v48, s47
    v_accvgpr_write_b32 a16, v80
    v_perm_b32 v80, v49, v48, s48
    v_accvgpr_write_b32 a24, v80
    v_perm_b32 v81, v51, v50, s47
    v_accvgpr_write_b32 a17, v81
    v_perm_b32 v81, v51, v50, s48
    v_accvgpr_write_b32 a25, v81
    v_perm_b32 v82, v53, v52, s47
    v_accvgpr_write_b32 a18, v82
    v_perm_b32 v82, v53, v52, s48
    v_accvgpr_write_b32 a26, v82
    v_perm_b32 v83, v55, v54, s47
    v_accvgpr_write_b32 a19, v83
    v_perm_b32 v83, v55, v54, s48
    v_accvgpr_write_b32 a27, v83
    v_perm_b32 v80, v57, v56, s47
    v_accvgpr_write_b32 a20, v80
    v_perm_b32 v80, v57, v56, s48
    v_accvgpr_write_b32 a28, v80
    v_perm_b32 v81, v59, v58, s47
    v_accvgpr_write_b32 a21, v81
    v_perm_b32 v81, v59, v58, s48
    v_accvgpr_write_b32 a29, v81
    v_perm_b32 v82, v61, v60, s47
    v_accvgpr_write_b32 a22, v82
    v_perm_b32 v82, v61, v60, s48
    v_accvgpr_write_b32 a30, v82
    v_perm_b32 v83, v63, v62, s47
    v_accvgpr_write_b32 a23, v83
    v_perm_b32 v83, v63, v62, s48
    v_accvgpr_write_b32 a31, v83
    buffer_load_dword v48, v10, s[16:19], s20 offen
    buffer_load_dword v49, v10, s[16:19], s21 offen
    buffer_load_dword v50, v10, s[16:19], s22 offen
    buffer_load_dword v51, v10, s[16:19], s23 offen
    buffer_load_dword v52, v10, s[16:19], s24 offen
    buffer_load_dword v53, v10, s[16:19], s25 offen
    buffer_load_dword v54, v10, s[16:19], s26 offen
    buffer_load_dword v55, v10, s[16:19], s27 offen
    buffer_load_dword v56, v10, s[16:19], s28 offen
    buffer_load_dword v57, v10, s[16:19], s29 offen
    buffer_load_dword v58, v10, s[16:19], s30 offen
    buffer_load_dword v59, v10, s[16:19], s31 offen
    buffer_load_dword v60, v10, s[16:19], s32 offen
    buffer_load_dword v61, v10, s[16:19], s33 offen
    buffer_load_dword v62, v10, s[16:19], s34 offen
    buffer_load_dword v63, v10, s[16:19], s35 offen
    v_add_u32 v10, 81920, v10
    s_or_b32 s96, s4, s86
    s_cbranch_scc1 L_ar_27
    s_and_b32 s96, s3, 31
    s_lshl_b32 s96, 1, s96
    s_lshl_b32 s97, s87, 3
    s_mov_b64 exec, 1
    v_mov_b32 v12, s97
    v_mov_b32 v14, s96
    v_mov_b32 v15, 0x100
    global_atomic_add_x2 v[14:15], v12, v[14:15], s[8:9] offset:128 sc0
    s_mov_b64 exec, -1
L_ar_27:
    s_waitcnt vmcnt(32)
    v_perm_b32 v80, v65, v64, s47
    v_accvgpr_write_b32 a32, v80
    v_perm_b32 v80, v65, v64, s48
    v_accvgpr_write_b32 a40, v80
    v_perm_b32 v81, v67, v66, s47
    v_accvgpr_write_b32 a33, v81
    v_perm_b32 v81, v67, v66, s48
    v_accvgpr_write_b32 a41, v81
    v_perm_b32 v82, v69, v68, s47
    v_accvgpr_write_b32 a34, v82
    v_perm_b32 v82, v69, v68, s48
    v_accvgpr_write_b32 a42, v82
    v_perm_b32 v83, v71, v70, s47
    v_accvgpr_write_b32 a35, v83
    v_perm_b32 v83, v71, v70, s48
    v_accvgpr_write_b32 a43, v83
    v_perm_b32 v80, v73, v72, s47
    v_accvgpr_write_b32 a36, v80
    v_perm_b32 v80, v73, v72, s48
    v_accvgpr_write_b32 a44, v80
    v_perm_b32 v81, v75, v74, s47
    v_accvgpr_write_b32 a37, v81
    v_perm_b32 v81, v75, v74, s48
    v_accvgpr_write_b32 a45, v81
    v_perm_b32 v82, v77, v76, s47
    v_accvgpr_write_b32 a38, v82
    v_perm_b32 v82, v77, v76, s48
    v_accvgpr_write_b32 a46, v82
    v_perm_b32 v83, v79, v78, s47
    v_accvgpr_write_b32 a39, v83
    v_perm_b32 v83, v79, v78, s48
    v_accvgpr_write_b32 a47, v83
    buffer_load_dword v64, v10, s[16:19], s20 offen
    buffer_load_dword v65, v10, s[16:19], s21 offen
    buffer_load_dword v66, v10, s[16:19], s22 offen
    buffer_load_dword v67, v10, s[16:19], s23 offen
    buffer_load_dword v68, v10, s[16:19], s24 offen
    buffer_load_dword v69, v10, s[16:19], s25 offen
    buffer_load_dword v70, v10, s[16:19], s26 offen
    buffer_load_dword v71, v10, s[16:19], s27 offen
    buffer_load_dword v72, v10, s[16:19], s28 offen
    buffer_load_dword v73, v10, s[16:19], s29 offen
    buffer_load_dword v74, v10, s[16:19], s30 offen
    buffer_load_dword v75, v10, s[16:19], s31 offen
    buffer_load_dword v76, v10, s[16:19], s32 offen
    buffer_load_dword v77, v10, s[16:19], s33 offen
    buffer_load_dword v78, v10, s[16:19], s34 offen
    buffer_load_dword v79, v10, s[16:19], s35 offen
    v_add_u32 v10, 81920, v10
    s_waitcnt vmcnt(32)
    v_perm_b32 v80, v33, v32, s47
    v_accvgpr_write_b32 a48, v80
    v_perm_b32 v80, v33, v32, s48
    v_accvgpr_write_b32 a56, v80
    v_perm_b32 v81, v35, v34, s47
    v_accvgpr_write_b32 a49, v81
    v_perm_b32 v81, v35, v34, s48
    v_accvgpr_write_b32 a57, v81
    v_perm_b32 v82, v37, v36, s47
    v_accvgpr_write_b32 a50, v82
    v_perm_b32 v82, v37, v36, s48
    v_accvgpr_write_b32 a58, v82
    v_perm_b32 v83, v39, v38, s47
    v_accvgpr_write_b32 a51, v83
    v_perm_b32 v83, v39, v38, s48
    v_accvgpr_write_b32 a59, v83
    v_perm_b32 v80, v41, v40, s47
    v_accvgpr_write_b32 a52, v80
    v_perm_b32 v80, v41, v40, s48
    v_accvgpr_write_b32 a60, v80
    v_perm_b32 v81, v43, v42, s47
    v_accvgpr_write_b32 a53, v81
    v_perm_b32 v81, v43, v42, s48
    v_accvgpr_write_b32 a61, v81
    v_perm_b32 v82, v45, v44, s47
    v_accvgpr_write_b32 a54, v82
    v_perm_b32 v82, v45, v44, s48
    v_accvgpr_write_b32 a62, v82
    v_perm_b32 v83, v47, v46, s47
    v_accvgpr_write_b32 a55, v83
    v_perm_b32 v83, v47, v46, s48
    v_accvgpr_write_b32 a63, v83
    buffer_load_dword v32, v10, s[16:19], s20 offen
    buffer_load_dword v33, v10, s[16:19], s21 offen
    buffer_load_dword v34, v10, s[16:19], s22 offen
    buffer_load_dword v35, v10, s[16:19], s23 offen
    buffer_load_dword v36, v10, s[16:19], s24 offen
    buffer_load_dword v37, v10, s[16:19], s25 offen
    buffer_load_dword v38, v10, s[16:19], s26 offen
    buffer_load_dword v39, v10, s[16:19], s27 offen
    buffer_load_dword v40, v10, s[16:19], s28 offen
    buffer_load_dword v41, v10, s[16:19], s29 offen
    buffer_load_dword v42, v10, s[16:19], s30 offen
    buffer_load_dword v43, v10, s[16:19], s31 offen
    buffer_load_dword v44, v10, s[16:19], s32 offen
    buffer_load_dword v45, v10, s[16:19], s33 offen
    buffer_load_dword v46, v10, s[16:19], s34 offen
    buffer_load_dword v47, v10, s[16:19], s35 offen
    v_add_u32 v10, 81920, v10
    s_waitcnt vmcnt(32)
    v_perm_b32 v80, v49, v48, s47
    v_accvgpr_write_b32 a64, v80
    v_perm_b32 v80, v49, v48, s48
    v_accvgpr_write_b32 a72, v80
    v_perm_b32 v81, v51, v50, s47
    v_accvgpr_write_b32 a65, v81
    v_perm_b32 v81, v51, v50, s48
    v_accvgpr_write_b32 a73, v81
    v_perm_b32 v82, v53, v52, s47
    v_accvgpr_write_b32 a66, v82
    v_perm_b32 v82, v53, v52, s48
    v_accvgpr_write_b32 a74, v82
    v_perm_b32 v83, v55, v54, s47
    v_accvgpr_write_b32 a67, v83
    v_perm_b32 v83, v55, v54, s48
    v_accvgpr_write_b32 a75, v83
    v_perm_b32 v80, v57, v56, s47
    v_accvgpr_write_b32 a68, v80
    v_perm_b32 v80, v57, v56, s48
    v_accvgpr_write_b32 a76, v80
    v_perm_b32 v81, v59, v58, s47
    v_accvgpr_write_b32 a69, v81
    v_perm_b32 v81, v59, v58, s48
    v_accvgpr_write_b32 a77, v81
    v_perm_b32 v82, v61, v60, s47
    v_accvgpr_write_b32 a70, v82
    v_perm_b32 v82, v61, v60, s48
    v_accvgpr_write_b32 a78, v82
    v_perm_b32 v83, v63, v62, s47
    v_accvgpr_write_b32 a71, v83
    v_perm_b32 v83, v63, v62, s48
    v_accvgpr_write_b32 a79, v83
    buffer_load_dword v48, v10, s[16:19], s20 offen
    buffer_load_dword v49, v10, s[16:19], s21 offen
    buffer_load_dword v50, v10, s[16:19], s22 offen
    buffer_load_dword v51, v10, s[16:19], s23 offen
    buffer_load_dword v52, v10, s[16:19], s24 offen
    buffer_load_dword v53, v10, s[16:19], s25 offen
    buffer_load_dword v54, v10, s[16:19], s26 offen
    buffer_load_dword v55, v10, s[16:19], s27 offen
    buffer_load_dword v56, v10, s[16:19], s28 offen
    buffer_load_dword v57, v10, s[16:19], s29 offen
    buffer_load_dword v58, v10, s[16:19], s30 offen
    buffer_load_dword v59, v10, s[16:19], s31 offen
    buffer_load_dword v60, v10, s[16:19], s32 offen
    buffer_load_dword v61, v10, s[16:19], s33 offen
    buffer_load_dword v62, v10, s[16:19], s34 offen
    buffer_load_dword v63, v10, s[16:19], s35 offen
    v_add_u32 v10, 81920, v10
    s_waitcnt vmcnt(32)
    v_perm_b32 v80, v65, v64, s47
    v_accvgpr_write_b32 a80, v80
    v_perm_b32 v80, v65, v64, s48
    v_accvgpr_write_b32 a88, v80
    v_perm_b32 v81, v67, v66, s47
    v_accvgpr_write_b32 a81, v81
    v_perm_b32 v81, v67, v66, s48
    v_accvgpr_write_b32 a89, v81
    v_perm_b32 v82, v69, v68, s47
    v_accvgpr_write_b32 a82, v82
    v_perm_b32 v82, v69, v68, s48
    v_accvgpr_write_b32 a90, v82
    v_perm_b32 v83, v71, v70, s47
    v_accvgpr_write_b32 a83, v83
    v_perm_b32 v83, v71, v70, s48
    v_accvgpr_write_b32 a91, v83
    v_perm_b32 v80, v73, v72, s47
    v_accvgpr_write_b32 a84, v80
    v_perm_b32 v80, v73, v72, s48
    v_accvgpr_write_b32 a92, v80
    v_perm_b32 v81, v75, v74, s47
    v_accvgpr_write_b32 a85, v81
    v_perm_b32 v81, v75, v74, s48
    v_accvgpr_write_b32 a93, v81
    v_perm_b32 v82, v77, v76, s47
    v_accvgpr_write_b32 a86, v82
    v_perm_b32 v82, v77, v76, s48
    v_accvgpr_write_b32 a94, v82
    v_perm_b32 v83, v79, v78, s47
    v_accvgpr_write_b32 a87, v83
    v_perm_b32 v83, v79, v78, s48
    v_accvgpr_write_b32 a95, v83
    buffer_load_dword v64, v10, s[16:19], s20 offen
    buffer_load_dword v65, v10, s[16:19], s21 offen
    buffer_load_dword v66, v10, s[16:19], s22 offen
    buffer_load_dword v67, v10, s[16:19], s23 offen
    buffer_load_dword v68, v10, s[16:19], s24 offen
    buffer_load_dword v69, v10, s[16:19], s25 offen
    buffer_load_dword v70, v10, s[16:19], s26 offen
    buffer_load_dword v71, v10, s[16:19], s27 offen
    buffer_load_dword v72, v10, s[16:19], s28 offen
    buffer_load_dword v73, v10, s[16:19], s29 offen
    buffer_load_dword v74, v10, s[16:19], s30 offen
    buffer_load_dword v75, v10, s[16:19], s31 offen
    buffer_load_dword v76, v10, s[16:19], s32 offen
    buffer_load_dword v77, v10, s[16:19], s33 offen
    buffer_load_dword v78, v10, s[16:19], s34 offen
    buffer_load_dword v79, v10, s[16:19], s35 offen
    v_add_u32 v10, 81920, v10
    s_waitcnt vmcnt(32)
    v_perm_b32 v80, v33, v32, s47
    v_accvgpr_write_b32 a96, v80
    v_perm_b32 v80, v33, v32, s48
    v_accvgpr_write_b32 a104, v80
    v_perm_b32 v81, v35, v34, s47
    v_accvgpr_write_b32 a97, v81
    v_perm_b32 v81, v35, v34, s48
    v_accvgpr_write_b32 a105, v81
    v_perm_b32 v82, v37, v36, s47
    v_accvgpr_write_b32 a98, v82
    v_perm_b32 v82, v37, v36, s48
    v_accvgpr_write_b32 a106, v82
    v_perm_b32 v83, v39, v38, s47
    v_accvgpr_write_b32 a99, v83
    v_perm_b32 v83, v39, v38, s48
    v_accvgpr_write_b32 a107, v83
    v_perm_b32 v80, v41, v40, s47
    v_accvgpr_write_b32 a100, v80
    v_perm_b32 v80, v41, v40, s48
    v_accvgpr_write_b32 a108, v80
    v_perm_b32 v81, v43, v42, s47
    v_accvgpr_write_b32 a101, v81
    v_perm_b32 v81, v43, v42, s48
    v_accvgpr_write_b32 a109, v81
    v_perm_b32 v82, v45, v44, s47
    v_accvgpr_write_b32 a102, v82
    v_perm_b32 v82, v45, v44, s48
    v_accvgpr_write_b32 a110, v82
    v_perm_b32 v83, v47, v46, s47
    v_accvgpr_write_b32 a103, v83
    v_perm_b32 v83, v47, v46, s48
    v_accvgpr_write_b32 a111, v83
    buffer_load_dword v32, v10, s[16:19], s20 offen
    buffer_load_dword v33, v10, s[16:19], s21 offen
    buffer_load_dword v34, v10, s[16:19], s22 offen
    buffer_load_dword v35, v10, s[16:19], s23 offen
    buffer_load_dword v36, v10, s[16:19], s24 offen
    buffer_load_dword v37, v10, s[16:19], s25 offen
    buffer_load_dword v38, v10, s[16:19], s26 offen
    buffer_load_dword v39, v10, s[16:19], s27 offen
    buffer_load_dword v40, v10, s[16:19], s28 offen
    buffer_load_dword v41, v10, s[16:19], s29 offen
    buffer_load_dword v42, v10, s[16:19], s30 offen
    buffer_load_dword v43, v10, s[16:19], s31 offen
    buffer_load_dword v44, v10, s[16:19], s32 offen
    buffer_load_dword v45, v10, s[16:19], s33 offen
    buffer_load_dword v46, v10, s[16:19], s34 offen
    buffer_load_dword v47, v10, s[16:19], s35 offen
    v_add_u32 v10, 81920, v10
    s_waitcnt vmcnt(32)
    v_perm_b32 v80, v49, v48, s47
    v_accvgpr_write_b32 a112, v80
    v_perm_b32 v80, v49, v48, s48
    v_accvgpr_write_b32 a120, v80
    v_perm_b32 v81, v51, v50, s47
    v_accvgpr_write_b32 a113, v81
    v_perm_b32 v81, v51, v50, s48
    v_accvgpr_write_b32 a121, v81
    v_perm_b32 v82, v53, v52, s47
    v_accvgpr_write_b32 a114, v82
    v_perm_b32 v82, v53, v52, s48
    v_accvgpr_write_b32 a122, v82
    v_perm_b32 v83, v55, v54, s47
    v_accvgpr_write_b32 a115, v83
    v_perm_b32 v83, v55, v54, s48
    v_accvgpr_write_b32 a123, v83
    v_perm_b32 v80, v57, v56, s47
    v_accvgpr_write_b32 a116, v80
    v_perm_b32 v80, v57, v56, s48
    v_accvgpr_write_b32 a124, v80
    v_perm_b32 v81, v59, v58, s47
    v_accvgpr_write_b32 a117, v81
    v_perm_b32 v81, v59, v58, s48
    v_accvgpr_write_b32 a125, v81
    v_perm_b32 v82, v61, v60, s47
    v_accvgpr_write_b32 a118, v82
    v_perm_b32 v82, v61, v60, s48
    v_accvgpr_write_b32 a126, v82
    v_perm_b32 v83, v63, v62, s47
    v_accvgpr_write_b32 a119, v83
    v_perm_b32 v83, v63, v62, s48
    v_accvgpr_write_b32 a127, v83
    buffer_load_dword v48, v10, s[16:19], s20 offen
    buffer_load_dword v49, v10, s[16:19], s21 offen
    buffer_load_dword v50, v10, s[16:19], s22 offen
    buffer_load_dword v51, v10, s[16:19], s23 offen
    buffer_load_dword v52, v10, s[16:19], s24 offen
    buffer_load_dword v53, v10, s[16:19], s25 offen
    buffer_load_dword v54, v10, s[16:19], s26 offen
    buffer_load_dword v55, v10, s[16:19], s27 offen
    buffer_load_dword v56, v10, s[16:19], s28 offen
    buffer_load_dword v57, v10, s[16:19], s29 offen
    buffer_load_dword v58, v10, s[16:19], s30 offen
    buffer_load_dword v59, v10, s[16:19], s31 offen
    buffer_load_dword v60, v10, s[16:19], s32 offen
    buffer_load_dword v61, v10, s[16:19], s33 offen
    buffer_load_dword v62, v10, s[16:19], s34 offen
    buffer_load_dword v63, v10, s[16:19], s35 offen
    v_add_u32 v10, 81920, v10
    s_waitcnt vmcnt(32)
    v_perm_b32 v80, v65, v64, s47
    v_accvgpr_write_b32 a128, v80
    v_perm_b32 v80, v65, v64, s48
    v_accvgpr_write_b32 a136, v80
    v_perm_b32 v81, v67, v66, s47
    v_accvgpr_write_b32 a129, v81
    v_perm_b32 v81, v67, v66, s48
    v_accvgpr_write_b32 a137, v81
    v_perm_b32 v82, v69, v68, s47
    v_accvgpr_write_b32 a130, v82
    v_perm_b32 v82, v69, v68, s48
    v_accvgpr_write_b32 a138, v82
    v_perm_b32 v83, v71, v70, s47
    v_accvgpr_write_b32 a131, v83
    v_perm_b32 v83, v71, v70, s48
    v_accvgpr_write_b32 a139, v83
    v_perm_b32 v80, v73, v72, s47
    v_accvgpr_write_b32 a132, v80
    v_perm_b32 v80, v73, v72, s48
    v_accvgpr_write_b32 a140, v80
    v_perm_b32 v81, v75, v74, s47
    v_accvgpr_write_b32 a133, v81
    v_perm_b32 v81, v75, v74, s48
    v_accvgpr_write_b32 a141, v81
    v_perm_b32 v82, v77, v76, s47
    v_accvgpr_write_b32 a134, v82
    v_perm_b32 v82, v77, v76, s48
    v_accvgpr_write_b32 a142, v82
    v_perm_b32 v83, v79, v78, s47
    v_accvgpr_write_b32 a135, v83
    v_perm_b32 v83, v79, v78, s48
    v_accvgpr_write_b32 a143, v83
    buffer_load_dword v64, v10, s[16:19], s20 offen
    buffer_load_dword v65, v10, s[16:19], s21 offen
    buffer_load_dword v66, v10, s[16:19], s22 offen
    buffer_load_dword v67, v10, s[16:19], s23 offen
    buffer_load_dword v68, v10, s[16:19], s24 offen
    buffer_load_dword v69, v10, s[16:19], s25 offen
    buffer_load_dword v70, v10, s[16:19], s26 offen
    buffer_load_dword v71, v10, s[16:19], s27 offen
    buffer_load_dword v72, v10, s[16:19], s28 offen
    buffer_load_dword v73, v10, s[16:19], s29 offen
    buffer_load_dword v74, v10, s[16:19], s30 offen
    buffer_load_dword v75, v10, s[16:19], s31 offen
    buffer_load_dword v76, v10, s[16:19], s32 offen
    buffer_load_dword v77, v10, s[16:19], s33 offen
    buffer_load_dword v78, v10, s[16:19], s34 offen
    buffer_load_dword v79, v10, s[16:19], s35 offen
    v_add_u32 v10, 81920, v10
    s_waitcnt vmcnt(32)
    v_perm_b32 v80, v33, v32, s47
    v_accvgpr_write_b32 a144, v80
    v_perm_b32 v80, v33, v32, s48
    v_accvgpr_write_b32 a152, v80
    v_perm_b32 v81, v35, v34, s47
    v_accvgpr_write_b32 a145, v81
    v_perm_b32 v81, v35, v34, s48
    v_accvgpr_write_b32 a153, v81
    v_perm_b32 v82, v37, v36, s47
    v_accvgpr_write_b32 a146, v82
    v_perm_b32 v82, v37, v36, s48
    v_accvgpr_write_b32 a154, v82
    v_perm_b32 v83, v39, v38, s47
    v_accvgpr_write_b32 a147, v83
    v_perm_b32 v83, v39, v38, s48
    v_accvgpr_write_b32 a155, v83
    v_perm_b32 v80, v41, v40, s47
    v_accvgpr_write_b32 a148, v80
    v_perm_b32 v80, v41, v40, s48
    v_accvgpr_write_b32 a156, v80
    v_perm_b32 v81, v43, v42, s47
    v_accvgpr_write_b32 a149, v81
    v_perm_b32 v81, v43, v42, s48
    v_accvgpr_write_b32 a157, v81
    v_perm_b32 v82, v45, v44, s47
    v_accvgpr_write_b32 a150, v82
    v_perm_b32 v82, v45, v44, s48
    v_accvgpr_write_b32 a158, v82
    v_perm_b32 v83, v47, v46, s47
    v_accvgpr_write_b32 a151, v83
    v_perm_b32 v83, v47, v46, s48
    v_accvgpr_write_b32 a159, v83
    buffer_load_dword v32, v10, s[16:19], s20 offen
    buffer_load_dword v33, v10, s[16:19], s21 offen
    buffer_load_dword v34, v10, s[16:19], s22 offen
    buffer_load_dword v35, v10, s[16:19], s23 offen
    buffer_load_dword v36, v10, s[16:19], s24 offen
    buffer_load_dword v37, v10, s[16:19], s25 offen
    buffer_load_dword v38, v10, s[16:19], s26 offen
    buffer_load_dword v39, v10, s[16:19], s27 offen
    buffer_load_dword v40, v10, s[16:19], s28 offen
    buffer_load_dword v41, v10, s[16:19], s29 offen
    buffer_load_dword v42, v10, s[16:19], s30 offen
    buffer_load_dword v43, v10, s[16:19], s31 offen
    buffer_load_dword v44, v10, s[16:19], s32 offen
    buffer_load_dword v45, v10, s[16:19], s33 offen
    buffer_load_dword v46, v10, s[16:19], s34 offen
    buffer_load_dword v47, v10, s[16:19], s35 offen
    v_add_u32 v10, 81920, v10
    s_waitcnt vmcnt(32)
    v_perm_b32 v80, v49, v48, s47
    v_accvgpr_write_b32 a160, v80
    v_perm_b32 v80, v49, v48, s48
    v_accvgpr_write_b32 a168, v80
    v_perm_b32 v81, v51, v50, s47
    v_accvgpr_write_b32 a161, v81
    v_perm_b32 v81, v51, v50, s48
    v_accvgpr_write_b32 a169, v81
    v_perm_b32 v82, v53, v52, s47
    v_accvgpr_write_b32 a162, v82
    v_perm_b32 v82, v53, v52, s48
    v_accvgpr_write_b32 a170, v82
    v_perm_b32 v83, v55, v54, s47
    v_accvgpr_write_b32 a163, v83
    v_perm_b32 v83, v55, v54, s48
    v_accvgpr_write_b32 a171, v83
    v_perm_b32 v80, v57, v56, s47
    v_accvgpr_write_b32 a164, v80
    v_perm_b32 v80, v57, v56, s48
    v_accvgpr_write_b32 a172, v80
    v_perm_b32 v81, v59, v58, s47
    v_accvgpr_write_b32 a165, v81
    v_perm_b32 v81, v59, v58, s48
    v_accvgpr_write_b32 a173, v81
    v_perm_b32 v82, v61, v60, s47
    v_accvgpr_write_b32 a166, v82
    v_perm_b32 v82, v61, v60, s48
    v_accvgpr_write_b32 a174, v82
    v_perm_b32 v83, v63, v62, s47
    v_accvgpr_write_b32 a167, v83
    v_perm_b32 v83, v63, v62, s48
    v_accvgpr_write_b32 a175, v83
    buffer_load_dword v48, v10, s[16:19], s20 offen
    buffer_load_dword v49, v10, s[16:19], s21 offen
    buffer_load_dword v50, v10, s[16:19], s22 offen
    buffer_load_dword v51, v10, s[16:19], s23 offen
    buffer_load_dword v52, v10, s[16:19], s24 offen
    buffer_load_dword v53, v10, s[16:19], s25 offen
    buffer_load_dword v54, v10, s[16:19], s26 offen
    buffer_load_dword v55, v10, s[16:19], s27 offen
    buffer_load_dword v56, v10, s[16:19], s28 offen
    buffer_load_dword v57, v10, s[16:19], s29 offen
    buffer_load_dword v58, v10, s[16:19], s30 offen
    buffer_load_dword v59, v10, s[16:19], s31 offen
    buffer_load_dword v60, v10, s[16:19], s32 offen
    buffer_load_dword v61, v10, s[16:19], s33 offen
    buffer_load_dword v62, v10, s[16:19], s34 offen
    buffer_load_dword v63, v10, s[16:19], s35 offen
    v_add_u32 v10, 81920, v10
    s_waitcnt vmcnt(32)
    v_perm_b32 v80, v65, v64, s47
    v_accvgpr_write_b32 a176, v80
    v_perm_b32 v80, v65, v64, s48
    v_accvgpr_write_b32 a184, v80
    v_perm_b32 v81, v67, v66, s47
    v_accvgpr_write_b32 a177, v81
    v_perm_b32 v81, v67, v66, s48
    v_accvgpr_write_b32 a185, v81
    v_perm_b32 v82, v69, v68, s47
    v_accvgpr_write_b32 a178, v82
    v_perm_b32 v82, v69, v68, s48
    v_accvgpr_write_b32 a186, v82
    v_perm_b32 v83, v71, v70, s47
    v_accvgpr_write_b32 a179, v83
    v_perm_b32 v83, v71, v70, s48
    v_accvgpr_write_b32 a187, v83
    v_perm_b32 v80, v73, v72, s47
    v_accvgpr_write_b32 a180, v80
    v_perm_b32 v80, v73, v72, s48
    v_accvgpr_write_b32 a188, v80
    v_perm_b32 v81, v75, v74, s47
    v_accvgpr_write_b32 a181, v81
    v_perm_b32 v81, v75, v74, s48
    v_accvgpr_write_b32 a189, v81
    v_perm_b32 v82, v77, v76, s47
    v_accvgpr_write_b32 a182, v82
    v_perm_b32 v82, v77, v76, s48
    v_accvgpr_write_b32 a190, v82
    v_perm_b32 v83, v79, v78, s47
    v_accvgpr_write_b32 a183, v83
    v_perm_b32 v83, v79, v78, s48
    v_accvgpr_write_b32 a191, v83
    buffer_load_dword v64, v10, s[16:19], s20 offen
    buffer_load_dword v65, v10, s[16:19], s21 offen
    buffer_load_dword v66, v10, s[16:19], s22 offen
    buffer_load_dword v67, v10, s[16:19], s23 offen
    buffer_load_dword v68, v10, s[16:19], s24 offen
    buffer_load_dword v69, v10, s[16:19], s25 offen
    buffer_load_dword v70, v10, s[16:19], s26 offen
    buffer_load_dword v71, v10, s[16:19], s27 offen
    buffer_load_dword v72, v10, s[16:19], s28 offen
    buffer_load_dword v73, v10, s[16:19], s29 offen
    buffer_load_dword v74, v10, s[16:19], s30 offen
    buffer_load_dword v75, v10, s[16:19], s31 offen
    buffer_load_dword v76, v10, s[16:19], s32 offen
    buffer_load_dword v77, v10, s[16:19], s33 offen
    buffer_load_dword v78, v10, s[16:19], s34 offen
    buffer_load_dword v79, v10, s[16:19], s35 offen
    v_add_u32 v10, 81920, v10
    s_waitcnt vmcnt(32)
    v_perm_b32 v80, v33, v32, s47
    v_accvgpr_write_b32 a192, v80
    v_perm_b32 v80, v33, v32, s48
    v_accvgpr_write_b32 a200, v80
    v_perm_b32 v81, v35, v34, s47
    v_accvgpr_write_b32 a193, v81
    v_perm_b32 v81, v35, v34, s48
    v_accvgpr_write_b32 a201, v81
    v_perm_b32 v82, v37, v36, s47
    v_accvgpr_write_b32 a194, v82
    v_perm_b32 v82, v37, v36, s48
    v_accvgpr_write_b32 a202, v82
    v_perm_b32 v83, v39, v38, s47
    v_accvgpr_write_b32 a195, v83
    v_perm_b32 v83, v39, v38, s48
    v_accvgpr_write_b32 a203, v83
    v_perm_b32 v80, v41, v40, s47
    v_accvgpr_write_b32 a196, v80
    v_perm_b32 v80, v41, v40, s48
    v_accvgpr_write_b32 a204, v80
    v_perm_b32 v81, v43, v42, s47
    v_accvgpr_write_b32 a197, v81
    v_perm_b32 v81, v43, v42, s48
    v_accvgpr_write_b32 a205, v81
    v_perm_b32 v82, v45, v44, s47
    v_accvgpr_write_b32 a198, v82
    v_perm_b32 v82, v45, v44, s48
    v_accvgpr_write_b32 a206, v82
    v_perm_b32 v83, v47, v46, s47
    v_accvgpr_write_b32 a199, v83
    v_perm_b32 v83, v47, v46, s48
    v_accvgpr_write_b32 a207, v83
    buffer_load_dword v32, v10, s[16:19], s20 offen
    buffer_load_dword v33, v10, s[16:19], s21 offen
    buffer_load_dword v34, v10, s[16:19], s22 offen
    buffer_load_dword v35, v10, s[16:19], s23 offen
    buffer_load_dword v36, v10, s[16:19], s24 offen
    buffer_load_dword v37, v10, s[16:19], s25 offen
    buffer_load_dword v38, v10, s[16:19], s26 offen
    buffer_load_dword v39, v10, s[16:19], s27 offen
    buffer_load_dword v40, v10, s[16:19], s28 offen
    buffer_load_dword v41, v10, s[16:19], s29 offen
    buffer_load_dword v42, v10, s[16:19], s30 offen
    buffer_load_dword v43, v10, s[16:19], s31 offen
    buffer_load_dword v44, v10, s[16:19], s32 offen
    buffer_load_dword v45, v10, s[16:19], s33 offen
    buffer_load_dword v46, v10, s[16:19], s34 offen
    buffer_load_dword v47, v10, s[16:19], s35 offen
    s_waitcnt vmcnt(32)
    v_perm_b32 v80, v49, v48, s47
    v_accvgpr_write_b32 a208, v80
    v_perm_b32 v80, v49, v48, s48
    v_accvgpr_write_b32 a216, v80
    v_perm_b32 v81, v51, v50, s47
    v_accvgpr_write_b32 a209, v81
    v_perm_b32 v81, v51, v50, s48
    v_accvgpr_write_b32 a217, v81
    v_perm_b32 v82, v53, v52, s47
    v_accvgpr_write_b32 a210, v82
    v_perm_b32 v82, v53, v52, s48
    v_accvgpr_write_b32 a218, v82
    v_perm_b32 v83, v55, v54, s47
    v_accvgpr_write_b32 a211, v83
    v_perm_b32 v83, v55, v54, s48
    v_accvgpr_write_b32 a219, v83
    v_perm_b32 v80, v57, v56, s47
    v_accvgpr_write_b32 a212, v80
    v_perm_b32 v80, v57, v56, s48
    v_accvgpr_write_b32 a220, v80
    v_perm_b32 v81, v59, v58, s47
    v_accvgpr_write_b32 a213, v81
    v_perm_b32 v81, v59, v58, s48
    v_accvgpr_write_b32 a221, v81
    v_perm_b32 v82, v61, v60, s47
    v_accvgpr_write_b32 a214, v82
    v_perm_b32 v82, v61, v60, s48
    v_accvgpr_write_b32 a222, v82
    v_perm_b32 v83, v63, v62, s47
    v_accvgpr_write_b32 a215, v83
    v_perm_b32 v83, v63, v62, s48
    v_accvgpr_write_b32 a223, v83
    s_waitcnt vmcnt(16)
    v_perm_b32 v80, v65, v64, s47
    v_accvgpr_write_b32 a224, v80
    v_perm_b32 v80, v65, v64, s48
    v_accvgpr_write_b32 a232, v80
    v_perm_b32 v81, v67, v66, s47
    v_accvgpr_write_b32 a225, v81
    v_perm_b32 v81, v67, v66, s48
    v_accvgpr_write_b32 a233, v81
    v_perm_b32 v82, v69, v68, s47
    v_accvgpr_write_b32 a226, v82
    v_perm_b32 v82, v69, v68, s48
    v_accvgpr_write_b32 a234, v82
    v_perm_b32 v83, v71, v70, s47
    v_accvgpr_write_b32 a227, v83
    v_perm_b32 v83, v71, v70, s48
    v_accvgpr_write_b32 a235, v83
    v_perm_b32 v80, v73, v72, s47
    v_accvgpr_write_b32 a228, v80
    v_perm_b32 v80, v73, v72, s48
    v_accvgpr_write_b32 a236, v80
    v_perm_b32 v81, v75, v74, s47
    v_accvgpr_write_b32 a229, v81
    v_perm_b32 v81, v75, v74, s48
    v_accvgpr_write_b32 a237, v81
    v_perm_b32 v82, v77, v76, s47
    v_accvgpr_write_b32 a230, v82
    v_perm_b32 v82, v77, v76, s48
    v_accvgpr_write_b32 a238, v82
    v_perm_b32 v83, v79, v78, s47
    v_accvgpr_write_b32 a231, v83
    v_perm_b32 v83, v79, v78, s48
    v_accvgpr_write_b32 a239, v83
    s_waitcnt vmcnt(0)
    v_perm_b32 v80, v33, v32, s47
    v_accvgpr_write_b32 a240, v80
    v_perm_b32 v80, v33, v32, s48
    v_accvgpr_write_b32 a248, v80
    v_perm_b32 v81, v35, v34, s47
    v_accvgpr_write_b32 a241, v81
    v_perm_b32 v81, v35, v34, s48
    v_accvgpr_write_b32 a249, v81
    v_perm_b32 v82, v37, v36, s47
    v_accvgpr_write_b32 a242, v82
    v_perm_b32 v82, v37, v36, s48
    v_accvgpr_write_b32 a250, v82
    v_perm_b32 v83, v39, v38, s47
    v_accvgpr_write_b32 a243, v83
    v_perm_b32 v83, v39, v38, s48
    v_accvgpr_write_b32 a251, v83
    v_perm_b32 v80, v41, v40, s47
    v_accvgpr_write_b32 a244, v80
    v_perm_b32 v80, v41, v40, s48
    v_accvgpr_write_b32 a252, v80
    v_perm_b32 v81, v43, v42, s47
    v_accvgpr_write_b32 a245, v81
    v_perm_b32 v81, v43, v42, s48
    v_accvgpr_write_b32 a253, v81
    v_perm_b32 v82, v45, v44, s47
    v_accvgpr_write_b32 a246, v82
    v_perm_b32 v82, v45, v44, s48
    v_accvgpr_write_b32 a254, v82
    v_perm_b32 v83, v47, v46, s47
    v_accvgpr_write_b32 a247, v83
    v_perm_b32 v83, v47, v46, s48
    v_accvgpr_write_b32 a255, v83
    s_cmp_lg_u32 s86, 0
    s_cbranch_scc1 L_vf_28
    s_cmp_lg_u32 s4, 0
    s_cbranch_scc1 L_vf_29
    s_mov_b64 exec, 0xffff
    v_mbcnt_lo_u32_b32 v18, -1, 0
    v_lshlrev_b32 v18, 3, v18
    s_mov_b32 s96, 1048576
L_vf_30:
    global_load_dwordx2 v[16:17], v18, s[8:9] offset:128 sc1
    s_sub_u32 s96, s96, 1
    s_cbranch_scc1 L_bail1
    s_waitcnt vmcnt(0)
    v_lshrrev_b32 v19, 8, v17
    s_nop 1
    v_add_u32_dpp v19, v19, v19 row_shr:1 row_mask:0xf bank_mask:0xf bound_ctrl:0
    s_nop 1
    v_add_u32_dpp v19, v19, v19 row_shr:2 row_mask:0xf bank_mask:0xf bound_ctrl:0
    s_nop 1
    v_add_u32_dpp v19, v19, v19 row_shr:4 row_mask:0xf bank_mask:0xf bound_ctrl:0
    s_nop 1
    v_add_u32_dpp v19, v19, v19 row_shr:8 row_mask:0xf bank_mask:0xf bound_ctrl:0
    s_nop 0
    v_readlane_b32 s97, v19, 15
    s_nop 0
    s_cmp_lt_u32 s97, 256
    s_cbranch_scc1 L_vf_30
    v_cmp_eq_u32 vcc, -1, v16
    s_nop 0
    s_mov_b32 s98, vcc_lo
    v_cmp_eq_u32 vcc, 0x2000, v17
    s_nop 0
    s_and_b32 s98, s98, vcc_lo
    s_mov_b32 s97, -1
    s_cmp_eq_u32 s98, 0xff
    s_cbranch_scc1 L_vf_31
    v_readlane_b32 s97, v19, s87
    v_readlane_b32 s98, v17, s87
    v_readlane_b32 s99, v15, 0
    s_lshr_b32 s98, s98, 8
    s_lshr_b32 s99, s99, 8
    s_sub_u32 s97, s97, s98
    s_add_u32 s97, s97, s99
    v_readlane_b32 s98, v19, 0
    v_readlane_b32 s99, v19, 1
    s_xor_b32 s98, s98, 32
    s_xor_b32 s99, s99, 64
    s_or_b32 s98, s98, s99
    s_cmp_eq_u32 s98, 0
    s_cselect_b32 s98, 0x10000, 0
    s_or_b32 s97, s97, s98
L_vf_31:
    v_mov_b32 v16, 122880
    v_mov_b32 v17, s97
    ds_write_b32 v16, v17
    s_waitcnt lgkmcnt(0)
    s_mov_b64 exec, -1
L_vf_29:
    s_barrier
    v_mov_b32 v16, 122880
    ds_read_b32 v17, v16
    s_waitcnt lgkmcnt(0)
    v_readfirstlane_b32 s97, v17
    s_barrier
    s_mov_b32 s86, 1
    s_cmp_lg_u32 s97, -1
    s_cbranch_scc1 L_redo
L_vf_28:
    s_lshr_b32 s15, s86, 1
    s_lshl_b32 s15, s15, 2
    v_mov_b32 v12, s15
    s_mov_b32 s15, 1048576
L_par_32:
    global_load_dword v13, v12, s[8:9] offset:68 sc1
    s_sub_u32 s15, s15, 1
    s_cbranch_scc1 L_bail2
    s_waitcnt vmcnt(0)
    v_readfirstlane_b32 s5, v13
    s_nop 0
    s_cmp_eq_u32 s5, 0
    s_cbranch_scc1 L_par_32
    s_sub_u32 s5, s5, 1
    s_lshl_b32 s12, s4, 4
    v_add_u32 v12, s12, v2
    v_mul_u32_u24 v12, 2560, v12
    v_lshl_add_u32 v12, v3, 4, v12
    s_lshl_b32 s12, s42, 6
    s_add_u32 s12, s12, 1280
    v_add_u32 v9, s12, v12
    s_lshl_b32 s42, s4, 18
    v_add_u32 v11, 4096, v5
    s_lshl_b32 s12, s4, 12
    v_add_u32 v7, s12, v5
    v_add_u32 v8, s43, v5
L_o_top:
    s_add_u32 s12, s40, 128
    s_lshl_b32 s12, s12, 7
    s_add_u32 s44, s6, s12
    s_addc_u32 s45, s7, 0
    s_lshr_b32 s12, s40, 1
    s_xor_b32 s12, s12, s5
    s_and_b32 s12, s12, 1
    s_xor_b32 s12, s12, 1
    s_lshl_b32 s12, s12, 13
    s_lshl_b32 s13, s40, 20
    s_add_u32 s12, s12, s13
    s_add_u32 s12, s12, s42
    s_add_u32 s12, s12, 8388608
    s_add_u32 s54, s6, s12
    s_addc_u32 s55, s7, 0
    s_cmp_lg_u32 s4, 0
    s_cbranch_scc1 L_wf_33
    s_mov_b64 exec, 1
    v_mul_u32_u24 v12, 0, v1
    s_mov_b32 s15, 1048576
L_wf_34:
    global_load_dword v13, v12, s[44:45] sc1
    s_sub_u32 s15, s15, 1
    s_cbranch_scc1 L_bail10
    s_waitcnt vmcnt(0)
    v_cmp_gt_u32 vcc, 32, v13
    s_nop 0
    s_cbranch_vccnz L_wf_34
    s_mov_b64 exec, -1
L_wf_33:
    s_barrier
    global_load_dwordx4 v[32:35], v5, s[54:55] offset:0 sc1
    global_load_dwordx4 v[36:39], v11, s[54:55] offset:0 sc1
    global_load_dwordx4 v[40:43], v5, s[54:55] offset:1024 sc1
    global_load_dwordx4 v[44:47], v11, s[54:55] offset:1024 sc1
    global_load_dwordx4 v[48:51], v5, s[54:55] offset:2048 sc1
    global_load_dwordx4 v[52:55], v11, s[54:55] offset:2048 sc1
    global_load_dwordx4 v[56:59], v5, s[54:55] offset:3072 sc1
    global_load_dwordx4 v[60:63], v11, s[54:55] offset:3072 sc1
    s_add_u32 s54, s54, 0x8000
    s_addc_u32 s55, s55, 0
    global_load_dwordx4 v[64:67], v5, s[54:55] offset:0 sc1
    global_load_dwordx4 v[68:71], v11, s[54:55] offset:0 sc1
    global_load_dwordx4 v[72:75], v5, s[54:55] offset:1024 sc1
    global_load_dwordx4 v[76:79], v11, s[54:55] offset:1024 sc1
    global_load_dwordx4 v[80:83], v5, s[54:55] offset:2048 sc1
    global_load_dwordx4 v[84:87], v11, s[54:55] offset:2048 sc1
    global_load_dwordx4 v[88:91], v5, s[54:55] offset:3072 sc1
    global_load_dwordx4 v[92:95], v11, s[54:55] offset:3072 sc1
    s_add_u32 s54, s54, 0x8000
    s_addc_u32 s55, s55, 0
    global_load_dwordx4 v[96:99], v5, s[54:55] offset:0 sc1
    global_load_dwordx4 v[100:103], v11, s[54:55] offset:0 sc1
    global_load_dwordx4 v[104:107], v5, s[54:55] offset:1024 sc1
    global_load_dwordx4 v[108:111], v11, s[54:55] offset:1024 sc1
    global_load_dwordx4 v[112:115], v5, s[54:55] offset:2048 sc1
    global_load_dwordx4 v[116:119], v11, s[54:55] offset:2048 sc1
    global_load_dwordx4 v[120:123], v5, s[54:55] offset:3072 sc1
    global_load_dwordx4 v[124:127], v11, s[54:55] offset:3072 sc1
    s_add_u32 s54, s54, 0x8000
    s_addc_u32 s55, s55, 0
    global_load_dwordx4 v[128:131], v5, s[54:55] offset:0 sc1
    global_load_dwordx4 v[132:135], v11, s[54:55] offset:0 sc1
    global_load_dwordx4 v[136:139], v5, s[54:55] offset:1024 sc1
    global_load_dwordx4 v[140:143], v11, s[54:55] offset:1024 sc1
    global_load_dwordx4 v[144:147], v5, s[54:55] offset:2048 sc1
    global_load_dwordx4 v[148:151], v11, s[54:55] offset:2048 sc1
    global_load_dwordx4 v[152:155], v5, s[54:55] offset:3072 sc1
    global_load_dwordx4 v[156:159], v11, s[54:55] offset:3072 sc1
    s_add_u32 s54, s54, 0x8000
    s_addc_u32 s55, s55, 0
    global_load_dwordx4 v[160:163], v5, s[54:55] offset:0 sc1
    global_load_dwordx4 v[164:167], v11, s[54:55] offset:0 sc1
    global_load_dwordx4 v[168:171], v5, s[54:55] offset:1024 sc1
    global_load_dwordx4 v[172:175], v11, s[54:55] offset:1024 sc1
    global_load_dwordx4 v[176:179], v5, s[54:55] offset:2048 sc1
    global_load_dwordx4 v[180:183], v11, s[54:55] offset:2048 sc1
    global_load_dwordx4 v[184:187], v5, s[54:55] offset:3072 sc1
    global_load_dwordx4 v[188:191], v11, s[54:55] offset:3072 sc1
    s_add_u32 s54, s54, 0x8000
    s_addc_u32 s55, s55, 0
    global_load_dwordx4 v[192:195], v5, s[54:55] offset:0 sc1
    global_load_dwordx4 v[196:199], v11, s[54:55] offset:0 sc1
    global_load_dwordx4 v[200:203], v5, s[54:55] offset:1024 sc1
    global_load_dwordx4 v[204:207], v11, s[54:55] offset:1024 sc1
    global_load_dwordx4 v[208:211], v5, s[54:55] offset:2048 sc1
    global_load_dwordx4 v[212:215], v11, s[54:55] offset:2048 sc1
    global_load_dwordx4 v[216:219], v5, s[54:55] offset:3072 sc1
    global_load_dwordx4 v[220:223], v11, s[54:55] offset:3072 sc1
    s_waitcnt vmcnt(47)
    v_mfma_f32_16x16x32_bf16 v[16:19], a[0:3], v[32:35], 0
    v_mfma_f32_16x16x32_bf16 v[24:27], a[8:11], v[32:35], 0
    s_add_u32 s54, s54, 0x8000
    s_addc_u32 s55, s55, 0
    global_load_dwordx4 v[32:35], v5, s[54:55] offset:0 sc1
    s_waitcnt vmcnt(47)
    v_mfma_f32_16x16x32_bf16 v[20:23], a[0:3], v[36:39], 0
    v_mfma_f32_16x16x32_bf16 v[28:31], a[8:11], v[36:39], 0
    global_load_dwordx4 v[36:39], v11, s[54:55] offset:0 sc1
    s_waitcnt vmcnt(47)
    v_mfma_f32_16x16x32_bf16 v[16:19], a[4:7], v[40:43], v[16:19]
    v_mfma_f32_16x16x32_bf16 v[24:27], a[12:15], v[40:43], v[24:27]
    global_load_dwordx4 v[40:43], v5, s[54:55] offset:1024 sc1
    s_waitcnt vmcnt(47)
    v_mfma_f32_16x16x32_bf16 v[20:23], a[4:7], v[44:47], v[20:23]
    v_mfma_f32_16x16x32_bf16 v[28:31], a[12:15], v[44:47], v[28:31]
    global_load_dwordx4 v[44:47], v11, s[54:55] offset:1024 sc1
    s_waitcnt vmcnt(47)
    v_mfma_f32_16x16x32_bf16 v[16:19], a[16:19], v[48:51], v[16:19]
    v_mfma_f32_16x16x32_bf16 v[24:27], a[24:27], v[48:51], v[24:27]
    global_load_dwordx4 v[48:51], v5, s[54:55] offset:2048 sc1
    s_waitcnt vmcnt(47)
    v_mfma_f32_16x16x32_bf16 v[20:23], a[16:19], v[52:55], v[20:23]
    v_mfma_f32_16x16x32_bf16 v[28:31], a[24:27], v[52:55], v[28:31]
    global_load_dwordx4 v[52:55], v11, s[54:55] offset:2048 sc1
    s_waitcnt vmcnt(47)
    v_mfma_f32_16x16x32_bf16 v[16:19], a[20:23], v[56:59], v[16:19]
    v_mfma_f32_16x16x32_bf16 v[24:27], a[28:31], v[56:59], v[24:27]
    global_load_dwordx4 v[56:59], v5, s[54:55] offset:3072 sc1
    s_waitcnt vmcnt(47)
    v_mfma_f32_16x16x32_bf16 v[20:23], a[20:23], v[60:63], v[20:23]
    v_mfma_f32_16x16x32_bf16 v[28:31], a[28:31], v[60:63], v[28:31]
    global_load_dwordx4 v[60:63], v11, s[54:55] offset:3072 sc1
    s_waitcnt vmcnt(47)
    v_mfma_f32_16x16x32_bf16 v[16:19], a[32:35], v[64:67], v[16:19]
    v_mfma_f32_16x16x32_bf16 v[24:27], a[40:43], v[64:67], v[24:27]
    s_add_u32 s54, s54, 0x8000
    s_addc_u32 s55, s55, 0
    global_load_dwordx4 v[64:67], v5, s[54:55] offset:0 sc1
    s_waitcnt vmcnt(47)
    v_mfma_f32_16x16x32_bf16 v[20:23], a[32:35], v[68:71], v[20:23]
    v_mfma_f32_16x16x32_bf16 v[28:31], a[40:43], v[68:71], v[28:31]
    global_load_dwordx4 v[68:71], v11, s[54:55] offset:0 sc1
    s_waitcnt vmcnt(47)
    v_mfma_f32_16x16x32_bf16 v[16:19], a[36:39], v[72:75], v[16:19]
    v_mfma_f32_16x16x32_bf16 v[24:27], a[44:47], v[72:75], v[24:27]
    global_load_dwordx4 v[72:75], v5, s[54:55] offset:1024 sc1
    s_waitcnt vmcnt(47)
    v_mfma_f32_16x16x32_bf16 v[20:23], a[36:39], v[76:79], v[20:23]
    v_mfma_f32_16x16x32_bf16 v[28:31], a[44:47], v[76:79], v[28:31]
    global_load_dwordx4 v[76:79], v11, s[54:55] offset:1024 sc1
    s_waitcnt vmcnt(47)
    v_mfma_f32_16x16x32_bf16 v[16:19], a[48:51], v[80:83], v[16:19]
    v_mfma_f32_16x16x32_bf16 v[24:27], a[56:59], v[80:83], v[24:27]
    global_load_dwordx4 v[80:83], v5, s[54:55] offset:2048 sc1
    s_waitcnt vmcnt(47)
    v_mfma_f32_16x16x32_bf16 v[20:23], a[48:51], v[84:87], v[20:23]
    v_mfma_f32_16x16x32_bf16 v[28:31], a[56:59], v[84:87], v[28:31]
    global_load_dwordx4 v[84:87], v11, s[54:55] offset:2048 sc1
    s_waitcnt vmcnt(47)
    v_mfma_f32_16x16x32_bf16 v[16:19], a[52:55], v[88:91], v[16:19]
    v_mfma_f32_16x16x32_bf16 v[24:27], a[60:63], v[88:91], v[24:27]
    global_load_dwordx4 v[88:91], v5, s[54:55] offset:3072 sc1
    s_waitcnt vmcnt(47)
    v_mfma_f32_16x16x32_bf16 v[20:23], a[52:55], v[92:95], v[20:23]
    v_mfma_f32_16x16x32_bf16 v[28:31], a[60:63], v[92:95], v[28:31]
    global_load_dwordx4 v[92:95], v11, s[54:55] offset:3072 sc1
    s_waitcnt vmcnt(47)
    v_mfma_f32_16x16x32_bf16 v[16:19], a[64:67], v[96:99], v[16:19]
    v_mfma_f32_16x16x32_bf16 v[24:27], a[72:75], v[96:99], v[24:27]
    s_waitcnt vmcnt(46)
    v_mfma_f32_16x16x32_bf16 v[20:23], a[64:67], v[100:103], v[20:23]
    v_mfma_f32_16x16x32_bf16 v[28:31], a[72:75], v[100:103], v[28:31]
    s_waitcnt vmcnt(45)
    v_mfma_f32_16x16x32_bf16 v[16:19], a[68:71], v[104:107], v[16:19]
    v_mfma_f32_16x16x32_bf16 v[24:27], a[76:79], v[104:107], v[24:27]
    s_waitcnt vmcnt(44)
    v_mfma_f32_16x16x32_bf16 v[20:23], a[68:71], v[108:111], v[20:23]
    v_mfma_f32_16x16x32_bf16 v[28:31], a[76:79], v[108:111], v[28:31]
    s_waitcnt vmcnt(43)
    v_mfma_f32_16x16x32_bf16 v[16:19], a[80:83], v[112:115], v[16:19]
    v_mfma_f32_16x16x32_bf16 v[24:27], a[88:91], v[112:115], v[24:27]
    s_waitcnt vmcnt(42)
    v_mfma_f32_16x16x32_bf16 v[20:23], a[80:83], v[116:119], v[20:23]
    v_mfma_f32_16x16x32_bf16 v[28:31], a[88:91], v[116:119], v[28:31]
    s_waitcnt vmcnt(41)
    v_mfma_f32_16x16x32_bf16 v[16:19], a[84:87], v[120:123], v[16:19]
    v_mfma_f32_16x16x32_bf16 v[24:27], a[92:95], v[120:123], v[24:27]
    s_waitcnt vmcnt(40)
    v_mfma_f32_16x16x32_bf16 v[20:23], a[84:87], v[124:127], v[20:23]
    v_mfma_f32_16x16x32_bf16 v[28:31], a[92:95], v[124:127], v[28:31]
    s_waitcnt vmcnt(39)
    v_mfma_f32_16x16x32_bf16 v[16:19], a[96:99], v[128:131], v[16:19]
    v_mfma_f32_16x16x32_bf16 v[24:27], a[104:107], v[128:131], v[24:27]
    s_waitcnt vmcnt(38)
    v_mfma_f32_16x16x32_bf16 v[20:23], a[96:99], v[132:135], v[20:23]
    v_mfma_f32_16x16x32_bf16 v[28:31], a[104:107], v[132:135], v[28:31]
    s_waitcnt vmcnt(37)
    v_mfma_f32_16x16x32_bf16 v[16:19], a[100:103], v[136:139], v[16:19]
    v_mfma_f32_16x16x32_bf16 v[24:27], a[108:111], v[136:139], v[24:27]
    s_waitcnt vmcnt(36)
    v_mfma_f32_16x16x32_bf16 v[20:23], a[100:103], v[140:143], v[20:23]
    v_mfma_f32_16x16x32_bf16 v[28:31], a[108:111], v[140:143], v[28:31]
    s_waitcnt vmcnt(35)
    v_mfma_f32_16x16x32_bf16 v[16:19], a[112:115], v[144:147], v[16:19]
    v_mfma_f32_16x16x32_bf16 v[24:27], a[120:123], v[144:147], v[24:27]
    s_waitcnt vmcnt(34)
    v_mfma_f32_16x16x32_bf16 v[20:23], a[112:115], v[148:151], v[20:23]
    v_mfma_f32_16x16x32_bf16 v[28:31], a[120:123], v[148:151], v[28:31]
    s_waitcnt vmcnt(33)
    v_mfma_f32_16x16x32_bf16 v[16:19], a[116:119], v[152:155], v[16:19]
    v_mfma_f32_16x16x32_bf16 v[24:27], a[124:127], v[152:155], v[24:27]
    s_waitcnt vmcnt(32)
    v_mfma_f32_16x16x32_bf16 v[20:23], a[116:119], v[156:159], v[20:23]
    v_mfma_f32_16x16x32_bf16 v[28:31], a[124:127], v[156:159], v[28:31]
    s_waitcnt vmcnt(31)
    v_mfma_f32_16x16x32_bf16 v[16:19], a[128:131], v[160:163], v[16:19]
    v_mfma_f32_16x16x32_bf16 v[24:27], a[136:139], v[160:163], v[24:27]
    s_waitcnt vmcnt(30)
    v_mfma_f32_16x16x32_bf16 v[20:23], a[128:131], v[164:167], v[20:23]
    v_mfma_f32_16x16x32_bf16 v[28:31], a[136:139], v[164:167], v[28:31]
    s_waitcnt vmcnt(29)
    v_mfma_f32_16x16x32_bf16 v[16:19], a[132:135], v[168:171], v[16:19]
    v_mfma_f32_16x16x32_bf16 v[24:27], a[140:143], v[168:171], v[24:27]
    s_waitcnt vmcnt(28)
    v_mfma_f32_16x16x32_bf16 v[20:23], a[132:135], v[172:175], v[20:23]
    v_mfma_f32_16x16x32_bf16 v[28:31], a[140:143], v[172:175], v[28:31]
    s_waitcnt vmcnt(27)
    v_mfma_f32_16x16x32_bf16 v[16:19], a[144:147], v[176:179], v[16:19]
    v_mfma_f32_16x16x32_bf16 v[24:27], a[152:155], v[176:179], v[24:27]
    s_waitcnt vmcnt(26)
    v_mfma_f32_16x16x32_bf16 v[20:23], a[144:147], v[180:183], v[20:23]
    v_mfma_f32_16x16x32_bf16 v[28:31], a[152:155], v[180:183], v[28:31]
    s_waitcnt vmcnt(25)
    v_mfma_f32_16x16x32_bf16 v[16:19], a[148:151], v[184:187], v[16:19]
    v_mfma_f32_16x16x32_bf16 v[24:27], a[156:159], v[184:187], v[24:27]
    s_waitcnt vmcnt(24)
    v_mfma_f32_16x16x32_bf16 v[20:23], a[148:151], v[188:191], v[20:23]
    v_mfma_f32_16x16x32_bf16 v[28:31], a[156:159], v[188:191], v[28:31]
    s_waitcnt vmcnt(23)
    v_mfma_f32_16x16x32_bf16 v[16:19], a[160:163], v[192:195], v[16:19]
    v_mfma_f32_16x16x32_bf16 v[24:27], a[168:171], v[192:195], v[24:27]
    s_waitcnt vmcnt(22)
    v_mfma_f32_16x16x32_bf16 v[20:23], a[160:163], v[196:199], v[20:23]
    v_mfma_f32_16x16x32_bf16 v[28:31], a[168:171], v[196:199], v[28:31]
    s_waitcnt vmcnt(21)
    v_mfma_f32_16x16x32_bf16 v[16:19], a[164:167], v[200:203], v[16:19]
    v_mfma_f32_16x16x32_bf16 v[24:27], a[172:175], v[200:203], v[24:27]
    s_waitcnt vmcnt(20)
    v_mfma_f32_16x16x32_bf16 v[20:23], a[164:167], v[204:207], v[20:23]
    v_mfma_f32_16x16x32_bf16 v[28:31], a[172:175], v[204:207], v[28:31]
    s_waitcnt vmcnt(19)
    v_mfma_f32_16x16x32_bf16 v[16:19], a[176:179], v[208:211], v[16:19]
    v_mfma_f32_16x16x32_bf16 v[24:27], a[184:187], v[208:211], v[24:27]
    s_waitcnt vmcnt(18)
    v_mfma_f32_16x16x32_bf16 v[20:23], a[176:179], v[212:215], v[20:23]
    v_mfma_f32_16x16x32_bf16 v[28:31], a[184:187], v[212:215], v[28:31]
    s_waitcnt vmcnt(17)
    v_mfma_f32_16x16x32_bf16 v[16:19], a[180:183], v[216:219], v[16:19]
    v_mfma_f32_16x16x32_bf16 v[24:27], a[188:191], v[216:219], v[24:27]
    s_waitcnt vmcnt(16)
    v_mfma_f32_16x16x32_bf16 v[20:23], a[180:183], v[220:223], v[20:23]
    v_mfma_f32_16x16x32_bf16 v[28:31], a[188:191], v[220:223], v[28:31]
    s_waitcnt vmcnt(15)
    v_mfma_f32_16x16x32_bf16 v[16:19], a[192:195], v[32:35], v[16:19]
    v_mfma_f32_16x16x32_bf16 v[24:27], a[200:203], v[32:35], v[24:27]
    s_waitcnt vmcnt(14)
    v_mfma_f32_16x16x32_bf16 v[20:23], a[192:195], v[36:39], v[20:23]
    v_mfma_f32_16x16x32_bf16 v[28:31], a[200:203], v[36:39], v[28:31]
    s_waitcnt vmcnt(13)
    v_mfma_f32_16x16x32_bf16 v[16:19], a[196:199], v[40:43], v[16:19]
    v_mfma_f32_16x16x32_bf16 v[24:27], a[204:207], v[40:43], v[24:27]
    s_waitcnt vmcnt(12)
    v_mfma_f32_16x16x32_bf16 v[20:23], a[196:199], v[44:47], v[20:23]
    v_mfma_f32_16x16x32_bf16 v[28:31], a[204:207], v[44:47], v[28:31]
    s_waitcnt vmcnt(11)
    v_mfma_f32_16x16x32_bf16 v[16:19], a[208:211], v[48:51], v[16:19]
    v_mfma_f32_16x16x32_bf16 v[24:27], a[216:219], v[48:51], v[24:27]
    s_waitcnt vmcnt(10)
    v_mfma_f32_16x16x32_bf16 v[20:23], a[208:211], v[52:55], v[20:23]
    v_mfma_f32_16x16x32_bf16 v[28:31], a[216:219], v[52:55], v[28:31]
    s_waitcnt vmcnt(9)
    v_mfma_f32_16x16x32_bf16 v[16:19], a[212:215], v[56:59], v[16:19]
    v_mfma_f32_16x16x32_bf16 v[24:27], a[220:223], v[56:59], v[24:27]
    s_waitcnt vmcnt(8)
    v_mfma_f32_16x16x32_bf16 v[20:23], a[212:215], v[60:63], v[20:23]
    v_mfma_f32_16x16x32_bf16 v[28:31], a[220:223], v[60:63], v[28:31]
    s_waitcnt vmcnt(7)
    v_mfma_f32_16x16x32_bf16 v[16:19], a[224:227], v[64:67], v[16:19]
    v_mfma_f32_16x16x32_bf16 v[24:27], a[232:235], v[64:67], v[24:27]
    s_waitcnt vmcnt(6)
    v_mfma_f32_16x16x32_bf16 v[20:23], a[224:227], v[68:71], v[20:23]
    v_mfma_f32_16x16x32_bf16 v[28:31], a[232:235], v[68:71], v[28:31]
    s_waitcnt vmcnt(5)
    v_mfma_f32_16x16x32_bf16 v[16:19], a[228:231], v[72:75], v[16:19]
    v_mfma_f32_16x16x32_bf16 v[24:27], a[236:239], v[72:75], v[24:27]
    s_waitcnt vmcnt(4)
    v_mfma_f32_16x16x32_bf16 v[20:23], a[228:231], v[76:79], v[20:23]
    v_mfma_f32_16x16x32_bf16 v[28:31], a[236:239], v[76:79], v[28:31]
    s_waitcnt vmcnt(3)
    v_mfma_f32_16x16x32_bf16 v[16:19], a[240:243], v[80:83], v[16:19]
    v_mfma_f32_16x16x32_bf16 v[24:27], a[248:251], v[80:83], v[24:27]
    s_waitcnt vmcnt(2)
    v_mfma_f32_16x16x32_bf16 v[20:23], a[240:243], v[84:87], v[20:23]
    v_mfma_f32_16x16x32_bf16 v[28:31], a[248:251], v[84:87], v[28:31]
    s_waitcnt vmcnt(1)
    v_mfma_f32_16x16x32_bf16 v[16:19], a[244:247], v[88:91], v[16:19]
    v_mfma_f32_16x16x32_bf16 v[24:27], a[252:255], v[88:91], v[24:27]
    s_waitcnt vmcnt(0)
    v_mfma_f32_16x16x32_bf16 v[20:23], a[244:247], v[92:95], v[20:23]
    v_mfma_f32_16x16x32_bf16 v[28:31], a[252:255], v[92:95], v[28:31]
    s_nop 3
    ds_write_b128 v7, v[16:19] offset:0
    s_nop 1
    ds_write_b128 v7, v[20:23] offset:1024
    ds_write_b128 v7, v[24:27] offset:2048
    ds_write_b128 v7, v[28:31] offset:3072
    s_mul_i32 s12, s40, 81920
    s_add_u32 s38, s36, s12
    s_addc_u32 s39, s37, 0
    s_waitcnt lgkmcnt(0)
    s_barrier
    s_cmp_ge_u32 s4, 2
    s_cbranch_scc1 L_of_35
    ds_read_b128 v[32:35], v8 offset:0
    ds_read_b128 v[36:39], v8 offset:2048
    ds_read_b128 v[40:43], v8 offset:4096
    ds_read_b128 v[44:47], v8 offset:6144
    ds_read_b128 v[48:51], v8 offset:8192
    ds_read_b128 v[52:55], v8 offset:10240
    ds_read_b128 v[56:59], v8 offset:12288
    ds_read_b128 v[60:63], v8 offset:14336
    s_waitcnt lgkmcnt(0)
    v_pk_add_f32 v[32:33], v[32:33], v[40:41]
    v_pk_add_f32 v[48:49], v[48:49], v[56:57]
    v_pk_add_f32 v[32:33], v[32:33], v[48:49]
    v_pk_add_f32 v[34:35], v[34:35], v[42:43]
    v_pk_add_f32 v[50:51], v[50:51], v[58:59]
    v_pk_add_f32 v[34:35], v[34:35], v[50:51]
    v_pk_add_f32 v[36:37], v[36:37], v[44:45]
    v_pk_add_f32 v[52:53], v[52:53], v[60:61]
    v_pk_add_f32 v[36:37], v[36:37], v[52:53]
    v_pk_add_f32 v[38:39], v[38:39], v[46:47]
    v_pk_add_f32 v[54:55], v[54:55], v[62:63]
    v_pk_add_f32 v[38:39], v[38:39], v[54:55]
    v_cvt_pk_bf16_f32 v56, v32, v36
    v_cvt_pk_bf16_f32 v57, v33, v37
    v_cvt_pk_bf16_f32 v58, v34, v38
    v_cvt_pk_bf16_f32 v59, v35, v39
    global_store_dwordx4 v9, v[56:59], s[38:39]
L_of_35:
    s_add_u32 s40, s40, 2
    s_cmp_lt_u32 s40, 64
    s_cbranch_scc1 L_o_top
    s_waitcnt vmcnt(0)
    s_branch L_done
L_queue:
    s_barrier
    s_cmp_lg_u32 s4, 0
    s_cbranch_scc1 L_qq_36
    s_mov_b64 exec, 1
    v_mov_b32 v12, 76
    v_mov_b32 v13, 1
    global_atomic_add v13, v12, v13, s[8:9] sc0
    v_mov_b32 v12, 122880
    s_waitcnt vmcnt(0)
    ds_write_b32 v12, v13
    s_waitcnt lgkmcnt(0)
    s_mov_b64 exec, -1
L_qq_36:
    s_barrier
    v_mov_b32 v12, 122880
    ds_read_b32 v13, v12
    s_waitcnt lgkmcnt(0)
    v_readfirstlane_b32 s49, v13
    s_nop 0
    s_cmp_lt_u32 s49, 8
    s_cbranch_scc1 L_t_kv
    s_cmp_lt_u32 s49, 48
    s_cbranch_scc1 L_t_q
    s_cmp_lt_u32 s49, 176
    s_cbranch_scc1 L_att
    s_cmp_ge_u32 s49, 216
    s_cbranch_scc1 L_done
    s_sub_u32 s12, s49, 176
    s_mul_i32 s49, s12, 52
    s_lshr_b32 s49, s49, 8
    s_mul_i32 s13, s49, 5
    s_sub_u32 s42, s12, s13
    s_load_dwordx2 s[52:53], s[0:1], 32
    s_load_dwordx2 s[54:55], s[0:1], 96
    s_add_u32 s36, s6, 5242880
    s_addc_u32 s37, s7, 0
    s_mov_b32 s11, 4
    s_branch L_t_w
L_t_q:
    s_sub_u32 s12, s49, 8
    s_mul_i32 s49, s12, 52
    s_lshr_b32 s49, s49, 8
    s_mul_i32 s13, s49, 5
    s_sub_u32 s42, s12, s13
    s_load_dwordx2 s[52:53], s[0:1], 8
    s_load_dwordx2 s[36:37], s[0:1], 0
    s_mov_b32 s11, 3
L_t_w:
    s_lshl_b32 s13, s42, 8
    s_mov_b32 s14, 1280
    s_waitcnt lgkmcnt(0)
    s_add_u32 s16, s52, s13
    s_addc_u32 s17, s53, 0
    s_and_b32 s17, s17, 0xffff
    s_sub_u32 s18, 819200, s13
    s_mov_b32 s19, 0x20000
    s_lshl_b32 s40, s49, 3
    s_add_u32 s41, s40, 8
    s_mul_i32 s12, s40, 40960
    s_add_u32 s36, s36, s12
    s_addc_u32 s37, s37, 0
    s_lshl_b32 s12, s4, 6
    v_lshl_add_u32 v10, v2, 2, s12
    s_branch L_gload
L_t_kv:
    s_load_dwordx4 s[52:55], s[0:1], 16
    s_load_dwordx2 s[36:37], s[0:1], 0
    s_mov_b32 s11, 5
    s_mov_b32 s13, 0
    s_mov_b32 s14, 40
    s_waitcnt lgkmcnt(0)
    s_bitcmp1_b32 s4, 0
    s_cselect_b32 s52, s54, s52
    s_cselect_b32 s53, s55, s53
    s_add_u32 s16, s52, s13
    s_addc_u32 s17, s53, 0
    s_and_b32 s17, s17, 0xffff
    s_sub_u32 s18, 25600, s13
    s_mov_b32 s19, 0x20000
    s_lshl_b32 s40, s49, 3
    s_add_u32 s41, s40, 8
    s_mul_i32 s12, s40, 40960
    s_add_u32 s36, s36, s12
    s_addc_u32 s37, s37, 0
    v_lshlrev_b32 v10, 2, v2
    v_mov_b32 v12, 0x100000
    v_cmp_gt_u32 vcc, 10, v2
    s_nop 1
    v_cndmask_b32 v10, v12, v10, vcc
    s_branch L_gload
L_aq:
    s_lshl_b32 s12, s42, 8
    s_lshl_b32 s13, s4, 6
    s_add_u32 s12, s12, s13
    v_mul_u32_u24 v12, 1280, v2
    v_lshl_add_u32 v12, v3, 4, v12
    v_add_u32 v9, s12, v12
    v_add_u32 v11, 20480, v9
    s_mov_b32 s50, 0x3ea52b5c
    s_mov_b32 s51, 0x3ea52b5c
    s_add_u32 s54, s6, 2097152
    s_addc_u32 s55, s7, 0
L_aq_g:
    s_mov_b32 s46, 0
    s_mov_b32 s58, 0
    s_add_u32 m0, s46, s43
    s_nop 0
    global_load_lds_dwordx4 v6, s[36:37] offset:0
    s_add_u32 m0, m0, 3968
    s_nop 0
    global_load_lds_dwordx4 v6, s[36:37] offset:128
    s_add_u32 m0, m0, 3968
    s_nop 0
    global_load_lds_dwordx4 v6, s[36:37] offset:256
    s_add_u32 m0, m0, 3968
    s_nop 0
    global_load_lds_dwordx4 v6, s[36:37] offset:384
    s_add_u32 m0, m0, 3968
    s_nop 0
    global_load_lds_dwordx4 v6, s[36:37] offset:512
    s_add_u32 m0, m0, 3968
    s_nop 0
    global_load_lds_dwordx4 v6, s[36:37] offset:640
    s_add_u32 m0, m0, 3968
    s_nop 0
    global_load_lds_dwordx4 v6, s[36:37] offset:768
    s_add_u32 m0, m0, 3968
    s_nop 0
    global_load_lds_dwordx4 v6, s[36:37] offset:896
    s_add_u32 m0, m0, 3968
    s_nop 0
    global_load_lds_dwordx4 v6, s[36:37] offset:1024
    s_add_u32 m0, m0, 3968
    s_nop 0
    global_load_lds_dwordx4 v6, s[36:37] offset:1152
    s_add_u32 s36, s36, 40960
    s_addc_u32 s37, s37, 0
    s_mov_b32 s46, 40960
    s_add_u32 m0, s46, s43
    s_nop 0
    global_load_lds_dwordx4 v6, s[36:37] offset:0
    s_add_u32 m0, m0, 3968
    s_nop 0
    global_load_lds_dwordx4 v6, s[36:37] offset:128
    s_add_u32 m0, m0, 3968
    s_nop 0
    global_load_lds_dwordx4 v6, s[36:37] offset:256
    s_add_u32 m0, m0, 3968
    s_nop 0
    global_load_lds_dwordx4 v6, s[36:37] offset:384
    s_add_u32 m0, m0, 3968
    s_nop 0
    global_load_lds_dwordx4 v6, s[36:37] offset:512
    s_add_u32 m0, m0, 3968
    s_nop 0
    global_load_lds_dwordx4 v6, s[36:37] offset:640
    s_add_u32 m0, m0, 3968
    s_nop 0
    global_load_lds_dwordx4 v6, s[36:37] offset:768
    s_add_u32 m0, m0, 3968
    s_nop 0
    global_load_lds_dwordx4 v6, s[36:37] offset:896
    s_add_u32 m0, m0, 3968
    s_nop 0
    global_load_lds_dwordx4 v6, s[36:37] offset:1024
    s_add_u32 m0, m0, 3968
    s_nop 0
    global_load_lds_dwordx4 v6, s[36:37] offset:1152
    s_add_u32 s36, s36, 40960
    s_addc_u32 s37, s37, 0
    s_waitcnt vmcnt(10)
L_aq_g_top:
    s_waitcnt vmcnt(14)
    s_barrier
    s_add_u32 s46, s46, 40960
    s_cmp_eq_u32 s46, 122880
    s_cselect_b32 s46, 0, s46
    s_add_u32 s12, s40, 2
    s_cmp_lt_u32 s12, s41
    s_cselect_b32 s12, 0, 40960
    s_sub_u32 s36, s36, s12
    s_subb_u32 s37, s37, 0
    ds_read_b128 v[32:35], v7 offset:0
    ds_read_b128 v[36:39], v7 offset:2048
    ds_read_b128 v[40:43], v8 offset:0
    ds_read_b128 v[44:47], v8 offset:2048
    ds_read_b128 v[48:51], v7 offset:4096
    s_waitcnt lgkmcnt(4)
    v_mfma_f32_16x16x32_bf16 v[16:19], v[96:99], v[32:35], 0
    ds_read_b128 v[52:55], v7 offset:6144
    v_mfma_f32_16x16x32_bf16 v[24:27], v[104:107], v[32:35], 0
    s_add_u32 m0, s46, s43
    s_waitcnt lgkmcnt(4)
    v_mfma_f32_16x16x32_bf16 v[20:23], v[96:99], v[36:39], 0
    ds_read_b128 v[32:35], v8 offset:4096
    v_mfma_f32_16x16x32_bf16 v[28:31], v[104:107], v[36:39], 0
    global_load_lds_dwordx4 v6, s[36:37] offset:0
    s_waitcnt lgkmcnt(4)
    v_mfma_f32_16x16x32_bf16 v[16:19], v[100:103], v[40:43], v[16:19]
    ds_read_b128 v[36:39], v8 offset:6144
    v_mfma_f32_16x16x32_bf16 v[24:27], v[108:111], v[40:43], v[24:27]
    s_add_u32 m0, m0, 3968
    s_waitcnt lgkmcnt(4)
    v_mfma_f32_16x16x32_bf16 v[20:23], v[100:103], v[44:47], v[20:23]
    ds_read_b128 v[40:43], v7 offset:8192
    v_mfma_f32_16x16x32_bf16 v[28:31], v[108:111], v[44:47], v[28:31]
    global_load_lds_dwordx4 v6, s[36:37] offset:128
    s_waitcnt lgkmcnt(4)
    v_mfma_f32_16x16x32_bf16 v[16:19], v[112:115], v[48:51], v[16:19]
    ds_read_b128 v[44:47], v7 offset:10240
    v_mfma_f32_16x16x32_bf16 v[24:27], v[120:123], v[48:51], v[24:27]
    s_add_u32 m0, m0, 3968
    s_waitcnt lgkmcnt(4)
    v_mfma_f32_16x16x32_bf16 v[20:23], v[112:115], v[52:55], v[20:23]
    ds_read_b128 v[48:51], v8 offset:8192
    v_mfma_f32_16x16x32_bf16 v[28:31], v[120:123], v[52:55], v[28:31]
    global_load_lds_dwordx4 v6, s[36:37] offset:256
    s_waitcnt lgkmcnt(4)
    v_mfma_f32_16x16x32_bf16 v[16:19], v[116:119], v[32:35], v[16:19]
    ds_read_b128 v[52:55], v8 offset:10240
    v_mfma_f32_16x16x32_bf16 v[24:27], v[124:127], v[32:35], v[24:27]
    s_add_u32 m0, m0, 3968
    s_waitcnt lgkmcnt(4)
    v_mfma_f32_16x16x32_bf16 v[20:23], v[116:119], v[36:39], v[20:23]
    ds_read_b128 v[32:35], v7 offset:12288
    v_mfma_f32_16x16x32_bf16 v[28:31], v[124:127], v[36:39], v[28:31]
    global_load_lds_dwordx4 v6, s[36:37] offset:384
    s_waitcnt lgkmcnt(4)
    v_mfma_f32_16x16x32_bf16 v[16:19], v[128:131], v[40:43], v[16:19]
    ds_read_b128 v[36:39], v7 offset:14336
    v_mfma_f32_16x16x32_bf16 v[24:27], v[136:139], v[40:43], v[24:27]
    s_add_u32 m0, m0, 3968
    s_waitcnt lgkmcnt(4)
    v_mfma_f32_16x16x32_bf16 v[20:23], v[128:131], v[44:47], v[20:23]
    ds_read_b128 v[40:43], v8 offset:12288
    v_mfma_f32_16x16x32_bf16 v[28:31], v[136:139], v[44:47], v[28:31]
    global_load_lds_dwordx4 v6, s[36:37] offset:512
    s_waitcnt lgkmcnt(4)
    v_mfma_f32_16x16x32_bf16 v[16:19], v[132:135], v[48:51], v[16:19]
    ds_read_b128 v[44:47], v8 offset:14336
    v_mfma_f32_16x16x32_bf16 v[24:27], v[140:143], v[48:51], v[24:27]
    s_add_u32 m0, m0, 3968
    s_waitcnt lgkmcnt(4)
    v_mfma_f32_16x16x32_bf16 v[20:23], v[132:135], v[52:55], v[20:23]
    ds_read_b128 v[48:51], v7 offset:16384
    v_mfma_f32_16x16x32_bf16 v[28:31], v[140:143], v[52:55], v[28:31]
    global_load_lds_dwordx4 v6, s[36:37] offset:640
    s_waitcnt lgkmcnt(4)
    v_mfma_f32_16x16x32_bf16 v[16:19], v[144:147], v[32:35], v[16:19]
    ds_read_b128 v[52:55], v7 offset:18432
    v_mfma_f32_16x16x32_bf16 v[24:27], v[152:155], v[32:35], v[24:27]
    s_add_u32 m0, m0, 3968
    s_waitcnt lgkmcnt(4)
    v_mfma_f32_16x16x32_bf16 v[20:23], v[144:147], v[36:39], v[20:23]
    ds_read_b128 v[32:35], v8 offset:16384
    v_mfma_f32_16x16x32_bf16 v[28:31], v[152:155], v[36:39], v[28:31]
    global_load_lds_dwordx4 v6, s[36:37] offset:768
    s_waitcnt lgkmcnt(4)
    v_mfma_f32_16x16x32_bf16 v[16:19], v[148:151], v[40:43], v[16:19]
    ds_read_b128 v[36:39], v8 offset:18432
    v_mfma_f32_16x16x32_bf16 v[24:27], v[156:159], v[40:43], v[24:27]
    s_add_u32 m0, m0, 3968
    s_waitcnt lgkmcnt(4)
    v_mfma_f32_16x16x32_bf16 v[20:23], v[148:151], v[44:47], v[20:23]
    ds_read_b128 v[40:43], v7 offset:20480
    v_mfma_f32_16x16x32_bf16 v[28:31], v[156:159], v[44:47], v[28:31]
    global_load_lds_dwordx4 v6, s[36:37] offset:896
    s_waitcnt lgkmcnt(4)
    v_mfma_f32_16x16x32_bf16 v[16:19], v[160:163], v[48:51], v[16:19]
    ds_read_b128 v[44:47], v7 offset:22528
    v_mfma_f32_16x16x32_bf16 v[24:27], v[168:171], v[48:51], v[24:27]
    s_add_u32 m0, m0, 3968
    s_waitcnt lgkmcnt(4)
    v_mfma_f32_16x16x32_bf16 v[20:23], v[160:163], v[52:55], v[20:23]
    ds_read_b128 v[48:51], v8 offset:20480
    v_mfma_f32_16x16x32_bf16 v[28:31], v[168:171], v[52:55], v[28:31]
    global_load_lds_dwordx4 v6, s[36:37] offset:1024
    s_waitcnt lgkmcnt(4)
    v_mfma_f32_16x16x32_bf16 v[16:19], v[164:167], v[32:35], v[16:19]
    ds_read_b128 v[52:55], v8 offset:22528
    v_mfma_f32_16x16x32_bf16 v[24:27], v[172:175], v[32:35], v[24:27]
    s_add_u32 m0, m0, 3968
    s_waitcnt lgkmcnt(4)
    v_mfma_f32_16x16x32_bf16 v[20:23], v[164:167], v[36:39], v[20:23]
    ds_read_b128 v[32:35], v7 offset:24576
    v_mfma_f32_16x16x32_bf16 v[28:31], v[172:175], v[36:39], v[28:31]
    global_load_lds_dwordx4 v6, s[36:37] offset:1152
    s_waitcnt lgkmcnt(4)
    v_mfma_f32_16x16x32_bf16 v[16:19], v[176:179], v[40:43], v[16:19]
    ds_read_b128 v[36:39], v7 offset:26624
    v_mfma_f32_16x16x32_bf16 v[24:27], v[184:187], v[40:43], v[24:27]
    s_add_u32 s36, s36, 40960
    s_addc_u32 s37, s37, 0
    s_waitcnt lgkmcnt(4)
    v_mfma_f32_16x16x32_bf16 v[20:23], v[176:179], v[44:47], v[20:23]
    ds_read_b128 v[40:43], v8 offset:24576
    v_mfma_f32_16x16x32_bf16 v[28:31], v[184:187], v[44:47], v[28:31]
    s_waitcnt lgkmcnt(4)
    v_mfma_f32_16x16x32_bf16 v[16:19], v[180:183], v[48:51], v[16:19]
    ds_read_b128 v[44:47], v8 offset:26624
    v_mfma_f32_16x16x32_bf16 v[24:27], v[188:191], v[48:51], v[24:27]
    s_waitcnt lgkmcnt(4)
    v_mfma_f32_16x16x32_bf16 v[20:23], v[180:183], v[52:55], v[20:23]
    ds_read_b128 v[48:51], v7 offset:28672
    v_mfma_f32_16x16x32_bf16 v[28:31], v[188:191], v[52:55], v[28:31]
    s_waitcnt lgkmcnt(4)
    v_mfma_f32_16x16x32_bf16 v[16:19], v[192:195], v[32:35], v[16:19]
    ds_read_b128 v[52:55], v7 offset:30720
    v_mfma_f32_16x16x32_bf16 v[24:27], v[200:203], v[32:35], v[24:27]
    s_waitcnt lgkmcnt(4)
    v_mfma_f32_16x16x32_bf16 v[20:23], v[192:195], v[36:39], v[20:23]
    ds_read_b128 v[32:35], v8 offset:28672
    v_mfma_f32_16x16x32_bf16 v[28:31], v[200:203], v[36:39], v[28:31]
    s_waitcnt lgkmcnt(4)
    v_mfma_f32_16x16x32_bf16 v[16:19], v[196:199], v[40:43], v[16:19]
    ds_read_b128 v[36:39], v8 offset:30720
    v_mfma_f32_16x16x32_bf16 v[24:27], v[204:207], v[40:43], v[24:27]
    s_waitcnt lgkmcnt(4)
    v_mfma_f32_16x16x32_bf16 v[20:23], v[196:199], v[44:47], v[20:23]
    ds_read_b128 v[40:43], v7 offset:32768
    v_mfma_f32_16x16x32_bf16 v[28:31], v[204:207], v[44:47], v[28:31]
    s_waitcnt lgkmcnt(4)
    v_mfma_f32_16x16x32_bf16 v[16:19], v[208:211], v[48:51], v[16:19]
    ds_read_b128 v[44:47], v7 offset:34816
    v_mfma_f32_16x16x32_bf16 v[24:27], v[216:219], v[48:51], v[24:27]
    s_waitcnt lgkmcnt(4)
    v_mfma_f32_16x16x32_bf16 v[20:23], v[208:211], v[52:55], v[20:23]
    ds_read_b128 v[48:51], v8 offset:32768
    v_mfma_f32_16x16x32_bf16 v[28:31], v[216:219], v[52:55], v[28:31]
    s_waitcnt lgkmcnt(4)
    v_mfma_f32_16x16x32_bf16 v[16:19], v[212:215], v[32:35], v[16:19]
    ds_read_b128 v[52:55], v8 offset:34816
    v_mfma_f32_16x16x32_bf16 v[24:27], v[220:223], v[32:35], v[24:27]
    s_waitcnt lgkmcnt(4)
    v_mfma_f32_16x16x32_bf16 v[20:23], v[212:215], v[36:39], v[20:23]
    ds_read_b128 v[32:35], v7 offset:36864
    v_mfma_f32_16x16x32_bf16 v[28:31], v[220:223], v[36:39], v[28:31]
    s_waitcnt lgkmcnt(4)
    v_mfma_f32_16x16x32_bf16 v[16:19], v[224:227], v[40:43], v[16:19]
    ds_read_b128 v[36:39], v7 offset:38912
    v_mfma_f32_16x16x32_bf16 v[24:27], v[232:235], v[40:43], v[24:27]
    s_waitcnt lgkmcnt(4)
    v_mfma_f32_16x16x32_bf16 v[20:23], v[224:227], v[44:47], v[20:23]
    ds_read_b128 v[40:43], v8 offset:36864
    v_mfma_f32_16x16x32_bf16 v[28:31], v[232:235], v[44:47], v[28:31]
    s_waitcnt lgkmcnt(4)
    v_mfma_f32_16x16x32_bf16 v[16:19], v[228:231], v[48:51], v[16:19]
    ds_read_b128 v[44:47], v8 offset:38912
    v_mfma_f32_16x16x32_bf16 v[24:27], v[236:239], v[48:51], v[24:27]
    s_waitcnt lgkmcnt(4)
    v_mfma_f32_16x16x32_bf16 v[20:23], v[228:231], v[52:55], v[20:23]
    v_mfma_f32_16x16x32_bf16 v[28:31], v[236:239], v[52:55], v[28:31]
    s_waitcnt lgkmcnt(3)
    v_mfma_f32_16x16x32_bf16 v[16:19], v[240:243], v[32:35], v[16:19]
    v_mfma_f32_16x16x32_bf16 v[24:27], v[248:251], v[32:35], v[24:27]
    s_waitcnt lgkmcnt(2)
    v_mfma_f32_16x16x32_bf16 v[20:23], v[240:243], v[36:39], v[20:23]
    v_mfma_f32_16x16x32_bf16 v[28:31], v[248:251], v[36:39], v[28:31]
    s_waitcnt lgkmcnt(1)
    v_mfma_f32_16x16x32_bf16 v[16:19], v[244:247], v[40:43], v[16:19]
    v_mfma_f32_16x16x32_bf16 v[24:27], v[252:255], v[40:43], v[24:27]
    s_waitcnt lgkmcnt(0)
    v_mfma_f32_16x16x32_bf16 v[20:23], v[244:247], v[44:47], v[20:23]
    v_mfma_f32_16x16x32_bf16 v[28:31], v[252:255], v[44:47], v[28:31]
    s_mul_i32 s12, s40, 40960
    s_add_u32 s38, s54, s12
    s_addc_u32 s39, s55, 0
    s_nop 0
    v_pk_mul_f32 v[16:17], v[16:17], s[50:51]
    v_pk_mul_f32 v[24:25], v[24:25], s[50:51]
    v_pk_mul_f32 v[18:19], v[18:19], s[50:51]
    v_pk_mul_f32 v[26:27], v[26:27], s[50:51]
    v_cvt_pk_bf16_f32 v56, v16, v24
    v_cvt_pk_bf16_f32 v57, v17, v25
    v_cvt_pk_bf16_f32 v58, v18, v26
    v_cvt_pk_bf16_f32 v59, v19, v27
    global_store_dwordx4 v9, v[56:59], s[38:39] sc1
    v_pk_mul_f32 v[20:21], v[20:21], s[50:51]
    v_pk_mul_f32 v[28:29], v[28:29], s[50:51]
    v_pk_mul_f32 v[22:23], v[22:23], s[50:51]
    v_pk_mul_f32 v[30:31], v[30:31], s[50:51]
    v_cvt_pk_bf16_f32 v60, v20, v28
    v_cvt_pk_bf16_f32 v61, v21, v29
    v_cvt_pk_bf16_f32 v62, v22, v30
    v_cvt_pk_bf16_f32 v63, v23, v31
    global_store_dwordx4 v11, v[60:63], s[38:39] sc1
    s_cmp_eq_u32 s58, 81920
    s_cselect_b32 s12, 122880, 0
    s_sub_u32 s12, 40960, s12
    s_add_u32 s58, s58, s12
    v_add_u32 v7, s12, v7
    v_add_u32 v8, s12, v8
    s_add_u32 s40, s40, 1
    s_cmp_lt_u32 s40, s41
    s_cbranch_scc1 L_aq_g_top
    s_waitcnt vmcnt(0)
    s_barrier
    v_subrev_u32 v7, s58, v7
    v_subrev_u32 v8, s58, v8
    s_add_u32 s12, s49, 192
    s_lshl_b32 s12, s12, 7
    s_add_u32 s44, s6, s12
    s_addc_u32 s45, s7, 0
    s_cmp_lg_u32 s4, 0
    s_cbranch_scc1 L_sg_37
    s_mov_b64 exec, 1
    v_mov_b32 v12, 0
    v_mov_b32 v13, 1
    global_atomic_add v12, v13, s[44:45]
    s_mov_b64 exec, -1
L_sg_37:
    s_branch L_queue
L_ao:
    s_lshl_b32 s12, s42, 8
    s_lshl_b32 s13, s4, 6
    s_add_u32 s12, s12, s13
    v_mul_u32_u24 v12, 2560, v2
    v_lshl_add_u32 v12, v3, 4, v12
    v_add_u32 v9, s12, v12
    v_add_u32 v11, 40960, v9
    s_add_u32 s12, s49, 208
    s_lshl_b32 s12, s12, 7
    s_add_u32 s44, s6, s12
    s_addc_u32 s45, s7, 0
    s_cmp_lg_u32 s4, 0
    s_cbranch_scc1 L_wf_38
    s_mov_b64 exec, 1
    v_mul_u32_u24 v12, 0, v1
    s_mov_b32 s15, 1048576
L_wf_39:
    global_load_dword v13, v12, s[44:45] sc1
    s_sub_u32 s15, s15, 1
    s_cbranch_scc1 L_bail11
    s_waitcnt vmcnt(0)
    v_cmp_gt_u32 vcc, 16, v13
    s_nop 0
    s_cbranch_vccnz L_wf_39
    s_mov_b64 exec, -1
L_wf_38:
    s_barrier
L_ao_g:
    s_mov_b32 s46, 0
    s_mov_b32 s58, 0
    s_add_u32 m0, s46, s43
    s_nop 0
    global_load_lds_dwordx4 v6, s[36:37] offset:0 sc1
    s_add_u32 m0, m0, 3968
    s_nop 0
    global_load_lds_dwordx4 v6, s[36:37] offset:128 sc1
    s_add_u32 m0, m0, 3968
    s_nop 0
    global_load_lds_dwordx4 v6, s[36:37] offset:256 sc1
    s_add_u32 m0, m0, 3968
    s_nop 0
    global_load_lds_dwordx4 v6, s[36:37] offset:384 sc1
    s_add_u32 m0, m0, 3968
    s_nop 0
    global_load_lds_dwordx4 v6, s[36:37] offset:512 sc1
    s_add_u32 m0, m0, 3968
    s_nop 0
    global_load_lds_dwordx4 v6, s[36:37] offset:640 sc1
    s_add_u32 m0, m0, 3968
    s_nop 0
    global_load_lds_dwordx4 v6, s[36:37] offset:768 sc1
    s_add_u32 m0, m0, 3968
    s_nop 0
    global_load_lds_dwordx4 v6, s[36:37] offset:896 sc1
    s_add_u32 m0, m0, 3968
    s_nop 0
    global_load_lds_dwordx4 v6, s[36:37] offset:1024 sc1
    s_add_u32 m0, m0, 3968
    s_nop 0
    global_load_lds_dwordx4 v6, s[36:37] offset:1152 sc1
    s_add_u32 s36, s36, 40960
    s_addc_u32 s37, s37, 0
    s_mov_b32 s46, 40960
    s_add_u32 m0, s46, s43
    s_nop 0
    global_load_lds_dwordx4 v6, s[36:37] offset:0 sc1
    s_add_u32 m0, m0, 3968
    s_nop 0
    global_load_lds_dwordx4 v6, s[36:37] offset:128 sc1
    s_add_u32 m0, m0, 3968
    s_nop 0
    global_load_lds_dwordx4 v6, s[36:37] offset:256 sc1
    s_add_u32 m0, m0, 3968
    s_nop 0
    global_load_lds_dwordx4 v6, s[36:37] offset:384 sc1
    s_add_u32 m0, m0, 3968
    s_nop 0
    global_load_lds_dwordx4 v6, s[36:37] offset:512 sc1
    s_add_u32 m0, m0, 3968
    s_nop 0
    global_load_lds_dwordx4 v6, s[36:37] offset:640 sc1
    s_add_u32 m0, m0, 3968
    s_nop 0
    global_load_lds_dwordx4 v6, s[36:37] offset:768 sc1
    s_add_u32 m0, m0, 3968
    s_nop 0
    global_load_lds_dwordx4 v6, s[36:37] offset:896 sc1
    s_add_u32 m0, m0, 3968
    s_nop 0
    global_load_lds_dwordx4 v6, s[36:37] offset:1024 sc1
    s_add_u32 m0, m0, 3968
    s_nop 0
    global_load_lds_dwordx4 v6, s[36:37] offset:1152 sc1
    s_add_u32 s36, s36, 40960
    s_addc_u32 s37, s37, 0
    s_waitcnt vmcnt(10)
L_ao_g_top:
    s_waitcnt vmcnt(14)
    s_barrier
    s_add_u32 s46, s46, 40960
    s_cmp_eq_u32 s46, 122880
    s_cselect_b32 s46, 0, s46
    s_add_u32 s12, s40, 2
    s_cmp_lt_u32 s12, s41
    s_cselect_b32 s12, 0, 40960
    s_sub_u32 s36, s36, s12
    s_subb_u32 s37, s37, 0
    ds_read_b128 v[32:35], v7 offset:0
    ds_read_b128 v[36:39], v7 offset:2048
    ds_read_b128 v[40:43], v8 offset:0
    ds_read_b128 v[44:47], v8 offset:2048
    ds_read_b128 v[48:51], v7 offset:4096
    s_waitcnt lgkmcnt(4)
    v_mfma_f32_16x16x32_bf16 v[16:19], v[96:99], v[32:35], 0
    ds_read_b128 v[52:55], v7 offset:6144
    v_mfma_f32_16x16x32_bf16 v[24:27], v[104:107], v[32:35], 0
    s_add_u32 m0, s46, s43
    s_waitcnt lgkmcnt(4)
    v_mfma_f32_16x16x32_bf16 v[20:23], v[96:99], v[36:39], 0
    ds_read_b128 v[32:35], v8 offset:4096
    v_mfma_f32_16x16x32_bf16 v[28:31], v[104:107], v[36:39], 0
    global_load_lds_dwordx4 v6, s[36:37] offset:0 sc1
    s_waitcnt lgkmcnt(4)
    v_mfma_f32_16x16x32_bf16 v[16:19], v[100:103], v[40:43], v[16:19]
    ds_read_b128 v[36:39], v8 offset:6144
    v_mfma_f32_16x16x32_bf16 v[24:27], v[108:111], v[40:43], v[24:27]
    s_add_u32 m0, m0, 3968
    s_waitcnt lgkmcnt(4)
    v_mfma_f32_16x16x32_bf16 v[20:23], v[100:103], v[44:47], v[20:23]
    ds_read_b128 v[40:43], v7 offset:8192
    v_mfma_f32_16x16x32_bf16 v[28:31], v[108:111], v[44:47], v[28:31]
    global_load_lds_dwordx4 v6, s[36:37] offset:128 sc1
    s_waitcnt lgkmcnt(4)
    v_mfma_f32_16x16x32_bf16 v[16:19], v[112:115], v[48:51], v[16:19]
    ds_read_b128 v[44:47], v7 offset:10240
    v_mfma_f32_16x16x32_bf16 v[24:27], v[120:123], v[48:51], v[24:27]
    s_add_u32 m0, m0, 3968
    s_waitcnt lgkmcnt(4)
    v_mfma_f32_16x16x32_bf16 v[20:23], v[112:115], v[52:55], v[20:23]
    ds_read_b128 v[48:51], v8 offset:8192
    v_mfma_f32_16x16x32_bf16 v[28:31], v[120:123], v[52:55], v[28:31]
    global_load_lds_dwordx4 v6, s[36:37] offset:256 sc1
    s_waitcnt lgkmcnt(4)
    v_mfma_f32_16x16x32_bf16 v[16:19], v[116:119], v[32:35], v[16:19]
    ds_read_b128 v[52:55], v8 offset:10240
    v_mfma_f32_16x16x32_bf16 v[24:27], v[124:127], v[32:35], v[24:27]
    s_add_u32 m0, m0, 3968
    s_waitcnt lgkmcnt(4)
    v_mfma_f32_16x16x32_bf16 v[20:23], v[116:119], v[36:39], v[20:23]
    ds_read_b128 v[32:35], v7 offset:12288
    v_mfma_f32_16x16x32_bf16 v[28:31], v[124:127], v[36:39], v[28:31]
    global_load_lds_dwordx4 v6, s[36:37] offset:384 sc1
    s_waitcnt lgkmcnt(4)
    v_mfma_f32_16x16x32_bf16 v[16:19], v[128:131], v[40:43], v[16:19]
    ds_read_b128 v[36:39], v7 offset:14336
    v_mfma_f32_16x16x32_bf16 v[24:27], v[136:139], v[40:43], v[24:27]
    s_add_u32 m0, m0, 3968
    s_waitcnt lgkmcnt(4)
    v_mfma_f32_16x16x32_bf16 v[20:23], v[128:131], v[44:47], v[20:23]
    ds_read_b128 v[40:43], v8 offset:12288
    v_mfma_f32_16x16x32_bf16 v[28:31], v[136:139], v[44:47], v[28:31]
    global_load_lds_dwordx4 v6, s[36:37] offset:512 sc1
    s_waitcnt lgkmcnt(4)
    v_mfma_f32_16x16x32_bf16 v[16:19], v[132:135], v[48:51], v[16:19]
    ds_read_b128 v[44:47], v8 offset:14336
    v_mfma_f32_16x16x32_bf16 v[24:27], v[140:143], v[48:51], v[24:27]
    s_add_u32 m0, m0, 3968
    s_waitcnt lgkmcnt(4)
    v_mfma_f32_16x16x32_bf16 v[20:23], v[132:135], v[52:55], v[20:23]
    ds_read_b128 v[48:51], v7 offset:16384
    v_mfma_f32_16x16x32_bf16 v[28:31], v[140:143], v[52:55], v[28:31]
    global_load_lds_dwordx4 v6, s[36:37] offset:640 sc1
    s_waitcnt lgkmcnt(4)
    v_mfma_f32_16x16x32_bf16 v[16:19], v[144:147], v[32:35], v[16:19]
    ds_read_b128 v[52:55], v7 offset:18432
    v_mfma_f32_16x16x32_bf16 v[24:27], v[152:155], v[32:35], v[24:27]
    s_add_u32 m0, m0, 3968
    s_waitcnt lgkmcnt(4)
    v_mfma_f32_16x16x32_bf16 v[20:23], v[144:147], v[36:39], v[20:23]
    ds_read_b128 v[32:35], v8 offset:16384
    v_mfma_f32_16x16x32_bf16 v[28:31], v[152:155], v[36:39], v[28:31]
    global_load_lds_dwordx4 v6, s[36:37] offset:768 sc1
    s_waitcnt lgkmcnt(4)
    v_mfma_f32_16x16x32_bf16 v[16:19], v[148:151], v[40:43], v[16:19]
    ds_read_b128 v[36:39], v8 offset:18432
    v_mfma_f32_16x16x32_bf16 v[24:27], v[156:159], v[40:43], v[24:27]
    s_add_u32 m0, m0, 3968
    s_waitcnt lgkmcnt(4)
    v_mfma_f32_16x16x32_bf16 v[20:23], v[148:151], v[44:47], v[20:23]
    ds_read_b128 v[40:43], v7 offset:20480
    v_mfma_f32_16x16x32_bf16 v[28:31], v[156:159], v[44:47], v[28:31]
    global_load_lds_dwordx4 v6, s[36:37] offset:896 sc1
    s_waitcnt lgkmcnt(4)
    v_mfma_f32_16x16x32_bf16 v[16:19], v[160:163], v[48:51], v[16:19]
    ds_read_b128 v[44:47], v7 offset:22528
    v_mfma_f32_16x16x32_bf16 v[24:27], v[168:171], v[48:51], v[24:27]
    s_add_u32 m0, m0, 3968
    s_waitcnt lgkmcnt(4)
    v_mfma_f32_16x16x32_bf16 v[20:23], v[160:163], v[52:55], v[20:23]
    ds_read_b128 v[48:51], v8 offset:20480
    v_mfma_f32_16x16x32_bf16 v[28:31], v[168:171], v[52:55], v[28:31]
    global_load_lds_dwordx4 v6, s[36:37] offset:1024 sc1
    s_waitcnt lgkmcnt(4)
    v_mfma_f32_16x16x32_bf16 v[16:19], v[164:167], v[32:35], v[16:19]
    ds_read_b128 v[52:55], v8 offset:22528
    v_mfma_f32_16x16x32_bf16 v[24:27], v[172:175], v[32:35], v[24:27]
    s_add_u32 m0, m0, 3968
    s_waitcnt lgkmcnt(4)
    v_mfma_f32_16x16x32_bf16 v[20:23], v[164:167], v[36:39], v[20:23]
    ds_read_b128 v[32:35], v7 offset:24576
    v_mfma_f32_16x16x32_bf16 v[28:31], v[172:175], v[36:39], v[28:31]
    global_load_lds_dwordx4 v6, s[36:37] offset:1152 sc1
    s_waitcnt lgkmcnt(4)
    v_mfma_f32_16x16x32_bf16 v[16:19], v[176:179], v[40:43], v[16:19]
    ds_read_b128 v[36:39], v7 offset:26624
    v_mfma_f32_16x16x32_bf16 v[24:27], v[184:187], v[40:43], v[24:27]
    s_add_u32 s36, s36, 40960
    s_addc_u32 s37, s37, 0
    s_waitcnt lgkmcnt(4)
    v_mfma_f32_16x16x32_bf16 v[20:23], v[176:179], v[44:47], v[20:23]
    ds_read_b128 v[40:43], v8 offset:24576
    v_mfma_f32_16x16x32_bf16 v[28:31], v[184:187], v[44:47], v[28:31]
    s_waitcnt lgkmcnt(4)
    v_mfma_f32_16x16x32_bf16 v[16:19], v[180:183], v[48:51], v[16:19]
    ds_read_b128 v[44:47], v8 offset:26624
    v_mfma_f32_16x16x32_bf16 v[24:27], v[188:191], v[48:51], v[24:27]
    s_waitcnt lgkmcnt(4)
    v_mfma_f32_16x16x32_bf16 v[20:23], v[180:183], v[52:55], v[20:23]
    ds_read_b128 v[48:51], v7 offset:28672
    v_mfma_f32_16x16x32_bf16 v[28:31], v[188:191], v[52:55], v[28:31]
    s_waitcnt lgkmcnt(4)
    v_mfma_f32_16x16x32_bf16 v[16:19], v[192:195], v[32:35], v[16:19]
    ds_read_b128 v[52:55], v7 offset:30720
    v_mfma_f32_16x16x32_bf16 v[24:27], v[200:203], v[32:35], v[24:27]
    s_waitcnt lgkmcnt(4)
    v_mfma_f32_16x16x32_bf16 v[20:23], v[192:195], v[36:39], v[20:23]
    ds_read_b128 v[32:35], v8 offset:28672
    v_mfma_f32_16x16x32_bf16 v[28:31], v[200:203], v[36:39], v[28:31]
    s_waitcnt lgkmcnt(4)
    v_mfma_f32_16x16x32_bf16 v[16:19], v[196:199], v[40:43], v[16:19]
    ds_read_b128 v[36:39], v8 offset:30720
    v_mfma_f32_16x16x32_bf16 v[24:27], v[204:207], v[40:43], v[24:27]
    s_waitcnt lgkmcnt(4)
    v_mfma_f32_16x16x32_bf16 v[20:23], v[196:199], v[44:47], v[20:23]
    ds_read_b128 v[40:43], v7 offset:32768
    v_mfma_f32_16x16x32_bf16 v[28:31], v[204:207], v[44:47], v[28:31]
    s_waitcnt lgkmcnt(4)
    v_mfma_f32_16x16x32_bf16 v[16:19], v[208:211], v[48:51], v[16:19]
    ds_read_b128 v[44:47], v7 offset:34816
    v_mfma_f32_16x16x32_bf16 v[24:27], v[216:219], v[48:51], v[24:27]
    s_waitcnt lgkmcnt(4)
    v_mfma_f32_16x16x32_bf16 v[20:23], v[208:211], v[52:55], v[20:23]
    ds_read_b128 v[48:51], v8 offset:32768
    v_mfma_f32_16x16x32_bf16 v[28:31], v[216:219], v[52:55], v[28:31]
    s_waitcnt lgkmcnt(4)
    v_mfma_f32_16x16x32_bf16 v[16:19], v[212:215], v[32:35], v[16:19]
    ds_read_b128 v[52:55], v8 offset:34816
    v_mfma_f32_16x16x32_bf16 v[24:27], v[220:223], v[32:35], v[24:27]
    s_waitcnt lgkmcnt(4)
    v_mfma_f32_16x16x32_bf16 v[20:23], v[212:215], v[36:39], v[20:23]
    ds_read_b128 v[32:35], v7 offset:36864
    v_mfma_f32_16x16x32_bf16 v[28:31], v[220:223], v[36:39], v[28:31]
    s_waitcnt lgkmcnt(4)
    v_mfma_f32_16x16x32_bf16 v[16:19], v[224:227], v[40:43], v[16:19]
    ds_read_b128 v[36:39], v7 offset:38912
    v_mfma_f32_16x16x32_bf16 v[24:27], v[232:235], v[40:43], v[24:27]
    s_waitcnt lgkmcnt(4)
    v_mfma_f32_16x16x32_bf16 v[20:23], v[224:227], v[44:47], v[20:23]
    ds_read_b128 v[40:43], v8 offset:36864
    v_mfma_f32_16x16x32_bf16 v[28:31], v[232:235], v[44:47], v[28:31]
    s_waitcnt lgkmcnt(4)
    v_mfma_f32_16x16x32_bf16 v[16:19], v[228:231], v[48:51], v[16:19]
    ds_read_b128 v[44:47], v8 offset:38912
    v_mfma_f32_16x16x32_bf16 v[24:27], v[236:239], v[48:51], v[24:27]
    s_waitcnt lgkmcnt(4)
    v_mfma_f32_16x16x32_bf16 v[20:23], v[228:231], v[52:55], v[20:23]
    v_mfma_f32_16x16x32_bf16 v[28:31], v[236:239], v[52:55], v[28:31]
    s_waitcnt lgkmcnt(3)
    v_mfma_f32_16x16x32_bf16 v[16:19], v[240:243], v[32:35], v[16:19]
    v_mfma_f32_16x16x32_bf16 v[24:27], v[248:251], v[32:35], v[24:27]
    s_waitcnt lgkmcnt(2)
    v_mfma_f32_16x16x32_bf16 v[20:23], v[240:243], v[36:39], v[20:23]
    v_mfma_f32_16x16x32_bf16 v[28:31], v[248:251], v[36:39], v[28:31]
    s_waitcnt lgkmcnt(1)
    v_mfma_f32_16x16x32_bf16 v[16:19], v[244:247], v[40:43], v[16:19]
    v_mfma_f32_16x16x32_bf16 v[24:27], v[252:255], v[40:43], v[24:27]
    s_waitcnt lgkmcnt(0)
    v_mfma_f32_16x16x32_bf16 v[20:23], v[244:247], v[44:47], v[20:23]
    v_mfma_f32_16x16x32_bf16 v[28:31], v[252:255], v[44:47], v[28:31]
    s_mul_i32 s12, s40, 81920
    s_add_u32 s38, s54, s12
    s_addc_u32 s39, s55, 0
    s_nop 1
    v_cvt_pk_bf16_f32 v56, v16, v24
    v_cvt_pk_bf16_f32 v57, v17, v25
    v_cvt_pk_bf16_f32 v58, v18, v26
    v_cvt_pk_bf16_f32 v59, v19, v27
    global_store_dwordx4 v9, v[56:59], s[38:39]
    v_cvt_pk_bf16_f32 v60, v20, v28
    v_cvt_pk_bf16_f32 v61, v21, v29
    v_cvt_pk_bf16_f32 v62, v22, v30
    v_cvt_pk_bf16_f32 v63, v23, v31
    global_store_dwordx4 v11, v[60:63], s[38:39]
    s_cmp_eq_u32 s58, 81920
    s_cselect_b32 s12, 122880, 0
    s_sub_u32 s12, 40960, s12
    s_add_u32 s58, s58, s12
    v_add_u32 v7, s12, v7
    v_add_u32 v8, s12, v8
    s_add_u32 s40, s40, 1
    s_cmp_lt_u32 s40, s41
    s_cbranch_scc1 L_ao_g_top
    s_waitcnt vmcnt(0)
    s_barrier
    v_subrev_u32 v7, s58, v7
    v_subrev_u32 v8, s58, v8
    s_branch L_queue
L_akv:
    s_lshr_b32 s14, s4, 1
    s_lshl_b32 s12, s14, 11
    v_add_u32 v7, s12, v7
    v_add_u32 v8, s12, v8
    s_add_u32 s54, s6, 8126464
    s_addc_u32 s55, s7, 0
    s_bitcmp1_b32 s4, 0
    s_cbranch_scc1 L_av
    s_lshl_b32 s12, s14, 8
    v_lshlrev_b32 v12, 9, v3
    v_lshl_add_u32 v12, v2, 4, v12
    v_add_u32 v9, s12, v12
L_ak_g:
    s_mov_b32 s46, 0
    s_mov_b32 s58, 0
    s_add_u32 m0, s46, s43
    s_nop 0
    global_load_lds_dwordx4 v6, s[36:37] offset:0
    s_add_u32 m0, m0, 3968
    s_nop 0
    global_load_lds_dwordx4 v6, s[36:37] offset:128
    s_add_u32 m0, m0, 3968
    s_nop 0
    global_load_lds_dwordx4 v6, s[36:37] offset:256
    s_add_u32 m0, m0, 3968
    s_nop 0
    global_load_lds_dwordx4 v6, s[36:37] offset:384
    s_add_u32 m0, m0, 3968
    s_nop 0
    global_load_lds_dwordx4 v6, s[36:37] offset:512
    s_add_u32 m0, m0, 3968
    s_nop 0
    global_load_lds_dwordx4 v6, s[36:37] offset:640
    s_add_u32 m0, m0, 3968
    s_nop 0
    global_load_lds_dwordx4 v6, s[36:37] offset:768
    s_add_u32 m0, m0, 3968
    s_nop 0
    global_load_lds_dwordx4 v6, s[36:37] offset:896
    s_add_u32 m0, m0, 3968
    s_nop 0
    global_load_lds_dwordx4 v6, s[36:37] offset:1024
    s_add_u32 m0, m0, 3968
    s_nop 0
    global_load_lds_dwordx4 v6, s[36:37] offset:1152
    s_add_u32 s36, s36, 40960
    s_addc_u32 s37, s37, 0
    s_mov_b32 s46, 40960
    s_add_u32 m0, s46, s43
    s_nop 0
    global_load_lds_dwordx4 v6, s[36:37] offset:0
    s_add_u32 m0, m0, 3968
    s_nop 0
    global_load_lds_dwordx4 v6, s[36:37] offset:128
    s_add_u32 m0, m0, 3968
    s_nop 0
    global_load_lds_dwordx4 v6, s[36:37] offset:256
    s_add_u32 m0, m0, 3968
    s_nop 0
    global_load_lds_dwordx4 v6, s[36:37] offset:384
    s_add_u32 m0, m0, 3968
    s_nop 0
    global_load_lds_dwordx4 v6, s[36:37] offset:512
    s_add_u32 m0, m0, 3968
    s_nop 0
    global_load_lds_dwordx4 v6, s[36:37] offset:640
    s_add_u32 m0, m0, 3968
    s_nop 0
    global_load_lds_dwordx4 v6, s[36:37] offset:768
    s_add_u32 m0, m0, 3968
    s_nop 0
    global_load_lds_dwordx4 v6, s[36:37] offset:896
    s_add_u32 m0, m0, 3968
    s_nop 0
    global_load_lds_dwordx4 v6, s[36:37] offset:1024
    s_add_u32 m0, m0, 3968
    s_nop 0
    global_load_lds_dwordx4 v6, s[36:37] offset:1152
    s_add_u32 s36, s36, 40960
    s_addc_u32 s37, s37, 0
    s_waitcnt vmcnt(10)
L_ak_g_top:
    s_waitcnt vmcnt(12)
    s_barrier
    s_add_u32 s46, s46, 40960
    s_cmp_eq_u32 s46, 122880
    s_cselect_b32 s46, 0, s46
    s_add_u32 s12, s40, 2
    s_cmp_lt_u32 s12, s41
    s_cselect_b32 s12, 0, 40960
    s_sub_u32 s36, s36, s12
    s_subb_u32 s37, s37, 0
    ds_read_b128 v[32:35], v7 offset:0
    ds_read_b128 v[36:39], v8 offset:0
    ds_read_b128 v[40:43], v7 offset:4096
    ds_read_b128 v[44:47], v8 offset:4096
    ds_read_b128 v[48:51], v7 offset:8192
    s_waitcnt lgkmcnt(4)
    v_mfma_f32_16x16x32_bf16 v[16:19], v[96:99], v[32:35], 0
    ds_read_b128 v[52:55], v8 offset:8192
    v_mfma_f32_16x16x32_bf16 v[24:27], v[104:107], v[32:35], 0
    s_add_u32 m0, s46, s43
    s_waitcnt lgkmcnt(4)
    v_mfma_f32_16x16x32_bf16 v[16:19], v[100:103], v[36:39], v[16:19]
    ds_read_b128 v[32:35], v7 offset:12288
    v_mfma_f32_16x16x32_bf16 v[24:27], v[108:111], v[36:39], v[24:27]
    global_load_lds_dwordx4 v6, s[36:37] offset:0
    s_waitcnt lgkmcnt(4)
    v_mfma_f32_16x16x32_bf16 v[16:19], v[112:115], v[40:43], v[16:19]
    ds_read_b128 v[36:39], v8 offset:12288
    v_mfma_f32_16x16x32_bf16 v[24:27], v[120:123], v[40:43], v[24:27]
    s_add_u32 m0, m0, 3968
    s_waitcnt lgkmcnt(4)
    v_mfma_f32_16x16x32_bf16 v[16:19], v[116:119], v[44:47], v[16:19]
    ds_read_b128 v[40:43], v7 offset:16384
    v_mfma_f32_16x16x32_bf16 v[24:27], v[124:127], v[44:47], v[24:27]
    global_load_lds_dwordx4 v6, s[36:37] offset:128
    s_waitcnt lgkmcnt(4)
    v_mfma_f32_16x16x32_bf16 v[16:19], v[128:131], v[48:51], v[16:19]
    ds_read_b128 v[44:47], v8 offset:16384
    v_mfma_f32_16x16x32_bf16 v[24:27], v[136:139], v[48:51], v[24:27]
    s_add_u32 m0, m0, 3968
    s_waitcnt lgkmcnt(4)
    v_mfma_f32_16x16x32_bf16 v[16:19], v[132:135], v[52:55], v[16:19]
    ds_read_b128 v[48:51], v7 offset:20480
    v_mfma_f32_16x16x32_bf16 v[24:27], v[140:143], v[52:55], v[24:27]
    global_load_lds_dwordx4 v6, s[36:37] offset:256
    s_waitcnt lgkmcnt(4)
    v_mfma_f32_16x16x32_bf16 v[16:19], v[144:147], v[32:35], v[16:19]
    ds_read_b128 v[52:55], v8 offset:20480
    v_mfma_f32_16x16x32_bf16 v[24:27], v[152:155], v[32:35], v[24:27]
    s_add_u32 m0, m0, 3968
    s_waitcnt lgkmcnt(4)
    v_mfma_f32_16x16x32_bf16 v[16:19], v[148:151], v[36:39], v[16:19]
    ds_read_b128 v[32:35], v7 offset:24576
    v_mfma_f32_16x16x32_bf16 v[24:27], v[156:159], v[36:39], v[24:27]
    global_load_lds_dwordx4 v6, s[36:37] offset:384
    s_waitcnt lgkmcnt(4)
    v_mfma_f32_16x16x32_bf16 v[16:19], v[160:163], v[40:43], v[16:19]
    ds_read_b128 v[36:39], v8 offset:24576
    v_mfma_f32_16x16x32_bf16 v[24:27], v[168:171], v[40:43], v[24:27]
    s_add_u32 m0, m0, 3968
    s_waitcnt lgkmcnt(4)
    v_mfma_f32_16x16x32_bf16 v[16:19], v[164:167], v[44:47], v[16:19]
    ds_read_b128 v[40:43], v7 offset:28672
    v_mfma_f32_16x16x32_bf16 v[24:27], v[172:175], v[44:47], v[24:27]
    global_load_lds_dwordx4 v6, s[36:37] offset:512
    s_waitcnt lgkmcnt(4)
    v_mfma_f32_16x16x32_bf16 v[16:19], v[176:179], v[48:51], v[16:19]
    ds_read_b128 v[44:47], v8 offset:28672
    v_mfma_f32_16x16x32_bf16 v[24:27], v[184:187], v[48:51], v[24:27]
    s_add_u32 m0, m0, 3968
    s_waitcnt lgkmcnt(4)
    v_mfma_f32_16x16x32_bf16 v[16:19], v[180:183], v[52:55], v[16:19]
    ds_read_b128 v[48:51], v7 offset:32768
    v_mfma_f32_16x16x32_bf16 v[24:27], v[188:191], v[52:55], v[24:27]
    global_load_lds_dwordx4 v6, s[36:37] offset:640
    s_waitcnt lgkmcnt(4)
    v_mfma_f32_16x16x32_bf16 v[16:19], v[192:195], v[32:35], v[16:19]
    ds_read_b128 v[52:55], v8 offset:32768
    v_mfma_f32_16x16x32_bf16 v[24:27], v[200:203], v[32:35], v[24:27]
    s_add_u32 m0, m0, 3968
    s_waitcnt lgkmcnt(4)
    v_mfma_f32_16x16x32_bf16 v[16:19], v[196:199], v[36:39], v[16:19]
    ds_read_b128 v[32:35], v7 offset:36864
    v_mfma_f32_16x16x32_bf16 v[24:27], v[204:207], v[36:39], v[24:27]
    global_load_lds_dwordx4 v6, s[36:37] offset:768
    s_waitcnt lgkmcnt(4)
    v_mfma_f32_16x16x32_bf16 v[16:19], v[208:211], v[40:43], v[16:19]
    ds_read_b128 v[36:39], v8 offset:36864
    v_mfma_f32_16x16x32_bf16 v[24:27], v[216:219], v[40:43], v[24:27]
    s_add_u32 m0, m0, 3968
    s_waitcnt lgkmcnt(4)
    v_mfma_f32_16x16x32_bf16 v[16:19], v[212:215], v[44:47], v[16:19]
    global_load_lds_dwordx4 v6, s[36:37] offset:896
    v_mfma_f32_16x16x32_bf16 v[24:27], v[220:223], v[44:47], v[24:27]
    s_add_u32 m0, m0, 3968
    s_waitcnt lgkmcnt(3)
    v_mfma_f32_16x16x32_bf16 v[16:19], v[224:227], v[48:51], v[16:19]
    global_load_lds_dwordx4 v6, s[36:37] offset:1024
    v_mfma_f32_16x16x32_bf16 v[24:27], v[232:235], v[48:51], v[24:27]
    s_add_u32 m0, m0, 3968
    s_waitcnt lgkmcnt(2)
    v_mfma_f32_16x16x32_bf16 v[16:19], v[228:231], v[52:55], v[16:19]
    global_load_lds_dwordx4 v6, s[36:37] offset:1152
    v_mfma_f32_16x16x32_bf16 v[24:27], v[236:239], v[52:55], v[24:27]
    s_add_u32 s36, s36, 40960
    s_addc_u32 s37, s37, 0
    s_waitcnt lgkmcnt(1)
    v_mfma_f32_16x16x32_bf16 v[16:19], v[240:243], v[32:35], v[16:19]
    v_mfma_f32_16x16x32_bf16 v[24:27], v[248:251], v[32:35], v[24:27]
    s_waitcnt lgkmcnt(0)
    v_mfma_f32_16x16x32_bf16 v[16:19], v[244:247], v[36:39], v[16:19]
    v_mfma_f32_16x16x32_bf16 v[24:27], v[252:255], v[36:39], v[24:27]
    s_lshl_b32 s12, s40, 12
    s_add_u32 s38, s54, s12
    s_addc_u32 s39, s55, 0
    s_nop 4
    v_cvt_pk_bf16_f32 v56, v16, v24
    v_cvt_pk_bf16_f32 v57, v17, v25
    v_cvt_pk_bf16_f32 v58, v18, v26
    v_cvt_pk_bf16_f32 v59, v19, v27
    global_store_dwordx4 v9, v[56:59], s[38:39] sc1
    s_cmp_eq_u32 s58, 81920
    s_cselect_b32 s12, 122880, 0
    s_sub_u32 s12, 40960, s12
    s_add_u32 s58, s58, s12
    v_add_u32 v7, s12, v7
    v_add_u32 v8, s12, v8
    s_add_u32 s40, s40, 1
    s_cmp_lt_u32 s40, s41
    s_cbranch_scc1 L_ak_g_top
    s_waitcnt vmcnt(0)
    s_barrier
    v_subrev_u32 v7, s58, v7
    v_subrev_u32 v8, s58, v8
    s_branch L_akv_end
L_av:
    s_lshl_b32 s12, s14, 10
    s_add_u32 s12, s12, 2048
    v_lshrrev_b32 v12, 1, v3
    v_lshlrev_b32 v12, 9, v12
    v_lshl_add_u32 v12, v2, 5, v12
    v_and_b32 v13, 1, v3
    v_lshl_add_u32 v12, v13, 3, v12
    v_add_u32 v9, s12, v12
    s_mov_b32 s64, 0x14001400
    s_mov_b32 s65, 0x14001400
    v_mov_b32 v11, 0x3f803f80
L_av_g:
    s_mov_b32 s46, 0
    s_mov_b32 s58, 0
    s_add_u32 m0, s46, s43
    s_nop 0
    global_load_lds_dwordx4 v6, s[36:37] offset:0
    s_add_u32 m0, m0, 3968
    s_nop 0
    global_load_lds_dwordx4 v6, s[36:37] offset:128
    s_add_u32 m0, m0, 3968
    s_nop 0
    global_load_lds_dwordx4 v6, s[36:37] offset:256
    s_add_u32 m0, m0, 3968
    s_nop 0
    global_load_lds_dwordx4 v6, s[36:37] offset:384
    s_add_u32 m0, m0, 3968
    s_nop 0
    global_load_lds_dwordx4 v6, s[36:37] offset:512
    s_add_u32 m0, m0, 3968
    s_nop 0
    global_load_lds_dwordx4 v6, s[36:37] offset:640
    s_add_u32 m0, m0, 3968
    s_nop 0
    global_load_lds_dwordx4 v6, s[36:37] offset:768
    s_add_u32 m0, m0, 3968
    s_nop 0
    global_load_lds_dwordx4 v6, s[36:37] offset:896
    s_add_u32 m0, m0, 3968
    s_nop 0
    global_load_lds_dwordx4 v6, s[36:37] offset:1024
    s_add_u32 m0, m0, 3968
    s_nop 0
    global_load_lds_dwordx4 v6, s[36:37] offset:1152
    s_add_u32 s36, s36, 40960
    s_addc_u32 s37, s37, 0
    s_mov_b32 s46, 40960
    s_add_u32 m0, s46, s43
    s_nop 0
    global_load_lds_dwordx4 v6, s[36:37] offset:0
    s_add_u32 m0, m0, 3968
    s_nop 0
    global_load_lds_dwordx4 v6, s[36:37] offset:128
    s_add_u32 m0, m0, 3968
    s_nop 0
    global_load_lds_dwordx4 v6, s[36:37] offset:256
    s_add_u32 m0, m0, 3968
    s_nop 0
    global_load_lds_dwordx4 v6, s[36:37] offset:384
    s_add_u32 m0, m0, 3968
    s_nop 0
    global_load_lds_dwordx4 v6, s[36:37] offset:512
    s_add_u32 m0, m0, 3968
    s_nop 0
    global_load_lds_dwordx4 v6, s[36:37] offset:640
    s_add_u32 m0, m0, 3968
    s_nop 0
    global_load_lds_dwordx4 v6, s[36:37] offset:768
    s_add_u32 m0, m0, 3968
    s_nop 0
    global_load_lds_dwordx4 v6, s[36:37] offset:896
    s_add_u32 m0, m0, 3968
    s_nop 0
    global_load_lds_dwordx4 v6, s[36:37] offset:1024
    s_add_u32 m0, m0, 3968
    s_nop 0
    global_load_lds_dwordx4 v6, s[36:37] offset:1152
    s_add_u32 s36, s36, 40960
    s_addc_u32 s37, s37, 0
    s_waitcnt vmcnt(10)
L_av_g_top:
    s_waitcnt vmcnt(14)
    s_barrier
    s_add_u32 s46, s46, 40960
    s_cmp_eq_u32 s46, 122880
    s_cselect_b32 s46, 0, s46
    s_add_u32 s12, s40, 2
    s_cmp_lt_u32 s12, s41
    s_cselect_b32 s12, 0, 40960
    s_sub_u32 s36, s36, s12
    s_subb_u32 s37, s37, 0
    ds_read_b128 v[32:35], v7 offset:0
    ds_read_b128 v[36:39], v8 offset:0
    ds_read_b128 v[40:43], v7 offset:4096
    ds_read_b128 v[44:47], v8 offset:4096
    ds_read_b128 v[48:51], v7 offset:8192
    s_waitcnt lgkmcnt(4)
    v_mfma_f32_16x16x32_bf16 v[16:19], v[32:35], v[96:99], 0
    ds_read_b128 v[52:55], v8 offset:8192
    v_mfma_f32_16x16x32_bf16 v[24:27], v[32:35], v[104:107], 0
    s_add_u32 m0, s46, s43
    s_waitcnt lgkmcnt(4)
    v_mfma_f32_16x16x32_bf16 v[16:19], v[36:39], v[100:103], v[16:19]
    ds_read_b128 v[32:35], v7 offset:12288
    v_mfma_f32_16x16x32_bf16 v[24:27], v[36:39], v[108:111], v[24:27]
    global_load_lds_dwordx4 v6, s[36:37] offset:0
    s_waitcnt lgkmcnt(4)
    v_mfma_f32_16x16x32_bf16 v[16:19], v[40:43], v[112:115], v[16:19]
    ds_read_b128 v[36:39], v8 offset:12288
    v_mfma_f32_16x16x32_bf16 v[24:27], v[40:43], v[120:123], v[24:27]
    s_add_u32 m0, m0, 3968
    s_waitcnt lgkmcnt(4)
    v_mfma_f32_16x16x32_bf16 v[16:19], v[44:47], v[116:119], v[16:19]
    ds_read_b128 v[40:43], v7 offset:16384
    v_mfma_f32_16x16x32_bf16 v[24:27], v[44:47], v[124:127], v[24:27]
    global_load_lds_dwordx4 v6, s[36:37] offset:128
    s_waitcnt lgkmcnt(4)
    v_mfma_f32_16x16x32_bf16 v[16:19], v[48:51], v[128:131], v[16:19]
    ds_read_b128 v[44:47], v8 offset:16384
    v_mfma_f32_16x16x32_bf16 v[24:27], v[48:51], v[136:139], v[24:27]
    s_add_u32 m0, m0, 3968
    s_waitcnt lgkmcnt(4)
    v_mfma_f32_16x16x32_bf16 v[16:19], v[52:55], v[132:135], v[16:19]
    ds_read_b128 v[48:51], v7 offset:20480
    v_mfma_f32_16x16x32_bf16 v[24:27], v[52:55], v[140:143], v[24:27]
    global_load_lds_dwordx4 v6, s[36:37] offset:256
    s_waitcnt lgkmcnt(4)
    v_mfma_f32_16x16x32_bf16 v[16:19], v[32:35], v[144:147], v[16:19]
    ds_read_b128 v[52:55], v8 offset:20480
    v_mfma_f32_16x16x32_bf16 v[24:27], v[32:35], v[152:155], v[24:27]
    s_add_u32 m0, m0, 3968
    s_waitcnt lgkmcnt(4)
    v_mfma_f32_16x16x32_bf16 v[16:19], v[36:39], v[148:151], v[16:19]
    ds_read_b128 v[32:35], v7 offset:24576
    v_mfma_f32_16x16x32_bf16 v[24:27], v[36:39], v[156:159], v[24:27]
    global_load_lds_dwordx4 v6, s[36:37] offset:384
    s_waitcnt lgkmcnt(4)
    v_mfma_f32_16x16x32_bf16 v[16:19], v[40:43], v[160:163], v[16:19]
    ds_read_b128 v[36:39], v8 offset:24576
    v_mfma_f32_16x16x32_bf16 v[24:27], v[40:43], v[168:171], v[24:27]
    s_add_u32 m0, m0, 3968
    s_waitcnt lgkmcnt(4)
    v_mfma_f32_16x16x32_bf16 v[16:19], v[44:47], v[164:167], v[16:19]
    ds_read_b128 v[40:43], v7 offset:28672
    v_mfma_f32_16x16x32_bf16 v[24:27], v[44:47], v[172:175], v[24:27]
    global_load_lds_dwordx4 v6, s[36:37] offset:512
    s_waitcnt lgkmcnt(4)
    v_mfma_f32_16x16x32_bf16 v[16:19], v[48:51], v[176:179], v[16:19]
    ds_read_b128 v[44:47], v8 offset:28672
    v_mfma_f32_16x16x32_bf16 v[24:27], v[48:51], v[184:187], v[24:27]
    s_add_u32 m0, m0, 3968
    s_waitcnt lgkmcnt(4)
    v_mfma_f32_16x16x32_bf16 v[16:19], v[52:55], v[180:183], v[16:19]
    ds_read_b128 v[48:51], v7 offset:32768
    v_mfma_f32_16x16x32_bf16 v[24:27], v[52:55], v[188:191], v[24:27]
    global_load_lds_dwordx4 v6, s[36:37] offset:640
    s_waitcnt lgkmcnt(4)
    v_mfma_f32_16x16x32_bf16 v[16:19], v[32:35], v[192:195], v[16:19]
    ds_read_b128 v[52:55], v8 offset:32768
    v_mfma_f32_16x16x32_bf16 v[24:27], v[32:35], v[200:203], v[24:27]
    s_add_u32 m0, m0, 3968
    s_waitcnt lgkmcnt(4)
    v_mfma_f32_16x16x32_bf16 v[16:19], v[36:39], v[196:199], v[16:19]
    ds_read_b128 v[32:35], v7 offset:36864
    v_mfma_f32_16x16x32_bf16 v[24:27], v[36:39], v[204:207], v[24:27]
    global_load_lds_dwordx4 v6, s[36:37] offset:768
    s_waitcnt lgkmcnt(4)
    v_mfma_f32_16x16x32_bf16 v[16:19], v[40:43], v[208:211], v[16:19]
    ds_read_b128 v[36:39], v8 offset:36864
    v_mfma_f32_16x16x32_bf16 v[24:27], v[40:43], v[216:219], v[24:27]
    s_add_u32 m0, m0, 3968
    s_waitcnt lgkmcnt(4)
    v_mfma_f32_16x16x32_bf16 v[16:19], v[44:47], v[212:215], v[16:19]
    global_load_lds_dwordx4 v6, s[36:37] offset:896
    v_mfma_f32_16x16x32_bf16 v[24:27], v[44:47], v[220:223], v[24:27]
    s_add_u32 m0, m0, 3968
    s_waitcnt lgkmcnt(3)
    v_mfma_f32_16x16x32_bf16 v[16:19], v[48:51], v[224:227], v[16:19]
    global_load_lds_dwordx4 v6, s[36:37] offset:1024
    v_mfma_f32_16x16x32_bf16 v[24:27], v[48:51], v[232:235], v[24:27]
    s_add_u32 m0, m0, 3968
    s_waitcnt lgkmcnt(2)
    v_mfma_f32_16x16x32_bf16 v[16:19], v[52:55], v[228:231], v[16:19]
    global_load_lds_dwordx4 v6, s[36:37] offset:1152
    v_mfma_f32_16x16x32_bf16 v[24:27], v[52:55], v[236:239], v[24:27]
    s_add_u32 s36, s36, 40960
    s_addc_u32 s37, s37, 0
    s_waitcnt lgkmcnt(1)
    v_mfma_f32_16x16x32_bf16 v[16:19], v[32:35], v[240:243], v[16:19]
    v_mfma_f32_16x16x32_bf16 v[24:27], v[32:35], v[248:251], v[24:27]
    s_waitcnt lgkmcnt(0)
    v_mfma_f32_16x16x32_bf16 v[16:19], v[36:39], v[244:247], v[16:19]
    v_mfma_f32_16x16x32_bf16 v[24:27], v[36:39], v[252:255], v[24:27]
    s_lshl_b32 s12, s40, 12
    s_add_u32 s38, s54, s12
    s_addc_u32 s39, s55, 0
    s_nop 3
    v_cvt_pk_bf16_f32 v56, v16, v17
    v_cvt_pk_bf16_f32 v57, v18, v19
    v_cndmask_b32 v56, v56, v11, s[64:65]
    v_cndmask_b32 v57, v57, v11, s[64:65]
    global_store_dwordx2 v9, v[56:57], s[38:39] offset:0 sc1
    v_cvt_pk_bf16_f32 v58, v24, v25
    v_cvt_pk_bf16_f32 v59, v26, v27
    global_store_dwordx2 v9, v[58:59], s[38:39] offset:16 sc1
    s_cmp_eq_u32 s58, 81920
    s_cselect_b32 s12, 122880, 0
    s_sub_u32 s12, 40960, s12
    s_add_u32 s58, s58, s12
    v_add_u32 v7, s12, v7
    v_add_u32 v8, s12, v8
    s_add_u32 s40, s40, 1
    s_cmp_lt_u32 s40, s41
    s_cbranch_scc1 L_av_g_top
    s_waitcnt vmcnt(0)
    s_barrier
    v_subrev_u32 v7, s58, v7
    v_subrev_u32 v8, s58, v8
L_akv_end:
    s_lshr_b32 s14, s4, 1
    s_lshl_b32 s12, s14, 11
    v_subrev_u32 v7, s12, v7
    v_subrev_u32 v8, s12, v8
    s_add_u32 s44, s6, 25600
    s_addc_u32 s45, s7, 0
    s_cmp_lg_u32 s4, 0
    s_cbranch_scc1 L_sg_40
    s_mov_b64 exec, 1
    v_mov_b32 v12, 0
    v_mov_b32 v13, 1
    global_atomic_add v12, v13, s[44:45]
    s_mov_b64 exec, -1
L_sg_40:
    s_branch L_queue
L_att:
    s_sub_u32 s49, s49, 48
    s_lshr_b32 s42, s49, 4
    s_add_u32 s44, s6, 25600
    s_addc_u32 s45, s7, 0
    s_cmp_lg_u32 s4, 0
    s_cbranch_scc1 L_wf_41
    s_mov_b64 exec, 1
    v_mul_u32_u24 v12, 0, v1
    s_mov_b32 s15, 1048576
L_wf_42:
    global_load_dword v13, v12, s[44:45] sc1
    s_sub_u32 s15, s15, 1
    s_cbranch_scc1 L_bail12
    s_waitcnt vmcnt(0)
    v_cmp_gt_u32 vcc, 8, v13
    s_nop 0
    s_cbranch_vccnz L_wf_42
    s_mov_b64 exec, -1
L_wf_41:
    s_add_u32 s12, s42, 192
    s_lshl_b32 s12, s12, 7
    s_add_u32 s44, s6, s12
    s_addc_u32 s45, s7, 0
    s_cmp_lg_u32 s4, 0
    s_cbranch_scc1 L_wf_43
    s_mov_b64 exec, 1
    v_mul_u32_u24 v12, 0, v1
    s_mov_b32 s15, 1048576
L_wf_44:
    global_load_dword v13, v12, s[44:45] sc1
    s_sub_u32 s15, s15, 1
    s_cbranch_scc1 L_bail13
    s_waitcnt vmcnt(0)
    v_cmp_gt_u32 vcc, 5, v13
    s_nop 0
    s_cbranch_vccnz L_wf_44
    s_mov_b64 exec, -1
L_wf_43:
    s_barrier
    s_lshl_b32 s12, s49, 2
    s_add_u32 s12, s12, s4
    s_mul_i32 s12, s12, 5120
    s_add_u32 s13, s12, 2097152
    s_add_u32 s54, s6, s13
    s_addc_u32 s55, s7, 0
    s_add_u32 s13, s12, 5242880
    s_add_u32 s38, s6, s13
    s_addc_u32 s39, s7, 0
    v_and_b32 v12, 31, v1
    v_mul_u32_u24 v12, 40, v12
    v_lshrrev_b32 v13, 5, v1
    v_lshl_add_u32 v15, v13, 4, v12
    v_lshl_add_u32 v9, v13, 3, v12
    v_mov_b32 v14, 0xdddd
    s_mov_b32 s80, 0x21800000
    s_mov_b32 s81, 0x3c000000
    v_mov_b64 v[20:21], 0
    v_mov_b64 v[22:23], 0
    v_mov_b64 v[28:29], 0
    v_mov_b64 v[30:31], 0
    v_mov_b64 v[36:37], 0
    v_mov_b64 v[38:39], 0
    v_mov_b64 v[44:45], 0
    v_mov_b64 v[46:47], 0
    global_load_dwordx2 v[16:17], v15, s[54:55] offset:0 sc1
    global_load_dwordx2 v[18:19], v15, s[54:55] offset:8 sc1
    global_load_dwordx2 v[24:25], v15, s[54:55] offset:1280 sc1
    global_load_dwordx2 v[26:27], v15, s[54:55] offset:1288 sc1
    global_load_dwordx2 v[32:33], v15, s[54:55] offset:2560 sc1
    global_load_dwordx2 v[34:35], v15, s[54:55] offset:2568 sc1
    global_load_dwordx2 v[40:41], v15, s[54:55] offset:3840 sc1
    global_load_dwordx2 v[42:43], v15, s[54:55] offset:3848 sc1
    s_mov_b32 exec_hi, 0
    global_load_dwordx2 v[20:21], v15, s[54:55] offset:32 sc1
    global_load_dwordx2 v[28:29], v15, s[54:55] offset:1312 sc1
    global_load_dwordx2 v[36:37], v15, s[54:55] offset:2592 sc1
    global_load_dwordx2 v[44:45], v15, s[54:55] offset:3872 sc1
    s_mov_b64 exec, -1
    s_add_u32 s56, s6, 8126464
    s_addc_u32 s57, s7, 0
    global_load_dwordx4 v[176:179], v5, s[56:57] offset:0
    global_load_dwordx4 v[180:183], v5, s[56:57] offset:1024
    global_load_dwordx4 v[184:187], v5, s[56:57] offset:2048
    global_load_dwordx4 v[188:191], v5, s[56:57] offset:3072
    s_add_u32 s56, s56, 4096
    s_addc_u32 s57, s57, 0
    global_load_dwordx4 v[192:195], v5, s[56:57] offset:0
    global_load_dwordx4 v[196:199], v5, s[56:57] offset:1024
    global_load_dwordx4 v[200:203], v5, s[56:57] offset:2048
    global_load_dwordx4 v[204:207], v5, s[56:57] offset:3072
    s_add_u32 s56, s56, 4096
    s_addc_u32 s57, s57, 0
    global_load_dwordx4 v[208:211], v5, s[56:57] offset:0
    global_load_dwordx4 v[212:215], v5, s[56:57] offset:1024
    global_load_dwordx4 v[216:219], v5, s[56:57] offset:2048
    global_load_dwordx4 v[220:223], v5, s[56:57] offset:3072
    s_add_u32 s56, s56, 4096
    s_addc_u32 s57, s57, 0
    v_mov_b64 v[48:49], 0
    v_mov_b64 v[50:51], 0
    v_mov_b64 v[52:53], 0
    v_mov_b64 v[54:55], 0
    v_mov_b64 v[56:57], 0
    v_mov_b64 v[58:59], 0
    v_mov_b64 v[60:61], 0
    v_mov_b64 v[62:63], 0
    v_mov_b64 v[64:65], 0
    v_mov_b64 v[66:67], 0
    v_mov_b64 v[68:69], 0
    v_mov_b64 v[70:71], 0
    v_mov_b64 v[72:73], 0
    v_mov_b64 v[74:75], 0
    v_mov_b64 v[76:77], 0
    v_mov_b64 v[78:79], 0
    v_mov_b64 v[80:81], 0
    v_mov_b64 v[82:83], 0
    v_mov_b64 v[84:85], 0
    v_mov_b64 v[86:87], 0
    v_mov_b64 v[88:89], 0
    v_mov_b64 v[90:91], 0
    v_mov_b64 v[92:93], 0
    v_mov_b64 v[94:95], 0
    v_mov_b64 v[96:97], 0
    v_mov_b64 v[98:99], 0
    v_mov_b64 v[100:101], 0
    v_mov_b64 v[102:103], 0
    v_mov_b64 v[104:105], 0
    v_mov_b64 v[106:107], 0
    v_mov_b64 v[108:109], 0
    v_mov_b64 v[110:111], 0
    v_mov_b64 v[168:169], 0
    v_mov_b64 v[170:171], 0
    v_mov_b64 v[172:173], 0
    v_mov_b64 v[174:175], 0
    v_mov_b64 v[236:237], 0
    v_mov_b64 v[238:239], 0
    s_waitcnt vmcnt(10)
    v_mfma_f32_32x32x16_bf16 v[112:127], v[176:179], v[16:19], 0
    v_mfma_f32_32x32x16_bf16 v[112:127], v[180:183], v[20:23], v[112:127]
    v_mfma_f32_32x32x16_bf16 v[128:143], v[176:179], v[24:27], 0
    v_mfma_f32_32x32x16_bf16 v[128:143], v[180:183], v[28:31], v[128:143]
    s_mov_b32 s15, 0
    s_nop 9
L_att_loop:
    v_exp_f32 v112, v112
    v_exp_f32 v113, v113
    v_smfmac_f32_32x32x32_bf16 v[96:111], v[236:239], v[168:175], v14
    global_load_dwordx4 v[224:227], v5, s[56:57] offset:0
    v_exp_f32 v114, v114
    v_exp_f32 v115, v115
    v_exp_f32 v116, v116
    v_exp_f32 v117, v117
    v_mfma_f32_32x32x16_bf16 v[144:159], v[176:179], v[32:35], 0
    global_load_dwordx4 v[228:231], v5, s[56:57] offset:1024
    v_exp_f32 v118, v118
    v_exp_f32 v119, v119
    v_exp_f32 v120, v120
    v_exp_f32 v121, v121
    v_mfma_f32_32x32x16_bf16 v[144:159], v[180:183], v[36:39], v[144:159]
    global_load_dwordx4 v[232:235], v5, s[56:57] offset:2048
    v_exp_f32 v122, v122
    v_exp_f32 v123, v123
    v_exp_f32 v124, v124
    v_exp_f32 v125, v125
    s_waitcnt vmcnt(11)
    v_smfmac_f32_32x32x32_bf16 v[48:63], v[184:187], v[112:119], v14
    global_load_dwordx4 v[236:239], v5, s[56:57] offset:3072
    v_exp_f32 v126, v126
    v_exp_f32 v127, v127
    v_exp_f32 v128, v128
    v_exp_f32 v129, v129
    v_smfmac_f32_32x32x32_bf16 v[48:63], v[188:191], v[120:127], v14
    s_add_u32 s56, s56, 4096
    s_addc_u32 s57, s57, 0
    v_exp_f32 v130, v130
    v_exp_f32 v131, v131
    v_exp_f32 v132, v132
    v_exp_f32 v133, v133
    v_mfma_f32_32x32x16_bf16 v[160:175], v[176:179], v[40:43], 0
    v_exp_f32 v134, v134
    v_exp_f32 v135, v135
    v_exp_f32 v136, v136
    v_exp_f32 v137, v137
    v_mfma_f32_32x32x16_bf16 v[160:175], v[180:183], v[44:47], v[160:175]
    v_exp_f32 v138, v138
    v_exp_f32 v139, v139
    v_exp_f32 v140, v140
    v_exp_f32 v141, v141
    v_smfmac_f32_32x32x32_bf16 v[64:79], v[184:187], v[128:135], v14
    v_exp_f32 v142, v142
    v_exp_f32 v143, v143
    v_exp_f32 v144, v144
    v_exp_f32 v145, v145
    v_smfmac_f32_32x32x32_bf16 v[64:79], v[188:191], v[136:143], v14
    v_exp_f32 v146, v146
    v_exp_f32 v147, v147
    v_exp_f32 v148, v148
    v_exp_f32 v149, v149
    s_waitcnt vmcnt(10)
    v_mfma_f32_32x32x16_bf16 v[112:127], v[192:195], v[16:19], 0
    v_exp_f32 v150, v150
    v_exp_f32 v151, v151
    v_exp_f32 v152, v152
    v_exp_f32 v153, v153
    v_mfma_f32_32x32x16_bf16 v[112:127], v[196:199], v[20:23], v[112:127]
    v_exp_f32 v154, v154
    v_exp_f32 v155, v155
    v_exp_f32 v156, v156
    v_exp_f32 v157, v157
    v_smfmac_f32_32x32x32_bf16 v[80:95], v[184:187], v[144:151], v14
    v_exp_f32 v158, v158
    v_exp_f32 v159, v159
    v_exp_f32 v160, v160
    v_exp_f32 v161, v161
    v_smfmac_f32_32x32x32_bf16 v[80:95], v[188:191], v[152:159], v14
    v_exp_f32 v162, v162
    v_exp_f32 v163, v163
    v_exp_f32 v164, v164
    v_exp_f32 v165, v165
    v_mfma_f32_32x32x16_bf16 v[128:143], v[192:195], v[24:27], 0
    v_exp_f32 v166, v166
    v_exp_f32 v167, v167
    v_exp_f32 v168, v168
    v_exp_f32 v169, v169
    v_mfma_f32_32x32x16_bf16 v[128:143], v[196:199], v[28:31], v[128:143]
    v_exp_f32 v170, v170
    v_exp_f32 v171, v171
    v_exp_f32 v172, v172
    v_exp_f32 v173, v173
    v_smfmac_f32_32x32x32_bf16 v[96:111], v[184:187], v[160:167], v14
    v_exp_f32 v174, v174
    v_exp_f32 v175, v175
    v_exp_f32 v112, v112
    v_exp_f32 v113, v113
    v_smfmac_f32_32x32x32_bf16 v[96:111], v[188:191], v[168:175], v14
    global_load_dwordx4 v[176:179], v5, s[56:57] offset:0
    v_exp_f32 v114, v114
    v_exp_f32 v115, v115
    v_exp_f32 v116, v116
    v_exp_f32 v117, v117
    v_mfma_f32_32x32x16_bf16 v[144:159], v[192:195], v[32:35], 0
    global_load_dwordx4 v[180:183], v5, s[56:57] offset:1024
    v_exp_f32 v118, v118
    v_exp_f32 v119, v119
    v_exp_f32 v120, v120
    v_exp_f32 v121, v121
    v_mfma_f32_32x32x16_bf16 v[144:159], v[196:199], v[36:39], v[144:159]
    global_load_dwordx4 v[184:187], v5, s[56:57] offset:2048
    v_exp_f32 v122, v122
    v_exp_f32 v123, v123
    v_exp_f32 v124, v124
    v_exp_f32 v125, v125
    s_waitcnt vmcnt(11)
    v_smfmac_f32_32x32x32_bf16 v[48:63], v[200:203], v[112:119], v14
    global_load_dwordx4 v[188:191], v5, s[56:57] offset:3072
    v_exp_f32 v126, v126
    v_exp_f32 v127, v127
    v_exp_f32 v128, v128
    v_exp_f32 v129, v129
    v_smfmac_f32_32x32x32_bf16 v[48:63], v[204:207], v[120:127], v14
    s_add_u32 s56, s56, 4096
    s_addc_u32 s57, s57, 0
    v_exp_f32 v130, v130
    v_exp_f32 v131, v131
    v_exp_f32 v132, v132
    v_exp_f32 v133, v133
    v_mfma_f32_32x32x16_bf16 v[160:175], v[192:195], v[40:43], 0
    v_exp_f32 v134, v134
    v_exp_f32 v135, v135
    v_exp_f32 v136, v136
    v_exp_f32 v137, v137
    v_mfma_f32_32x32x16_bf16 v[160:175], v[196:199], v[44:47], v[160:175]
    v_exp_f32 v138, v138
    v_exp_f32 v139, v139
    v_exp_f32 v140, v140
    v_exp_f32 v141, v141
    v_smfmac_f32_32x32x32_bf16 v[64:79], v[200:203], v[128:135], v14
    v_exp_f32 v142, v142
    v_exp_f32 v143, v143
    v_exp_f32 v144, v144
    v_exp_f32 v145, v145
    v_smfmac_f32_32x32x32_bf16 v[64:79], v[204:207], v[136:143], v14
    v_exp_f32 v146, v146
    v_exp_f32 v147, v147
    v_exp_f32 v148, v148
    v_exp_f32 v149, v149
    s_waitcnt vmcnt(10)
    v_mfma_f32_32x32x16_bf16 v[112:127], v[208:211], v[16:19], 0
    v_exp_f32 v150, v150
    v_exp_f32 v151, v151
    v_exp_f32 v152, v152
    v_exp_f32 v153, v153
    v_mfma_f32_32x32x16_bf16 v[112:127], v[212:215], v[20:23], v[112:127]
    v_exp_f32 v154, v154
    v_exp_f32 v155, v155
    v_exp_f32 v156, v156
    v_exp_f32 v157, v157
    v_smfmac_f32_32x32x32_bf16 v[80:95], v[200:203], v[144:151], v14
    v_exp_f32 v158, v158
    v_exp_f32 v159, v159
    v_exp_f32 v160, v160
    v_exp_f32 v161, v161
    v_smfmac_f32_32x32x32_bf16 v[80:95], v[204:207], v[152:159], v14
    v_exp_f32 v162, v162
    v_exp_f32 v163, v163
    v_exp_f32 v164, v164
    v_exp_f32 v165, v165
    v_mfma_f32_32x32x16_bf16 v[128:143], v[208:211], v[24:27], 0
    v_exp_f32 v166, v166
    v_exp_f32 v167, v167
    v_exp_f32 v168, v168
    v_exp_f32 v169, v169
    v_mfma_f32_32x32x16_bf16 v[128:143], v[212:215], v[28:31], v[128:143]
    v_exp_f32 v170, v170
    v_exp_f32 v171, v171
    v_exp_f32 v172, v172
    v_exp_f32 v173, v173
    v_smfmac_f32_32x32x32_bf16 v[96:111], v[200:203], v[160:167], v14
    v_exp_f32 v174, v174
    v_exp_f32 v175, v175
    v_exp_f32 v112, v112
    v_exp_f32 v113, v113
    v_smfmac_f32_32x32x32_bf16 v[96:111], v[204:207], v[168:175], v14
    global_load_dwordx4 v[192:195], v5, s[56:57] offset:0
    v_exp_f32 v114, v114
    v_exp_f32 v115, v115
    v_exp_f32 v116, v116
    v_exp_f32 v117, v117
    v_mfma_f32_32x32x16_bf16 v[144:159], v[208:211], v[32:35], 0
    global_load_dwordx4 v[196:199], v5, s[56:57] offset:1024
    v_exp_f32 v118, v118
    v_exp_f32 v119, v119
    v_exp_f32 v120, v120
    v_exp_f32 v121, v121
    v_mfma_f32_32x32x16_bf16 v[144:159], v[212:215], v[36:39], v[144:159]
    global_load_dwordx4 v[200:203], v5, s[56:57] offset:2048
    v_exp_f32 v122, v122
    v_exp_f32 v123, v123
    v_exp_f32 v124, v124
    v_exp_f32 v125, v125
    s_waitcnt vmcnt(11)
    v_smfmac_f32_32x32x32_bf16 v[48:63], v[216:219], v[112:119], v14
    global_load_dwordx4 v[204:207], v5, s[56:57] offset:3072
    v_exp_f32 v126, v126
    v_exp_f32 v127, v127
    v_exp_f32 v128, v128
    v_exp_f32 v129, v129
    v_smfmac_f32_32x32x32_bf16 v[48:63], v[220:223], v[120:127], v14
    s_add_u32 s56, s56, 4096
    s_addc_u32 s57, s57, 0
    v_exp_f32 v130, v130
    v_exp_f32 v131, v131
    v_exp_f32 v132, v132
    v_exp_f32 v133, v133
    v_mfma_f32_32x32x16_bf16 v[160:175], v[208:211], v[40:43], 0
    v_exp_f32 v134, v134
    v_exp_f32 v135, v135
    v_exp_f32 v136, v136
    v_exp_f32 v137, v137
    v_mfma_f32_32x32x16_bf16 v[160:175], v[212:215], v[44:47], v[160:175]
    v_exp_f32 v138, v138
    v_exp_f32 v139, v139
    v_exp_f32 v140, v140
    v_exp_f32 v141, v141
    v_smfmac_f32_32x32x32_bf16 v[64:79], v[216:219], v[128:135], v14
    v_exp_f32 v142, v142
    v_exp_f32 v143, v143
    v_exp_f32 v144, v144
    v_exp_f32 v145, v145
    v_smfmac_f32_32x32x32_bf16 v[64:79], v[220:223], v[136:143], v14
    v_exp_f32 v146, v146
    v_exp_f32 v147, v147
    v_exp_f32 v148, v148
    v_exp_f32 v149, v149
    s_waitcnt vmcnt(10)
    v_mfma_f32_32x32x16_bf16 v[112:127], v[224:227], v[16:19], 0
    v_exp_f32 v150, v150
    v_exp_f32 v151, v151
    v_exp_f32 v152, v152
    v_exp_f32 v153, v153
    v_mfma_f32_32x32x16_bf16 v[112:127], v[228:231], v[20:23], v[112:127]
    v_exp_f32 v154, v154
    v_exp_f32 v155, v155
    v_exp_f32 v156, v156
    v_exp_f32 v157, v157
    v_smfmac_f32_32x32x32_bf16 v[80:95], v[216:219], v[144:151], v14
    v_exp_f32 v158, v158
    v_exp_f32 v159, v159
    v_exp_f32 v160, v160
    v_exp_f32 v161, v161
    v_smfmac_f32_32x32x32_bf16 v[80:95], v[220:223], v[152:159], v14
    v_exp_f32 v162, v162
    v_exp_f32 v163, v163
    v_exp_f32 v164, v164
    v_exp_f32 v165, v165
    v_mfma_f32_32x32x16_bf16 v[128:143], v[224:227], v[24:27], 0
    v_exp_f32 v166, v166
    v_exp_f32 v167, v167
    v_exp_f32 v168, v168
    v_exp_f32 v169, v169
    v_mfma_f32_32x32x16_bf16 v[128:143], v[228:231], v[28:31], v[128:143]
    v_exp_f32 v170, v170
    v_exp_f32 v171, v171
    v_exp_f32 v172, v172
    v_exp_f32 v173, v173
    v_smfmac_f32_32x32x32_bf16 v[96:111], v[216:219], v[160:167], v14
    v_exp_f32 v174, v174
    v_exp_f32 v175, v175
    v_exp_f32 v112, v112
    v_exp_f32 v113, v113
    v_smfmac_f32_32x32x32_bf16 v[96:111], v[220:223], v[168:175], v14
    global_load_dwordx4 v[208:211], v5, s[56:57] offset:0
    v_exp_f32 v114, v114
    v_exp_f32 v115, v115
    v_exp_f32 v116, v116
    v_exp_f32 v117, v117
    v_mfma_f32_32x32x16_bf16 v[144:159], v[224:227], v[32:35], 0
    global_load_dwordx4 v[212:215], v5, s[56:57] offset:1024
    v_exp_f32 v118, v118
    v_exp_f32 v119, v119
    v_exp_f32 v120, v120
    v_exp_f32 v121, v121
    v_mfma_f32_32x32x16_bf16 v[144:159], v[228:231], v[36:39], v[144:159]
    global_load_dwordx4 v[216:219], v5, s[56:57] offset:2048
    v_exp_f32 v122, v122
    v_exp_f32 v123, v123
    v_exp_f32 v124, v124
    v_exp_f32 v125, v125
    s_waitcnt vmcnt(11)
    v_smfmac_f32_32x32x32_bf16 v[48:63], v[232:235], v[112:119], v14
    global_load_dwordx4 v[220:223], v5, s[56:57] offset:3072
    v_exp_f32 v126, v126
    v_exp_f32 v127, v127
    v_exp_f32 v128, v128
    v_exp_f32 v129, v129
    v_smfmac_f32_32x32x32_bf16 v[48:63], v[236:239], v[120:127], v14
    s_add_u32 s56, s56, 4096
    s_addc_u32 s57, s57, 0
    v_exp_f32 v130, v130
    v_exp_f32 v131, v131
    v_exp_f32 v132, v132
    v_exp_f32 v133, v133
    v_mfma_f32_32x32x16_bf16 v[160:175], v[224:227], v[40:43], 0
    v_exp_f32 v134, v134
    v_exp_f32 v135, v135
    v_exp_f32 v136, v136
    v_exp_f32 v137, v137
    v_mfma_f32_32x32x16_bf16 v[160:175], v[228:231], v[44:47], v[160:175]
    v_exp_f32 v138, v138
    v_exp_f32 v139, v139
    v_exp_f32 v140, v140
    v_exp_f32 v141, v141
    v_smfmac_f32_32x32x32_bf16 v[64:79], v[232:235], v[128:135], v14
    v_exp_f32 v142, v142
    v_exp_f32 v143, v143
    v_exp_f32 v144, v144
    v_exp_f32 v145, v145
    v_smfmac_f32_32x32x32_bf16 v[64:79], v[236:239], v[136:143], v14
    v_exp_f32 v146, v146
    v_exp_f32 v147, v147
    v_exp_f32 v148, v148
    v_exp_f32 v149, v149
    s_waitcnt vmcnt(10)
    v_mfma_f32_32x32x16_bf16 v[112:127], v[176:179], v[16:19], 0
    v_exp_f32 v150, v150
    v_exp_f32 v151, v151
    v_exp_f32 v152, v152
    v_exp_f32 v153, v153
    v_mfma_f32_32x32x16_bf16 v[112:127], v[180:183], v[20:23], v[112:127]
    v_exp_f32 v154, v154
    v_exp_f32 v155, v155
    v_exp_f32 v156, v156
    v_exp_f32 v157, v157
    v_smfmac_f32_32x32x32_bf16 v[80:95], v[232:235], v[144:151], v14
    v_exp_f32 v158, v158
    v_exp_f32 v159, v159
    v_exp_f32 v160, v160
    v_exp_f32 v161, v161
    v_smfmac_f32_32x32x32_bf16 v[80:95], v[236:239], v[152:159], v14
    v_exp_f32 v162, v162
    v_exp_f32 v163, v163
    v_exp_f32 v164, v164
    v_exp_f32 v165, v165
    v_mfma_f32_32x32x16_bf16 v[128:143], v[176:179], v[24:27], 0
    v_exp_f32 v166, v166
    v_exp_f32 v167, v167
    v_exp_f32 v168, v168
    v_exp_f32 v169, v169
    v_mfma_f32_32x32x16_bf16 v[128:143], v[180:183], v[28:31], v[128:143]
    v_exp_f32 v170, v170
    v_exp_f32 v171, v171
    v_exp_f32 v172, v172
    v_exp_f32 v173, v173
    v_smfmac_f32_32x32x32_bf16 v[96:111], v[232:235], v[160:167], v14
    v_exp_f32 v174, v174
    v_exp_f32 v175, v175
    s_add_u32 s15, s15, 1
    s_cmp_lt_u32 s15, 16
    s_cbranch_scc1 L_att_loop
    v_smfmac_f32_32x32x32_bf16 v[96:111], v[236:239], v[168:175], v14
    s_waitcnt vmcnt(0)
    s_mov_b32 s64, 0
    s_mov_b32 s65, -1
    s_mov_b64 s[66:67], 0
    v_cndmask_b32 v240, v60, v56, s[64:65]
    v_subrev_u32 v12, s80, v240
    v_cmp_lt_u32 vcc, s81, v12
    s_nop 0
    s_or_b64 s[66:67], s[66:67], vcc
    v_cndmask_b32 v241, v76, v72, s[64:65]
    v_subrev_u32 v12, s80, v241
    v_cmp_lt_u32 vcc, s81, v12
    s_nop 0
    s_or_b64 s[66:67], s[66:67], vcc
    v_cndmask_b32 v242, v92, v88, s[64:65]
    v_subrev_u32 v12, s80, v242
    v_cmp_lt_u32 vcc, s81, v12
    s_nop 0
    s_or_b64 s[66:67], s[66:67], vcc
    v_cndmask_b32 v243, v108, v104, s[64:65]
    v_subrev_u32 v12, s80, v243
    v_cmp_lt_u32 vcc, s81, v12
    s_nop 0
    s_or_b64 s[66:67], s[66:67], vcc
    s_cbranch_scc1 L_att_fb
L_att_fin:
    v_cndmask_b32 v240, v60, v56, s[64:65]
    v_rcp_f32 v240, v240
    s_nop 0
    v_pk_mul_f32 v[48:49], v[48:49], v[240:241] op_sel_hi:[1,0]
    v_pk_mul_f32 v[50:51], v[50:51], v[240:241] op_sel_hi:[1,0]
    v_pk_mul_f32 v[52:53], v[52:53], v[240:241] op_sel_hi:[1,0]
    v_pk_mul_f32 v[54:55], v[54:55], v[240:241] op_sel_hi:[1,0]
    v_pk_mul_f32 v[56:57], v[56:57], v[240:241] op_sel_hi:[1,0]
    v_pk_mul_f32 v[58:59], v[58:59], v[240:241] op_sel_hi:[1,0]
    v_cvt_pk_bf16_f32 v112, v48, v49
    v_cvt_pk_bf16_f32 v113, v50, v51
    v_cvt_pk_bf16_f32 v114, v52, v53
    v_cvt_pk_bf16_f32 v115, v54, v55
    v_cvt_pk_bf16_f32 v116, v56, v57
    v_cvt_pk_bf16_f32 v117, v58, v59
    global_store_dwordx2 v9, v[112:113], s[38:39] offset:0 sc1
    global_store_dwordx2 v9, v[114:115], s[38:39] offset:16 sc1
    v_cndmask_b32 v240, v76, v72, s[64:65]
    v_rcp_f32 v240, v240
    s_nop 0
    v_pk_mul_f32 v[64:65], v[64:65], v[240:241] op_sel_hi:[1,0]
    v_pk_mul_f32 v[66:67], v[66:67], v[240:241] op_sel_hi:[1,0]
    v_pk_mul_f32 v[68:69], v[68:69], v[240:241] op_sel_hi:[1,0]
    v_pk_mul_f32 v[70:71], v[70:71], v[240:241] op_sel_hi:[1,0]
    v_pk_mul_f32 v[72:73], v[72:73], v[240:241] op_sel_hi:[1,0]
    v_pk_mul_f32 v[74:75], v[74:75], v[240:241] op_sel_hi:[1,0]
    v_cvt_pk_bf16_f32 v120, v64, v65
    v_cvt_pk_bf16_f32 v121, v66, v67
    v_cvt_pk_bf16_f32 v122, v68, v69
    v_cvt_pk_bf16_f32 v123, v70, v71
    v_cvt_pk_bf16_f32 v124, v72, v73
    v_cvt_pk_bf16_f32 v125, v74, v75
    global_store_dwordx2 v9, v[120:121], s[38:39] offset:1280 sc1
    global_store_dwordx2 v9, v[122:123], s[38:39] offset:1296 sc1
    v_cndmask_b32 v240, v92, v88, s[64:65]
    v_rcp_f32 v240, v240
    s_nop 0
    v_pk_mul_f32 v[80:81], v[80:81], v[240:241] op_sel_hi:[1,0]
    v_pk_mul_f32 v[82:83], v[82:83], v[240:241] op_sel_hi:[1,0]
    v_pk_mul_f32 v[84:85], v[84:85], v[240:241] op_sel_hi:[1,0]
    v_pk_mul_f32 v[86:87], v[86:87], v[240:241] op_sel_hi:[1,0]
    v_pk_mul_f32 v[88:89], v[88:89], v[240:241] op_sel_hi:[1,0]
    v_pk_mul_f32 v[90:91], v[90:91], v[240:241] op_sel_hi:[1,0]
    v_cvt_pk_bf16_f32 v128, v80, v81
    v_cvt_pk_bf16_f32 v129, v82, v83
    v_cvt_pk_bf16_f32 v130, v84, v85
    v_cvt_pk_bf16_f32 v131, v86, v87
    v_cvt_pk_bf16_f32 v132, v88, v89
    v_cvt_pk_bf16_f32 v133, v90, v91
    global_store_dwordx2 v9, v[128:129], s[38:39] offset:2560 sc1
    global_store_dwordx2 v9, v[130:131], s[38:39] offset:2576 sc1
    v_cndmask_b32 v240, v108, v104, s[64:65]
    v_rcp_f32 v240, v240
    s_nop 0
    v_pk_mul_f32 v[96:97], v[96:97], v[240:241] op_sel_hi:[1,0]
    v_pk_mul_f32 v[98:99], v[98:99], v[240:241] op_sel_hi:[1,0]
    v_pk_mul_f32 v[100:101], v[100:101], v[240:241] op_sel_hi:[1,0]
    v_pk_mul_f32 v[102:103], v[102:103], v[240:241] op_sel_hi:[1,0]
    v_pk_mul_f32 v[104:105], v[104:105], v[240:241] op_sel_hi:[1,0]
    v_pk_mul_f32 v[106:107], v[106:107], v[240:241] op_sel_hi:[1,0]
    v_cvt_pk_bf16_f32 v136, v96, v97
    v_cvt_pk_bf16_f32 v137, v98, v99
    v_cvt_pk_bf16_f32 v138, v100, v101
    v_cvt_pk_bf16_f32 v139, v102, v103
    v_cvt_pk_bf16_f32 v140, v104, v105
    v_cvt_pk_bf16_f32 v141, v106, v107
    global_store_dwordx2 v9, v[136:137], s[38:39] offset:3840 sc1
    global_store_dwordx2 v9, v[138:139], s[38:39] offset:3856 sc1
    s_mov_b32 exec_hi, 0
    global_store_dwordx2 v9, v[116:117], s[38:39] offset:32 sc1
    global_store_dwordx2 v9, v[124:125], s[38:39] offset:1312 sc1
    global_store_dwordx2 v9, v[132:133], s[38:39] offset:2592 sc1
    global_store_dwordx2 v9, v[140:141], s[38:39] offset:3872 sc1
    s_mov_b64 exec, -1
    s_add_u32 s12, s42, 208
    s_lshl_b32 s12, s12, 7
    s_add_u32 s44, s6, s12
    s_addc_u32 s45, s7, 0
    s_waitcnt vmcnt(0)
    s_barrier
    s_cmp_lg_u32 s4, 0
    s_cbranch_scc1 L_sg_45
    s_mov_b64 exec, 1
    v_mov_b32 v12, 0
    v_mov_b32 v13, 1
    global_atomic_add v12, v13, s[44:45]
    s_mov_b64 exec, -1
L_sg_45:
    s_branch L_queue
L_att_fb:
    v_mov_b32 v244, 0xff800000
    v_mov_b32 v245, 0xff800000
    v_mov_b32 v246, 0xff800000
    v_mov_b32 v247, 0xff800000
    s_add_u32 s56, s6, 8126464
    s_addc_u32 s57, s7, 0
    s_mov_b32 s15, 0
L_att_fb0:
    global_load_dwordx4 v[176:179], v5, s[56:57] offset:0
    global_load_dwordx4 v[180:183], v5, s[56:57] offset:1024
    global_load_dwordx4 v[184:187], v5, s[56:57] offset:2048
    global_load_dwordx4 v[188:191], v5, s[56:57] offset:3072
    s_add_u32 s56, s56, 4096
    s_addc_u32 s57, s57, 0
    s_waitcnt vmcnt(0)
    v_mfma_f32_32x32x16_bf16 v[112:127], v[176:179], v[16:19], 0
    v_mfma_f32_32x32x16_bf16 v[112:127], v[180:183], v[20:23], v[112:127]
    v_mfma_f32_32x32x16_bf16 v[128:143], v[176:179], v[24:27], 0
    v_mfma_f32_32x32x16_bf16 v[128:143], v[180:183], v[28:31], v[128:143]
    v_mfma_f32_32x32x16_bf16 v[144:159], v[176:179], v[32:35], 0
    v_mfma_f32_32x32x16_bf16 v[144:159], v[180:183], v[36:39], v[144:159]
    v_mfma_f32_32x32x16_bf16 v[160:175], v[176:179], v[40:43], 0
    v_mfma_f32_32x32x16_bf16 v[160:175], v[180:183], v[44:47], v[160:175]
    s_nop 5
    v_max3_f32 v244, v244, v112, v113
    v_max3_f32 v244, v244, v114, v115
    v_max3_f32 v244, v244, v116, v117
    v_max3_f32 v244, v244, v118, v119
    v_max3_f32 v244, v244, v120, v121
    v_max3_f32 v244, v244, v122, v123
    v_max3_f32 v244, v244, v124, v125
    v_max3_f32 v244, v244, v126, v127
    v_max3_f32 v245, v245, v128, v129
    v_max3_f32 v245, v245, v130, v131
    v_max3_f32 v245, v245, v132, v133
    v_max3_f32 v245, v245, v134, v135
    v_max3_f32 v245, v245, v136, v137
    v_max3_f32 v245, v245, v138, v139
    v_max3_f32 v245, v245, v140, v141
    v_max3_f32 v245, v245, v142, v143
    v_max3_f32 v246, v246, v144, v145
    v_max3_f32 v246, v246, v146, v147
    v_max3_f32 v246, v246, v148, v149
    v_max3_f32 v246, v246, v150, v151
    v_max3_f32 v246, v246, v152, v153
    v_max3_f32 v246, v246, v154, v155
    v_max3_f32 v246, v246, v156, v157
    v_max3_f32 v246, v246, v158, v159
    v_max3_f32 v247, v247, v160, v161
    v_max3_f32 v247, v247, v162, v163
    v_max3_f32 v247, v247, v164, v165
    v_max3_f32 v247, v247, v166, v167
    v_max3_f32 v247, v247, v168, v169
    v_max3_f32 v247, v247, v170, v171
    v_max3_f32 v247, v247, v172, v173
    v_max3_f32 v247, v247, v174, v175
    s_add_u32 s15, s15, 1
    s_cmp_lt_u32 s15, 64
    s_cbranch_scc1 L_att_fb0
    v_mov_b32 v240, v244
    s_nop 1
    v_permlane32_swap_b32 v244, v240
    v_max_f32 v244, v244, v240
    v_mov_b32 v240, v245
    s_nop 1
    v_permlane32_swap_b32 v245, v240
    v_max_f32 v245, v245, v240
    v_mov_b32 v240, v246
    s_nop 1
    v_permlane32_swap_b32 v246, v240
    v_max_f32 v246, v246, v240
    v_mov_b32 v240, v247
    s_nop 1
    v_permlane32_swap_b32 v247, v240
    v_max_f32 v247, v247, v240
    s_add_u32 s56, s6, 8126464
    s_addc_u32 s57, s7, 0
    s_mov_b32 s15, 0
    v_mov_b64 v[48:49], 0
    v_mov_b64 v[50:51], 0
    v_mov_b64 v[52:53], 0
    v_mov_b64 v[54:55], 0
    v_mov_b64 v[56:57], 0
    v_mov_b64 v[58:59], 0
    v_mov_b64 v[60:61], 0
    v_mov_b64 v[62:63], 0
    v_mov_b64 v[64:65], 0
    v_mov_b64 v[66:67], 0
    v_mov_b64 v[68:69], 0
    v_mov_b64 v[70:71], 0
    v_mov_b64 v[72:73], 0
    v_mov_b64 v[74:75], 0
    v_mov_b64 v[76:77], 0
    v_mov_b64 v[78:79], 0
    v_mov_b64 v[80:81], 0
    v_mov_b64 v[82:83], 0
    v_mov_b64 v[84:85], 0
    v_mov_b64 v[86:87], 0
    v_mov_b64 v[88:89], 0
    v_mov_b64 v[90:91], 0
    v_mov_b64 v[92:93], 0
    v_mov_b64 v[94:95], 0
    v_mov_b64 v[96:97], 0
    v_mov_b64 v[98:99], 0
    v_mov_b64 v[100:101], 0
    v_mov_b64 v[102:103], 0
    v_mov_b64 v[104:105], 0
    v_mov_b64 v[106:107], 0
    v_mov_b64 v[108:109], 0
    v_mov_b64 v[110:111], 0
L_att_fb1:
    global_load_dwordx4 v[176:179], v5, s[56:57] offset:0
    global_load_dwordx4 v[180:183], v5, s[56:57] offset:1024
    global_load_dwordx4 v[184:187], v5, s[56:57] offset:2048
    global_load_dwordx4 v[188:191], v5, s[56:57] offset:3072
    s_add_u32 s56, s56, 4096
    s_addc_u32 s57, s57, 0
    s_waitcnt vmcnt(0)
    v_mfma_f32_32x32x16_bf16 v[112:127], v[176:179], v[16:19], 0
    v_mfma_f32_32x32x16_bf16 v[112:127], v[180:183], v[20:23], v[112:127]
    v_mfma_f32_32x32x16_bf16 v[128:143], v[176:179], v[24:27], 0
    v_mfma_f32_32x32x16_bf16 v[128:143], v[180:183], v[28:31], v[128:143]
    v_mfma_f32_32x32x16_bf16 v[144:159], v[176:179], v[32:35], 0
    v_mfma_f32_32x32x16_bf16 v[144:159], v[180:183], v[36:39], v[144:159]
    v_mfma_f32_32x32x16_bf16 v[160:175], v[176:179], v[40:43], 0
    v_mfma_f32_32x32x16_bf16 v[160:175], v[180:183], v[44:47], v[160:175]
    s_nop 5
    v_sub_f32 v112, v112, v244
    v_sub_f32 v113, v113, v244
    v_sub_f32 v114, v114, v244
    v_sub_f32 v115, v115, v244
    v_sub_f32 v116, v116, v244
    v_sub_f32 v117, v117, v244
    v_sub_f32 v118, v118, v244
    v_sub_f32 v119, v119, v244
    v_sub_f32 v120, v120, v244
    v_sub_f32 v121, v121, v244
    v_sub_f32 v122, v122, v244
    v_sub_f32 v123, v123, v244
    v_sub_f32 v124, v124, v244
    v_sub_f32 v125, v125, v244
    v_sub_f32 v126, v126, v244
    v_sub_f32 v127, v127, v244
    v_exp_f32 v112, v112
    v_exp_f32 v113, v113
    v_exp_f32 v114, v114
    v_exp_f32 v115, v115
    v_exp_f32 v116, v116
    v_exp_f32 v117, v117
    v_exp_f32 v118, v118
    v_exp_f32 v119, v119
    v_exp_f32 v120, v120
    v_exp_f32 v121, v121
    v_exp_f32 v122, v122
    v_exp_f32 v123, v123
    v_exp_f32 v124, v124
    v_exp_f32 v125, v125
    v_exp_f32 v126, v126
    v_exp_f32 v127, v127
    v_smfmac_f32_32x32x32_bf16 v[48:63], v[184:187], v[112:119], v14
    s_nop 0
    v_smfmac_f32_32x32x32_bf16 v[48:63], v[188:191], v[120:127], v14
    v_sub_f32 v128, v128, v245
    v_sub_f32 v129, v129, v245
    v_sub_f32 v130, v130, v245
    v_sub_f32 v131, v131, v245
    v_sub_f32 v132, v132, v245
    v_sub_f32 v133, v133, v245
    v_sub_f32 v134, v134, v245
    v_sub_f32 v135, v135, v245
    v_sub_f32 v136, v136, v245
    v_sub_f32 v137, v137, v245
    v_sub_f32 v138, v138, v245
    v_sub_f32 v139, v139, v245
    v_sub_f32 v140, v140, v245
    v_sub_f32 v141, v141, v245
    v_sub_f32 v142, v142, v245
    v_sub_f32 v143, v143, v245
    v_exp_f32 v128, v128
    v_exp_f32 v129, v129
    v_exp_f32 v130, v130
    v_exp_f32 v131, v131
    v_exp_f32 v132, v132
    v_exp_f32 v133, v133
    v_exp_f32 v134, v134
    v_exp_f32 v135, v135
    v_exp_f32 v136, v136
    v_exp_f32 v137, v137
    v_exp_f32 v138, v138
    v_exp_f32 v139, v139
    v_exp_f32 v140, v140
    v_exp_f32 v141, v141
    v_exp_f32 v142, v142
    v_exp_f32 v143, v143
    v_smfmac_f32_32x32x32_bf16 v[64:79], v[184:187], v[128:135], v14
    s_nop 0
    v_smfmac_f32_32x32x32_bf16 v[64:79], v[188:191], v[136:143], v14
    v_sub_f32 v144, v144, v246
    v_sub_f32 v145, v145, v246
    v_sub_f32 v146, v146, v246
    v_sub_f32 v147, v147, v246
    v_sub_f32 v148, v148, v246
    v_sub_f32 v149, v149, v246
    v_sub_f32 v150, v150, v246
    v_sub_f32 v151, v151, v246
    v_sub_f32 v152, v152, v246
    v_sub_f32 v153, v153, v246
    v_sub_f32 v154, v154, v246
    v_sub_f32 v155, v155, v246
    v_sub_f32 v156, v156, v246
    v_sub_f32 v157, v157, v246
    v_sub_f32 v158, v158, v246
    v_sub_f32 v159, v159, v246
    v_exp_f32 v144, v144
    v_exp_f32 v145, v145
    v_exp_f32 v146, v146
    v_exp_f32 v147, v147
    v_exp_f32 v148, v148
    v_exp_f32 v149, v149
    v_exp_f32 v150, v150
    v_exp_f32 v151, v151
    v_exp_f32 v152, v152
    v_exp_f32 v153, v153
    v_exp_f32 v154, v154
    v_exp_f32 v155, v155
    v_exp_f32 v156, v156
    v_exp_f32 v157, v157
    v_exp_f32 v158, v158
    v_exp_f32 v159, v159
    v_smfmac_f32_32x32x32_bf16 v[80:95], v[184:187], v[144:151], v14
    s_nop 0
    v_smfmac_f32_32x32x32_bf16 v[80:95], v[188:191], v[152:159], v14
    v_sub_f32 v160, v160, v247
    v_sub_f32 v161, v161, v247
    v_sub_f32 v162, v162, v247
    v_sub_f32 v163, v163, v247
    v_sub_f32 v164, v164, v247
    v_sub_f32 v165, v165, v247
    v_sub_f32 v166, v166, v247
    v_sub_f32 v167, v167, v247
    v_sub_f32 v168, v168, v247
    v_sub_f32 v169, v169, v247
    v_sub_f32 v170, v170, v247
    v_sub_f32 v171, v171, v247
    v_sub_f32 v172, v172, v247
    v_sub_f32 v173, v173, v247
    v_sub_f32 v174, v174, v247
    v_sub_f32 v175, v175, v247
    v_exp_f32 v160, v160
    v_exp_f32 v161, v161
    v_exp_f32 v162, v162
    v_exp_f32 v163, v163
    v_exp_f32 v164, v164
    v_exp_f32 v165, v165
    v_exp_f32 v166, v166
    v_exp_f32 v167, v167
    v_exp_f32 v168, v168
    v_exp_f32 v169, v169
    v_exp_f32 v170, v170
    v_exp_f32 v171, v171
    v_exp_f32 v172, v172
    v_exp_f32 v173, v173
    v_exp_f32 v174, v174
    v_exp_f32 v175, v175
    v_smfmac_f32_32x32x32_bf16 v[96:111], v[184:187], v[160:167], v14
    s_nop 0
    v_smfmac_f32_32x32x32_bf16 v[96:111], v[188:191], v[168:175], v14
    s_add_u32 s15, s15, 1
    s_cmp_lt_u32 s15, 64
    s_cbranch_scc1 L_att_fb1
    s_branch L_att_fin
L_done:
    s_branch L_end
L_redo:
    s_waitcnt vmcnt(0) lgkmcnt(0)
    s_and_b32 s3, s97, 0xffff
    s_lshr_b32 s10, s97, 16
    s_mov_b32 s86, 2
    v_mbcnt_lo_u32_b32 v0, -1, 0
    v_mbcnt_hi_u32_b32 v0, -1, v0
    s_lshl_b32 s96, s4, 6
    v_add_u32 v0, s96, v0
    s_branch L_dispatch
L_bail1:
    s_mov_b32 s12, 1
    s_branch L_bail
L_bail2:
    s_mov_b32 s12, 2
    s_branch L_bail
L_bail3:
    s_mov_b32 s12, 3
    s_branch L_bail
L_bail4:
    s_mov_b32 s12, 4
    s_branch L_bail
L_bail5:
    s_mov_b32 s12, 5
    s_branch L_bail
L_bail6:
    s_mov_b32 s12, 6
    s_branch L_bail
L_bail7:
    s_mov_b32 s12, 7
    s_branch L_bail
L_bail8:
    s_mov_b32 s12, 8
    s_branch L_bail
L_bail9:
    s_mov_b32 s12, 9
    s_branch L_bail
L_bail10:
    s_mov_b32 s12, 10
    s_branch L_bail
L_bail11:
    s_mov_b32 s12, 11
    s_branch L_bail
L_bail12:
    s_mov_b32 s12, 12
    s_branch L_bail
L_bail13:
    s_mov_b32 s12, 13
    s_branch L_bail
L_bail14:
    s_mov_b32 s12, 14
    s_branch L_bail
L_bail15:
    s_mov_b32 s12, 15
    s_branch L_bail
L_bail:
    s_mov_b64 exec, 1
    v_mov_b32 v2, s12
    v_mov_b32 v1, 60
    global_store_dword v1, v2, s[8:9] sc1
    s_waitcnt vmcnt(0)
L_end:
    s_endpgm
L_chain:
    s_or_b32 s96, s4, s86
    s_cbranch_scc1 L_ar_46
    v_mbcnt_lo_u32_b32 v203, -1, 0
    v_mbcnt_hi_u32_b32 v203, -1, v203
    s_lshl_b32 s96, s2, 8
    v_lshl_add_u32 v203, v203, 2, s96
    v_mov_b32 v204, 0
    global_store_dword v203, v204, s[6:7] sc1
L_ar_46:
    s_lshr_b32 s11, s3, 5
    s_and_b32 s12, s3, 31
    s_load_dwordx8 s[60:67], s[0:1], 48
    s_load_dwordx2 s[68:69], s[0:1], 80
    v_lshlrev_b32 v3, 4, v0
    v_add_u32 v4, 0x10000, v3
    v_add_u32 v5, 0x20000, v3
    v_lshlrev_b32 v6, 2, v0
    v_add_u32 v6, 0x1000, v6
    v_and_b32 v200, 63, v0
    v_and_b32 v201, 15, v0
    v_lshlrev_b32 v2, 4, v200
    v_bfe_u32 v202, v0, 4, 2
    v_lshrrev_b32 v205, 5, v200
    v_and_b32 v206, 1, v202
    v_lshlrev_b32 v203, 4, v205
    v_lshl_add_u32 v211, v206, 2, v203
    s_lshl_b32 s17, s4, 6
    s_mul_i32 s18, s11, 2621440
    s_add_u32 s17, s17, s18
    v_lshlrev_b32 v203, 13, v211
    v_lshl_add_u32 v203, v201, 2, v203
    v_add_u32 v0, s17, v203
    s_mov_b32 s24, 0
    s_mov_b32 s25, 8192
    s_mov_b32 s26, 65536
    s_mov_b32 s27, 73728
    s_mov_b32 s28, 16384
    s_mov_b32 s29, 24576
    s_mov_b32 s30, 81920
    s_mov_b32 s31, 90112
    s_mov_b32 s32, 262144
    s_mov_b32 s33, 270336
    s_mov_b32 s34, 327680
    s_mov_b32 s35, 335872
    s_mov_b32 s36, 278528
    s_mov_b32 s37, 286720
    s_mov_b32 s38, 344064
    s_mov_b32 s39, 352256
    s_mov_b32 s72, 0x05040100
    s_mov_b32 s73, 0x07060302
    s_lshl_b32 s18, s18, 1
    s_sub_u32 s74, 524288, s18
    s_sub_u32 s75, s18, 4718592
    s_lshl_b32 s76, s12, 8
    s_waitcnt lgkmcnt(0)
    s_add_u32 s20, s62, s76
    s_addc_u32 s21, s63, 0
    s_and_b32 s21, s21, 0xffff
    s_sub_u32 s22, 5242880, s76
    s_mov_b32 s23, 0x20000
    buffer_load_dword v14, v0, s[20:23], s24 offen
    buffer_load_dword v15, v0, s[20:23], s25 offen
    buffer_load_dword v16, v0, s[20:23], s26 offen
    buffer_load_dword v17, v0, s[20:23], s27 offen
    buffer_load_dword v18, v0, s[20:23], s28 offen
    buffer_load_dword v19, v0, s[20:23], s29 offen
    buffer_load_dword v20, v0, s[20:23], s30 offen
    buffer_load_dword v21, v0, s[20:23], s31 offen
    buffer_load_dword v22, v0, s[20:23], s32 offen
    buffer_load_dword v23, v0, s[20:23], s33 offen
    buffer_load_dword v24, v0, s[20:23], s34 offen
    buffer_load_dword v25, v0, s[20:23], s35 offen
    buffer_load_dword v26, v0, s[20:23], s36 offen
    buffer_load_dword v27, v0, s[20:23], s37 offen
    buffer_load_dword v28, v0, s[20:23], s38 offen
    buffer_load_dword v29, v0, s[20:23], s39 offen
    v_add_u32 v0, 524288, v0
    buffer_load_dword v30, v0, s[20:23], s24 offen
    buffer_load_dword v31, v0, s[20:23], s25 offen
    buffer_load_dword v32, v0, s[20:23], s26 offen
    buffer_load_dword v33, v0, s[20:23], s27 offen
    buffer_load_dword v34, v0, s[20:23], s28 offen
    buffer_load_dword v35, v0, s[20:23], s29 offen
    buffer_load_dword v36, v0, s[20:23], s30 offen
    buffer_load_dword v37, v0, s[20:23], s31 offen
    buffer_load_dword v38, v0, s[20:23], s32 offen
    buffer_load_dword v39, v0, s[20:23], s33 offen
    buffer_load_dword v40, v0, s[20:23], s34 offen
    buffer_load_dword v41, v0, s[20:23], s35 offen
    buffer_load_dword v42, v0, s[20:23], s36 offen
    buffer_load_dword v43, v0, s[20:23], s37 offen
    buffer_load_dword v44, v0, s[20:23], s38 offen
    buffer_load_dword v45, v0, s[20:23], s39 offen
    v_add_u32 v0, 524288, v0
    buffer_load_dword v46, v0, s[20:23], s24 offen
    buffer_load_dword v47, v0, s[20:23], s25 offen
    buffer_load_dword v48, v0, s[20:23], s26 offen
    buffer_load_dword v49, v0, s[20:23], s27 offen
    buffer_load_dword v50, v0, s[20:23], s28 offen
    buffer_load_dword v51, v0, s[20:23], s29 offen
    buffer_load_dword v52, v0, s[20:23], s30 offen
    buffer_load_dword v53, v0, s[20:23], s31 offen
    buffer_load_dword v54, v0, s[20:23], s32 offen
    buffer_load_dword v55, v0, s[20:23], s33 offen
    buffer_load_dword v56, v0, s[20:23], s34 offen
    buffer_load_dword v57, v0, s[20:23], s35 offen
    buffer_load_dword v58, v0, s[20:23], s36 offen
    buffer_load_dword v59, v0, s[20:23], s37 offen
    buffer_load_dword v60, v0, s[20:23], s38 offen
    buffer_load_dword v61, v0, s[20:23], s39 offen
    v_add_u32 v0, 524288, v0
    v_bfe_u32 v203, v200, 1, 1
    v_mul_u32_u24 v203, 0xaaaa, v203
    v_add_u32 v1, 0x4444, v203
    s_lshl_b32 s17, s4, 15
    s_lshl_b32 s18, s12, 6
    s_add_u32 s17, s17, s18
    v_lshrrev_b32 v203, 3, v201
    v_lshl_add_u32 v203, v203, 2, v202
    v_lshlrev_b32 v203, 11, v203
    v_and_b32 v204, 7, v201
    v_lshl_add_u32 v203, v204, 3, v203
    v_add_u32 v7, s17, v203
    s_lshl_b32 s17, s4, 13
    s_add_u32 s17, s17, s18
    s_add_u32 s17, s17, 0x20000
    v_lshlrev_b32 v203, 11, v202
    v_lshl_add_u32 v203, v201, 2, v203
    v_add_u32 v8, s17, v203
    s_lshl_b32 s13, s4, 5
    s_add_u32 s13, s13, s12
    s_cmp_lt_u32 s13, 80
    s_cselect_b32 s19, 1, 0
    s_cselect_b32 s13, s13, 0
    v_and_b32 v203, 3, v200
    v_lshl_add_u32 v203, v202, 2, v203
    v_lshlrev_b32 v203, 6, v203
    v_lshrrev_b32 v204, 2, v201
    v_lshl_add_u32 v203, v204, 4, v203
    s_lshl_b32 s17, s13, 11
    v_add_u32 v9, s17, v203
    v_bfe_u32 v203, v201, 1, 1
    v_lshl_add_u32 v208, v205, 1, v203
    v_bfe_u32 v203, v201, 2, 1
    v_lshlrev_b32 v203, 1, v203
    v_lshl_add_u32 v209, v206, 2, v203
    s_lshl_b32 s17, s13, 6
    v_lshlrev_b32 v203, 1, v209
    v_lshl_add_u32 v203, v208, 4, v203
    v_add_u32 v10, s17, v203
    s_lshl_b32 s17, s4, 6
    v_mul_u32_u24 v203, 576, v202
    v_lshl_add_u32 v203, v201, 2, v203
    v_add_u32 v11, s17, v203
    v_lshrrev_b32 v203, 2, v201
    v_and_b32 v204, 1, v201
    v_lshl_add_u32 v207, v203, 1, v204
    v_mul_u32_u24 v207, 288, v207
    v_lshl_add_u32 v12, v202, 4, v207
    s_lshl_b32 s17, s4, 9
    v_lshlrev_b32 v203, 1, v203
    v_add_u32 v203, v203, v206
    v_lshl_add_u32 v203, v203, 1, v204
    v_lshlrev_b32 v203, 4, v203
    v_lshl_add_u32 v203, v205, 8, v203
    v_add_u32 v13, s17, v203
    v_and_b32 v203, 12, v201
    v_and_b32 v204, 1, v201
    v_lshl_add_u32 v203, v204, 1, v203
    v_bfe_u32 v204, v201, 1, 1
    v_add_u32 v203, v203, v204
    s_cmp_eq_u32 s4, 2
    s_cselect_b64 vcc, -1, 0
    v_cndmask_b32 v203, v201, v203, vcc
    v_mov_b32 v204, 0x3f80
    v_mov_b32 v207, 0x3f800000
    v_cmp_eq_u32 vcc, 0, v203
    s_nop 1
    v_cndmask_b32 v192, 0, v204, vcc
    v_cmp_eq_u32 vcc, 1, v203
    s_nop 1
    v_cndmask_b32 v192, v192, v207, vcc
    v_cmp_eq_u32 vcc, 2, v203
    s_nop 1
    v_cndmask_b32 v193, 0, v204, vcc
    v_cmp_eq_u32 vcc, 3, v203
    s_nop 1
    v_cndmask_b32 v193, v193, v207, vcc
    v_cmp_eq_u32 vcc, 4, v203
    s_nop 1
    v_cndmask_b32 v194, 0, v204, vcc
    v_cmp_eq_u32 vcc, 5, v203
    s_nop 1
    v_cndmask_b32 v194, v194, v207, vcc
    v_cmp_eq_u32 vcc, 6, v203
    s_nop 1
    v_cndmask_b32 v195, 0, v204, vcc
    v_cmp_eq_u32 vcc, 7, v203
    s_nop 1
    v_cndmask_b32 v195, v195, v207, vcc
    ds_write_b128 v3, v[192:195] offset:26624
    s_and_b32 s17, s13, 3
    s_mul_i32 s17, s17, 2560
    s_lshr_b32 s18, s13, 2
    s_lshl_b32 s18, s18, 5
    s_add_u32 s17, s17, s18
    s_mul_i32 s18, s11, 640
    s_add_u32 s17, s17, s18
    v_bfe_u32 v203, v201, 1, 1
    v_mul_u32_u24 v203, 1280, v203
    v_lshl_add_u32 v203, v202, 3, v203
    v_bfe_u32 v204, v201, 2, 1
    v_lshl_add_u32 v203, v204, 2, v203
    v_add_u32 v203, s17, v203
    global_load_dword v210, v203, s[60:61]
    s_mov_b32 s44, 0x3e0293ee
    s_mov_b32 s45, 0x3e0293ee
    s_mov_b32 s54, 0x21800000
    s_mov_b32 s55, 0x3c000000
    s_mov_b32 s58, 0x00550055
    s_mov_b32 s59, 0x00550055
    s_mov_b32 s70, 0x33333333
    s_mov_b32 s71, 0x33333333
    s_waitcnt vmcnt(33)
    v_perm_b32 v62, v15, v14, s72
    v_accvgpr_write_b32 a0, v62
    v_perm_b32 v62, v15, v14, s73
    v_accvgpr_write_b32 a8, v62
    v_perm_b32 v63, v17, v16, s72
    v_accvgpr_write_b32 a1, v63
    v_perm_b32 v63, v17, v16, s73
    v_accvgpr_write_b32 a9, v63
    v_perm_b32 v64, v19, v18, s72
    v_accvgpr_write_b32 a2, v64
    v_perm_b32 v64, v19, v18, s73
    v_accvgpr_write_b32 a10, v64
    v_perm_b32 v65, v21, v20, s72
    v_accvgpr_write_b32 a3, v65
    v_perm_b32 v65, v21, v20, s73
    v_accvgpr_write_b32 a11, v65
    v_perm_b32 v66, v23, v22, s72
    v_accvgpr_write_b32 a4, v66
    v_perm_b32 v66, v23, v22, s73
    v_accvgpr_write_b32 a12, v66
    v_perm_b32 v67, v25, v24, s72
    v_accvgpr_write_b32 a5, v67
    v_perm_b32 v67, v25, v24, s73
    v_accvgpr_write_b32 a13, v67
    v_perm_b32 v68, v27, v26, s72
    v_accvgpr_write_b32 a6, v68
    v_perm_b32 v68, v27, v26, s73
    v_accvgpr_write_b32 a14, v68
    v_perm_b32 v69, v29, v28, s72
    v_accvgpr_write_b32 a7, v69
    v_perm_b32 v69, v29, v28, s73
    v_accvgpr_write_b32 a15, v69
    buffer_load_dword v14, v0, s[20:23], s24 offen
    buffer_load_dword v15, v0, s[20:23], s25 offen
    buffer_load_dword v16, v0, s[20:23], s26 offen
    buffer_load_dword v17, v0, s[20:23], s27 offen
    buffer_load_dword v18, v0, s[20:23], s28 offen
    buffer_load_dword v19, v0, s[20:23], s29 offen
    buffer_load_dword v20, v0, s[20:23], s30 offen
    buffer_load_dword v21, v0, s[20:23], s31 offen
    buffer_load_dword v22, v0, s[20:23], s32 offen
    buffer_load_dword v23, v0, s[20:23], s33 offen
    buffer_load_dword v24, v0, s[20:23], s34 offen
    buffer_load_dword v25, v0, s[20:23], s35 offen
    buffer_load_dword v26, v0, s[20:23], s36 offen
    buffer_load_dword v27, v0, s[20:23], s37 offen
    buffer_load_dword v28, v0, s[20:23], s38 offen
    buffer_load_dword v29, v0, s[20:23], s39 offen
    v_add_u32 v0, 524288, v0
    s_waitcnt vmcnt(33)
    v_perm_b32 v62, v31, v30, s72
    v_accvgpr_write_b32 a16, v62
    v_perm_b32 v62, v31, v30, s73
    v_accvgpr_write_b32 a24, v62
    v_perm_b32 v63, v33, v32, s72
    v_accvgpr_write_b32 a17, v63
    v_perm_b32 v63, v33, v32, s73
    v_accvgpr_write_b32 a25, v63
    v_perm_b32 v64, v35, v34, s72
    v_accvgpr_write_b32 a18, v64
    v_perm_b32 v64, v35, v34, s73
    v_accvgpr_write_b32 a26, v64
    v_perm_b32 v65, v37, v36, s72
    v_accvgpr_write_b32 a19, v65
    v_perm_b32 v65, v37, v36, s73
    v_accvgpr_write_b32 a27, v65
    v_perm_b32 v66, v39, v38, s72
    v_accvgpr_write_b32 a20, v66
    v_perm_b32 v66, v39, v38, s73
    v_accvgpr_write_b32 a28, v66
    v_perm_b32 v67, v41, v40, s72
    v_accvgpr_write_b32 a21, v67
    v_perm_b32 v67, v41, v40, s73
    v_accvgpr_write_b32 a29, v67
    v_perm_b32 v68, v43, v42, s72
    v_accvgpr_write_b32 a22, v68
    v_perm_b32 v68, v43, v42, s73
    v_accvgpr_write_b32 a30, v68
    v_perm_b32 v69, v45, v44, s72
    v_accvgpr_write_b32 a23, v69
    v_perm_b32 v69, v45, v44, s73
    v_accvgpr_write_b32 a31, v69
    buffer_load_dword v30, v0, s[20:23], s24 offen
    buffer_load_dword v31, v0, s[20:23], s25 offen
    buffer_load_dword v32, v0, s[20:23], s26 offen
    buffer_load_dword v33, v0, s[20:23], s27 offen
    buffer_load_dword v34, v0, s[20:23], s28 offen
    buffer_load_dword v35, v0, s[20:23], s29 offen
    buffer_load_dword v36, v0, s[20:23], s30 offen
    buffer_load_dword v37, v0, s[20:23], s31 offen
    buffer_load_dword v38, v0, s[20:23], s32 offen
    buffer_load_dword v39, v0, s[20:23], s33 offen
    buffer_load_dword v40, v0, s[20:23], s34 offen
    buffer_load_dword v41, v0, s[20:23], s35 offen
    buffer_load_dword v42, v0, s[20:23], s36 offen
    buffer_load_dword v43, v0, s[20:23], s37 offen
    buffer_load_dword v44, v0, s[20:23], s38 offen
    buffer_load_dword v45, v0, s[20:23], s39 offen
    v_add_u32 v0, s74, v0
    s_or_b32 s96, s4, s86
    s_cbranch_scc1 L_ar_47
    s_and_b32 s96, s3, 31
    s_lshl_b32 s96, 1, s96
    s_lshl_b32 s97, s87, 3
    s_mov_b64 exec, 1
    v_mov_b32 v203, s97
    v_mov_b32 v214, s96
    v_mov_b32 v215, 0x100
    global_atomic_add_x2 v[214:215], v203, v[214:215], s[8:9] offset:128 sc0
    s_mov_b64 exec, -1
L_ar_47:
    s_waitcnt vmcnt(33)
    v_perm_b32 v62, v47, v46, s72
    v_accvgpr_write_b32 a32, v62
    v_perm_b32 v62, v47, v46, s73
    v_accvgpr_write_b32 a40, v62
    v_perm_b32 v63, v49, v48, s72
    v_accvgpr_write_b32 a33, v63
    v_perm_b32 v63, v49, v48, s73
    v_accvgpr_write_b32 a41, v63
    v_perm_b32 v64, v51, v50, s72
    v_accvgpr_write_b32 a34, v64
    v_perm_b32 v64, v51, v50, s73
    v_accvgpr_write_b32 a42, v64
    v_perm_b32 v65, v53, v52, s72
    v_accvgpr_write_b32 a35, v65
    v_perm_b32 v65, v53, v52, s73
    v_accvgpr_write_b32 a43, v65
    v_perm_b32 v66, v55, v54, s72
    v_accvgpr_write_b32 a36, v66
    v_perm_b32 v66, v55, v54, s73
    v_accvgpr_write_b32 a44, v66
    v_perm_b32 v67, v57, v56, s72
    v_accvgpr_write_b32 a37, v67
    v_perm_b32 v67, v57, v56, s73
    v_accvgpr_write_b32 a45, v67
    v_perm_b32 v68, v59, v58, s72
    v_accvgpr_write_b32 a38, v68
    v_perm_b32 v68, v59, v58, s73
    v_accvgpr_write_b32 a46, v68
    v_perm_b32 v69, v61, v60, s72
    v_accvgpr_write_b32 a39, v69
    v_perm_b32 v69, v61, v60, s73
    v_accvgpr_write_b32 a47, v69
    buffer_load_dword v46, v0, s[20:23], s24 offen
    buffer_load_dword v47, v0, s[20:23], s25 offen
    buffer_load_dword v48, v0, s[20:23], s26 offen
    buffer_load_dword v49, v0, s[20:23], s27 offen
    buffer_load_dword v50, v0, s[20:23], s28 offen
    buffer_load_dword v51, v0, s[20:23], s29 offen
    buffer_load_dword v52, v0, s[20:23], s30 offen
    buffer_load_dword v53, v0, s[20:23], s31 offen
    buffer_load_dword v54, v0, s[20:23], s32 offen
    buffer_load_dword v55, v0, s[20:23], s33 offen
    buffer_load_dword v56, v0, s[20:23], s34 offen
    buffer_load_dword v57, v0, s[20:23], s35 offen
    buffer_load_dword v58, v0, s[20:23], s36 offen
    buffer_load_dword v59, v0, s[20:23], s37 offen
    buffer_load_dword v60, v0, s[20:23], s38 offen
    buffer_load_dword v61, v0, s[20:23], s39 offen
    v_add_u32 v0, 524288, v0
    s_waitcnt vmcnt(32)
    v_perm_b32 v62, v15, v14, s72
    v_accvgpr_write_b32 a48, v62
    v_perm_b32 v62, v15, v14, s73
    v_accvgpr_write_b32 a56, v62
    v_perm_b32 v63, v17, v16, s72
    v_accvgpr_write_b32 a49, v63
    v_perm_b32 v63, v17, v16, s73
    v_accvgpr_write_b32 a57, v63
    v_perm_b32 v64, v19, v18, s72
    v_accvgpr_write_b32 a50, v64
    v_perm_b32 v64, v19, v18, s73
    v_accvgpr_write_b32 a58, v64
    v_perm_b32 v65, v21, v20, s72
    v_accvgpr_write_b32 a51, v65
    v_perm_b32 v65, v21, v20, s73
    v_accvgpr_write_b32 a59, v65
    v_perm_b32 v66, v23, v22, s72
    v_accvgpr_write_b32 a52, v66
    v_perm_b32 v66, v23, v22, s73
    v_accvgpr_write_b32 a60, v66
    v_perm_b32 v67, v25, v24, s72
    v_accvgpr_write_b32 a53, v67
    v_perm_b32 v67, v25, v24, s73
    v_accvgpr_write_b32 a61, v67
    v_perm_b32 v68, v27, v26, s72
    v_accvgpr_write_b32 a54, v68
    v_perm_b32 v68, v27, v26, s73
    v_accvgpr_write_b32 a62, v68
    v_perm_b32 v69, v29, v28, s72
    v_accvgpr_write_b32 a55, v69
    v_perm_b32 v69, v29, v28, s73
    v_accvgpr_write_b32 a63, v69
    buffer_load_dword v14, v0, s[20:23], s24 offen
    buffer_load_dword v15, v0, s[20:23], s25 offen
    buffer_load_dword v16, v0, s[20:23], s26 offen
    buffer_load_dword v17, v0, s[20:23], s27 offen
    buffer_load_dword v18, v0, s[20:23], s28 offen
    buffer_load_dword v19, v0, s[20:23], s29 offen
    buffer_load_dword v20, v0, s[20:23], s30 offen
    buffer_load_dword v21, v0, s[20:23], s31 offen
    buffer_load_dword v22, v0, s[20:23], s32 offen
    buffer_load_dword v23, v0, s[20:23], s33 offen
    buffer_load_dword v24, v0, s[20:23], s34 offen
    buffer_load_dword v25, v0, s[20:23], s35 offen
    buffer_load_dword v26, v0, s[20:23], s36 offen
    buffer_load_dword v27, v0, s[20:23], s37 offen
    buffer_load_dword v28, v0, s[20:23], s38 offen
    buffer_load_dword v29, v0, s[20:23], s39 offen
    v_add_u32 v0, 524288, v0
    s_waitcnt vmcnt(32)
    v_perm_b32 v62, v31, v30, s72
    v_accvgpr_write_b32 a64, v62
    v_perm_b32 v62, v31, v30, s73
    v_accvgpr_write_b32 a72, v62
    v_perm_b32 v63, v33, v32, s72
    v_accvgpr_write_b32 a65, v63
    v_perm_b32 v63, v33, v32, s73
    v_accvgpr_write_b32 a73, v63
    v_perm_b32 v64, v35, v34, s72
    v_accvgpr_write_b32 a66, v64
    v_perm_b32 v64, v35, v34, s73
    v_accvgpr_write_b32 a74, v64
    v_perm_b32 v65, v37, v36, s72
    v_accvgpr_write_b32 a67, v65
    v_perm_b32 v65, v37, v36, s73
    v_accvgpr_write_b32 a75, v65
    v_perm_b32 v66, v39, v38, s72
    v_accvgpr_write_b32 a68, v66
    v_perm_b32 v66, v39, v38, s73
    v_accvgpr_write_b32 a76, v66
    v_perm_b32 v67, v41, v40, s72
    v_accvgpr_write_b32 a69, v67
    v_perm_b32 v67, v41, v40, s73
    v_accvgpr_write_b32 a77, v67
    v_perm_b32 v68, v43, v42, s72
    v_accvgpr_write_b32 a70, v68
    v_perm_b32 v68, v43, v42, s73
    v_accvgpr_write_b32 a78, v68
    v_perm_b32 v69, v45, v44, s72
    v_accvgpr_write_b32 a71, v69
    v_perm_b32 v69, v45, v44, s73
    v_accvgpr_write_b32 a79, v69
    buffer_load_dword v30, v0, s[20:23], s24 offen
    buffer_load_dword v31, v0, s[20:23], s25 offen
    buffer_load_dword v32, v0, s[20:23], s26 offen
    buffer_load_dword v33, v0, s[20:23], s27 offen
    buffer_load_dword v34, v0, s[20:23], s28 offen
    buffer_load_dword v35, v0, s[20:23], s29 offen
    buffer_load_dword v36, v0, s[20:23], s30 offen
    buffer_load_dword v37, v0, s[20:23], s31 offen
    buffer_load_dword v38, v0, s[20:23], s32 offen
    buffer_load_dword v39, v0, s[20:23], s33 offen
    buffer_load_dword v40, v0, s[20:23], s34 offen
    buffer_load_dword v41, v0, s[20:23], s35 offen
    buffer_load_dword v42, v0, s[20:23], s36 offen
    buffer_load_dword v43, v0, s[20:23], s37 offen
    buffer_load_dword v44, v0, s[20:23], s38 offen
    buffer_load_dword v45, v0, s[20:23], s39 offen
    v_add_u32 v0, 524288, v0
    s_waitcnt vmcnt(32)
    v_perm_b32 v62, v47, v46, s72
    v_accvgpr_write_b32 a80, v62
    v_perm_b32 v62, v47, v46, s73
    v_accvgpr_write_b32 a88, v62
    v_perm_b32 v63, v49, v48, s72
    v_accvgpr_write_b32 a81, v63
    v_perm_b32 v63, v49, v48, s73
    v_accvgpr_write_b32 a89, v63
    v_perm_b32 v64, v51, v50, s72
    v_accvgpr_write_b32 a82, v64
    v_perm_b32 v64, v51, v50, s73
    v_accvgpr_write_b32 a90, v64
    v_perm_b32 v65, v53, v52, s72
    v_accvgpr_write_b32 a83, v65
    v_perm_b32 v65, v53, v52, s73
    v_accvgpr_write_b32 a91, v65
    v_perm_b32 v66, v55, v54, s72
    v_accvgpr_write_b32 a84, v66
    v_perm_b32 v66, v55, v54, s73
    v_accvgpr_write_b32 a92, v66
    v_perm_b32 v67, v57, v56, s72
    v_accvgpr_write_b32 a85, v67
    v_perm_b32 v67, v57, v56, s73
    v_accvgpr_write_b32 a93, v67
    v_perm_b32 v68, v59, v58, s72
    v_accvgpr_write_b32 a86, v68
    v_perm_b32 v68, v59, v58, s73
    v_accvgpr_write_b32 a94, v68
    v_perm_b32 v69, v61, v60, s72
    v_accvgpr_write_b32 a87, v69
    v_perm_b32 v69, v61, v60, s73
    v_accvgpr_write_b32 a95, v69
    buffer_load_dword v46, v0, s[20:23], s24 offen
    buffer_load_dword v47, v0, s[20:23], s25 offen
    buffer_load_dword v48, v0, s[20:23], s26 offen
    buffer_load_dword v49, v0, s[20:23], s27 offen
    buffer_load_dword v50, v0, s[20:23], s28 offen
    buffer_load_dword v51, v0, s[20:23], s29 offen
    buffer_load_dword v52, v0, s[20:23], s30 offen
    buffer_load_dword v53, v0, s[20:23], s31 offen
    buffer_load_dword v54, v0, s[20:23], s32 offen
    buffer_load_dword v55, v0, s[20:23], s33 offen
    buffer_load_dword v56, v0, s[20:23], s34 offen
    buffer_load_dword v57, v0, s[20:23], s35 offen
    buffer_load_dword v58, v0, s[20:23], s36 offen
    buffer_load_dword v59, v0, s[20:23], s37 offen
    buffer_load_dword v60, v0, s[20:23], s38 offen
    buffer_load_dword v61, v0, s[20:23], s39 offen
    v_add_u32 v0, 524288, v0
    s_waitcnt vmcnt(32)
    v_perm_b32 v62, v15, v14, s72
    v_accvgpr_write_b32 a96, v62
    v_perm_b32 v62, v15, v14, s73
    v_accvgpr_write_b32 a104, v62
    v_perm_b32 v63, v17, v16, s72
    v_accvgpr_write_b32 a97, v63
    v_perm_b32 v63, v17, v16, s73
    v_accvgpr_write_b32 a105, v63
    v_perm_b32 v64, v19, v18, s72
    v_accvgpr_write_b32 a98, v64
    v_perm_b32 v64, v19, v18, s73
    v_accvgpr_write_b32 a106, v64
    v_perm_b32 v65, v21, v20, s72
    v_accvgpr_write_b32 a99, v65
    v_perm_b32 v65, v21, v20, s73
    v_accvgpr_write_b32 a107, v65
    v_perm_b32 v66, v23, v22, s72
    v_accvgpr_write_b32 a100, v66
    v_perm_b32 v66, v23, v22, s73
    v_accvgpr_write_b32 a108, v66
    v_perm_b32 v67, v25, v24, s72
    v_accvgpr_write_b32 a101, v67
    v_perm_b32 v67, v25, v24, s73
    v_accvgpr_write_b32 a109, v67
    v_perm_b32 v68, v27, v26, s72
    v_accvgpr_write_b32 a102, v68
    v_perm_b32 v68, v27, v26, s73
    v_accvgpr_write_b32 a110, v68
    v_perm_b32 v69, v29, v28, s72
    v_accvgpr_write_b32 a103, v69
    v_perm_b32 v69, v29, v28, s73
    v_accvgpr_write_b32 a111, v69
    buffer_load_dword v14, v0, s[20:23], s24 offen
    buffer_load_dword v15, v0, s[20:23], s25 offen
    buffer_load_dword v16, v0, s[20:23], s26 offen
    buffer_load_dword v17, v0, s[20:23], s27 offen
    buffer_load_dword v18, v0, s[20:23], s28 offen
    buffer_load_dword v19, v0, s[20:23], s29 offen
    buffer_load_dword v20, v0, s[20:23], s30 offen
    buffer_load_dword v21, v0, s[20:23], s31 offen
    buffer_load_dword v22, v0, s[20:23], s32 offen
    buffer_load_dword v23, v0, s[20:23], s33 offen
    buffer_load_dword v24, v0, s[20:23], s34 offen
    buffer_load_dword v25, v0, s[20:23], s35 offen
    buffer_load_dword v26, v0, s[20:23], s36 offen
    buffer_load_dword v27, v0, s[20:23], s37 offen
    buffer_load_dword v28, v0, s[20:23], s38 offen
    buffer_load_dword v29, v0, s[20:23], s39 offen
    v_add_u32 v0, s75, v0
    s_add_u32 s20, s64, s76
    s_addc_u32 s21, s65, 0
    s_and_b32 s21, s21, 0xffff
    s_sub_u32 s22, 5242880, s76
    s_mov_b32 s23, 0x20000
    s_waitcnt vmcnt(32)
    v_perm_b32 v62, v31, v30, s72
    v_accvgpr_write_b32 a112, v62
    v_perm_b32 v62, v31, v30, s73
    v_accvgpr_write_b32 a120, v62
    v_perm_b32 v63, v33, v32, s72
    v_accvgpr_write_b32 a113, v63
    v_perm_b32 v63, v33, v32, s73
    v_accvgpr_write_b32 a121, v63
    v_perm_b32 v64, v35, v34, s72
    v_accvgpr_write_b32 a114, v64
    v_perm_b32 v64, v35, v34, s73
    v_accvgpr_write_b32 a122, v64
    v_perm_b32 v65, v37, v36, s72
    v_accvgpr_write_b32 a115, v65
    v_perm_b32 v65, v37, v36, s73
    v_accvgpr_write_b32 a123, v65
    v_perm_b32 v66, v39, v38, s72
    v_accvgpr_write_b32 a116, v66
    v_perm_b32 v66, v39, v38, s73
    v_accvgpr_write_b32 a124, v66
    v_perm_b32 v67, v41, v40, s72
    v_accvgpr_write_b32 a117, v67
    v_perm_b32 v67, v41, v40, s73
    v_accvgpr_write_b32 a125, v67
    v_perm_b32 v68, v43, v42, s72
    v_accvgpr_write_b32 a118, v68
    v_perm_b32 v68, v43, v42, s73
    v_accvgpr_write_b32 a126, v68
    v_perm_b32 v69, v45, v44, s72
    v_accvgpr_write_b32 a119, v69
    v_perm_b32 v69, v45, v44, s73
    v_accvgpr_write_b32 a127, v69
    buffer_load_dword v30, v0, s[20:23], s24 offen
    buffer_load_dword v31, v0, s[20:23], s25 offen
    buffer_load_dword v32, v0, s[20:23], s26 offen
    buffer_load_dword v33, v0, s[20:23], s27 offen
    buffer_load_dword v34, v0, s[20:23], s28 offen
    buffer_load_dword v35, v0, s[20:23], s29 offen
    buffer_load_dword v36, v0, s[20:23], s30 offen
    buffer_load_dword v37, v0, s[20:23], s31 offen
    buffer_load_dword v38, v0, s[20:23], s32 offen
    buffer_load_dword v39, v0, s[20:23], s33 offen
    buffer_load_dword v40, v0, s[20:23], s34 offen
    buffer_load_dword v41, v0, s[20:23], s35 offen
    buffer_load_dword v42, v0, s[20:23], s36 offen
    buffer_load_dword v43, v0, s[20:23], s37 offen
    buffer_load_dword v44, v0, s[20:23], s38 offen
    buffer_load_dword v45, v0, s[20:23], s39 offen
    v_add_u32 v0, 524288, v0
    s_waitcnt vmcnt(32)
    v_perm_b32 v62, v47, v46, s72
    v_accvgpr_write_b32 a128, v62
    v_perm_b32 v62, v47, v46, s73
    v_accvgpr_write_b32 a136, v62
    v_perm_b32 v63, v49, v48, s72
    v_accvgpr_write_b32 a129, v63
    v_perm_b32 v63, v49, v48, s73
    v_accvgpr_write_b32 a137, v63
    v_perm_b32 v64, v51, v50, s72
    v_accvgpr_write_b32 a130, v64
    v_perm_b32 v64, v51, v50, s73
    v_accvgpr_write_b32 a138, v64
    v_perm_b32 v65, v53, v52, s72
    v_accvgpr_write_b32 a131, v65
    v_perm_b32 v65, v53, v52, s73
    v_accvgpr_write_b32 a139, v65
    v_perm_b32 v66, v55, v54, s72
    v_accvgpr_write_b32 a132, v66
    v_perm_b32 v66, v55, v54, s73
    v_accvgpr_write_b32 a140, v66
    v_perm_b32 v67, v57, v56, s72
    v_accvgpr_write_b32 a133, v67
    v_perm_b32 v67, v57, v56, s73
    v_accvgpr_write_b32 a141, v67
    v_perm_b32 v68, v59, v58, s72
    v_accvgpr_write_b32 a134, v68
    v_perm_b32 v68, v59, v58, s73
    v_accvgpr_write_b32 a142, v68
    v_perm_b32 v69, v61, v60, s72
    v_accvgpr_write_b32 a135, v69
    v_perm_b32 v69, v61, v60, s73
    v_accvgpr_write_b32 a143, v69
    buffer_load_dword v46, v0, s[20:23], s24 offen
    buffer_load_dword v47, v0, s[20:23], s25 offen
    buffer_load_dword v48, v0, s[20:23], s26 offen
    buffer_load_dword v49, v0, s[20:23], s27 offen
    buffer_load_dword v50, v0, s[20:23], s28 offen
    buffer_load_dword v51, v0, s[20:23], s29 offen
    buffer_load_dword v52, v0, s[20:23], s30 offen
    buffer_load_dword v53, v0, s[20:23], s31 offen
    buffer_load_dword v54, v0, s[20:23], s32 offen
    buffer_load_dword v55, v0, s[20:23], s33 offen
    buffer_load_dword v56, v0, s[20:23], s34 offen
    buffer_load_dword v57, v0, s[20:23], s35 offen
    buffer_load_dword v58, v0, s[20:23], s36 offen
    buffer_load_dword v59, v0, s[20:23], s37 offen
    buffer_load_dword v60, v0, s[20:23], s38 offen
    buffer_load_dword v61, v0, s[20:23], s39 offen
    v_add_u32 v0, 524288, v0
    s_waitcnt vmcnt(32)
    v_perm_b32 v62, v15, v14, s72
    v_accvgpr_write_b32 a144, v62
    v_perm_b32 v62, v15, v14, s73
    v_accvgpr_write_b32 a152, v62
    v_perm_b32 v63, v17, v16, s72
    v_accvgpr_write_b32 a145, v63
    v_perm_b32 v63, v17, v16, s73
    v_accvgpr_write_b32 a153, v63
    v_perm_b32 v64, v19, v18, s72
    v_accvgpr_write_b32 a146, v64
    v_perm_b32 v64, v19, v18, s73
    v_accvgpr_write_b32 a154, v64
    v_perm_b32 v65, v21, v20, s72
    v_accvgpr_write_b32 a147, v65
    v_perm_b32 v65, v21, v20, s73
    v_accvgpr_write_b32 a155, v65
    v_perm_b32 v66, v23, v22, s72
    v_accvgpr_write_b32 a148, v66
    v_perm_b32 v66, v23, v22, s73
    v_accvgpr_write_b32 a156, v66
    v_perm_b32 v67, v25, v24, s72
    v_accvgpr_write_b32 a149, v67
    v_perm_b32 v67, v25, v24, s73
    v_accvgpr_write_b32 a157, v67
    v_perm_b32 v68, v27, v26, s72
    v_accvgpr_write_b32 a150, v68
    v_perm_b32 v68, v27, v26, s73
    v_accvgpr_write_b32 a158, v68
    v_perm_b32 v69, v29, v28, s72
    v_accvgpr_write_b32 a151, v69
    v_perm_b32 v69, v29, v28, s73
    v_accvgpr_write_b32 a159, v69
    buffer_load_dword v14, v0, s[20:23], s24 offen
    buffer_load_dword v15, v0, s[20:23], s25 offen
    buffer_load_dword v16, v0, s[20:23], s26 offen
    buffer_load_dword v17, v0, s[20:23], s27 offen
    buffer_load_dword v18, v0, s[20:23], s28 offen
    buffer_load_dword v19, v0, s[20:23], s29 offen
    buffer_load_dword v20, v0, s[20:23], s30 offen
    buffer_load_dword v21, v0, s[20:23], s31 offen
    buffer_load_dword v22, v0, s[20:23], s32 offen
    buffer_load_dword v23, v0, s[20:23], s33 offen
    buffer_load_dword v24, v0, s[20:23], s34 offen
    buffer_load_dword v25, v0, s[20:23], s35 offen
    buffer_load_dword v26, v0, s[20:23], s36 offen
    buffer_load_dword v27, v0, s[20:23], s37 offen
    buffer_load_dword v28, v0, s[20:23], s38 offen
    buffer_load_dword v29, v0, s[20:23], s39 offen
    v_add_u32 v0, 524288, v0
    s_waitcnt lgkmcnt(0)
    s_cmp_lg_u32 s86, 0
    s_cbranch_scc1 L_vf_48
    s_cmp_lg_u32 s4, 0
    s_cbranch_scc1 L_vf_49
    s_mov_b64 exec, 0xffff
    v_mbcnt_lo_u32_b32 v198, -1, 0
    v_lshlrev_b32 v198, 3, v198
    s_mov_b32 s96, 1048576
L_vf_50:
    global_load_dwordx2 v[196:197], v198, s[8:9] offset:128 sc1
    s_sub_u32 s96, s96, 1
    s_cbranch_scc1 L_bail1
    s_waitcnt vmcnt(0)
    v_lshrrev_b32 v199, 8, v197
    s_nop 1
    v_add_u32_dpp v199, v199, v199 row_shr:1 row_mask:0xf bank_mask:0xf bound_ctrl:0
    s_nop 1
    v_add_u32_dpp v199, v199, v199 row_shr:2 row_mask:0xf bank_mask:0xf bound_ctrl:0
    s_nop 1
    v_add_u32_dpp v199, v199, v199 row_shr:4 row_mask:0xf bank_mask:0xf bound_ctrl:0
    s_nop 1
    v_add_u32_dpp v199, v199, v199 row_shr:8 row_mask:0xf bank_mask:0xf bound_ctrl:0
    s_nop 0
    v_readlane_b32 s97, v199, 15
    s_nop 0
    s_cmp_lt_u32 s97, 256
    s_cbranch_scc1 L_vf_50
    v_cmp_eq_u32 vcc, -1, v196
    s_nop 0
    s_mov_b32 s98, vcc_lo
    v_cmp_eq_u32 vcc, 0x2000, v197
    s_nop 0
    s_and_b32 s98, s98, vcc_lo
    s_mov_b32 s97, -1
    s_cmp_eq_u32 s98, 0xff
    s_cbranch_scc1 L_vf_51
    v_readlane_b32 s97, v199, s87
    v_readlane_b32 s98, v197, s87
    v_readlane_b32 s99, v215, 0
    s_lshr_b32 s98, s98, 8
    s_lshr_b32 s99, s99, 8
    s_sub_u32 s97, s97, s98
    s_add_u32 s97, s97, s99
    v_readlane_b32 s98, v199, 0
    v_readlane_b32 s99, v199, 1
    s_xor_b32 s98, s98, 32
    s_xor_b32 s99, s99, 64
    s_or_b32 s98, s98, s99
    s_cmp_eq_u32 s98, 0
    s_cselect_b32 s98, 0x10000, 0
    s_or_b32 s97, s97, s98
L_vf_51:
    v_mov_b32 v196, 30720
    v_mov_b32 v197, s97
    ds_write_b32 v196, v197
    s_waitcnt lgkmcnt(0)
    s_mov_b64 exec, -1
L_vf_49:
    s_barrier
    v_mov_b32 v196, 30720
    ds_read_b32 v197, v196
    s_waitcnt lgkmcnt(0)
    v_readfirstlane_b32 s97, v197
    s_barrier
    s_mov_b32 s86, 1
    s_cmp_lg_u32 s97, -1
    s_cbranch_scc1 L_redo
L_vf_48:
    s_waitcnt vmcnt(32)
    v_perm_b32 v62, v31, v30, s72
    v_accvgpr_write_b32 a160, v62
    v_perm_b32 v62, v31, v30, s73
    v_accvgpr_write_b32 a168, v62
    v_perm_b32 v63, v33, v32, s72
    v_accvgpr_write_b32 a161, v63
    v_perm_b32 v63, v33, v32, s73
    v_accvgpr_write_b32 a169, v63
    v_perm_b32 v64, v35, v34, s72
    v_accvgpr_write_b32 a162, v64
    v_perm_b32 v64, v35, v34, s73
    v_accvgpr_write_b32 a170, v64
    v_perm_b32 v65, v37, v36, s72
    v_accvgpr_write_b32 a163, v65
    v_perm_b32 v65, v37, v36, s73
    v_accvgpr_write_b32 a171, v65
    v_perm_b32 v66, v39, v38, s72
    v_accvgpr_write_b32 a164, v66
    v_perm_b32 v66, v39, v38, s73
    v_accvgpr_write_b32 a172, v66
    v_perm_b32 v67, v41, v40, s72
    v_accvgpr_write_b32 a165, v67
    v_perm_b32 v67, v41, v40, s73
    v_accvgpr_write_b32 a173, v67
    v_perm_b32 v68, v43, v42, s72
    v_accvgpr_write_b32 a166, v68
    v_perm_b32 v68, v43, v42, s73
    v_accvgpr_write_b32 a174, v68
    v_perm_b32 v69, v45, v44, s72
    v_accvgpr_write_b32 a167, v69
    v_perm_b32 v69, v45, v44, s73
    v_accvgpr_write_b32 a175, v69
    s_lshr_b32 s16, s86, 1
    s_lshl_b32 s16, s16, 2
    v_mov_b32 v203, s16
    s_mov_b32 s16, 1048576
L_par_52:
    global_load_dword v204, v203, s[8:9] offset:68 sc1
    s_sub_u32 s16, s16, 1
    s_cbranch_scc1 L_bail2
    s_waitcnt vmcnt(0)
    v_readfirstlane_b32 s5, v204
    s_nop 0
    s_cmp_eq_u32 s5, 0
    s_cbranch_scc1 L_par_52
    s_sub_u32 s5, s5, 1
    s_mul_i32 s17, s11, 327680
    s_add_u32 s17, s17, 524288
    s_add_u32 s52, s6, s17
    s_addc_u32 s53, s7, 0
    s_lshl_b32 s17, s11, 15
    s_add_u32 s17, s17, 262144
    s_add_u32 s46, s6, s17
    s_addc_u32 s47, s7, 0
    s_lshl_b32 s17, s5, 13
    s_add_u32 s17, s17, 131072
    s_add_u32 s48, s6, s17
    s_addc_u32 s49, s7, 0
    s_lshl_b32 s17, s12, 15
    s_add_u32 s17, s17, 8388608
    s_add_u32 s50, s6, s17
    s_addc_u32 s51, s7, 0
    s_lshl_b32 s17, s12, 14
    s_lshl_b32 s18, s11, 12
    s_add_u32 s17, s17, s18
    s_add_u32 s17, s17, 79691776
    s_add_u32 s100, s6, s17
    s_addc_u32 s101, s7, 0
    s_lshl_b32 s17, s11, 5
    s_add_u32 s17, s17, s12
    s_add_u32 s17, s17, 64
    s_lshl_b32 s17, s17, 7
    s_add_u32 s42, s6, s17
    s_addc_u32 s43, s7, 0
    s_add_u32 s17, s12, 0
    s_lshl_b32 s17, s17, 7
    s_add_u32 s56, s6, s17
    s_addc_u32 s57, s7, 0
    v_mov_b32 v212, -1
    v_mov_b32 v213, -1
    s_add_u32 s78, s52, 0
    s_addc_u32 s79, s53, 0
    s_add_u32 s80, s78, 16384
    s_addc_u32 s81, s79, 0
    global_store_dwordx2 v7, v[212:213], s[78:79] sc1
    global_store_dwordx2 v7, v[212:213], s[80:81] sc1
    global_store_dword v8, v212, s[78:79] sc1
    s_add_u32 s78, s52, 163840
    s_addc_u32 s79, s53, 0
    s_add_u32 s80, s78, 16384
    s_addc_u32 s81, s79, 0
    global_store_dwordx2 v7, v[212:213], s[78:79] sc1
    global_store_dwordx2 v7, v[212:213], s[80:81] sc1
    global_store_dword v8, v212, s[78:79] sc1
    s_cmp_eq_u32 s19, 0
    s_cbranch_scc1 L_ci_53
    s_lshl_b32 s18, s11, 14
    v_min_u32 v210, -2, v210
    s_mov_b64 exec, s[58:59]
    s_add_u32 s78, s46, 0
    s_addc_u32 s79, s47, 0
    s_add_u32 s17, s18, 0
    s_add_u32 s80, s48, s17
    s_addc_u32 s81, s49, 0
    global_store_dword v10, v210, s[78:79] sc1
    global_store_dword v10, v210, s[80:81] sc1
    s_add_u32 s78, s46, 8192
    s_addc_u32 s79, s47, 0
    s_add_u32 s17, s18, 32768
    s_add_u32 s80, s48, s17
    s_addc_u32 s81, s49, 0
    global_store_dword v10, v212, s[78:79] sc1
    global_store_dword v10, v212, s[80:81] sc1
    s_add_u32 s78, s46, 16384
    s_addc_u32 s79, s47, 0
    s_add_u32 s17, s18, 65536
    s_add_u32 s80, s48, s17
    s_addc_u32 s81, s49, 0
    global_store_dword v10, v212, s[78:79] sc1
    global_store_dword v10, v212, s[80:81] sc1
    s_add_u32 s78, s46, 24576
    s_addc_u32 s79, s47, 0
    s_add_u32 s17, s18, 98304
    s_add_u32 s80, s48, s17
    s_addc_u32 s81, s49, 0
    global_store_dword v10, v212, s[78:79] sc1
    global_store_dword v10, v212, s[80:81] sc1
    s_mov_b64 exec, -1
L_ci_53:
    buffer_load_dword v30, v0, s[20:23], s24 offen
    buffer_load_dword v31, v0, s[20:23], s25 offen
    buffer_load_dword v32, v0, s[20:23], s26 offen
    buffer_load_dword v33, v0, s[20:23], s27 offen
    buffer_load_dword v34, v0, s[20:23], s28 offen
    buffer_load_dword v35, v0, s[20:23], s29 offen
    buffer_load_dword v36, v0, s[20:23], s30 offen
    buffer_load_dword v37, v0, s[20:23], s31 offen
    buffer_load_dword v38, v0, s[20:23], s32 offen
    buffer_load_dword v39, v0, s[20:23], s33 offen
    buffer_load_dword v40, v0, s[20:23], s34 offen
    buffer_load_dword v41, v0, s[20:23], s35 offen
    buffer_load_dword v42, v0, s[20:23], s36 offen
    buffer_load_dword v43, v0, s[20:23], s37 offen
    buffer_load_dword v44, v0, s[20:23], s38 offen
    buffer_load_dword v45, v0, s[20:23], s39 offen
    v_add_u32 v0, 524288, v0
    s_waitcnt vmcnt(32)
    v_perm_b32 v62, v47, v46, s72
    v_accvgpr_write_b32 a176, v62
    v_perm_b32 v62, v47, v46, s73
    v_accvgpr_write_b32 a184, v62
    v_perm_b32 v63, v49, v48, s72
    v_accvgpr_write_b32 a177, v63
    v_perm_b32 v63, v49, v48, s73
    v_accvgpr_write_b32 a185, v63
    v_perm_b32 v64, v51, v50, s72
    v_accvgpr_write_b32 a178, v64
    v_perm_b32 v64, v51, v50, s73
    v_accvgpr_write_b32 a186, v64
    v_perm_b32 v65, v53, v52, s72
    v_accvgpr_write_b32 a179, v65
    v_perm_b32 v65, v53, v52, s73
    v_accvgpr_write_b32 a187, v65
    v_perm_b32 v66, v55, v54, s72
    v_accvgpr_write_b32 a180, v66
    v_perm_b32 v66, v55, v54, s73
    v_accvgpr_write_b32 a188, v66
    v_perm_b32 v67, v57, v56, s72
    v_accvgpr_write_b32 a181, v67
    v_perm_b32 v67, v57, v56, s73
    v_accvgpr_write_b32 a189, v67
    v_perm_b32 v68, v59, v58, s72
    v_accvgpr_write_b32 a182, v68
    v_perm_b32 v68, v59, v58, s73
    v_accvgpr_write_b32 a190, v68
    v_perm_b32 v69, v61, v60, s72
    v_accvgpr_write_b32 a183, v69
    v_perm_b32 v69, v61, v60, s73
    v_accvgpr_write_b32 a191, v69
    buffer_load_dword v46, v0, s[20:23], s24 offen
    buffer_load_dword v47, v0, s[20:23], s25 offen
    buffer_load_dword v48, v0, s[20:23], s26 offen
    buffer_load_dword v49, v0, s[20:23], s27 offen
    buffer_load_dword v50, v0, s[20:23], s28 offen
    buffer_load_dword v51, v0, s[20:23], s29 offen
    buffer_load_dword v52, v0, s[20:23], s30 offen
    buffer_load_dword v53, v0, s[20:23], s31 offen
    buffer_load_dword v54, v0, s[20:23], s32 offen
    buffer_load_dword v55, v0, s[20:23], s33 offen
    buffer_load_dword v56, v0, s[20:23], s34 offen
    buffer_load_dword v57, v0, s[20:23], s35 offen
    buffer_load_dword v58, v0, s[20:23], s36 offen
    buffer_load_dword v59, v0, s[20:23], s37 offen
    buffer_load_dword v60, v0, s[20:23], s38 offen
    buffer_load_dword v61, v0, s[20:23], s39 offen
    v_add_u32 v0, s74, v0
    s_waitcnt vmcnt(32)
    v_perm_b32 v62, v15, v14, s72
    v_accvgpr_write_b32 a192, v62
    v_perm_b32 v62, v15, v14, s73
    v_accvgpr_write_b32 a200, v62
    v_perm_b32 v63, v17, v16, s72
    v_accvgpr_write_b32 a193, v63
    v_perm_b32 v63, v17, v16, s73
    v_accvgpr_write_b32 a201, v63
    v_perm_b32 v64, v19, v18, s72
    v_accvgpr_write_b32 a194, v64
    v_perm_b32 v64, v19, v18, s73
    v_accvgpr_write_b32 a202, v64
    v_perm_b32 v65, v21, v20, s72
    v_accvgpr_write_b32 a195, v65
    v_perm_b32 v65, v21, v20, s73
    v_accvgpr_write_b32 a203, v65
    v_perm_b32 v66, v23, v22, s72
    v_accvgpr_write_b32 a196, v66
    v_perm_b32 v66, v23, v22, s73
    v_accvgpr_write_b32 a204, v66
    v_perm_b32 v67, v25, v24, s72
    v_accvgpr_write_b32 a197, v67
    v_perm_b32 v67, v25, v24, s73
    v_accvgpr_write_b32 a205, v67
    v_perm_b32 v68, v27, v26, s72
    v_accvgpr_write_b32 a198, v68
    v_perm_b32 v68, v27, v26, s73
    v_accvgpr_write_b32 a206, v68
    v_perm_b32 v69, v29, v28, s72
    v_accvgpr_write_b32 a199, v69
    v_perm_b32 v69, v29, v28, s73
    v_accvgpr_write_b32 a207, v69
    buffer_load_dword v14, v0, s[20:23], s24 offen
    buffer_load_dword v15, v0, s[20:23], s25 offen
    buffer_load_dword v16, v0, s[20:23], s26 offen
    buffer_load_dword v17, v0, s[20:23], s27 offen
    buffer_load_dword v18, v0, s[20:23], s28 offen
    buffer_load_dword v19, v0, s[20:23], s29 offen
    buffer_load_dword v20, v0, s[20:23], s30 offen
    buffer_load_dword v21, v0, s[20:23], s31 offen
    buffer_load_dword v22, v0, s[20:23], s32 offen
    buffer_load_dword v23, v0, s[20:23], s33 offen
    buffer_load_dword v24, v0, s[20:23], s34 offen
    buffer_load_dword v25, v0, s[20:23], s35 offen
    buffer_load_dword v26, v0, s[20:23], s36 offen
    buffer_load_dword v27, v0, s[20:23], s37 offen
    buffer_load_dword v28, v0, s[20:23], s38 offen
    buffer_load_dword v29, v0, s[20:23], s39 offen
    v_add_u32 v0, 524288, v0
    s_waitcnt vmcnt(32)
    v_perm_b32 v62, v31, v30, s72
    v_accvgpr_write_b32 a208, v62
    v_perm_b32 v62, v31, v30, s73
    v_accvgpr_write_b32 a216, v62
    v_perm_b32 v63, v33, v32, s72
    v_accvgpr_write_b32 a209, v63
    v_perm_b32 v63, v33, v32, s73
    v_accvgpr_write_b32 a217, v63
    v_perm_b32 v64, v35, v34, s72
    v_accvgpr_write_b32 a210, v64
    v_perm_b32 v64, v35, v34, s73
    v_accvgpr_write_b32 a218, v64
    v_perm_b32 v65, v37, v36, s72
    v_accvgpr_write_b32 a211, v65
    v_perm_b32 v65, v37, v36, s73
    v_accvgpr_write_b32 a219, v65
    v_perm_b32 v66, v39, v38, s72
    v_accvgpr_write_b32 a212, v66
    v_perm_b32 v66, v39, v38, s73
    v_accvgpr_write_b32 a220, v66
    v_perm_b32 v67, v41, v40, s72
    v_accvgpr_write_b32 a213, v67
    v_perm_b32 v67, v41, v40, s73
    v_accvgpr_write_b32 a221, v67
    v_perm_b32 v68, v43, v42, s72
    v_accvgpr_write_b32 a214, v68
    v_perm_b32 v68, v43, v42, s73
    v_accvgpr_write_b32 a222, v68
    v_perm_b32 v69, v45, v44, s72
    v_accvgpr_write_b32 a215, v69
    v_perm_b32 v69, v45, v44, s73
    v_accvgpr_write_b32 a223, v69
    buffer_load_dword v30, v0, s[20:23], s24 offen
    buffer_load_dword v31, v0, s[20:23], s25 offen
    buffer_load_dword v32, v0, s[20:23], s26 offen
    buffer_load_dword v33, v0, s[20:23], s27 offen
    buffer_load_dword v34, v0, s[20:23], s28 offen
    buffer_load_dword v35, v0, s[20:23], s29 offen
    buffer_load_dword v36, v0, s[20:23], s30 offen
    buffer_load_dword v37, v0, s[20:23], s31 offen
    buffer_load_dword v38, v0, s[20:23], s32 offen
    buffer_load_dword v39, v0, s[20:23], s33 offen
    buffer_load_dword v40, v0, s[20:23], s34 offen
    buffer_load_dword v41, v0, s[20:23], s35 offen
    buffer_load_dword v42, v0, s[20:23], s36 offen
    buffer_load_dword v43, v0, s[20:23], s37 offen
    buffer_load_dword v44, v0, s[20:23], s38 offen
    buffer_load_dword v45, v0, s[20:23], s39 offen
    v_add_u32 v0, 524288, v0
    s_waitcnt vmcnt(32)
    v_perm_b32 v62, v47, v46, s72
    v_accvgpr_write_b32 a224, v62
    v_perm_b32 v62, v47, v46, s73
    v_accvgpr_write_b32 a232, v62
    v_perm_b32 v63, v49, v48, s72
    v_accvgpr_write_b32 a225, v63
    v_perm_b32 v63, v49, v48, s73
    v_accvgpr_write_b32 a233, v63
    v_perm_b32 v64, v51, v50, s72
    v_accvgpr_write_b32 a226, v64
    v_perm_b32 v64, v51, v50, s73
    v_accvgpr_write_b32 a234, v64
    v_perm_b32 v65, v53, v52, s72
    v_accvgpr_write_b32 a227, v65
    v_perm_b32 v65, v53, v52, s73
    v_accvgpr_write_b32 a235, v65
    v_perm_b32 v66, v55, v54, s72
    v_accvgpr_write_b32 a228, v66
    v_perm_b32 v66, v55, v54, s73
    v_accvgpr_write_b32 a236, v66
    v_perm_b32 v67, v57, v56, s72
    v_accvgpr_write_b32 a229, v67
    v_perm_b32 v67, v57, v56, s73
    v_accvgpr_write_b32 a237, v67
    v_perm_b32 v68, v59, v58, s72
    v_accvgpr_write_b32 a230, v68
    v_perm_b32 v68, v59, v58, s73
    v_accvgpr_write_b32 a238, v68
    v_perm_b32 v69, v61, v60, s72
    v_accvgpr_write_b32 a231, v69
    v_perm_b32 v69, v61, v60, s73
    v_accvgpr_write_b32 a239, v69
    buffer_load_dword v46, v0, s[20:23], s24 offen
    buffer_load_dword v47, v0, s[20:23], s25 offen
    buffer_load_dword v48, v0, s[20:23], s26 offen
    buffer_load_dword v49, v0, s[20:23], s27 offen
    buffer_load_dword v50, v0, s[20:23], s28 offen
    buffer_load_dword v51, v0, s[20:23], s29 offen
    buffer_load_dword v52, v0, s[20:23], s30 offen
    buffer_load_dword v53, v0, s[20:23], s31 offen
    buffer_load_dword v54, v0, s[20:23], s32 offen
    buffer_load_dword v55, v0, s[20:23], s33 offen
    buffer_load_dword v56, v0, s[20:23], s34 offen
    buffer_load_dword v57, v0, s[20:23], s35 offen
    buffer_load_dword v58, v0, s[20:23], s36 offen
    buffer_load_dword v59, v0, s[20:23], s37 offen
    buffer_load_dword v60, v0, s[20:23], s38 offen
    buffer_load_dword v61, v0, s[20:23], s39 offen
    v_add_u32 v0, 524288, v0
    s_waitcnt vmcnt(32)
    v_perm_b32 v62, v15, v14, s72
    v_accvgpr_write_b32 a240, v62
    v_perm_b32 v62, v15, v14, s73
    v_accvgpr_write_b32 a248, v62
    v_perm_b32 v63, v17, v16, s72
    v_accvgpr_write_b32 a241, v63
    v_perm_b32 v63, v17, v16, s73
    v_accvgpr_write_b32 a249, v63
    v_perm_b32 v64, v19, v18, s72
    v_accvgpr_write_b32 a242, v64
    v_perm_b32 v64, v19, v18, s73
    v_accvgpr_write_b32 a250, v64
    v_perm_b32 v65, v21, v20, s72
    v_accvgpr_write_b32 a243, v65
    v_perm_b32 v65, v21, v20, s73
    v_accvgpr_write_b32 a251, v65
    v_perm_b32 v66, v23, v22, s72
    v_accvgpr_write_b32 a244, v66
    v_perm_b32 v66, v23, v22, s73
    v_accvgpr_write_b32 a252, v66
    v_perm_b32 v67, v25, v24, s72
    v_accvgpr_write_b32 a245, v67
    v_perm_b32 v67, v25, v24, s73
    v_accvgpr_write_b32 a253, v67
    v_perm_b32 v68, v27, v26, s72
    v_accvgpr_write_b32 a246, v68
    v_perm_b32 v68, v27, v26, s73
    v_accvgpr_write_b32 a254, v68
    v_perm_b32 v69, v29, v28, s72
    v_accvgpr_write_b32 a247, v69
    v_perm_b32 v69, v29, v28, s73
    v_accvgpr_write_b32 a255, v69
    buffer_load_dword v14, v0, s[20:23], s24 offen
    buffer_load_dword v15, v0, s[20:23], s25 offen
    buffer_load_dword v16, v0, s[20:23], s26 offen
    buffer_load_dword v17, v0, s[20:23], s27 offen
    buffer_load_dword v18, v0, s[20:23], s28 offen
    buffer_load_dword v19, v0, s[20:23], s29 offen
    buffer_load_dword v20, v0, s[20:23], s30 offen
    buffer_load_dword v21, v0, s[20:23], s31 offen
    buffer_load_dword v22, v0, s[20:23], s32 offen
    buffer_load_dword v23, v0, s[20:23], s33 offen
    buffer_load_dword v24, v0, s[20:23], s34 offen
    buffer_load_dword v25, v0, s[20:23], s35 offen
    buffer_load_dword v26, v0, s[20:23], s36 offen
    buffer_load_dword v27, v0, s[20:23], s37 offen
    buffer_load_dword v28, v0, s[20:23], s38 offen
    buffer_load_dword v29, v0, s[20:23], s39 offen
    v_add_u32 v0, 524288, v0
    s_waitcnt vmcnt(32)
    v_perm_b32 v72, v31, v30, s72
    v_perm_b32 v80, v31, v30, s73
    v_perm_b32 v73, v33, v32, s72
    v_perm_b32 v81, v33, v32, s73
    v_perm_b32 v74, v35, v34, s72
    v_perm_b32 v82, v35, v34, s73
    v_perm_b32 v75, v37, v36, s72
    v_perm_b32 v83, v37, v36, s73
    v_perm_b32 v76, v39, v38, s72
    v_perm_b32 v84, v39, v38, s73
    v_perm_b32 v77, v41, v40, s72
    v_perm_b32 v85, v41, v40, s73
    v_perm_b32 v78, v43, v42, s72
    v_perm_b32 v86, v43, v42, s73
    v_perm_b32 v79, v45, v44, s72
    v_perm_b32 v87, v45, v44, s73
    buffer_load_dword v30, v0, s[20:23], s24 offen
    buffer_load_dword v31, v0, s[20:23], s25 offen
    buffer_load_dword v32, v0, s[20:23], s26 offen
    buffer_load_dword v33, v0, s[20:23], s27 offen
    buffer_load_dword v34, v0, s[20:23], s28 offen
    buffer_load_dword v35, v0, s[20:23], s29 offen
    buffer_load_dword v36, v0, s[20:23], s30 offen
    buffer_load_dword v37, v0, s[20:23], s31 offen
    buffer_load_dword v38, v0, s[20:23], s32 offen
    buffer_load_dword v39, v0, s[20:23], s33 offen
    buffer_load_dword v40, v0, s[20:23], s34 offen
    buffer_load_dword v41, v0, s[20:23], s35 offen
    buffer_load_dword v42, v0, s[20:23], s36 offen
    buffer_load_dword v43, v0, s[20:23], s37 offen
    buffer_load_dword v44, v0, s[20:23], s38 offen
    buffer_load_dword v45, v0, s[20:23], s39 offen
    v_add_u32 v0, s75, v0
    s_barrier
    s_cmp_lg_u32 s4, 3
    s_cbranch_scc1 L_cb_54
    s_mov_b64 exec, 1
    v_mov_b32 v203, 64
    v_mov_b32 v204, 1
    global_atomic_add v203, v204, s[8:9]
    s_mov_b64 exec, -1
L_cb_54:
    s_add_u32 s20, s66, s76
    s_addc_u32 s21, s67, 0
    s_and_b32 s21, s21, 0xffff
    s_sub_u32 s22, 5242880, s76
    s_mov_b32 s23, 0x20000
    s_waitcnt vmcnt(32)
    v_perm_b32 v88, v47, v46, s72
    v_perm_b32 v96, v47, v46, s73
    v_perm_b32 v89, v49, v48, s72
    v_perm_b32 v97, v49, v48, s73
    v_perm_b32 v90, v51, v50, s72
    v_perm_b32 v98, v51, v50, s73
    v_perm_b32 v91, v53, v52, s72
    v_perm_b32 v99, v53, v52, s73
    v_perm_b32 v92, v55, v54, s72
    v_perm_b32 v100, v55, v54, s73
    v_perm_b32 v93, v57, v56, s72
    v_perm_b32 v101, v57, v56, s73
    v_perm_b32 v94, v59, v58, s72
    v_perm_b32 v102, v59, v58, s73
    v_perm_b32 v95, v61, v60, s72
    v_perm_b32 v103, v61, v60, s73
    buffer_load_dword v46, v0, s[20:23], s24 offen
    buffer_load_dword v47, v0, s[20:23], s25 offen
    buffer_load_dword v48, v0, s[20:23], s26 offen
    buffer_load_dword v49, v0, s[20:23], s27 offen
    buffer_load_dword v50, v0, s[20:23], s28 offen
    buffer_load_dword v51, v0, s[20:23], s29 offen
    buffer_load_dword v52, v0, s[20:23], s30 offen
    buffer_load_dword v53, v0, s[20:23], s31 offen
    buffer_load_dword v54, v0, s[20:23], s32 offen
    buffer_load_dword v55, v0, s[20:23], s33 offen
    buffer_load_dword v56, v0, s[20:23], s34 offen
    buffer_load_dword v57, v0, s[20:23], s35 offen
    buffer_load_dword v58, v0, s[20:23], s36 offen
    buffer_load_dword v59, v0, s[20:23], s37 offen
    buffer_load_dword v60, v0, s[20:23], s38 offen
    buffer_load_dword v61, v0, s[20:23], s39 offen
    v_add_u32 v0, 524288, v0
    s_waitcnt vmcnt(32)
    v_perm_b32 v104, v15, v14, s72
    v_perm_b32 v112, v15, v14, s73
    v_perm_b32 v105, v17, v16, s72
    v_perm_b32 v113, v17, v16, s73
    v_perm_b32 v106, v19, v18, s72
    v_perm_b32 v114, v19, v18, s73
    v_perm_b32 v107, v21, v20, s72
    v_perm_b32 v115, v21, v20, s73
    v_perm_b32 v108, v23, v22, s72
    v_perm_b32 v116, v23, v22, s73
    v_perm_b32 v109, v25, v24, s72
    v_perm_b32 v117, v25, v24, s73
    v_perm_b32 v110, v27, v26, s72
    v_perm_b32 v118, v27, v26, s73
    v_perm_b32 v111, v29, v28, s72
    v_perm_b32 v119, v29, v28, s73
    buffer_load_dword v14, v0, s[20:23], s24 offen
    buffer_load_dword v15, v0, s[20:23], s25 offen
    buffer_load_dword v16, v0, s[20:23], s26 offen
    buffer_load_dword v17, v0, s[20:23], s27 offen
    buffer_load_dword v18, v0, s[20:23], s28 offen
    buffer_load_dword v19, v0, s[20:23], s29 offen
    buffer_load_dword v20, v0, s[20:23], s30 offen
    buffer_load_dword v21, v0, s[20:23], s31 offen
    buffer_load_dword v22, v0, s[20:23], s32 offen
    buffer_load_dword v23, v0, s[20:23], s33 offen
    buffer_load_dword v24, v0, s[20:23], s34 offen
    buffer_load_dword v25, v0, s[20:23], s35 offen
    buffer_load_dword v26, v0, s[20:23], s36 offen
    buffer_load_dword v27, v0, s[20:23], s37 offen
    buffer_load_dword v28, v0, s[20:23], s38 offen
    buffer_load_dword v29, v0, s[20:23], s39 offen
    v_add_u32 v0, 524288, v0
    s_waitcnt vmcnt(32)
    v_perm_b32 v120, v31, v30, s72
    v_perm_b32 v128, v31, v30, s73
    v_perm_b32 v121, v33, v32, s72
    v_perm_b32 v129, v33, v32, s73
    v_perm_b32 v122, v35, v34, s72
    v_perm_b32 v130, v35, v34, s73
    v_perm_b32 v123, v37, v36, s72
    v_perm_b32 v131, v37, v36, s73
    v_perm_b32 v124, v39, v38, s72
    v_perm_b32 v132, v39, v38, s73
    v_perm_b32 v125, v41, v40, s72
    v_perm_b32 v133, v41, v40, s73
    v_perm_b32 v126, v43, v42, s72
    v_perm_b32 v134, v43, v42, s73
    v_perm_b32 v127, v45, v44, s72
    v_perm_b32 v135, v45, v44, s73
    buffer_load_dword v30, v0, s[20:23], s24 offen
    buffer_load_dword v31, v0, s[20:23], s25 offen
    buffer_load_dword v32, v0, s[20:23], s26 offen
    buffer_load_dword v33, v0, s[20:23], s27 offen
    buffer_load_dword v34, v0, s[20:23], s28 offen
    buffer_load_dword v35, v0, s[20:23], s29 offen
    buffer_load_dword v36, v0, s[20:23], s30 offen
    buffer_load_dword v37, v0, s[20:23], s31 offen
    buffer_load_dword v38, v0, s[20:23], s32 offen
    buffer_load_dword v39, v0, s[20:23], s33 offen
    buffer_load_dword v40, v0, s[20:23], s34 offen
    buffer_load_dword v41, v0, s[20:23], s35 offen
    buffer_load_dword v42, v0, s[20:23], s36 offen
    buffer_load_dword v43, v0, s[20:23], s37 offen
    buffer_load_dword v44, v0, s[20:23], s38 offen
    buffer_load_dword v45, v0, s[20:23], s39 offen
    v_add_u32 v0, 524288, v0
    s_waitcnt vmcnt(32)
    s_waitcnt lgkmcnt(0)
    v_perm_b32 v62, v47, v46, s72
    v_perm_b32 v63, v49, v48, s72
    v_perm_b32 v64, v51, v50, s72
    v_perm_b32 v65, v53, v52, s72
    v_perm_b32 v66, v55, v54, s72
    v_perm_b32 v67, v57, v56, s72
    v_perm_b32 v68, v59, v58, s72
    v_perm_b32 v69, v61, v60, s72
    ds_write_b128 v3, v[62:65] offset:32768
    ds_write_b128 v3, v[66:69] offset:36864
    s_waitcnt lgkmcnt(0)
    v_perm_b32 v62, v47, v46, s73
    v_perm_b32 v63, v49, v48, s73
    v_perm_b32 v64, v51, v50, s73
    v_perm_b32 v65, v53, v52, s73
    v_perm_b32 v66, v55, v54, s73
    v_perm_b32 v67, v57, v56, s73
    v_perm_b32 v68, v59, v58, s73
    v_perm_b32 v69, v61, v60, s73
    ds_write_b128 v3, v[62:65] offset:40960
    ds_write_b128 v3, v[66:69] offset:45056
    buffer_load_dword v46, v0, s[20:23], s24 offen
    buffer_load_dword v47, v0, s[20:23], s25 offen
    buffer_load_dword v48, v0, s[20:23], s26 offen
    buffer_load_dword v49, v0, s[20:23], s27 offen
    buffer_load_dword v50, v0, s[20:23], s28 offen
    buffer_load_dword v51, v0, s[20:23], s29 offen
    buffer_load_dword v52, v0, s[20:23], s30 offen
    buffer_load_dword v53, v0, s[20:23], s31 offen
    buffer_load_dword v54, v0, s[20:23], s32 offen
    buffer_load_dword v55, v0, s[20:23], s33 offen
    buffer_load_dword v56, v0, s[20:23], s34 offen
    buffer_load_dword v57, v0, s[20:23], s35 offen
    buffer_load_dword v58, v0, s[20:23], s36 offen
    buffer_load_dword v59, v0, s[20:23], s37 offen
    buffer_load_dword v60, v0, s[20:23], s38 offen
    buffer_load_dword v61, v0, s[20:23], s39 offen
    v_add_u32 v0, 524288, v0
    s_waitcnt vmcnt(32)
    s_waitcnt lgkmcnt(0)
    v_perm_b32 v62, v15, v14, s72
    v_perm_b32 v63, v17, v16, s72
    v_perm_b32 v64, v19, v18, s72
    v_perm_b32 v65, v21, v20, s72
    v_perm_b32 v66, v23, v22, s72
    v_perm_b32 v67, v25, v24, s72
    v_perm_b32 v68, v27, v26, s72
    v_perm_b32 v69, v29, v28, s72
    ds_write_b128 v3, v[62:65] offset:49152
    ds_write_b128 v3, v[66:69] offset:53248
    s_waitcnt lgkmcnt(0)
    v_perm_b32 v62, v15, v14, s73
    v_perm_b32 v63, v17, v16, s73
    v_perm_b32 v64, v19, v18, s73
    v_perm_b32 v65, v21, v20, s73
    v_perm_b32 v66, v23, v22, s73
    v_perm_b32 v67, v25, v24, s73
    v_perm_b32 v68, v27, v26, s73
    v_perm_b32 v69, v29, v28, s73
    ds_write_b128 v3, v[62:65] offset:57344
    ds_write_b128 v3, v[66:69] offset:61440
    buffer_load_dword v14, v0, s[20:23], s24 offen
    buffer_load_dword v15, v0, s[20:23], s25 offen
    buffer_load_dword v16, v0, s[20:23], s26 offen
    buffer_load_dword v17, v0, s[20:23], s27 offen
    buffer_load_dword v18, v0, s[20:23], s28 offen
    buffer_load_dword v19, v0, s[20:23], s29 offen
    buffer_load_dword v20, v0, s[20:23], s30 offen
    buffer_load_dword v21, v0, s[20:23], s31 offen
    buffer_load_dword v22, v0, s[20:23], s32 offen
    buffer_load_dword v23, v0, s[20:23], s33 offen
    buffer_load_dword v24, v0, s[20:23], s34 offen
    buffer_load_dword v25, v0, s[20:23], s35 offen
    buffer_load_dword v26, v0, s[20:23], s36 offen
    buffer_load_dword v27, v0, s[20:23], s37 offen
    buffer_load_dword v28, v0, s[20:23], s38 offen
    buffer_load_dword v29, v0, s[20:23], s39 offen
    v_add_u32 v0, s74, v0
    s_waitcnt vmcnt(32)
    s_waitcnt lgkmcnt(0)
    v_perm_b32 v62, v31, v30, s72
    v_perm_b32 v63, v33, v32, s72
    v_perm_b32 v64, v35, v34, s72
    v_perm_b32 v65, v37, v36, s72
    v_perm_b32 v66, v39, v38, s72
    v_perm_b32 v67, v41, v40, s72
    v_perm_b32 v68, v43, v42, s72
    v_perm_b32 v69, v45, v44, s72
    ds_write_b128 v4, v[62:65] offset:0
    ds_write_b128 v4, v[66:69] offset:4096
    s_waitcnt lgkmcnt(0)
    v_perm_b32 v62, v31, v30, s73
    v_perm_b32 v63, v33, v32, s73
    v_perm_b32 v64, v35, v34, s73
    v_perm_b32 v65, v37, v36, s73
    v_perm_b32 v66, v39, v38, s73
    v_perm_b32 v67, v41, v40, s73
    v_perm_b32 v68, v43, v42, s73
    v_perm_b32 v69, v45, v44, s73
    ds_write_b128 v4, v[62:65] offset:8192
    ds_write_b128 v4, v[66:69] offset:12288
    buffer_load_dword v30, v0, s[20:23], s24 offen
    buffer_load_dword v31, v0, s[20:23], s25 offen
    buffer_load_dword v32, v0, s[20:23], s26 offen
    buffer_load_dword v33, v0, s[20:23], s27 offen
    buffer_load_dword v34, v0, s[20:23], s28 offen
    buffer_load_dword v35, v0, s[20:23], s29 offen
    buffer_load_dword v36, v0, s[20:23], s30 offen
    buffer_load_dword v37, v0, s[20:23], s31 offen
    buffer_load_dword v38, v0, s[20:23], s32 offen
    buffer_load_dword v39, v0, s[20:23], s33 offen
    buffer_load_dword v40, v0, s[20:23], s34 offen
    buffer_load_dword v41, v0, s[20:23], s35 offen
    buffer_load_dword v42, v0, s[20:23], s36 offen
    buffer_load_dword v43, v0, s[20:23], s37 offen
    buffer_load_dword v44, v0, s[20:23], s38 offen
    buffer_load_dword v45, v0, s[20:23], s39 offen
    v_add_u32 v0, 524288, v0
    s_waitcnt vmcnt(32)
    s_waitcnt lgkmcnt(0)
    v_perm_b32 v62, v47, v46, s72
    v_perm_b32 v63, v49, v48, s72
    v_perm_b32 v64, v51, v50, s72
    v_perm_b32 v65, v53, v52, s72
    v_perm_b32 v66, v55, v54, s72
    v_perm_b32 v67, v57, v56, s72
    v_perm_b32 v68, v59, v58, s72
    v_perm_b32 v69, v61, v60, s72
    ds_write_b128 v4, v[62:65] offset:16384
    ds_write_b128 v4, v[66:69] offset:20480
    s_waitcnt lgkmcnt(0)
    v_perm_b32 v62, v47, v46, s73
    v_perm_b32 v63, v49, v48, s73
    v_perm_b32 v64, v51, v50, s73
    v_perm_b32 v65, v53, v52, s73
    v_perm_b32 v66, v55, v54, s73
    v_perm_b32 v67, v57, v56, s73
    v_perm_b32 v68, v59, v58, s73
    v_perm_b32 v69, v61, v60, s73
    ds_write_b128 v4, v[62:65] offset:24576
    ds_write_b128 v4, v[66:69] offset:28672
    buffer_load_dword v46, v0, s[20:23], s24 offen
    buffer_load_dword v47, v0, s[20:23], s25 offen
    buffer_load_dword v48, v0, s[20:23], s26 offen
    buffer_load_dword v49, v0, s[20:23], s27 offen
    buffer_load_dword v50, v0, s[20:23], s28 offen
    buffer_load_dword v51, v0, s[20:23], s29 offen
    buffer_load_dword v52, v0, s[20:23], s30 offen
    buffer_load_dword v53, v0, s[20:23], s31 offen
    buffer_load_dword v54, v0, s[20:23], s32 offen
    buffer_load_dword v55, v0, s[20:23], s33 offen
    buffer_load_dword v56, v0, s[20:23], s34 offen
    buffer_load_dword v57, v0, s[20:23], s35 offen
    buffer_load_dword v58, v0, s[20:23], s36 offen
    buffer_load_dword v59, v0, s[20:23], s37 offen
    buffer_load_dword v60, v0, s[20:23], s38 offen
    buffer_load_dword v61, v0, s[20:23], s39 offen
    v_add_u32 v0, 524288, v0
    s_waitcnt vmcnt(32)
    s_waitcnt lgkmcnt(0)
    v_perm_b32 v62, v15, v14, s72
    v_perm_b32 v63, v17, v16, s72
    v_perm_b32 v64, v19, v18, s72
    v_perm_b32 v65, v21, v20, s72
    v_perm_b32 v66, v23, v22, s72
    v_perm_b32 v67, v25, v24, s72
    v_perm_b32 v68, v27, v26, s72
    v_perm_b32 v69, v29, v28, s72
    ds_write_b128 v4, v[62:65] offset:32768
    ds_write_b128 v4, v[66:69] offset:36864
    s_waitcnt lgkmcnt(0)
    v_perm_b32 v62, v15, v14, s73
    v_perm_b32 v63, v17, v16, s73
    v_perm_b32 v64, v19, v18, s73
    v_perm_b32 v65, v21, v20, s73
    v_perm_b32 v66, v23, v22, s73
    v_perm_b32 v67, v25, v24, s73
    v_perm_b32 v68, v27, v26, s73
    v_perm_b32 v69, v29, v28, s73
    ds_write_b128 v4, v[62:65] offset:40960
    ds_write_b128 v4, v[66:69] offset:45056
    buffer_load_dword v14, v0, s[20:23], s24 offen
    buffer_load_dword v15, v0, s[20:23], s25 offen
    buffer_load_dword v16, v0, s[20:23], s26 offen
    buffer_load_dword v17, v0, s[20:23], s27 offen
    buffer_load_dword v18, v0, s[20:23], s28 offen
    buffer_load_dword v19, v0, s[20:23], s29 offen
    buffer_load_dword v20, v0, s[20:23], s30 offen
    buffer_load_dword v21, v0, s[20:23], s31 offen
    buffer_load_dword v22, v0, s[20:23], s32 offen
    buffer_load_dword v23, v0, s[20:23], s33 offen
    buffer_load_dword v24, v0, s[20:23], s34 offen
    buffer_load_dword v25, v0, s[20:23], s35 offen
    buffer_load_dword v26, v0, s[20:23], s36 offen
    buffer_load_dword v27, v0, s[20:23], s37 offen
    buffer_load_dword v28, v0, s[20:23], s38 offen
    buffer_load_dword v29, v0, s[20:23], s39 offen
    v_add_u32 v0, 524288, v0
    s_waitcnt vmcnt(32)
    s_waitcnt lgkmcnt(0)
    v_perm_b32 v62, v31, v30, s72
    v_perm_b32 v63, v33, v32, s72
    v_perm_b32 v64, v35, v34, s72
    v_perm_b32 v65, v37, v36, s72
    v_perm_b32 v66, v39, v38, s72
    v_perm_b32 v67, v41, v40, s72
    v_perm_b32 v68, v43, v42, s72
    v_perm_b32 v69, v45, v44, s72
    ds_write_b128 v4, v[62:65] offset:49152
    ds_write_b128 v4, v[66:69] offset:53248
    v_perm_b32 v216, v31, v30, s73
    v_perm_b32 v217, v33, v32, s73
    v_perm_b32 v218, v35, v34, s73
    v_perm_b32 v219, v37, v36, s73
    v_perm_b32 v220, v39, v38, s73
    v_perm_b32 v221, v41, v40, s73
    v_perm_b32 v222, v43, v42, s73
    v_perm_b32 v223, v45, v44, s73
    buffer_load_dword v30, v0, s[20:23], s24 offen
    buffer_load_dword v31, v0, s[20:23], s25 offen
    buffer_load_dword v32, v0, s[20:23], s26 offen
    buffer_load_dword v33, v0, s[20:23], s27 offen
    buffer_load_dword v34, v0, s[20:23], s28 offen
    buffer_load_dword v35, v0, s[20:23], s29 offen
    buffer_load_dword v36, v0, s[20:23], s30 offen
    buffer_load_dword v37, v0, s[20:23], s31 offen
    buffer_load_dword v38, v0, s[20:23], s32 offen
    buffer_load_dword v39, v0, s[20:23], s33 offen
    buffer_load_dword v40, v0, s[20:23], s34 offen
    buffer_load_dword v41, v0, s[20:23], s35 offen
    buffer_load_dword v42, v0, s[20:23], s36 offen
    buffer_load_dword v43, v0, s[20:23], s37 offen
    buffer_load_dword v44, v0, s[20:23], s38 offen
    buffer_load_dword v45, v0, s[20:23], s39 offen
    v_add_u32 v0, 524288, v0
    s_waitcnt vmcnt(32)
    s_waitcnt lgkmcnt(0)
    v_perm_b32 v62, v47, v46, s72
    v_perm_b32 v63, v49, v48, s72
    v_perm_b32 v64, v51, v50, s72
    v_perm_b32 v65, v53, v52, s72
    v_perm_b32 v66, v55, v54, s72
    v_perm_b32 v67, v57, v56, s72
    v_perm_b32 v68, v59, v58, s72
    v_perm_b32 v69, v61, v60, s72
    ds_write_b128 v4, v[62:65] offset:57344
    ds_write_b128 v4, v[66:69] offset:61440
    v_perm_b32 v224, v47, v46, s73
    v_perm_b32 v225, v49, v48, s73
    v_perm_b32 v226, v51, v50, s73
    v_perm_b32 v227, v53, v52, s73
    v_perm_b32 v228, v55, v54, s73
    v_perm_b32 v229, v57, v56, s73
    v_perm_b32 v230, v59, v58, s73
    v_perm_b32 v231, v61, v60, s73
    buffer_load_dword v46, v0, s[20:23], s24 offen
    buffer_load_dword v47, v0, s[20:23], s25 offen
    buffer_load_dword v48, v0, s[20:23], s26 offen
    buffer_load_dword v49, v0, s[20:23], s27 offen
    buffer_load_dword v50, v0, s[20:23], s28 offen
    buffer_load_dword v51, v0, s[20:23], s29 offen
    buffer_load_dword v52, v0, s[20:23], s30 offen
    buffer_load_dword v53, v0, s[20:23], s31 offen
    buffer_load_dword v54, v0, s[20:23], s32 offen
    buffer_load_dword v55, v0, s[20:23], s33 offen
    buffer_load_dword v56, v0, s[20:23], s34 offen
    buffer_load_dword v57, v0, s[20:23], s35 offen
    buffer_load_dword v58, v0, s[20:23], s36 offen
    buffer_load_dword v59, v0, s[20:23], s37 offen
    buffer_load_dword v60, v0, s[20:23], s38 offen
    buffer_load_dword v61, v0, s[20:23], s39 offen
    v_add_u32 v0, s75, v0
    s_mov_b32 s24, 0
    s_mov_b32 s25, 1280
    s_mov_b32 s26, 10240
    s_mov_b32 s27, 11520
    s_mov_b32 s28, 2560
    s_mov_b32 s29, 3840
    s_mov_b32 s30, 12800
    s_mov_b32 s31, 14080
    s_mov_b32 s32, 40960
    s_mov_b32 s33, 42240
    s_mov_b32 s34, 51200
    s_mov_b32 s35, 52480
    s_mov_b32 s36, 43520
    s_mov_b32 s37, 44800
    s_mov_b32 s38, 53760
    s_mov_b32 s39, 55040
    s_mul_i32 s18, s12, 163840
    s_mul_i32 s17, s11, 640
    s_add_u32 s18, s18, s17
    s_add_u32 s20, s68, s18
    s_addc_u32 s21, s69, 0
    s_and_b32 s21, s21, 0xffff
    s_sub_u32 s22, 5242880, s18
    s_mov_b32 s23, 0x20000
    v_mul_u32_u24 v211, 1280, v211
    s_lshl_b32 s17, s4, 7
    v_lshl_add_u32 v0, v201, 2, v211
    v_add_u32 v0, s17, v0
    s_lshl_b32 s17, s4, 5
    s_add_u32 s17, s17, 512
    v_lshrrev_b32 v70, 1, v201
    v_lshl_add_u32 v70, v70, 2, v211
    v_add_u32 v70, s17, v70
    v_and_b32 v71, 1, v201
    v_mul_u32_u24 v71, 0x0202, v71
    v_lshl_or_b32 v71, v71, 16, v71
    v_add_u32 v71, 0x05040100, v71
    s_waitcnt vmcnt(32)
    s_waitcnt lgkmcnt(0)
    v_perm_b32 v62, v15, v14, s72
    v_perm_b32 v63, v17, v16, s72
    v_perm_b32 v64, v19, v18, s72
    v_perm_b32 v65, v21, v20, s72
    v_perm_b32 v66, v23, v22, s72
    v_perm_b32 v67, v25, v24, s72
    v_perm_b32 v68, v27, v26, s72
    v_perm_b32 v69, v29, v28, s72
    ds_write_b128 v5, v[62:65] offset:0
    ds_write_b128 v5, v[66:69] offset:4096
    v_perm_b32 v232, v15, v14, s73
    v_perm_b32 v233, v17, v16, s73
    v_perm_b32 v234, v19, v18, s73
    v_perm_b32 v235, v21, v20, s73
    v_perm_b32 v236, v23, v22, s73
    v_perm_b32 v237, v25, v24, s73
    v_perm_b32 v238, v27, v26, s73
    v_perm_b32 v239, v29, v28, s73
    buffer_load_dword v14, v0, s[20:23], s24 offen
    buffer_load_dword v15, v0, s[20:23], s25 offen
    buffer_load_dword v16, v0, s[20:23], s26 offen
    buffer_load_dword v17, v0, s[20:23], s27 offen
    buffer_load_dword v18, v0, s[20:23], s28 offen
    buffer_load_dword v19, v0, s[20:23], s29 offen
    buffer_load_dword v20, v0, s[20:23], s30 offen
    buffer_load_dword v21, v0, s[20:23], s31 offen
    buffer_load_dword v22, v0, s[20:23], s32 offen
    buffer_load_dword v23, v0, s[20:23], s33 offen
    buffer_load_dword v24, v0, s[20:23], s34 offen
    buffer_load_dword v25, v0, s[20:23], s35 offen
    buffer_load_dword v26, v0, s[20:23], s36 offen
    buffer_load_dword v27, v0, s[20:23], s37 offen
    buffer_load_dword v28, v0, s[20:23], s38 offen
    buffer_load_dword v29, v0, s[20:23], s39 offen
    v_add_u32 v0, 81920, v0
    s_waitcnt vmcnt(32)
    s_waitcnt lgkmcnt(0)
    v_perm_b32 v62, v31, v30, s72
    v_perm_b32 v63, v33, v32, s72
    v_perm_b32 v64, v35, v34, s72
    v_perm_b32 v65, v37, v36, s72
    v_perm_b32 v66, v39, v38, s72
    v_perm_b32 v67, v41, v40, s72
    v_perm_b32 v68, v43, v42, s72
    v_perm_b32 v69, v45, v44, s72
    ds_write_b128 v5, v[62:65] offset:8192
    ds_write_b128 v5, v[66:69] offset:12288
    v_perm_b32 v240, v31, v30, s73
    v_perm_b32 v241, v33, v32, s73
    v_perm_b32 v242, v35, v34, s73
    v_perm_b32 v243, v37, v36, s73
    v_perm_b32 v244, v39, v38, s73
    v_perm_b32 v245, v41, v40, s73
    v_perm_b32 v246, v43, v42, s73
    v_perm_b32 v247, v45, v44, s73
    buffer_load_dword v30, v0, s[20:23], s24 offen
    buffer_load_dword v31, v0, s[20:23], s25 offen
    buffer_load_dword v32, v0, s[20:23], s26 offen
    buffer_load_dword v33, v0, s[20:23], s27 offen
    buffer_load_dword v34, v0, s[20:23], s28 offen
    buffer_load_dword v35, v0, s[20:23], s29 offen
    buffer_load_dword v36, v0, s[20:23], s30 offen
    buffer_load_dword v37, v0, s[20:23], s31 offen
    buffer_load_dword v38, v0, s[20:23], s32 offen
    buffer_load_dword v39, v0, s[20:23], s33 offen
    buffer_load_dword v40, v0, s[20:23], s34 offen
    buffer_load_dword v41, v0, s[20:23], s35 offen
    buffer_load_dword v42, v0, s[20:23], s36 offen
    buffer_load_dword v43, v0, s[20:23], s37 offen
    buffer_load_dword v44, v0, s[20:23], s38 offen
    buffer_load_dword v45, v0, s[20:23], s39 offen
    v_add_u32 v0, -81856, v0
    s_waitcnt vmcnt(32)
    s_waitcnt lgkmcnt(0)
    v_perm_b32 v62, v47, v46, s72
    v_perm_b32 v63, v49, v48, s72
    v_perm_b32 v64, v51, v50, s72
    v_perm_b32 v65, v53, v52, s72
    v_perm_b32 v66, v55, v54, s72
    v_perm_b32 v67, v57, v56, s72
    v_perm_b32 v68, v59, v58, s72
    v_perm_b32 v69, v61, v60, s72
    ds_write_b128 v5, v[62:65] offset:16384
    ds_write_b128 v5, v[66:69] offset:20480
    v_perm_b32 v248, v47, v46, s73
    v_perm_b32 v249, v49, v48, s73
    v_perm_b32 v250, v51, v50, s73
    v_perm_b32 v251, v53, v52, s73
    v_perm_b32 v252, v55, v54, s73
    v_perm_b32 v253, v57, v56, s73
    v_perm_b32 v254, v59, v58, s73
    v_perm_b32 v255, v61, v60, s73
    buffer_load_dword v46, v0, s[20:23], s24 offen
    buffer_load_dword v47, v0, s[20:23], s25 offen
    buffer_load_dword v48, v0, s[20:23], s26 offen
    buffer_load_dword v49, v0, s[20:23], s27 offen
    buffer_load_dword v50, v0, s[20:23], s28 offen
    buffer_load_dword v51, v0, s[20:23], s29 offen
    buffer_load_dword v52, v0, s[20:23], s30 offen
    buffer_load_dword v53, v0, s[20:23], s31 offen
    buffer_load_dword v54, v0, s[20:23], s32 offen
    buffer_load_dword v55, v0, s[20:23], s33 offen
    buffer_load_dword v56, v0, s[20:23], s34 offen
    buffer_load_dword v57, v0, s[20:23], s35 offen
    buffer_load_dword v58, v0, s[20:23], s36 offen
    buffer_load_dword v59, v0, s[20:23], s37 offen
    buffer_load_dword v60, v0, s[20:23], s38 offen
    buffer_load_dword v61, v0, s[20:23], s39 offen
    v_add_u32 v0, 81920, v0
    s_waitcnt vmcnt(32)
    v_perm_b32 v136, v15, v14, s72
    v_perm_b32 v152, v15, v14, s73
    v_perm_b32 v137, v17, v16, s72
    v_perm_b32 v153, v17, v16, s73
    v_perm_b32 v138, v19, v18, s72
    v_perm_b32 v154, v19, v18, s73
    v_perm_b32 v139, v21, v20, s72
    v_perm_b32 v155, v21, v20, s73
    v_perm_b32 v140, v23, v22, s72
    v_perm_b32 v156, v23, v22, s73
    v_perm_b32 v141, v25, v24, s72
    v_perm_b32 v157, v25, v24, s73
    v_perm_b32 v142, v27, v26, s72
    v_perm_b32 v158, v27, v26, s73
    v_perm_b32 v143, v29, v28, s72
    v_perm_b32 v159, v29, v28, s73
    buffer_load_dword v14, v0, s[20:23], s24 offen
    buffer_load_dword v15, v0, s[20:23], s25 offen
    buffer_load_dword v16, v0, s[20:23], s26 offen
    buffer_load_dword v17, v0, s[20:23], s27 offen
    buffer_load_dword v18, v0, s[20:23], s28 offen
    buffer_load_dword v19, v0, s[20:23], s29 offen
    buffer_load_dword v20, v0, s[20:23], s30 offen
    buffer_load_dword v21, v0, s[20:23], s31 offen
    buffer_load_dword v22, v0, s[20:23], s32 offen
    buffer_load_dword v23, v0, s[20:23], s33 offen
    buffer_load_dword v24, v0, s[20:23], s34 offen
    buffer_load_dword v25, v0, s[20:23], s35 offen
    buffer_load_dword v26, v0, s[20:23], s36 offen
    buffer_load_dword v27, v0, s[20:23], s37 offen
    buffer_load_dword v28, v0, s[20:23], s38 offen
    buffer_load_dword v29, v0, s[20:23], s39 offen
    v_add_u32 v0, -81856, v0
    s_waitcnt vmcnt(32)
    v_perm_b32 v144, v31, v30, s72
    v_perm_b32 v160, v31, v30, s73
    v_perm_b32 v145, v33, v32, s72
    v_perm_b32 v161, v33, v32, s73
    v_perm_b32 v146, v35, v34, s72
    v_perm_b32 v162, v35, v34, s73
    v_perm_b32 v147, v37, v36, s72
    v_perm_b32 v163, v37, v36, s73
    v_perm_b32 v148, v39, v38, s72
    v_perm_b32 v164, v39, v38, s73
    v_perm_b32 v149, v41, v40, s72
    v_perm_b32 v165, v41, v40, s73
    v_perm_b32 v150, v43, v42, s72
    v_perm_b32 v166, v43, v42, s73
    v_perm_b32 v151, v45, v44, s72
    v_perm_b32 v167, v45, v44, s73
    buffer_load_dword v30, v70, s[20:23], s24 offen
    buffer_load_dword v31, v70, s[20:23], s25 offen
    buffer_load_dword v32, v70, s[20:23], s26 offen
    buffer_load_dword v33, v70, s[20:23], s27 offen
    buffer_load_dword v34, v70, s[20:23], s28 offen
    buffer_load_dword v35, v70, s[20:23], s29 offen
    buffer_load_dword v36, v70, s[20:23], s30 offen
    buffer_load_dword v37, v70, s[20:23], s31 offen
    buffer_load_dword v38, v70, s[20:23], s32 offen
    buffer_load_dword v39, v70, s[20:23], s33 offen
    buffer_load_dword v40, v70, s[20:23], s34 offen
    buffer_load_dword v41, v70, s[20:23], s35 offen
    buffer_load_dword v42, v70, s[20:23], s36 offen
    buffer_load_dword v43, v70, s[20:23], s37 offen
    buffer_load_dword v44, v70, s[20:23], s38 offen
    buffer_load_dword v45, v70, s[20:23], s39 offen
    v_add_u32 v70, 81920, v70
    s_waitcnt vmcnt(32)
    v_perm_b32 v168, v47, v46, s72
    v_perm_b32 v184, v47, v46, s73
    v_perm_b32 v169, v49, v48, s72
    v_perm_b32 v185, v49, v48, s73
    v_perm_b32 v170, v51, v50, s72
    v_perm_b32 v186, v51, v50, s73
    v_perm_b32 v171, v53, v52, s72
    v_perm_b32 v187, v53, v52, s73
    v_perm_b32 v172, v55, v54, s72
    v_perm_b32 v188, v55, v54, s73
    v_perm_b32 v173, v57, v56, s72
    v_perm_b32 v189, v57, v56, s73
    v_perm_b32 v174, v59, v58, s72
    v_perm_b32 v190, v59, v58, s73
    v_perm_b32 v175, v61, v60, s72
    v_perm_b32 v191, v61, v60, s73
    buffer_load_dword v46, v70, s[20:23], s24 offen
    buffer_load_dword v47, v70, s[20:23], s25 offen
    buffer_load_dword v48, v70, s[20:23], s26 offen
    buffer_load_dword v49, v70, s[20:23], s27 offen
    buffer_load_dword v50, v70, s[20:23], s28 offen
    buffer_load_dword v51, v70, s[20:23], s29 offen
    buffer_load_dword v52, v70, s[20:23], s30 offen
    buffer_load_dword v53, v70, s[20:23], s31 offen
    buffer_load_dword v54, v70, s[20:23], s32 offen
    buffer_load_dword v55, v70, s[20:23], s33 offen
    buffer_load_dword v56, v70, s[20:23], s34 offen
    buffer_load_dword v57, v70, s[20:23], s35 offen
    buffer_load_dword v58, v70, s[20:23], s36 offen
    buffer_load_dword v59, v70, s[20:23], s37 offen
    buffer_load_dword v60, v70, s[20:23], s38 offen
    buffer_load_dword v61, v70, s[20:23], s39 offen
    v_add_u32 v70, 81920, v70
    s_cmp_lg_u32 s4, 3
    s_cbranch_scc1 L_cb_55
    s_mov_b64 exec, 1
    v_mov_b32 v0, 64
    s_mov_b32 s16, 1048576
L_cb_56:
    global_load_dword v70, v0, s[8:9] sc1
    s_sub_u32 s16, s16, 1
    s_cbranch_scc1 L_bail3
    s_waitcnt vmcnt(0)
    v_cmp_gt_u32 vcc, 64, v70
    s_nop 0
    s_cbranch_vccnz L_cb_56
    s_mov_b64 exec, 3
    v_lshlrev_b32 v0, 8, v2
    s_mov_b32 s16, 1048576
L_cb_57:
    global_load_dword v70, v0, s[56:57] sc1
    s_sub_u32 s16, s16, 1
    s_cbranch_scc1 L_bail4
    s_waitcnt vmcnt(0)
    v_cmp_gt_u32 vcc, 2, v70
    s_nop 0
    s_cbranch_vccnz L_cb_57
    s_mov_b64 exec, -1
L_cb_55:
    s_waitcnt vmcnt(32)
    v_perm_b32 v176, v15, v14, s72
    v_perm_b32 v192, v15, v14, s73
    v_perm_b32 v177, v17, v16, s72
    v_perm_b32 v193, v17, v16, s73
    v_perm_b32 v178, v19, v18, s72
    v_perm_b32 v194, v19, v18, s73
    v_perm_b32 v179, v21, v20, s72
    v_perm_b32 v195, v21, v20, s73
    v_perm_b32 v180, v23, v22, s72
    v_perm_b32 v196, v23, v22, s73
    v_perm_b32 v181, v25, v24, s72
    v_perm_b32 v197, v25, v24, s73
    v_perm_b32 v182, v27, v26, s72
    v_perm_b32 v198, v27, v26, s73
    v_perm_b32 v183, v29, v28, s72
    v_perm_b32 v199, v29, v28, s73
    s_waitcnt vmcnt(16)
    v_perm_b32 v200, v31, v30, v71
    v_perm_b32 v201, v33, v32, v71
    v_perm_b32 v202, v35, v34, v71
    v_perm_b32 v203, v37, v36, v71
    v_perm_b32 v204, v39, v38, v71
    v_perm_b32 v205, v41, v40, v71
    v_perm_b32 v206, v43, v42, v71
    v_perm_b32 v207, v45, v44, v71
    s_waitcnt vmcnt(0)
    v_perm_b32 v208, v47, v46, v71
    v_perm_b32 v209, v49, v48, v71
    v_perm_b32 v210, v51, v50, v71
    v_perm_b32 v211, v53, v52, v71
    v_perm_b32 v212, v55, v54, v71
    v_perm_b32 v213, v57, v56, v71
    v_perm_b32 v214, v59, v58, v71
    v_perm_b32 v215, v61, v60, v71
    s_waitcnt lgkmcnt(0)
    s_barrier
    s_mov_b32 s62, 0x3f803f80
    s_mov_b32 s63, 0x3f803f80
    s_mov_b32 s14, 0
    s_lshl_b32 s21, s4, 10
    s_mov_b32 s20, 10240
    s_add_u32 s17, s14, 0
    s_lshr_b32 s18, s17, 1
    s_xor_b32 s18, s18, s5
    s_and_b32 s18, s18, 1
    s_lshl_b32 s18, s18, 13
    s_lshl_b32 s17, s17, 20
    s_add_u32 s17, s17, s18
    s_add_u32 s38, s50, s17
    s_addc_u32 s39, s51, 0
    s_add_u32 s22, s38, 0x4000
    s_addc_u32 s23, s39, 0
    s_add_u32 m0, s21, 10240
    s_nop 0
    global_load_lds_dwordx4 v3, s[38:39]
    s_add_u32 m0, s21, 14336
    s_add_u32 s38, s38, 0x1000
    s_addc_u32 s39, s39, 0
    global_load_lds_dwordx4 v3, s[38:39]
    s_add_u32 m0, s21, 18432
    s_nop 0
    global_load_lds_dwordx4 v3, s[22:23]
    s_add_u32 m0, s21, 22528
    s_add_u32 s22, s22, 0x1000
    s_addc_u32 s23, s23, 0
    global_load_lds_dwordx4 v3, s[22:23]
    s_mov_b32 s16, 0
    s_cmp_eq_u32 s4, 3
    s_cselect_b32 s17, 2, 1
    s_cmp_lg_u32 s19, 0
    s_cselect_b32 s17, 0, s17
    s_mul_i32 s18, s11, 3
    s_add_u32 s17, s17, s18
    s_cmp_eq_u32 s10, 0
    s_cselect_b32 s18, 6, 0
    s_add_u32 s17, s17, s18
    s_cmp_eq_u32 s17, 1
    s_cbranch_scc1 L_var1
    s_cmp_eq_u32 s17, 2
    s_cbranch_scc1 L_var2
    s_cmp_eq_u32 s17, 3
    s_cbranch_scc1 L_var3
    s_cmp_eq_u32 s17, 4
    s_cbranch_scc1 L_var4
    s_cmp_eq_u32 s17, 5
    s_cbranch_scc1 L_var5
    s_cmp_eq_u32 s17, 6
    s_cbranch_scc1 L_var6
    s_cmp_eq_u32 s17, 7
    s_cbranch_scc1 L_var7
    s_cmp_eq_u32 s17, 8
    s_cbranch_scc1 L_var8
    s_cmp_eq_u32 s17, 9
    s_cbranch_scc1 L_var9
    s_cmp_eq_u32 s17, 10
    s_cbranch_scc1 L_var10
    s_cmp_eq_u32 s17, 11
    s_cbranch_scc1 L_var11
L_var0:
    s_add_u32 s17, s14, 0
    s_and_b32 s17, s17, 3
    s_lshl_b32 s18, s17, 13
    s_add_u32 s28, s46, s18
    s_addc_u32 s29, s47, 0
    s_lshl_b32 s17, s17, 15
    s_add_u32 s18, s17, 16384
    s_add_u32 s32, s48, s18
    s_addc_u32 s33, s49, 0
    global_load_dwordx4 v[46:49], v3, s[28:29] sc1
    global_load_dword v71, v6, s[28:29] sc1
    v_mov_b64 v[14:15], 0
    v_mov_b64 v[16:17], 0
    v_mov_b64 v[18:19], 0
    v_mov_b64 v[20:21], 0
    v_mov_b64 v[22:23], 0
    v_mov_b64 v[24:25], 0
    v_mov_b64 v[26:27], 0
    v_mov_b64 v[28:29], 0
    v_mov_b64 v[30:31], 0
    v_mov_b64 v[32:33], 0
    v_mov_b64 v[34:35], 0
    v_mov_b64 v[36:37], 0
    ds_read_b128 v[50:53], v3 offset:32768
    ds_read_b128 v[54:57], v3 offset:36864
    ds_read_b128 v[58:61], v3 offset:40960
    ds_read_b128 v[62:65], v3 offset:45056
L_step_f0r:
    s_waitcnt vmcnt(0)
L_own2_f0r:
    v_max3_u32 v0, v46, v47, v48
    v_max3_u32 v0, v0, v49, v71
    v_cmp_eq_u32 vcc, -1, v0
    ds_write_b128 v3, v[46:49] offset:0
    ds_write_b32 v6, v71 offset:0
    s_cbranch_vccnz L_own_f0r
    global_load_dwordx4 v[66:69], v3, s[32:33] sc1
    global_load_dword v70, v6, s[32:33] sc1
    s_waitcnt lgkmcnt(0)
    s_barrier
    ds_read_b128 v[38:41], v2 offset:0
    ds_read_b128 v[42:45], v2 offset:1024
    ds_read_b128 v[46:49], v2 offset:2048
    s_waitcnt lgkmcnt(2)
    v_smfmac_f32_16x16x64_bf16 v[14:17], v[38:41], a[0:7], v1
    s_lshr_b32 s17, s14, 2
    s_xor_b32 s17, s17, s5
    v_smfmac_f32_16x16x64_bf16 v[18:21], v[38:41], a[8:15], v1
    s_and_b32 s17, s17, 1
    s_lshl_b32 s17, s17, 13
    v_smfmac_f32_16x16x64_bf16 v[22:25], v[38:41], a[160:167], v1
    s_lshl_b32 s18, s14, 19
    s_add_u32 s17, s17, s18
    v_smfmac_f32_16x16x64_bf16 v[26:29], v[38:41], a[168:175], v1
    s_add_u32 s40, s100, s17
    s_addc_u32 s41, s101, 0
    s_add_u32 s17, s14, 1
    v_smfmac_f32_16x16x64_bf16 v[30:33], v[38:41], v[50:57], v1
    ds_read_b128 v[50:53], v3 offset:49152
    s_lshr_b32 s18, s17, 1
    v_smfmac_f32_16x16x64_bf16 v[34:37], v[38:41], v[58:65], v1
    ds_read_b128 v[54:57], v3 offset:53248
    s_xor_b32 s18, s18, s5
    s_waitcnt lgkmcnt(3)
    v_smfmac_f32_16x16x64_bf16 v[14:17], v[42:45], a[16:23], v1
    ds_read_b128 v[58:61], v3 offset:57344
    s_and_b32 s18, s18, 1
    v_smfmac_f32_16x16x64_bf16 v[18:21], v[42:45], a[24:31], v1
    ds_read_b128 v[62:65], v3 offset:61440
    s_lshl_b32 s18, s18, 13
    v_smfmac_f32_16x16x64_bf16 v[22:25], v[42:45], a[176:183], v1
    ds_read_b128 v[38:41], v2 offset:3072
    s_lshl_b32 s17, s17, 20
    v_smfmac_f32_16x16x64_bf16 v[26:29], v[42:45], a[184:191], v1
    s_add_u32 s17, s17, s18
    s_add_u32 s38, s50, s17
    s_addc_u32 s39, s51, 0
    s_waitcnt lgkmcnt(3)
    v_smfmac_f32_16x16x64_bf16 v[30:33], v[42:45], v[50:57], v1
    ds_read_b128 v[50:53], v4 offset:0
    s_add_u32 s22, s38, 0x4000
    s_addc_u32 s23, s39, 0
    s_waitcnt lgkmcnt(2)
    v_smfmac_f32_16x16x64_bf16 v[34:37], v[42:45], v[58:65], v1
    ds_read_b128 v[54:57], v4 offset:4096
    s_add_u32 s17, s14, 3
    v_smfmac_f32_16x16x64_bf16 v[14:17], v[46:49], a[32:39], v1
    ds_read_b128 v[58:61], v4 offset:8192
    s_and_b32 s17, s17, 3
    v_smfmac_f32_16x16x64_bf16 v[18:21], v[46:49], a[40:47], v1
    ds_read_b128 v[62:65], v4 offset:12288
    s_lshl_b32 s18, s17, 13
    v_smfmac_f32_16x16x64_bf16 v[22:25], v[46:49], a[192:199], v1
    ds_read_b128 v[42:45], v2 offset:4096
    s_add_u32 s34, s46, s18
    s_addc_u32 s35, s47, 0
    v_smfmac_f32_16x16x64_bf16 v[26:29], v[46:49], a[200:207], v1
    s_lshl_b32 s17, s17, 15
    s_add_u32 s18, s17, 0
    s_waitcnt lgkmcnt(3)
    v_smfmac_f32_16x16x64_bf16 v[30:33], v[46:49], v[50:57], v1
    ds_read_b128 v[50:53], v4 offset:16384
    s_add_u32 s36, s48, s18
    s_addc_u32 s37, s49, 0
    s_waitcnt lgkmcnt(2)
    v_smfmac_f32_16x16x64_bf16 v[34:37], v[46:49], v[58:65], v1
    ds_read_b128 v[54:57], v4 offset:20480
    s_and_b32 s17, s14, 1
    v_smfmac_f32_16x16x64_bf16 v[14:17], v[38:41], a[48:55], v1
    ds_read_b128 v[58:61], v4 offset:24576
    s_mul_i32 s17, s17, 163840
    v_smfmac_f32_16x16x64_bf16 v[18:21], v[38:41], a[56:63], v1
    ds_read_b128 v[62:65], v4 offset:28672
    s_add_u32 s24, s52, s17
    s_addc_u32 s25, s53, 0
    v_smfmac_f32_16x16x64_bf16 v[22:25], v[38:41], a[208:215], v1
    s_add_u32 s26, s24, 16384
    s_addc_u32 s27, s25, 0
    s_bfe_u32 s15, s14, 0x10001
    v_smfmac_f32_16x16x64_bf16 v[26:29], v[38:41], a[216:223], v1
    s_waitcnt lgkmcnt(2)
    v_smfmac_f32_16x16x64_bf16 v[30:33], v[38:41], v[50:57], v1
    ds_read_b128 v[50:53], v4 offset:32768
    s_waitcnt lgkmcnt(1)
    v_smfmac_f32_16x16x64_bf16 v[34:37], v[38:41], v[58:65], v1
    ds_read_b128 v[54:57], v4 offset:36864
    s_waitcnt vmcnt(0)
L_oth2_f0r:
    v_max3_u32 v0, v66, v67, v68
    v_max3_u32 v0, v0, v69, v70
    v_cmp_eq_u32 vcc, -1, v0
    ds_write_b128 v3, v[66:69] offset:5120
    ds_write_b32 v6, v70 offset:5120
    s_cbranch_vccnz L_oth_f0r
    v_smfmac_f32_16x16x64_bf16 v[14:17], v[42:45], a[64:71], v1
    ds_read_b128 v[58:61], v4 offset:40960
    v_smfmac_f32_16x16x64_bf16 v[18:21], v[42:45], a[72:79], v1
    ds_read_b128 v[62:65], v4 offset:45056
    v_smfmac_f32_16x16x64_bf16 v[22:25], v[42:45], a[224:231], v1
    v_smfmac_f32_16x16x64_bf16 v[26:29], v[42:45], a[232:239], v1
    s_waitcnt lgkmcnt(4)
    v_smfmac_f32_16x16x64_bf16 v[30:33], v[42:45], v[50:57], v1
    s_waitcnt lgkmcnt(0)
    v_smfmac_f32_16x16x64_bf16 v[34:37], v[42:45], v[58:65], v1
    s_barrier
    ds_read_b128 v[46:49], v2 offset:5120
    ds_read_b128 v[38:41], v2 offset:6144
    ds_read_b128 v[42:45], v2 offset:7168
    v_mov_b32 v0, -1
    s_mov_b64 exec, s[58:59]
    global_store_dword v10, v0, s[34:35]
    global_store_dword v10, v0, s[36:37] sc1
    s_mov_b64 exec, -1
    s_waitcnt lgkmcnt(2)
    v_smfmac_f32_16x16x64_bf16 v[14:17], v[46:49], a[80:87], v1
    s_xor_b32 s17, s20, 149504
    v_smfmac_f32_16x16x64_bf16 v[18:21], v[46:49], a[88:95], v1
    s_add_u32 m0, s17, s21
    v_smfmac_f32_16x16x64_bf16 v[22:25], v[46:49], a[240:247], v1
    global_load_lds_dwordx4 v3, s[38:39]
    v_smfmac_f32_16x16x64_bf16 v[26:29], v[46:49], a[248:255], v1
    ds_read_b128 v[46:49], v2 offset:8192
    s_waitcnt lgkmcnt(2)
    v_smfmac_f32_16x16x64_bf16 v[14:17], v[38:41], a[96:103], v1
    s_add_u32 m0, m0, 0x1000
    v_smfmac_f32_16x16x64_bf16 v[18:21], v[38:41], a[104:111], v1
    s_add_u32 s38, s38, 0x1000
    s_addc_u32 s39, s39, 0
    v_smfmac_f32_16x16x64_bf16 v[22:25], v[38:41], v[72:79], v1
    global_load_lds_dwordx4 v3, s[38:39]
    v_smfmac_f32_16x16x64_bf16 v[26:29], v[38:41], v[80:87], v1
    ds_read_b128 v[38:41], v2 offset:9216
    s_waitcnt lgkmcnt(2)
    v_smfmac_f32_16x16x64_bf16 v[14:17], v[42:45], a[112:119], v1
    ds_read_b128 v[58:61], v5 offset:16384
    v_smfmac_f32_16x16x64_bf16 v[18:21], v[42:45], a[120:127], v1
    ds_read_b128 v[62:65], v5 offset:20480
    v_smfmac_f32_16x16x64_bf16 v[22:25], v[42:45], v[88:95], v1
    ds_read_b128 v[50:53], v5 offset:8192
    v_smfmac_f32_16x16x64_bf16 v[26:29], v[42:45], v[96:103], v1
    ds_read_b128 v[54:57], v5 offset:12288
    s_waitcnt lgkmcnt(5)
    v_smfmac_f32_16x16x64_bf16 v[14:17], v[46:49], a[128:135], v1
    v_add_u32 v0, s20, v2
    v_smfmac_f32_16x16x64_bf16 v[18:21], v[46:49], a[136:143], v1
    s_xor_b32 s20, s20, 149504
    v_smfmac_f32_16x16x64_bf16 v[22:25], v[46:49], v[104:111], v1
    v_smfmac_f32_16x16x64_bf16 v[26:29], v[46:49], v[112:119], v1
    s_waitcnt lgkmcnt(4)
    v_smfmac_f32_16x16x64_bf16 v[14:17], v[38:41], a[144:151], v1
    v_smfmac_f32_16x16x64_bf16 v[18:21], v[38:41], a[152:159], v1
    v_smfmac_f32_16x16x64_bf16 v[22:25], v[38:41], v[120:127], v1
    v_smfmac_f32_16x16x64_bf16 v[26:29], v[38:41], v[128:135], v1
    v_smfmac_f32_16x16x64_bf16 v[34:37], v[38:41], v[248:255], v1
    s_waitcnt lgkmcnt(2)
    v_smfmac_f32_16x16x64_bf16 v[30:33], v[38:41], v[58:65], v1
    ds_read_b128 v[58:61], v5 offset:0
    ds_read_b128 v[62:65], v5 offset:4096
    v_pk_add_f32 v[14:15], v[14:15], v[16:17]
    v_pk_add_f32 v[18:19], v[18:19], v[20:21]
    v_pk_mul_f32 v[14:15], v[14:15], s[44:45]
    v_pk_mul_f32 v[18:19], v[18:19], s[44:45]
    v_cvt_pk_bf16_f32 v16, v14, v18
    v_cvt_pk_bf16_f32 v17, v15, v19
    ds_write2_b32 v11, v16, v17 offset0:0 offset1:72
    v_pk_add_f32 v[22:23], v[22:23], v[24:25]
    v_pk_add_f32 v[26:27], v[26:27], v[28:29]
    v_cvt_pk_bf16_f32 v28, v22, v26
    v_cvt_pk_bf16_f32 v29, v23, v27
    v_add_u32 v71, 2304, v11
    ds_write2_b32 v71, v28, v29 offset0:0 offset1:72
    v_smfmac_f32_16x16x64_bf16 v[34:37], v[46:49], v[240:247], v1
    ds_read_b128 v[38:41], v2 offset:5120
    s_waitcnt lgkmcnt(5)
    v_smfmac_f32_16x16x64_bf16 v[30:33], v[46:49], v[50:57], v1
    ds_read_b128 v[50:53], v4 offset:57344
    ds_read_b128 v[54:57], v4 offset:61440
    v_smfmac_f32_16x16x64_bf16 v[34:37], v[42:45], v[232:239], v1
    ds_read_b128 v[46:49], v2 offset:6144
    s_waitcnt lgkmcnt(6)
    v_smfmac_f32_16x16x64_bf16 v[30:33], v[42:45], v[58:65], v1
    ds_read_b128 v[58:61], v4 offset:49152
    ds_read_b128 v[62:65], v4 offset:53248
    s_waitcnt lgkmcnt(6)
    s_barrier
    ds_read_b128 v[66:69], v0 offset:3072
    ds_read_b128 v[42:45], v0 offset:1024
    global_store_dword v11, v28, s[40:41] sc1
    global_store_dword v11, v29, s[40:41] offset:288 sc1
    s_waitcnt lgkmcnt(4)
    v_smfmac_f32_16x16x64_bf16 v[34:37], v[46:49], v[224:231], v1
    v_smfmac_f32_16x16x64_bf16 v[30:33], v[46:49], v[50:57], v1
    ds_read_b128 v[50:53], v12 offset:0
    ds_read_b128 v[54:57], v12 offset:64
    ds_read_b128 v[46:49], v0 offset:2048
    v_smfmac_f32_16x16x64_bf16 v[34:37], v[38:41], v[216:223], v1
    s_waitcnt lgkmcnt(5)
    v_smfmac_f32_16x16x64_bf16 v[30:33], v[38:41], v[58:65], v1
    ds_read_b128 v[58:61], v12 offset:128
    ds_read_b128 v[62:65], v12 offset:192
    ds_read_b128 v[38:41], v0 offset:0
    s_cmp_eq_u32 s14, 63
    s_cbranch_scc1 L_last_f0r
    s_waitcnt lgkmcnt(4)
    v_mfma_f32_16x16x32_bf16 v[14:17], v[42:45], v[54:57], 0
    ds_read_b128 v[42:45], v0 offset:5120
    s_waitcnt lgkmcnt(3)
    v_mfma_f32_16x16x32_bf16 v[14:17], v[46:49], v[58:61], v[14:17]
    ds_read_b128 v[46:49], v0 offset:6144
    v_pk_add_f32 v[30:31], v[30:31], v[32:33]
    v_pk_add_f32 v[34:35], v[34:35], v[36:37]
    s_waitcnt lgkmcnt(3)
    v_mfma_f32_16x16x32_bf16 v[14:17], v[66:69], v[62:65], v[14:17]
    ds_read_b128 v[66:69], v0 offset:7168
    v_cvt_pk_bf16_f32 v32, v30, v31
    v_cvt_pk_bf16_f32 v33, v34, v35
    s_waitcnt lgkmcnt(3)
    v_mfma_f32_16x16x32_bf16 v[14:17], v[38:41], v[50:53], v[14:17]
    ds_read_b128 v[38:41], v0 offset:4096
    v_mov_b32 v34, v33
    v_mov_b32 v35, 0
    s_waitcnt lgkmcnt(3)
    v_mfma_f32_16x16x32_bf16 v[18:21], v[42:45], v[54:57], 0
    ds_read_b128 v[42:45], v12 offset:2368
    s_waitcnt lgkmcnt(3)
    v_mfma_f32_16x16x32_bf16 v[18:21], v[46:49], v[58:61], v[18:21]
    ds_read_b128 v[46:49], v12 offset:2432
    s_waitcnt lgkmcnt(3)
    v_mfma_f32_16x16x32_bf16 v[18:21], v[66:69], v[62:65], v[18:21]
    ds_read_b128 v[66:69], v12 offset:2496
    s_waitcnt lgkmcnt(3)
    v_mfma_f32_16x16x32_bf16 v[18:21], v[38:41], v[50:53], v[18:21]
    ds_read_b128 v[38:41], v12 offset:2304
    v_exp_f32 v36, v14
    v_exp_f32 v37, v15
    v_exp_f32 v71, v16
    v_cvt_pk_bf16_f32 v26, v36, v37
    v_exp_f32 v36, v17
    s_nop 0
    v_cvt_pk_bf16_f32 v27, v71, v36
    s_waitcnt lgkmcnt(3)
    v_mfma_f32_16x16x32_bf16 v[22:25], v[42:45], v[54:57], 0
    ds_read_b128 v[42:45], v3 offset:18432
    s_waitcnt lgkmcnt(3)
    v_mfma_f32_16x16x32_bf16 v[22:25], v[46:49], v[58:61], v[22:25]
    ds_read_b128 v[46:49], v3 offset:22528
    v_exp_f32 v36, v18
    v_exp_f32 v37, v19
    s_waitcnt lgkmcnt(3)
    v_mfma_f32_16x16x32_bf16 v[22:25], v[66:69], v[62:65], v[22:25]
    v_exp_f32 v71, v20
    v_cvt_pk_bf16_f32 v28, v36, v37
    s_waitcnt lgkmcnt(2)
    v_mfma_f32_16x16x32_bf16 v[22:25], v[38:41], v[50:53], v[22:25]
    v_exp_f32 v36, v21
    s_nop 0
    v_cvt_pk_bf16_f32 v29, v71, v36
    v_mov_b64 v[66:67], s[62:63]
    v_mov_b64 v[68:69], s[62:63]
    s_waitcnt lgkmcnt(1)
    v_mfma_f32_16x16x32_bf16 v[54:57], v[42:45], v[26:29], 0
    s_nop 0
    v_exp_f32 v36, v22
    s_waitcnt lgkmcnt(0)
    v_mfma_f32_16x16x32_bf16 v[58:61], v[46:49], v[26:29], 0
    v_exp_f32 v37, v23
    v_mfma_f32_16x16x32_bf16 v[50:53], v[66:69], v[26:29], 0
    v_mov_b32 v31, 0
    v_cvt_pk_bf16_f32 v30, v36, v37
    s_add_u32 m0, s21, 18432
    s_nop 2
    v_mfma_f32_16x16x16_bf16 v[50:53], v[66:67], v[30:31], v[50:53]
    v_mfma_f32_16x16x16_bf16 v[54:57], v[32:33], v[30:31], v[54:57]
    v_mfma_f32_16x16x16_bf16 v[58:61], v[34:35], v[30:31], v[58:61]
    global_load_lds_dwordx4 v3, s[22:23]
    s_add_u32 m0, m0, 0x1000
    s_add_u32 s22, s22, 0x1000
    s_addc_u32 s23, s23, 0
    global_load_lds_dwordx4 v3, s[22:23]
    s_nop 0
    v_rcp_f32 v36, v50
    v_subrev_u32 v0, s54, v50
    v_cmp_lt_u32 vcc, s55, v0
    v_pk_mul_f32 v[54:55], v[54:55], v[36:37] op_sel_hi:[1,0]
    v_pk_mul_f32 v[58:59], v[58:59], v[36:37] op_sel_hi:[1,0]
    v_pk_mul_f32 v[56:57], v[56:57], v[36:37] op_sel_hi:[1,0]
    v_pk_mul_f32 v[60:61], v[60:61], v[36:37] op_sel_hi:[1,0]
    v_cvt_pk_bf16_f32 v62, v54, v58
    v_cvt_pk_bf16_f32 v63, v55, v59
    v_cvt_pk_bf16_f32 v64, v56, v60
    v_cvt_pk_bf16_f32 v65, v57, v61
    s_cbranch_vccnz L_fb_f0r
L_norm_f0r:
    s_mov_b64 exec, s[70:71]
    ds_write_b128 v13, v[62:65] offset:5120
    s_mov_b64 exec, -1
    v_mov_b64 v[14:15], 0
    v_mov_b64 v[16:17], 0
    v_mov_b64 v[18:19], 0
    v_mov_b64 v[20:21], 0
    v_mov_b64 v[22:23], 0
    v_mov_b64 v[24:25], 0
    v_mov_b64 v[26:27], 0
    v_mov_b64 v[28:29], 0
    v_mov_b64 v[30:31], 0
    v_mov_b64 v[32:33], 0
    s_waitcnt lgkmcnt(0)
    s_barrier
    ds_read_b128 v[38:41], v2 offset:5120
    ds_read_b128 v[42:45], v2 offset:6144
    ds_read_b128 v[46:49], v3 offset:26624
    s_add_u32 s14, s14, 1
    s_add_u32 s17, s14, 0
    s_and_b32 s17, s17, 3
    s_lshl_b32 s18, s17, 13
    s_add_u32 s28, s46, s18
    s_addc_u32 s29, s47, 0
    s_lshl_b32 s17, s17, 15
    s_add_u32 s18, s17, 0
    s_add_u32 s30, s48, s18
    s_addc_u32 s31, s49, 0
    s_add_u32 s18, s17, 16384
    s_add_u32 s32, s48, s18
    s_addc_u32 s33, s49, 0
    s_waitcnt lgkmcnt(2)
    v_smfmac_f32_16x16x64_bf16 v[14:17], v[38:41], v[136:143], v1
    s_waitcnt lgkmcnt(1)
    v_smfmac_f32_16x16x64_bf16 v[14:17], v[42:45], v[144:151], v1
    v_smfmac_f32_16x16x64_bf16 v[18:21], v[38:41], v[152:159], v1
    v_smfmac_f32_16x16x64_bf16 v[18:21], v[42:45], v[160:167], v1
    v_smfmac_f32_16x16x64_bf16 v[22:25], v[38:41], v[168:175], v1
    v_smfmac_f32_16x16x64_bf16 v[22:25], v[42:45], v[176:183], v1
    v_smfmac_f32_16x16x64_bf16 v[26:29], v[38:41], v[184:191], v1
    v_smfmac_f32_16x16x64_bf16 v[26:29], v[42:45], v[192:199], v1
    s_nop 1
    v_pk_add_f32 v[14:15], v[14:15], v[16:17]
    s_nop 0
    v_pk_add_f32 v[18:19], v[18:19], v[20:21]
    v_smfmac_f32_16x16x64_bf16 v[30:33], v[38:41], v[200:207], v1
    v_cvt_pk_bf16_f32 v16, v14, v18
    v_cvt_pk_bf16_f32 v17, v15, v19
    v_smfmac_f32_16x16x64_bf16 v[30:33], v[42:45], v[208:215], v1
    v_and_or_b32 v16, v16, -2, s15
    v_and_or_b32 v17, v17, -2, s15
    global_store_dwordx2 v7, v[16:17], s[24:25]
    v_pk_add_f32 v[22:23], v[22:23], v[24:25]
    v_pk_add_f32 v[26:27], v[26:27], v[28:29]
    v_cvt_pk_bf16_f32 v24, v22, v26
    v_cvt_pk_bf16_f32 v25, v23, v27
    v_and_or_b32 v24, v24, -2, s15
    v_and_or_b32 v25, v25, -2, s15
    global_store_dwordx2 v7, v[24:25], s[26:27]
    v_pk_add_f32 v[30:31], v[30:31], v[32:33]
    v_cvt_pk_bf16_f32 v32, v30, v31
    v_and_or_b32 v32, v32, -2, s15
    global_store_dword v8, v32, s[24:25]
    s_waitcnt lgkmcnt(0)
    s_waitcnt vmcnt(0)
L_pa2_f0r:
    global_load_dwordx4 v[38:41], v9, s[24:25] sc1
    global_load_dwordx4 v[42:45], v9, s[24:25] offset:1024 sc1
    s_waitcnt vmcnt(1)
    v_mfma_f32_16x16x32_bf16 v[50:53], v[38:41], v[46:49], 0
    v_bitop3_b32 v0, v38, v39, s15 bitop3:0x7e
    v_bitop3_b32 v71, v40, v41, s15 bitop3:0x7e
    s_waitcnt vmcnt(0)
    v_mfma_f32_16x16x32_bf16 v[50:53], v[42:45], v[46:49], v[50:53]
    v_bitop3_b32 v66, v42, v43, s15 bitop3:0x7e
    v_bitop3_b32 v67, v44, v45, s15 bitop3:0x7e
    v_or3_b32 v0, v0, v71, v66
    v_bitop3_b32 v0, v0, v67, 1 bitop3:0xa8
    v_cmp_ne_u32 vcc, 0, v0
    s_nop 2
    v_pk_add_f32 v[50:51], v[50:51], v[52:53]
    v_add_f32 v50, v50, v51
    s_cbranch_vccnz L_pa_f0r
    s_nop 0
    v_mov_b32_dpp v51, v50 quad_perm:[1,1,3,3] row_mask:0xf bank_mask:0xf
    v_cvt_pk_bf16_f32 v50, v50, v51
    v_min_u32 v50, -2, v50
    s_mov_b64 exec, s[58:59]
    global_store_dword v10, v50, s[28:29]
    global_store_dword v10, v50, s[30:31] sc1
    s_mov_b64 exec, -1
    s_waitcnt vmcnt(1)
    s_barrier
    global_load_dwordx4 v[46:49], v3, s[28:29] sc1
    global_load_dword v71, v6, s[28:29] sc1
    v_mov_b64 v[14:15], 0
    v_mov_b64 v[16:17], 0
    v_mov_b64 v[18:19], 0
    v_mov_b64 v[20:21], 0
    v_mov_b64 v[22:23], 0
    v_mov_b64 v[24:25], 0
    v_mov_b64 v[26:27], 0
    v_mov_b64 v[28:29], 0
    v_mov_b64 v[30:31], 0
    v_mov_b64 v[32:33], 0
    v_mov_b64 v[34:35], 0
    v_mov_b64 v[36:37], 0
    ds_read_b128 v[50:53], v3 offset:32768
    ds_read_b128 v[54:57], v3 offset:36864
    ds_read_b128 v[58:61], v3 offset:40960
    ds_read_b128 v[62:65], v3 offset:45056
    s_branch L_step_f0r
L_own_f0r:
    s_add_u32 s16, s16, 1
    s_cmp_gt_u32 s16, 1048576
    s_cbranch_scc1 L_bail5
    s_waitcnt lgkmcnt(0)
    global_load_dwordx4 v[46:49], v3, s[28:29] sc1
    global_load_dword v71, v6, s[28:29] sc1
    s_waitcnt vmcnt(0)
    s_branch L_own2_f0r
L_oth_f0r:
    s_add_u32 s16, s16, 1
    s_cmp_gt_u32 s16, 1048576
    s_cbranch_scc1 L_bail6
    s_waitcnt lgkmcnt(0)
    global_load_dwordx4 v[66:69], v3, s[32:33] sc1
    global_load_dword v70, v6, s[32:33] sc1
    s_waitcnt vmcnt(0)
    s_branch L_oth2_f0r
L_pa_f0r:
    s_add_u32 s16, s16, 1
    s_cmp_gt_u32 s16, 1048576
    s_cbranch_scc1 L_bail8
    s_branch L_pa2_f0r
L_fb_f0r:
    v_max3_f32 v0, v14, v15, v16
    v_max3_f32 v0, v0, v17, v18
    v_max3_f32 v0, v0, v19, v20
    v_max3_f32 v0, v0, v21, v22
    v_max3_f32 v0, v0, v23, v24
    v_max_f32 v0, v0, v25
    v_mov_b32 v36, v0
    s_nop 1
    v_permlane16_swap_b32 v0, v36
    v_max_f32 v0, v0, v36
    v_mov_b32 v36, v0
    s_nop 1
    v_permlane32_swap_b32 v0, v36
    v_max_f32 v0, v0, v36
    v_sub_f32 v14, v14, v0
    v_sub_f32 v15, v15, v0
    v_sub_f32 v16, v16, v0
    v_sub_f32 v17, v17, v0
    v_sub_f32 v18, v18, v0
    v_sub_f32 v19, v19, v0
    v_sub_f32 v20, v20, v0
    v_sub_f32 v21, v21, v0
    v_sub_f32 v22, v22, v0
    v_sub_f32 v23, v23, v0
    v_sub_f32 v24, v24, v0
    v_sub_f32 v25, v25, v0
    v_exp_f32 v36, v14
    v_exp_f32 v37, v15
    v_exp_f32 v71, v16
    v_cvt_pk_bf16_f32 v26, v36, v37
    v_exp_f32 v36, v17
    s_nop 0
    v_cvt_pk_bf16_f32 v27, v71, v36
    v_exp_f32 v36, v18
    v_exp_f32 v37, v19
    v_exp_f32 v71, v20
    v_cvt_pk_bf16_f32 v28, v36, v37
    v_exp_f32 v36, v21
    s_nop 0
    v_cvt_pk_bf16_f32 v29, v71, v36
    v_exp_f32 v36, v22
    v_exp_f32 v37, v23
    v_mov_b32 v31, 0
    v_cvt_pk_bf16_f32 v30, v36, v37
    v_mfma_f32_16x16x32_bf16 v[50:53], v[66:69], v[26:29], 0
    v_mfma_f32_16x16x32_bf16 v[54:57], v[42:45], v[26:29], 0
    v_mfma_f32_16x16x32_bf16 v[58:61], v[46:49], v[26:29], 0
    s_nop 3
    v_mfma_f32_16x16x16_bf16 v[50:53], v[66:67], v[30:31], v[50:53]
    v_mfma_f32_16x16x16_bf16 v[54:57], v[32:33], v[30:31], v[54:57]
    v_mfma_f32_16x16x16_bf16 v[58:61], v[34:35], v[30:31], v[58:61]
    s_nop 5
    v_rcp_f32 v36, v50
    s_nop 0
    v_pk_mul_f32 v[54:55], v[54:55], v[36:37] op_sel_hi:[1,0]
    v_pk_mul_f32 v[58:59], v[58:59], v[36:37] op_sel_hi:[1,0]
    v_pk_mul_f32 v[56:57], v[56:57], v[36:37] op_sel_hi:[1,0]
    v_pk_mul_f32 v[60:61], v[60:61], v[36:37] op_sel_hi:[1,0]
    v_cvt_pk_bf16_f32 v62, v54, v58
    v_cvt_pk_bf16_f32 v63, v55, v59
    v_cvt_pk_bf16_f32 v64, v56, v60
    v_cvt_pk_bf16_f32 v65, v57, v61
    s_branch L_norm_f0r
L_last_f0r:
    s_nop 2
    v_pk_add_f32 v[30:31], v[30:31], v[32:33]
    v_pk_add_f32 v[34:35], v[34:35], v[36:37]
    v_cvt_pk_bf16_f32 v32, v30, v31
    v_cvt_pk_bf16_f32 v33, v34, v35
    v_mov_b32 v34, v33
    v_mov_b32 v35, 0
    s_waitcnt vmcnt(0) lgkmcnt(0)
    s_barrier
    s_branch L_chain_end
L_var1:
    s_add_u32 s17, s14, 0
    s_and_b32 s17, s17, 3
    s_lshl_b32 s18, s17, 13
    s_add_u32 s28, s46, s18
    s_addc_u32 s29, s47, 0
    s_lshl_b32 s17, s17, 15
    s_add_u32 s18, s17, 16384
    s_add_u32 s32, s48, s18
    s_addc_u32 s33, s49, 0
    global_load_dwordx4 v[46:49], v3, s[28:29] sc1
    global_load_dword v71, v6, s[28:29] sc1
    v_mov_b64 v[14:15], 0
    v_mov_b64 v[16:17], 0
    v_mov_b64 v[18:19], 0
    v_mov_b64 v[20:21], 0
    v_mov_b64 v[22:23], 0
    v_mov_b64 v[24:25], 0
    v_mov_b64 v[26:27], 0
    v_mov_b64 v[28:29], 0
    v_mov_b64 v[30:31], 0
    v_mov_b64 v[32:33], 0
    v_mov_b64 v[34:35], 0
    v_mov_b64 v[36:37], 0
    ds_read_b128 v[50:53], v3 offset:32768
    ds_read_b128 v[54:57], v3 offset:36864
    ds_read_b128 v[58:61], v3 offset:40960
    ds_read_b128 v[62:65], v3 offset:45056
L_step_f0i:
    s_waitcnt vmcnt(0)
L_own2_f0i:
    v_max3_u32 v0, v46, v47, v48
    v_max3_u32 v0, v0, v49, v71
    v_cmp_eq_u32 vcc, -1, v0
    ds_write_b128 v3, v[46:49] offset:0
    ds_write_b32 v6, v71 offset:0
    s_cbranch_vccnz L_own_f0i
    global_load_dwordx4 v[66:69], v3, s[32:33] sc1
    global_load_dword v70, v6, s[32:33] sc1
    s_waitcnt lgkmcnt(0)
    s_barrier
    ds_read_b128 v[38:41], v2 offset:0
    ds_read_b128 v[42:45], v2 offset:1024
    ds_read_b128 v[46:49], v2 offset:2048
    s_waitcnt lgkmcnt(2)
    v_smfmac_f32_16x16x64_bf16 v[14:17], v[38:41], a[0:7], v1
    s_lshr_b32 s17, s14, 2
    s_xor_b32 s17, s17, s5
    v_smfmac_f32_16x16x64_bf16 v[18:21], v[38:41], a[8:15], v1
    s_and_b32 s17, s17, 1
    s_lshl_b32 s17, s17, 13
    v_smfmac_f32_16x16x64_bf16 v[22:25], v[38:41], a[160:167], v1
    s_lshl_b32 s18, s14, 19
    s_add_u32 s17, s17, s18
    v_smfmac_f32_16x16x64_bf16 v[26:29], v[38:41], a[168:175], v1
    s_add_u32 s40, s100, s17
    s_addc_u32 s41, s101, 0
    s_add_u32 s17, s14, 1
    v_smfmac_f32_16x16x64_bf16 v[30:33], v[38:41], v[50:57], v1
    ds_read_b128 v[50:53], v3 offset:49152
    s_lshr_b32 s18, s17, 1
    v_smfmac_f32_16x16x64_bf16 v[34:37], v[38:41], v[58:65], v1
    ds_read_b128 v[54:57], v3 offset:53248
    s_xor_b32 s18, s18, s5
    s_waitcnt lgkmcnt(3)
    v_smfmac_f32_16x16x64_bf16 v[14:17], v[42:45], a[16:23], v1
    ds_read_b128 v[58:61], v3 offset:57344
    s_and_b32 s18, s18, 1
    v_smfmac_f32_16x16x64_bf16 v[18:21], v[42:45], a[24:31], v1
    ds_read_b128 v[62:65], v3 offset:61440
    s_lshl_b32 s18, s18, 13
    v_smfmac_f32_16x16x64_bf16 v[22:25], v[42:45], a[176:183], v1
    ds_read_b128 v[38:41], v2 offset:3072
    s_lshl_b32 s17, s17, 20
    v_smfmac_f32_16x16x64_bf16 v[26:29], v[42:45], a[184:191], v1
    s_add_u32 s17, s17, s18
    s_add_u32 s38, s50, s17
    s_addc_u32 s39, s51, 0
    s_waitcnt lgkmcnt(3)
    v_smfmac_f32_16x16x64_bf16 v[30:33], v[42:45], v[50:57], v1
    ds_read_b128 v[50:53], v4 offset:0
    s_add_u32 s22, s38, 0x4000
    s_addc_u32 s23, s39, 0
    s_waitcnt lgkmcnt(2)
    v_smfmac_f32_16x16x64_bf16 v[34:37], v[42:45], v[58:65], v1
    ds_read_b128 v[54:57], v4 offset:4096
    s_and_b32 s17, s14, 1
    v_smfmac_f32_16x16x64_bf16 v[14:17], v[46:49], a[32:39], v1
    ds_read_b128 v[58:61], v4 offset:8192
    s_mul_i32 s17, s17, 163840
    v_smfmac_f32_16x16x64_bf16 v[18:21], v[46:49], a[40:47], v1
    ds_read_b128 v[62:65], v4 offset:12288
    s_add_u32 s24, s52, s17
    s_addc_u32 s25, s53, 0
    v_smfmac_f32_16x16x64_bf16 v[22:25], v[46:49], a[192:199], v1
    ds_read_b128 v[42:45], v2 offset:4096
    s_add_u32 s26, s24, 16384
    s_addc_u32 s27, s25, 0
    v_smfmac_f32_16x16x64_bf16 v[26:29], v[46:49], a[200:207], v1
    s_bfe_u32 s15, s14, 0x10001
    s_waitcnt lgkmcnt(3)
    v_smfmac_f32_16x16x64_bf16 v[30:33], v[46:49], v[50:57], v1
    ds_read_b128 v[50:53], v4 offset:16384
    s_waitcnt lgkmcnt(2)
    v_smfmac_f32_16x16x64_bf16 v[34:37], v[46:49], v[58:65], v1
    ds_read_b128 v[54:57], v4 offset:20480
    v_smfmac_f32_16x16x64_bf16 v[14:17], v[38:41], a[48:55], v1
    ds_read_b128 v[58:61], v4 offset:24576
    v_smfmac_f32_16x16x64_bf16 v[18:21], v[38:41], a[56:63], v1
    ds_read_b128 v[62:65], v4 offset:28672
    v_smfmac_f32_16x16x64_bf16 v[22:25], v[38:41], a[208:215], v1
    v_smfmac_f32_16x16x64_bf16 v[26:29], v[38:41], a[216:223], v1
    s_waitcnt lgkmcnt(2)
    v_smfmac_f32_16x16x64_bf16 v[30:33], v[38:41], v[50:57], v1
    ds_read_b128 v[50:53], v4 offset:32768
    s_waitcnt lgkmcnt(1)
    v_smfmac_f32_16x16x64_bf16 v[34:37], v[38:41], v[58:65], v1
    ds_read_b128 v[54:57], v4 offset:36864
    s_waitcnt vmcnt(0)
L_oth2_f0i:
    v_max3_u32 v0, v66, v67, v68
    v_max3_u32 v0, v0, v69, v70
    v_cmp_eq_u32 vcc, -1, v0
    ds_write_b128 v3, v[66:69] offset:5120
    ds_write_b32 v6, v70 offset:5120
    s_cbranch_vccnz L_oth_f0i
    v_smfmac_f32_16x16x64_bf16 v[14:17], v[42:45], a[64:71], v1
    ds_read_b128 v[58:61], v4 offset:40960
    v_smfmac_f32_16x16x64_bf16 v[18:21], v[42:45], a[72:79], v1
    ds_read_b128 v[62:65], v4 offset:45056
    v_smfmac_f32_16x16x64_bf16 v[22:25], v[42:45], a[224:231], v1
    v_smfmac_f32_16x16x64_bf16 v[26:29], v[42:45], a[232:239], v1
    s_waitcnt lgkmcnt(4)
    v_smfmac_f32_16x16x64_bf16 v[30:33], v[42:45], v[50:57], v1
    s_waitcnt lgkmcnt(0)
    v_smfmac_f32_16x16x64_bf16 v[34:37], v[42:45], v[58:65], v1
    s_barrier
    ds_read_b128 v[46:49], v2 offset:5120
    ds_read_b128 v[38:41], v2 offset:6144
    ds_read_b128 v[42:45], v2 offset:7168
    s_waitcnt lgkmcnt(2)
    v_smfmac_f32_16x16x64_bf16 v[14:17], v[46:49], a[80:87], v1
    s_xor_b32 s17, s20, 149504
    v_smfmac_f32_16x16x64_bf16 v[18:21], v[46:49], a[88:95], v1
    s_add_u32 m0, s17, s21
    v_smfmac_f32_16x16x64_bf16 v[22:25], v[46:49], a[240:247], v1
    global_load_lds_dwordx4 v3, s[38:39]
    v_smfmac_f32_16x16x64_bf16 v[26:29], v[46:49], a[248:255], v1
    ds_read_b128 v[46:49], v2 offset:8192
    s_waitcnt lgkmcnt(2)
    v_smfmac_f32_16x16x64_bf16 v[14:17], v[38:41], a[96:103], v1
    s_add_u32 m0, m0, 0x1000
    v_smfmac_f32_16x16x64_bf16 v[18:21], v[38:41], a[104:111], v1
    s_add_u32 s38, s38, 0x1000
    s_addc_u32 s39, s39, 0
    v_smfmac_f32_16x16x64_bf16 v[22:25], v[38:41], v[72:79], v1
    global_load_lds_dwordx4 v3, s[38:39]
    v_smfmac_f32_16x16x64_bf16 v[26:29], v[38:41], v[80:87], v1
    ds_read_b128 v[38:41], v2 offset:9216
    s_waitcnt lgkmcnt(2)
    v_smfmac_f32_16x16x64_bf16 v[14:17], v[42:45], a[112:119], v1
    ds_read_b128 v[58:61], v5 offset:16384
    v_smfmac_f32_16x16x64_bf16 v[18:21], v[42:45], a[120:127], v1
    ds_read_b128 v[62:65], v5 offset:20480
    v_smfmac_f32_16x16x64_bf16 v[22:25], v[42:45], v[88:95], v1
    ds_read_b128 v[50:53], v5 offset:8192
    v_smfmac_f32_16x16x64_bf16 v[26:29], v[42:45], v[96:103], v1
    ds_read_b128 v[54:57], v5 offset:12288
    s_waitcnt lgkmcnt(5)
    v_smfmac_f32_16x16x64_bf16 v[14:17], v[46:49], a[128:135], v1
    v_add_u32 v0, s20, v2
    v_smfmac_f32_16x16x64_bf16 v[18:21], v[46:49], a[136:143], v1
    s_xor_b32 s20, s20, 149504
    v_smfmac_f32_16x16x64_bf16 v[22:25], v[46:49], v[104:111], v1
    v_smfmac_f32_16x16x64_bf16 v[26:29], v[46:49], v[112:119], v1
    s_waitcnt lgkmcnt(4)
    v_smfmac_f32_16x16x64_bf16 v[14:17], v[38:41], a[144:151], v1
    v_smfmac_f32_16x16x64_bf16 v[18:21], v[38:41], a[152:159], v1
    v_smfmac_f32_16x16x64_bf16 v[22:25], v[38:41], v[120:127], v1
    v_smfmac_f32_16x16x64_bf16 v[26:29], v[38:41], v[128:135], v1
    v_smfmac_f32_16x16x64_bf16 v[34:37], v[38:41], v[248:255], v1
    s_waitcnt lgkmcnt(2)
    v_smfmac_f32_16x16x64_bf16 v[30:33], v[38:41], v[58:65], v1
    ds_read_b128 v[58:61], v5 offset:0
    ds_read_b128 v[62:65], v5 offset:4096
    v_pk_add_f32 v[14:15], v[14:15], v[16:17]
    v_pk_add_f32 v[18:19], v[18:19], v[20:21]
    v_pk_mul_f32 v[14:15], v[14:15], s[44:45]
    v_pk_mul_f32 v[18:19], v[18:19], s[44:45]
    v_cvt_pk_bf16_f32 v16, v14, v18
    v_cvt_pk_bf16_f32 v17, v15, v19
    ds_write2_b32 v11, v16, v17 offset0:0 offset1:72
    v_pk_add_f32 v[22:23], v[22:23], v[24:25]
    v_pk_add_f32 v[26:27], v[26:27], v[28:29]
    v_cvt_pk_bf16_f32 v28, v22, v26
    v_cvt_pk_bf16_f32 v29, v23, v27
    v_add_u32 v71, 2304, v11
    ds_write2_b32 v71, v28, v29 offset0:0 offset1:72
    v_smfmac_f32_16x16x64_bf16 v[34:37], v[46:49], v[240:247], v1
    ds_read_b128 v[38:41], v2 offset:5120
    s_waitcnt lgkmcnt(5)
    v_smfmac_f32_16x16x64_bf16 v[30:33], v[46:49], v[50:57], v1
    ds_read_b128 v[50:53], v4 offset:57344
    ds_read_b128 v[54:57], v4 offset:61440
    v_smfmac_f32_16x16x64_bf16 v[34:37], v[42:45], v[232:239], v1
    ds_read_b128 v[46:49], v2 offset:6144
    s_waitcnt lgkmcnt(6)
    v_smfmac_f32_16x16x64_bf16 v[30:33], v[42:45], v[58:65], v1
    ds_read_b128 v[58:61], v4 offset:49152
    ds_read_b128 v[62:65], v4 offset:53248
    s_waitcnt lgkmcnt(6)
    s_barrier
    ds_read_b128 v[66:69], v0 offset:3072
    ds_read_b128 v[42:45], v0 offset:1024
    global_store_dword v11, v28, s[40:41] sc1
    global_store_dword v11, v29, s[40:41] offset:288 sc1
    s_waitcnt lgkmcnt(4)
    v_smfmac_f32_16x16x64_bf16 v[34:37], v[46:49], v[224:231], v1
    v_smfmac_f32_16x16x64_bf16 v[30:33], v[46:49], v[50:57], v1
    ds_read_b128 v[50:53], v12 offset:0
    ds_read_b128 v[54:57], v12 offset:64
    ds_read_b128 v[46:49], v0 offset:2048
    v_smfmac_f32_16x16x64_bf16 v[34:37], v[38:41], v[216:223], v1
    s_waitcnt lgkmcnt(5)
    v_smfmac_f32_16x16x64_bf16 v[30:33], v[38:41], v[58:65], v1
    ds_read_b128 v[58:61], v12 offset:128
    ds_read_b128 v[62:65], v12 offset:192
    ds_read_b128 v[38:41], v0 offset:0
    s_cmp_eq_u32 s14, 63
    s_cbranch_scc1 L_last_f0i
    s_waitcnt lgkmcnt(4)
    v_mfma_f32_16x16x32_bf16 v[14:17], v[42:45], v[54:57], 0
    ds_read_b128 v[42:45], v0 offset:5120
    s_waitcnt lgkmcnt(3)
    v_mfma_f32_16x16x32_bf16 v[14:17], v[46:49], v[58:61], v[14:17]
    ds_read_b128 v[46:49], v0 offset:6144
    v_pk_add_f32 v[30:31], v[30:31], v[32:33]
    v_pk_add_f32 v[34:35], v[34:35], v[36:37]
    s_waitcnt lgkmcnt(3)
    v_mfma_f32_16x16x32_bf16 v[14:17], v[66:69], v[62:65], v[14:17]
    ds_read_b128 v[66:69], v0 offset:7168
    v_cvt_pk_bf16_f32 v32, v30, v31
    v_cvt_pk_bf16_f32 v33, v34, v35
    s_waitcnt lgkmcnt(3)
    v_mfma_f32_16x16x32_bf16 v[14:17], v[38:41], v[50:53], v[14:17]
    ds_read_b128 v[38:41], v0 offset:4096
    v_mov_b32 v34, v33
    v_mov_b32 v35, 0
    s_waitcnt lgkmcnt(3)
    v_mfma_f32_16x16x32_bf16 v[18:21], v[42:45], v[54:57], 0
    ds_read_b128 v[42:45], v12 offset:2368
    s_waitcnt lgkmcnt(3)
    v_mfma_f32_16x16x32_bf16 v[18:21], v[46:49], v[58:61], v[18:21]
    ds_read_b128 v[46:49], v12 offset:2432
    s_waitcnt lgkmcnt(3)
    v_mfma_f32_16x16x32_bf16 v[18:21], v[66:69], v[62:65], v[18:21]
    ds_read_b128 v[66:69], v12 offset:2496
    s_waitcnt lgkmcnt(3)
    v_mfma_f32_16x16x32_bf16 v[18:21], v[38:41], v[50:53], v[18:21]
    ds_read_b128 v[38:41], v12 offset:2304
    v_exp_f32 v36, v14
    v_exp_f32 v37, v15
    v_exp_f32 v71, v16
    v_cvt_pk_bf16_f32 v26, v36, v37
    v_exp_f32 v36, v17
    s_nop 0
    v_cvt_pk_bf16_f32 v27, v71, v36
    s_waitcnt lgkmcnt(3)
    v_mfma_f32_16x16x32_bf16 v[22:25], v[42:45], v[54:57], 0
    ds_read_b128 v[42:45], v3 offset:18432
    s_waitcnt lgkmcnt(3)
    v_mfma_f32_16x16x32_bf16 v[22:25], v[46:49], v[58:61], v[22:25]
    ds_read_b128 v[46:49], v3 offset:22528
    v_exp_f32 v36, v18
    v_exp_f32 v37, v19
    s_waitcnt lgkmcnt(3)
    v_mfma_f32_16x16x32_bf16 v[22:25], v[66:69], v[62:65], v[22:25]
    v_exp_f32 v71, v20
    v_cvt_pk_bf16_f32 v28, v36, v37
    s_waitcnt lgkmcnt(2)
    v_mfma_f32_16x16x32_bf16 v[22:25], v[38:41], v[50:53], v[22:25]
    v_exp_f32 v36, v21
    s_nop 0
    v_cvt_pk_bf16_f32 v29, v71, v36
    v_mov_b64 v[66:67], s[62:63]
    v_mov_b64 v[68:69], s[62:63]
    s_waitcnt lgkmcnt(1)
    v_mfma_f32_16x16x32_bf16 v[54:57], v[42:45], v[26:29], 0
    s_nop 0
    v_exp_f32 v36, v22
    s_waitcnt lgkmcnt(0)
    v_mfma_f32_16x16x32_bf16 v[58:61], v[46:49], v[26:29], 0
    v_exp_f32 v37, v23
    v_mfma_f32_16x16x32_bf16 v[50:53], v[66:69], v[26:29], 0
    v_mov_b32 v31, 0
    v_cvt_pk_bf16_f32 v30, v36, v37
    s_add_u32 m0, s21, 18432
    s_nop 2
    v_mfma_f32_16x16x16_bf16 v[50:53], v[66:67], v[30:31], v[50:53]
    v_mfma_f32_16x16x16_bf16 v[54:57], v[32:33], v[30:31], v[54:57]
    v_mfma_f32_16x16x16_bf16 v[58:61], v[34:35], v[30:31], v[58:61]
    global_load_lds_dwordx4 v3, s[22:23]
    s_add_u32 m0, m0, 0x1000
    s_add_u32 s22, s22, 0x1000
    s_addc_u32 s23, s23, 0
    global_load_lds_dwordx4 v3, s[22:23]
    s_nop 0
    v_rcp_f32 v36, v50
    v_subrev_u32 v0, s54, v50
    v_cmp_lt_u32 vcc, s55, v0
    v_pk_mul_f32 v[54:55], v[54:55], v[36:37] op_sel_hi:[1,0]
    v_pk_mul_f32 v[58:59], v[58:59], v[36:37] op_sel_hi:[1,0]
    v_pk_mul_f32 v[56:57], v[56:57], v[36:37] op_sel_hi:[1,0]
    v_pk_mul_f32 v[60:61], v[60:61], v[36:37] op_sel_hi:[1,0]
    v_cvt_pk_bf16_f32 v62, v54, v58
    v_cvt_pk_bf16_f32 v63, v55, v59
    v_cvt_pk_bf16_f32 v64, v56, v60
    v_cvt_pk_bf16_f32 v65, v57, v61
    s_cbranch_vccnz L_fb_f0i
L_norm_f0i:
    s_mov_b64 exec, s[70:71]
    ds_write_b128 v13, v[62:65] offset:5120
    s_mov_b64 exec, -1
    v_mov_b64 v[14:15], 0
    v_mov_b64 v[16:17], 0
    v_mov_b64 v[18:19], 0
    v_mov_b64 v[20:21], 0
    v_mov_b64 v[22:23], 0
    v_mov_b64 v[24:25], 0
    v_mov_b64 v[26:27], 0
    v_mov_b64 v[28:29], 0
    v_mov_b64 v[30:31], 0
    v_mov_b64 v[32:33], 0
    s_waitcnt lgkmcnt(0)
    s_barrier
    ds_read_b128 v[38:41], v2 offset:5120
    ds_read_b128 v[42:45], v2 offset:6144
    s_add_u32 s14, s14, 1
    s_add_u32 s17, s14, 0
    s_and_b32 s17, s17, 3
    s_lshl_b32 s18, s17, 13
    s_add_u32 s28, s46, s18
    s_addc_u32 s29, s47, 0
    s_lshl_b32 s17, s17, 15
    s_add_u32 s18, s17, 16384
    s_add_u32 s32, s48, s18
    s_addc_u32 s33, s49, 0
    s_waitcnt lgkmcnt(1)
    v_smfmac_f32_16x16x64_bf16 v[14:17], v[38:41], v[136:143], v1
    s_waitcnt lgkmcnt(0)
    v_smfmac_f32_16x16x64_bf16 v[14:17], v[42:45], v[144:151], v1
    v_smfmac_f32_16x16x64_bf16 v[18:21], v[38:41], v[152:159], v1
    v_smfmac_f32_16x16x64_bf16 v[18:21], v[42:45], v[160:167], v1
    v_smfmac_f32_16x16x64_bf16 v[22:25], v[38:41], v[168:175], v1
    v_smfmac_f32_16x16x64_bf16 v[22:25], v[42:45], v[176:183], v1
    v_smfmac_f32_16x16x64_bf16 v[26:29], v[38:41], v[184:191], v1
    v_smfmac_f32_16x16x64_bf16 v[26:29], v[42:45], v[192:199], v1
    s_nop 1
    v_pk_add_f32 v[14:15], v[14:15], v[16:17]
    s_nop 0
    v_pk_add_f32 v[18:19], v[18:19], v[20:21]
    v_smfmac_f32_16x16x64_bf16 v[30:33], v[38:41], v[200:207], v1
    v_cvt_pk_bf16_f32 v16, v14, v18
    v_cvt_pk_bf16_f32 v17, v15, v19
    v_smfmac_f32_16x16x64_bf16 v[30:33], v[42:45], v[208:215], v1
    v_and_or_b32 v16, v16, -2, s15
    v_and_or_b32 v17, v17, -2, s15
    global_store_dwordx2 v7, v[16:17], s[24:25]
    v_pk_add_f32 v[22:23], v[22:23], v[24:25]
    v_pk_add_f32 v[26:27], v[26:27], v[28:29]
    v_cvt_pk_bf16_f32 v24, v22, v26
    v_cvt_pk_bf16_f32 v25, v23, v27
    v_and_or_b32 v24, v24, -2, s15
    v_and_or_b32 v25, v25, -2, s15
    global_store_dwordx2 v7, v[24:25], s[26:27]
    v_pk_add_f32 v[30:31], v[30:31], v[32:33]
    v_cvt_pk_bf16_f32 v32, v30, v31
    v_and_or_b32 v32, v32, -2, s15
    global_store_dword v8, v32, s[24:25]
    s_waitcnt lgkmcnt(0)
    s_barrier
    global_load_dwordx4 v[46:49], v3, s[28:29] sc1
    global_load_dword v71, v6, s[28:29] sc1
    v_mov_b64 v[14:15], 0
    v_mov_b64 v[16:17], 0
    v_mov_b64 v[18:19], 0
    v_mov_b64 v[20:21], 0
    v_mov_b64 v[22:23], 0
    v_mov_b64 v[24:25], 0
    v_mov_b64 v[26:27], 0
    v_mov_b64 v[28:29], 0
    v_mov_b64 v[30:31], 0
    v_mov_b64 v[32:33], 0
    v_mov_b64 v[34:35], 0
    v_mov_b64 v[36:37], 0
    ds_read_b128 v[50:53], v3 offset:32768
    ds_read_b128 v[54:57], v3 offset:36864
    ds_read_b128 v[58:61], v3 offset:40960
    ds_read_b128 v[62:65], v3 offset:45056
    s_branch L_step_f0i
L_own_f0i:
    s_add_u32 s16, s16, 1
    s_cmp_gt_u32 s16, 1048576
    s_cbranch_scc1 L_bail5
    s_waitcnt lgkmcnt(0)
    global_load_dwordx4 v[46:49], v3, s[28:29] sc1
    global_load_dword v71, v6, s[28:29] sc1
    s_waitcnt vmcnt(0)
    s_branch L_own2_f0i
L_oth_f0i:
    s_add_u32 s16, s16, 1
    s_cmp_gt_u32 s16, 1048576
    s_cbranch_scc1 L_bail6
    s_waitcnt lgkmcnt(0)
    global_load_dwordx4 v[66:69], v3, s[32:33] sc1
    global_load_dword v70, v6, s[32:33] sc1
    s_waitcnt vmcnt(0)
    s_branch L_oth2_f0i
L_fb_f0i:
    v_max3_f32 v0, v14, v15, v16
    v_max3_f32 v0, v0, v17, v18
    v_max3_f32 v0, v0, v19, v20
    v_max3_f32 v0, v0, v21, v22
    v_max3_f32 v0, v0, v23, v24
    v_max_f32 v0, v0, v25
    v_mov_b32 v36, v0
    s_nop 1
    v_permlane16_swap_b32 v0, v36
    v_max_f32 v0, v0, v36
    v_mov_b32 v36, v0
    s_nop 1
    v_permlane32_swap_b32 v0, v36
    v_max_f32 v0, v0, v36
    v_sub_f32 v14, v14, v0
    v_sub_f32 v15, v15, v0
    v_sub_f32 v16, v16, v0
    v_sub_f32 v17, v17, v0
    v_sub_f32 v18, v18, v0
    v_sub_f32 v19, v19, v0
    v_sub_f32 v20, v20, v0
    v_sub_f32 v21, v21, v0
    v_sub_f32 v22, v22, v0
    v_sub_f32 v23, v23, v0
    v_sub_f32 v24, v24, v0
    v_sub_f32 v25, v25, v0
    v_exp_f32 v36, v14
    v_exp_f32 v37, v15
    v_exp_f32 v71, v16
    v_cvt_pk_bf16_f32 v26, v36, v37
    v_exp_f32 v36, v17
    s_nop 0
    v_cvt_pk_bf16_f32 v27, v71, v36
    v_exp_f32 v36, v18
    v_exp_f32 v37, v19
    v_exp_f32 v71, v20
    v_cvt_pk_bf16_f32 v28, v36, v37
    v_exp_f32 v36, v21
    s_nop 0
    v_cvt_pk_bf16_f32 v29, v71, v36
    v_exp_f32 v36, v22
    v_exp_f32 v37, v23
    v_mov_b32 v31, 0
    v_cvt_pk_bf16_f32 v30, v36, v37
    v_mfma_f32_16x16x32_bf16 v[50:53], v[66:69], v[26:29], 0
    v_mfma_f32_16x16x32_bf16 v[54:57], v[42:45], v[26:29], 0
    v_mfma_f32_16x16x32_bf16 v[58:61], v[46:49], v[26:29], 0
    s_nop 3
    v_mfma_f32_16x16x16_bf16 v[50:53], v[66:67], v[30:31], v[50:53]
    v_mfma_f32_16x16x16_bf16 v[54:57], v[32:33], v[30:31], v[54:57]
    v_mfma_f32_16x16x16_bf16 v[58:61], v[34:35], v[30:31], v[58:61]
    s_nop 5
    v_rcp_f32 v36, v50
    s_nop 0
    v_pk_mul_f32 v[54:55], v[54:55], v[36:37] op_sel_hi:[1,0]
    v_pk_mul_f32 v[58:59], v[58:59], v[36:37] op_sel_hi:[1,0]
    v_pk_mul_f32 v[56:57], v[56:57], v[36:37] op_sel_hi:[1,0]
    v_pk_mul_f32 v[60:61], v[60:61], v[36:37] op_sel_hi:[1,0]
    v_cvt_pk_bf16_f32 v62, v54, v58
    v_cvt_pk_bf16_f32 v63, v55, v59
    v_cvt_pk_bf16_f32 v64, v56, v60
    v_cvt_pk_bf16_f32 v65, v57, v61
    s_branch L_norm_f0i
L_last_f0i:
    s_nop 2
    v_pk_add_f32 v[30:31], v[30:31], v[32:33]
    v_pk_add_f32 v[34:35], v[34:35], v[36:37]
    v_cvt_pk_bf16_f32 v32, v30, v31
    v_cvt_pk_bf16_f32 v33, v34, v35
    v_mov_b32 v34, v33
    v_mov_b32 v35, 0
    s_waitcnt vmcnt(0) lgkmcnt(0)
    s_barrier
    s_branch L_chain_end
L_var2:
    s_add_u32 s17, s14, 0
    s_and_b32 s17, s17, 3
    s_lshl_b32 s18, s17, 13
    s_add_u32 s28, s46, s18
    s_addc_u32 s29, s47, 0
    s_lshl_b32 s17, s17, 15
    s_add_u32 s18, s17, 16384
    s_add_u32 s32, s48, s18
    s_addc_u32 s33, s49, 0
    global_load_dwordx4 v[46:49], v3, s[28:29] sc1
    global_load_dword v71, v6, s[28:29] sc1
    v_mov_b64 v[14:15], 0
    v_mov_b64 v[16:17], 0
    v_mov_b64 v[18:19], 0
    v_mov_b64 v[20:21], 0
    v_mov_b64 v[22:23], 0
    v_mov_b64 v[24:25], 0
    v_mov_b64 v[26:27], 0
    v_mov_b64 v[28:29], 0
    v_mov_b64 v[30:31], 0
    v_mov_b64 v[32:33], 0
    v_mov_b64 v[34:35], 0
    v_mov_b64 v[36:37], 0
    ds_read_b128 v[50:53], v3 offset:32768
    ds_read_b128 v[54:57], v3 offset:36864
    ds_read_b128 v[58:61], v3 offset:40960
    ds_read_b128 v[62:65], v3 offset:45056
L_step_f0g:
    s_waitcnt vmcnt(0)
L_own2_f0g:
    v_max3_u32 v0, v46, v47, v48
    v_max3_u32 v0, v0, v49, v71
    v_cmp_eq_u32 vcc, -1, v0
    ds_write_b128 v3, v[46:49] offset:0
    ds_write_b32 v6, v71 offset:0
    s_cbranch_vccnz L_own_f0g
    global_load_dwordx4 v[66:69], v3, s[32:33] sc1
    global_load_dword v70, v6, s[32:33] sc1
    s_waitcnt lgkmcnt(0)
    s_barrier
    ds_read_b128 v[38:41], v2 offset:0
    ds_read_b128 v[42:45], v2 offset:1024
    ds_read_b128 v[46:49], v2 offset:2048
    s_waitcnt lgkmcnt(2)
    v_smfmac_f32_16x16x64_bf16 v[14:17], v[38:41], a[0:7], v1
    s_lshr_b32 s17, s14, 2
    s_xor_b32 s17, s17, s5
    v_smfmac_f32_16x16x64_bf16 v[18:21], v[38:41], a[8:15], v1
    s_and_b32 s17, s17, 1
    s_lshl_b32 s17, s17, 13
    v_smfmac_f32_16x16x64_bf16 v[22:25], v[38:41], a[160:167], v1
    s_lshl_b32 s18, s14, 19
    s_add_u32 s17, s17, s18
    v_smfmac_f32_16x16x64_bf16 v[26:29], v[38:41], a[168:175], v1
    s_add_u32 s40, s100, s17
    s_addc_u32 s41, s101, 0
    s_add_u32 s17, s14, 1
    v_smfmac_f32_16x16x64_bf16 v[30:33], v[38:41], v[50:57], v1
    ds_read_b128 v[50:53], v3 offset:49152
    s_lshr_b32 s18, s17, 1
    v_smfmac_f32_16x16x64_bf16 v[34:37], v[38:41], v[58:65], v1
    ds_read_b128 v[54:57], v3 offset:53248
    s_xor_b32 s18, s18, s5
    s_waitcnt lgkmcnt(3)
    v_smfmac_f32_16x16x64_bf16 v[14:17], v[42:45], a[16:23], v1
    ds_read_b128 v[58:61], v3 offset:57344
    s_and_b32 s18, s18, 1
    v_smfmac_f32_16x16x64_bf16 v[18:21], v[42:45], a[24:31], v1
    ds_read_b128 v[62:65], v3 offset:61440
    s_lshl_b32 s18, s18, 13
    v_smfmac_f32_16x16x64_bf16 v[22:25], v[42:45], a[176:183], v1
    ds_read_b128 v[38:41], v2 offset:3072
    s_lshl_b32 s17, s17, 20
    v_smfmac_f32_16x16x64_bf16 v[26:29], v[42:45], a[184:191], v1
    s_add_u32 s17, s17, s18
    s_add_u32 s38, s50, s17
    s_addc_u32 s39, s51, 0
    s_waitcnt lgkmcnt(3)
    v_smfmac_f32_16x16x64_bf16 v[30:33], v[42:45], v[50:57], v1
    ds_read_b128 v[50:53], v4 offset:0
    s_add_u32 s22, s38, 0x4000
    s_addc_u32 s23, s39, 0
    s_waitcnt lgkmcnt(2)
    v_smfmac_f32_16x16x64_bf16 v[34:37], v[42:45], v[58:65], v1
    ds_read_b128 v[54:57], v4 offset:4096
    s_and_b32 s17, s14, 1
    v_smfmac_f32_16x16x64_bf16 v[14:17], v[46:49], a[32:39], v1
    ds_read_b128 v[58:61], v4 offset:8192
    s_mul_i32 s17, s17, 163840
    v_smfmac_f32_16x16x64_bf16 v[18:21], v[46:49], a[40:47], v1
    ds_read_b128 v[62:65], v4 offset:12288
    s_add_u32 s24, s52, s17
    s_addc_u32 s25, s53, 0
    v_smfmac_f32_16x16x64_bf16 v[22:25], v[46:49], a[192:199], v1
    ds_read_b128 v[42:45], v2 offset:4096
    s_add_u32 s26, s24, 16384
    s_addc_u32 s27, s25, 0
    v_smfmac_f32_16x16x64_bf16 v[26:29], v[46:49], a[200:207], v1
    s_bfe_u32 s15, s14, 0x10001
    s_add_u32 s60, s14, 3
    s_waitcnt lgkmcnt(3)
    v_smfmac_f32_16x16x64_bf16 v[30:33], v[46:49], v[50:57], v1
    ds_read_b128 v[50:53], v4 offset:16384
    s_min_u32 s60, s60, 64
    s_waitcnt lgkmcnt(2)
    v_smfmac_f32_16x16x64_bf16 v[34:37], v[46:49], v[58:65], v1
    ds_read_b128 v[54:57], v4 offset:20480
    v_smfmac_f32_16x16x64_bf16 v[14:17], v[38:41], a[48:55], v1
    ds_read_b128 v[58:61], v4 offset:24576
    v_smfmac_f32_16x16x64_bf16 v[18:21], v[38:41], a[56:63], v1
    ds_read_b128 v[62:65], v4 offset:28672
    v_smfmac_f32_16x16x64_bf16 v[22:25], v[38:41], a[208:215], v1
    v_smfmac_f32_16x16x64_bf16 v[26:29], v[38:41], a[216:223], v1
    s_waitcnt lgkmcnt(2)
    v_smfmac_f32_16x16x64_bf16 v[30:33], v[38:41], v[50:57], v1
    ds_read_b128 v[50:53], v4 offset:32768
    s_waitcnt lgkmcnt(1)
    v_smfmac_f32_16x16x64_bf16 v[34:37], v[38:41], v[58:65], v1
    ds_read_b128 v[54:57], v4 offset:36864
    s_waitcnt vmcnt(0)
L_oth2_f0g:
    v_max3_u32 v0, v66, v67, v68
    v_max3_u32 v0, v0, v69, v70
    v_cmp_eq_u32 vcc, -1, v0
    ds_write_b128 v3, v[66:69] offset:5120
    ds_write_b32 v6, v70 offset:5120
    s_cbranch_vccnz L_oth_f0g
    v_smfmac_f32_16x16x64_bf16 v[14:17], v[42:45], a[64:71], v1
    ds_read_b128 v[58:61], v4 offset:40960
    v_smfmac_f32_16x16x64_bf16 v[18:21], v[42:45], a[72:79], v1
    ds_read_b128 v[62:65], v4 offset:45056
    v_smfmac_f32_16x16x64_bf16 v[22:25], v[42:45], a[224:231], v1
    v_smfmac_f32_16x16x64_bf16 v[26:29], v[42:45], a[232:239], v1
    s_waitcnt lgkmcnt(4)
    v_smfmac_f32_16x16x64_bf16 v[30:33], v[42:45], v[50:57], v1
    s_waitcnt lgkmcnt(0)
    v_smfmac_f32_16x16x64_bf16 v[34:37], v[42:45], v[58:65], v1
    s_barrier
    ds_read_b128 v[46:49], v2 offset:5120
    ds_read_b128 v[38:41], v2 offset:6144
    ds_read_b128 v[42:45], v2 offset:7168
    s_mov_b64 exec, 3
    v_lshlrev_b32 v0, 8, v2
    global_load_dword v70, v0, s[56:57] sc1
    s_mov_b64 exec, 1
    v_mov_b32 v71, s14
    global_store_dword v2, v71, s[42:43] sc1
    s_mov_b64 exec, -1
    s_waitcnt lgkmcnt(2)
    v_smfmac_f32_16x16x64_bf16 v[14:17], v[46:49], a[80:87], v1
    s_xor_b32 s17, s20, 149504
    v_smfmac_f32_16x16x64_bf16 v[18:21], v[46:49], a[88:95], v1
    s_add_u32 m0, s17, s21
    v_smfmac_f32_16x16x64_bf16 v[22:25], v[46:49], a[240:247], v1
    global_load_lds_dwordx4 v3, s[38:39]
    v_smfmac_f32_16x16x64_bf16 v[26:29], v[46:49], a[248:255], v1
    ds_read_b128 v[46:49], v2 offset:8192
    s_waitcnt lgkmcnt(2)
    v_smfmac_f32_16x16x64_bf16 v[14:17], v[38:41], a[96:103], v1
    s_add_u32 m0, m0, 0x1000
    v_smfmac_f32_16x16x64_bf16 v[18:21], v[38:41], a[104:111], v1
    s_add_u32 s38, s38, 0x1000
    s_addc_u32 s39, s39, 0
    v_smfmac_f32_16x16x64_bf16 v[22:25], v[38:41], v[72:79], v1
    global_load_lds_dwordx4 v3, s[38:39]
    v_smfmac_f32_16x16x64_bf16 v[26:29], v[38:41], v[80:87], v1
    ds_read_b128 v[38:41], v2 offset:9216
    s_waitcnt lgkmcnt(2)
    v_smfmac_f32_16x16x64_bf16 v[14:17], v[42:45], a[112:119], v1
    ds_read_b128 v[58:61], v5 offset:16384
    v_smfmac_f32_16x16x64_bf16 v[18:21], v[42:45], a[120:127], v1
    ds_read_b128 v[62:65], v5 offset:20480
    v_smfmac_f32_16x16x64_bf16 v[22:25], v[42:45], v[88:95], v1
    ds_read_b128 v[50:53], v5 offset:8192
    v_smfmac_f32_16x16x64_bf16 v[26:29], v[42:45], v[96:103], v1
    ds_read_b128 v[54:57], v5 offset:12288
    s_waitcnt lgkmcnt(5)
    v_smfmac_f32_16x16x64_bf16 v[14:17], v[46:49], a[128:135], v1
    v_add_u32 v0, s20, v2
    v_smfmac_f32_16x16x64_bf16 v[18:21], v[46:49], a[136:143], v1
    s_xor_b32 s20, s20, 149504
    v_smfmac_f32_16x16x64_bf16 v[22:25], v[46:49], v[104:111], v1
    v_smfmac_f32_16x16x64_bf16 v[26:29], v[46:49], v[112:119], v1
    s_waitcnt lgkmcnt(4)
    v_smfmac_f32_16x16x64_bf16 v[14:17], v[38:41], a[144:151], v1
    v_smfmac_f32_16x16x64_bf16 v[18:21], v[38:41], a[152:159], v1
    v_smfmac_f32_16x16x64_bf16 v[22:25], v[38:41], v[120:127], v1
    v_smfmac_f32_16x16x64_bf16 v[26:29], v[38:41], v[128:135], v1
    v_smfmac_f32_16x16x64_bf16 v[34:37], v[38:41], v[248:255], v1
    s_waitcnt lgkmcnt(2)
    v_smfmac_f32_16x16x64_bf16 v[30:33], v[38:41], v[58:65], v1
    ds_read_b128 v[58:61], v5 offset:0
    ds_read_b128 v[62:65], v5 offset:4096
    v_pk_add_f32 v[14:15], v[14:15], v[16:17]
    v_pk_add_f32 v[18:19], v[18:19], v[20:21]
    v_pk_mul_f32 v[14:15], v[14:15], s[44:45]
    v_pk_mul_f32 v[18:19], v[18:19], s[44:45]
    v_cvt_pk_bf16_f32 v16, v14, v18
    v_cvt_pk_bf16_f32 v17, v15, v19
    ds_write2_b32 v11, v16, v17 offset0:0 offset1:72
    v_pk_add_f32 v[22:23], v[22:23], v[24:25]
    v_pk_add_f32 v[26:27], v[26:27], v[28:29]
    v_cvt_pk_bf16_f32 v28, v22, v26
    v_cvt_pk_bf16_f32 v29, v23, v27
    v_add_u32 v71, 2304, v11
    ds_write2_b32 v71, v28, v29 offset0:0 offset1:72
    v_smfmac_f32_16x16x64_bf16 v[34:37], v[46:49], v[240:247], v1
    ds_read_b128 v[38:41], v2 offset:5120
    s_waitcnt lgkmcnt(5)
    v_smfmac_f32_16x16x64_bf16 v[30:33], v[46:49], v[50:57], v1
    ds_read_b128 v[50:53], v4 offset:57344
    ds_read_b128 v[54:57], v4 offset:61440
    v_smfmac_f32_16x16x64_bf16 v[34:37], v[42:45], v[232:239], v1
    ds_read_b128 v[46:49], v2 offset:6144
    s_waitcnt lgkmcnt(6)
    v_smfmac_f32_16x16x64_bf16 v[30:33], v[42:45], v[58:65], v1
    ds_read_b128 v[58:61], v4 offset:49152
    ds_read_b128 v[62:65], v4 offset:53248
    s_waitcnt lgkmcnt(6)
    s_barrier
    ds_read_b128 v[66:69], v0 offset:3072
    ds_read_b128 v[42:45], v0 offset:1024
    global_store_dword v11, v28, s[40:41] sc1
    global_store_dword v11, v29, s[40:41] offset:288 sc1
    s_waitcnt lgkmcnt(4)
    v_smfmac_f32_16x16x64_bf16 v[34:37], v[46:49], v[224:231], v1
    v_smfmac_f32_16x16x64_bf16 v[30:33], v[46:49], v[50:57], v1
    ds_read_b128 v[50:53], v12 offset:0
    ds_read_b128 v[54:57], v12 offset:64
    ds_read_b128 v[46:49], v0 offset:2048
    v_smfmac_f32_16x16x64_bf16 v[34:37], v[38:41], v[216:223], v1
    s_waitcnt lgkmcnt(5)
    v_smfmac_f32_16x16x64_bf16 v[30:33], v[38:41], v[58:65], v1
    ds_read_b128 v[58:61], v12 offset:128
    ds_read_b128 v[62:65], v12 offset:192
    ds_read_b128 v[38:41], v0 offset:0
    s_cmp_eq_u32 s14, 63
    s_cbranch_scc1 L_last_f0g
    s_waitcnt lgkmcnt(4)
    v_mfma_f32_16x16x32_bf16 v[14:17], v[42:45], v[54:57], 0
    ds_read_b128 v[42:45], v0 offset:5120
    s_waitcnt lgkmcnt(3)
    v_mfma_f32_16x16x32_bf16 v[14:17], v[46:49], v[58:61], v[14:17]
    ds_read_b128 v[46:49], v0 offset:6144
    v_pk_add_f32 v[30:31], v[30:31], v[32:33]
    v_pk_add_f32 v[34:35], v[34:35], v[36:37]
    s_waitcnt lgkmcnt(3)
    v_mfma_f32_16x16x32_bf16 v[14:17], v[66:69], v[62:65], v[14:17]
    ds_read_b128 v[66:69], v0 offset:7168
    v_cvt_pk_bf16_f32 v32, v30, v31
    v_cvt_pk_bf16_f32 v33, v34, v35
    s_waitcnt lgkmcnt(3)
    v_mfma_f32_16x16x32_bf16 v[14:17], v[38:41], v[50:53], v[14:17]
    ds_read_b128 v[38:41], v0 offset:4096
    v_mov_b32 v34, v33
    v_mov_b32 v35, 0
    s_waitcnt lgkmcnt(3)
    v_mfma_f32_16x16x32_bf16 v[18:21], v[42:45], v[54:57], 0
    ds_read_b128 v[42:45], v12 offset:2368
    s_waitcnt lgkmcnt(3)
    v_mfma_f32_16x16x32_bf16 v[18:21], v[46:49], v[58:61], v[18:21]
    ds_read_b128 v[46:49], v12 offset:2432
    s_waitcnt lgkmcnt(3)
    v_mfma_f32_16x16x32_bf16 v[18:21], v[66:69], v[62:65], v[18:21]
    ds_read_b128 v[66:69], v12 offset:2496
    s_waitcnt lgkmcnt(3)
    v_mfma_f32_16x16x32_bf16 v[18:21], v[38:41], v[50:53], v[18:21]
    ds_read_b128 v[38:41], v12 offset:2304
    v_exp_f32 v36, v14
    v_exp_f32 v37, v15
    v_exp_f32 v71, v16
    v_cvt_pk_bf16_f32 v26, v36, v37
    v_exp_f32 v36, v17
    s_nop 0
    v_cvt_pk_bf16_f32 v27, v71, v36
    s_waitcnt lgkmcnt(3)
    v_mfma_f32_16x16x32_bf16 v[22:25], v[42:45], v[54:57], 0
    ds_read_b128 v[42:45], v3 offset:18432
    s_waitcnt lgkmcnt(3)
    v_mfma_f32_16x16x32_bf16 v[22:25], v[46:49], v[58:61], v[22:25]
    ds_read_b128 v[46:49], v3 offset:22528
    v_exp_f32 v36, v18
    v_exp_f32 v37, v19
    s_waitcnt lgkmcnt(3)
    v_mfma_f32_16x16x32_bf16 v[22:25], v[66:69], v[62:65], v[22:25]
    v_exp_f32 v71, v20
    v_cvt_pk_bf16_f32 v28, v36, v37
    s_waitcnt lgkmcnt(2)
    v_mfma_f32_16x16x32_bf16 v[22:25], v[38:41], v[50:53], v[22:25]
    v_exp_f32 v36, v21
    s_nop 0
    v_cvt_pk_bf16_f32 v29, v71, v36
    v_mov_b64 v[66:67], s[62:63]
    v_mov_b64 v[68:69], s[62:63]
    s_waitcnt lgkmcnt(1)
    v_mfma_f32_16x16x32_bf16 v[54:57], v[42:45], v[26:29], 0
    s_nop 0
    v_exp_f32 v36, v22
    s_waitcnt lgkmcnt(0)
    v_mfma_f32_16x16x32_bf16 v[58:61], v[46:49], v[26:29], 0
    v_exp_f32 v37, v23
    v_mfma_f32_16x16x32_bf16 v[50:53], v[66:69], v[26:29], 0
    v_mov_b32 v31, 0
    v_cvt_pk_bf16_f32 v30, v36, v37
    s_add_u32 m0, s21, 18432
    s_nop 2
    v_mfma_f32_16x16x16_bf16 v[50:53], v[66:67], v[30:31], v[50:53]
    v_mfma_f32_16x16x16_bf16 v[54:57], v[32:33], v[30:31], v[54:57]
    v_mfma_f32_16x16x16_bf16 v[58:61], v[34:35], v[30:31], v[58:61]
    global_load_lds_dwordx4 v3, s[22:23]
    s_add_u32 m0, m0, 0x1000
    s_add_u32 s22, s22, 0x1000
    s_addc_u32 s23, s23, 0
    global_load_lds_dwordx4 v3, s[22:23]
    s_nop 0
    v_rcp_f32 v36, v50
    v_subrev_u32 v0, s54, v50
    v_cmp_lt_u32 vcc, s55, v0
    v_pk_mul_f32 v[54:55], v[54:55], v[36:37] op_sel_hi:[1,0]
    v_pk_mul_f32 v[58:59], v[58:59], v[36:37] op_sel_hi:[1,0]
    v_pk_mul_f32 v[56:57], v[56:57], v[36:37] op_sel_hi:[1,0]
    v_pk_mul_f32 v[60:61], v[60:61], v[36:37] op_sel_hi:[1,0]
    v_cvt_pk_bf16_f32 v62, v54, v58
    v_cvt_pk_bf16_f32 v63, v55, v59
    v_cvt_pk_bf16_f32 v64, v56, v60
    v_cvt_pk_bf16_f32 v65, v57, v61
    s_cbranch_vccnz L_fb_f0g
L_norm_f0g:
    s_mov_b64 exec, s[70:71]
    ds_write_b128 v13, v[62:65] offset:5120
    s_mov_b64 exec, -1
    v_mov_b64 v[14:15], 0
    v_mov_b64 v[16:17], 0
    v_mov_b64 v[18:19], 0
    v_mov_b64 v[20:21], 0
    v_mov_b64 v[22:23], 0
    v_mov_b64 v[24:25], 0
    v_mov_b64 v[26:27], 0
    v_mov_b64 v[28:29], 0
    v_mov_b64 v[30:31], 0
    v_mov_b64 v[32:33], 0
    s_mov_b64 exec, 3
    s_waitcnt vmcnt(7)
L_kv2_f0g:
    v_cmp_gt_u32 vcc, s60, v70
    s_nop 0
    s_cbranch_vccnz L_kv_f0g
    s_mov_b64 exec, -1
    s_waitcnt lgkmcnt(0)
    s_barrier
    ds_read_b128 v[38:41], v2 offset:5120
    ds_read_b128 v[42:45], v2 offset:6144
    s_add_u32 s14, s14, 1
    s_add_u32 s17, s14, 0
    s_and_b32 s17, s17, 3
    s_lshl_b32 s18, s17, 13
    s_add_u32 s28, s46, s18
    s_addc_u32 s29, s47, 0
    s_lshl_b32 s17, s17, 15
    s_add_u32 s18, s17, 16384
    s_add_u32 s32, s48, s18
    s_addc_u32 s33, s49, 0
    s_waitcnt lgkmcnt(1)
    v_smfmac_f32_16x16x64_bf16 v[14:17], v[38:41], v[136:143], v1
    s_waitcnt lgkmcnt(0)
    v_smfmac_f32_16x16x64_bf16 v[14:17], v[42:45], v[144:151], v1
    v_smfmac_f32_16x16x64_bf16 v[18:21], v[38:41], v[152:159], v1
    v_smfmac_f32_16x16x64_bf16 v[18:21], v[42:45], v[160:167], v1
    v_smfmac_f32_16x16x64_bf16 v[22:25], v[38:41], v[168:175], v1
    v_smfmac_f32_16x16x64_bf16 v[22:25], v[42:45], v[176:183], v1
    v_smfmac_f32_16x16x64_bf16 v[26:29], v[38:41], v[184:191], v1
    v_smfmac_f32_16x16x64_bf16 v[26:29], v[42:45], v[192:199], v1
    s_nop 1
    v_pk_add_f32 v[14:15], v[14:15], v[16:17]
    s_nop 0
    v_pk_add_f32 v[18:19], v[18:19], v[20:21]
    v_smfmac_f32_16x16x64_bf16 v[30:33], v[38:41], v[200:207], v1
    v_cvt_pk_bf16_f32 v16, v14, v18
    v_cvt_pk_bf16_f32 v17, v15, v19
    v_smfmac_f32_16x16x64_bf16 v[30:33], v[42:45], v[208:215], v1
    v_and_or_b32 v16, v16, -2, s15
    v_and_or_b32 v17, v17, -2, s15
    global_store_dwordx2 v7, v[16:17], s[24:25]
    v_pk_add_f32 v[22:23], v[22:23], v[24:25]
    v_pk_add_f32 v[26:27], v[26:27], v[28:29]
    v_cvt_pk_bf16_f32 v24, v22, v26
    v_cvt_pk_bf16_f32 v25, v23, v27
    v_and_or_b32 v24, v24, -2, s15
    v_and_or_b32 v25, v25, -2, s15
    global_store_dwordx2 v7, v[24:25], s[26:27]
    v_pk_add_f32 v[30:31], v[30:31], v[32:33]
    v_cvt_pk_bf16_f32 v32, v30, v31
    v_and_or_b32 v32, v32, -2, s15
    global_store_dword v8, v32, s[24:25]
    s_waitcnt lgkmcnt(0)
    s_barrier
    global_load_dwordx4 v[46:49], v3, s[28:29] sc1
    global_load_dword v71, v6, s[28:29] sc1
    v_mov_b64 v[14:15], 0
    v_mov_b64 v[16:17], 0
    v_mov_b64 v[18:19], 0
    v_mov_b64 v[20:21], 0
    v_mov_b64 v[22:23], 0
    v_mov_b64 v[24:25], 0
    v_mov_b64 v[26:27], 0
    v_mov_b64 v[28:29], 0
    v_mov_b64 v[30:31], 0
    v_mov_b64 v[32:33], 0
    v_mov_b64 v[34:35], 0
    v_mov_b64 v[36:37], 0
    ds_read_b128 v[50:53], v3 offset:32768
    ds_read_b128 v[54:57], v3 offset:36864
    ds_read_b128 v[58:61], v3 offset:40960
    ds_read_b128 v[62:65], v3 offset:45056
    s_branch L_step_f0g
L_own_f0g:
    s_add_u32 s16, s16, 1
    s_cmp_gt_u32 s16, 1048576
    s_cbranch_scc1 L_bail5
    s_waitcnt lgkmcnt(0)
    global_load_dwordx4 v[46:49], v3, s[28:29] sc1
    global_load_dword v71, v6, s[28:29] sc1
    s_waitcnt vmcnt(0)
    s_branch L_own2_f0g
L_oth_f0g:
    s_add_u32 s16, s16, 1
    s_cmp_gt_u32 s16, 1048576
    s_cbranch_scc1 L_bail6
    s_waitcnt lgkmcnt(0)
    global_load_dwordx4 v[66:69], v3, s[32:33] sc1
    global_load_dword v70, v6, s[32:33] sc1
    s_waitcnt vmcnt(0)
    s_branch L_oth2_f0g
L_kv_f0g:
    s_add_u32 s16, s16, 1
    s_cmp_gt_u32 s16, 1048576
    s_cbranch_scc1 L_bail7
    v_lshlrev_b32 v0, 8, v2
    global_load_dword v70, v0, s[56:57] sc1
    s_waitcnt vmcnt(0)
    s_branch L_kv2_f0g
L_fb_f0g:
    v_max3_f32 v0, v14, v15, v16
    v_max3_f32 v0, v0, v17, v18
    v_max3_f32 v0, v0, v19, v20
    v_max3_f32 v0, v0, v21, v22
    v_max3_f32 v0, v0, v23, v24
    v_max_f32 v0, v0, v25
    v_mov_b32 v36, v0
    s_nop 1
    v_permlane16_swap_b32 v0, v36
    v_max_f32 v0, v0, v36
    v_mov_b32 v36, v0
    s_nop 1
    v_permlane32_swap_b32 v0, v36
    v_max_f32 v0, v0, v36
    v_sub_f32 v14, v14, v0
    v_sub_f32 v15, v15, v0
    v_sub_f32 v16, v16, v0
    v_sub_f32 v17, v17, v0
    v_sub_f32 v18, v18, v0
    v_sub_f32 v19, v19, v0
    v_sub_f32 v20, v20, v0
    v_sub_f32 v21, v21, v0
    v_sub_f32 v22, v22, v0
    v_sub_f32 v23, v23, v0
    v_sub_f32 v24, v24, v0
    v_sub_f32 v25, v25, v0
    v_exp_f32 v36, v14
    v_exp_f32 v37, v15
    v_exp_f32 v71, v16
    v_cvt_pk_bf16_f32 v26, v36, v37
    v_exp_f32 v36, v17
    s_nop 0
    v_cvt_pk_bf16_f32 v27, v71, v36
    v_exp_f32 v36, v18
    v_exp_f32 v37, v19
    v_exp_f32 v71, v20
    v_cvt_pk_bf16_f32 v28, v36, v37
    v_exp_f32 v36, v21
    s_nop 0
    v_cvt_pk_bf16_f32 v29, v71, v36
    v_exp_f32 v36, v22
    v_exp_f32 v37, v23
    v_mov_b32 v31, 0
    v_cvt_pk_bf16_f32 v30, v36, v37
    v_mfma_f32_16x16x32_bf16 v[50:53], v[66:69], v[26:29], 0
    v_mfma_f32_16x16x32_bf16 v[54:57], v[42:45], v[26:29], 0
    v_mfma_f32_16x16x32_bf16 v[58:61], v[46:49], v[26:29], 0
    s_nop 3
    v_mfma_f32_16x16x16_bf16 v[50:53], v[66:67], v[30:31], v[50:53]
    v_mfma_f32_16x16x16_bf16 v[54:57], v[32:33], v[30:31], v[54:57]
    v_mfma_f32_16x16x16_bf16 v[58:61], v[34:35], v[30:31], v[58:61]
    s_nop 5
    v_rcp_f32 v36, v50
    s_nop 0
    v_pk_mul_f32 v[54:55], v[54:55], v[36:37] op_sel_hi:[1,0]
    v_pk_mul_f32 v[58:59], v[58:59], v[36:37] op_sel_hi:[1,0]
    v_pk_mul_f32 v[56:57], v[56:57], v[36:37] op_sel_hi:[1,0]
    v_pk_mul_f32 v[60:61], v[60:61], v[36:37] op_sel_hi:[1,0]
    v_cvt_pk_bf16_f32 v62, v54, v58
    v_cvt_pk_bf16_f32 v63, v55, v59
    v_cvt_pk_bf16_f32 v64, v56, v60
    v_cvt_pk_bf16_f32 v65, v57, v61
    s_branch L_norm_f0g
L_last_f0g:
    s_nop 2
    v_pk_add_f32 v[30:31], v[30:31], v[32:33]
    v_pk_add_f32 v[34:35], v[34:35], v[36:37]
    v_cvt_pk_bf16_f32 v32, v30, v31
    v_cvt_pk_bf16_f32 v33, v34, v35
    v_mov_b32 v34, v33
    v_mov_b32 v35, 0
    s_waitcnt vmcnt(0) lgkmcnt(0)
    s_barrier
    s_mov_b64 exec, 1
    v_mov_b32 v0, 0
    v_mov_b32 v1, 64
    global_store_dword v0, v1, s[42:43] sc1
    s_waitcnt vmcnt(0)
    s_mov_b64 exec, -1
    s_branch L_chain_end
L_var3:
    s_add_u32 s17, s14, 0
    s_and_b32 s17, s17, 3
    s_lshl_b32 s18, s17, 13
    s_add_u32 s28, s46, s18
    s_addc_u32 s29, s47, 0
    s_lshl_b32 s17, s17, 15
    s_add_u32 s18, s17, 0
    s_add_u32 s32, s48, s18
    s_addc_u32 s33, s49, 0
    global_load_dwordx4 v[46:49], v3, s[28:29] sc1
    global_load_dword v71, v6, s[28:29] sc1
    v_mov_b64 v[14:15], 0
    v_mov_b64 v[16:17], 0
    v_mov_b64 v[18:19], 0
    v_mov_b64 v[20:21], 0
    v_mov_b64 v[22:23], 0
    v_mov_b64 v[24:25], 0
    v_mov_b64 v[26:27], 0
    v_mov_b64 v[28:29], 0
    v_mov_b64 v[30:31], 0
    v_mov_b64 v[32:33], 0
    v_mov_b64 v[34:35], 0
    v_mov_b64 v[36:37], 0
    ds_read_b128 v[50:53], v3 offset:32768
    ds_read_b128 v[54:57], v3 offset:36864
    ds_read_b128 v[58:61], v3 offset:40960
    ds_read_b128 v[62:65], v3 offset:45056
L_step_f1r:
    s_waitcnt vmcnt(0)
L_own2_f1r:
    v_max3_u32 v0, v46, v47, v48
    v_max3_u32 v0, v0, v49, v71
    v_cmp_eq_u32 vcc, -1, v0
    ds_write_b128 v3, v[46:49] offset:0
    ds_write_b32 v6, v71 offset:0
    s_cbranch_vccnz L_own_f1r
    global_load_dwordx4 v[66:69], v3, s[32:33] sc1
    global_load_dword v70, v6, s[32:33] sc1
    s_waitcnt lgkmcnt(0)
    s_barrier
    ds_read_b128 v[38:41], v2 offset:0
    ds_read_b128 v[42:45], v2 offset:1024
    ds_read_b128 v[46:49], v2 offset:2048
    s_waitcnt lgkmcnt(2)
    v_smfmac_f32_16x16x64_bf16 v[14:17], v[38:41], a[0:7], v1
    s_lshr_b32 s17, s14, 2
    s_xor_b32 s17, s17, s5
    v_smfmac_f32_16x16x64_bf16 v[18:21], v[38:41], a[8:15], v1
    s_and_b32 s17, s17, 1
    s_lshl_b32 s17, s17, 13
    v_smfmac_f32_16x16x64_bf16 v[22:25], v[38:41], a[160:167], v1
    s_lshl_b32 s18, s14, 19
    s_add_u32 s17, s17, s18
    v_smfmac_f32_16x16x64_bf16 v[26:29], v[38:41], a[168:175], v1
    s_add_u32 s40, s100, s17
    s_addc_u32 s41, s101, 0
    s_add_u32 s17, s14, 1
    v_smfmac_f32_16x16x64_bf16 v[30:33], v[38:41], v[50:57], v1
    ds_read_b128 v[50:53], v3 offset:49152
    s_lshr_b32 s18, s17, 1
    v_smfmac_f32_16x16x64_bf16 v[34:37], v[38:41], v[58:65], v1
    ds_read_b128 v[54:57], v3 offset:53248
    s_xor_b32 s18, s18, s5
    s_waitcnt lgkmcnt(3)
    v_smfmac_f32_16x16x64_bf16 v[14:17], v[42:45], a[16:23], v1
    ds_read_b128 v[58:61], v3 offset:57344
    s_and_b32 s18, s18, 1
    v_smfmac_f32_16x16x64_bf16 v[18:21], v[42:45], a[24:31], v1
    ds_read_b128 v[62:65], v3 offset:61440
    s_lshl_b32 s18, s18, 13
    v_smfmac_f32_16x16x64_bf16 v[22:25], v[42:45], a[176:183], v1
    ds_read_b128 v[38:41], v2 offset:3072
    s_lshl_b32 s17, s17, 20
    v_smfmac_f32_16x16x64_bf16 v[26:29], v[42:45], a[184:191], v1
    s_add_u32 s17, s17, s18
    s_add_u32 s38, s50, s17
    s_addc_u32 s39, s51, 0
    s_waitcnt lgkmcnt(3)
    v_smfmac_f32_16x16x64_bf16 v[30:33], v[42:45], v[50:57], v1
    ds_read_b128 v[50:53], v4 offset:0
    s_add_u32 s22, s38, 0x4000
    s_addc_u32 s23, s39, 0
    s_waitcnt lgkmcnt(2)
    v_smfmac_f32_16x16x64_bf16 v[34:37], v[42:45], v[58:65], v1
    ds_read_b128 v[54:57], v4 offset:4096
    s_add_u32 s17, s14, 3
    v_smfmac_f32_16x16x64_bf16 v[14:17], v[46:49], a[32:39], v1
    ds_read_b128 v[58:61], v4 offset:8192
    s_and_b32 s17, s17, 3
    v_smfmac_f32_16x16x64_bf16 v[18:21], v[46:49], a[40:47], v1
    ds_read_b128 v[62:65], v4 offset:12288
    s_lshl_b32 s18, s17, 13
    v_smfmac_f32_16x16x64_bf16 v[22:25], v[46:49], a[192:199], v1
    ds_read_b128 v[42:45], v2 offset:4096
    s_add_u32 s34, s46, s18
    s_addc_u32 s35, s47, 0
    v_smfmac_f32_16x16x64_bf16 v[26:29], v[46:49], a[200:207], v1
    s_lshl_b32 s17, s17, 15
    s_add_u32 s18, s17, 16384
    s_waitcnt lgkmcnt(3)
    v_smfmac_f32_16x16x64_bf16 v[30:33], v[46:49], v[50:57], v1
    ds_read_b128 v[50:53], v4 offset:16384
    s_add_u32 s36, s48, s18
    s_addc_u32 s37, s49, 0
    s_waitcnt lgkmcnt(2)
    v_smfmac_f32_16x16x64_bf16 v[34:37], v[46:49], v[58:65], v1
    ds_read_b128 v[54:57], v4 offset:20480
    s_and_b32 s17, s14, 1
    v_smfmac_f32_16x16x64_bf16 v[14:17], v[38:41], a[48:55], v1
    ds_read_b128 v[58:61], v4 offset:24576
    s_mul_i32 s17, s17, 163840
    v_smfmac_f32_16x16x64_bf16 v[18:21], v[38:41], a[56:63], v1
    ds_read_b128 v[62:65], v4 offset:28672
    s_add_u32 s24, s52, s17
    s_addc_u32 s25, s53, 0
    v_smfmac_f32_16x16x64_bf16 v[22:25], v[38:41], a[208:215], v1
    s_add_u32 s26, s24, 16384
    s_addc_u32 s27, s25, 0
    s_bfe_u32 s15, s14, 0x10001
    v_smfmac_f32_16x16x64_bf16 v[26:29], v[38:41], a[216:223], v1
    s_waitcnt lgkmcnt(2)
    v_smfmac_f32_16x16x64_bf16 v[30:33], v[38:41], v[50:57], v1
    ds_read_b128 v[50:53], v4 offset:32768
    s_waitcnt lgkmcnt(1)
    v_smfmac_f32_16x16x64_bf16 v[34:37], v[38:41], v[58:65], v1
    ds_read_b128 v[54:57], v4 offset:36864
    s_waitcnt vmcnt(0)
L_oth2_f1r:
    v_max3_u32 v0, v66, v67, v68
    v_max3_u32 v0, v0, v69, v70
    v_cmp_eq_u32 vcc, -1, v0
    ds_write_b128 v3, v[66:69] offset:5120
    ds_write_b32 v6, v70 offset:5120
    s_cbranch_vccnz L_oth_f1r
    v_smfmac_f32_16x16x64_bf16 v[14:17], v[42:45], a[64:71], v1
    ds_read_b128 v[58:61], v4 offset:40960
    v_smfmac_f32_16x16x64_bf16 v[18:21], v[42:45], a[72:79], v1
    ds_read_b128 v[62:65], v4 offset:45056
    v_smfmac_f32_16x16x64_bf16 v[22:25], v[42:45], a[224:231], v1
    v_smfmac_f32_16x16x64_bf16 v[26:29], v[42:45], a[232:239], v1
    s_waitcnt lgkmcnt(4)
    v_smfmac_f32_16x16x64_bf16 v[30:33], v[42:45], v[50:57], v1
    s_waitcnt lgkmcnt(0)
    v_smfmac_f32_16x16x64_bf16 v[34:37], v[42:45], v[58:65], v1
    s_barrier
    ds_read_b128 v[46:49], v2 offset:5120
    ds_read_b128 v[38:41], v2 offset:6144
    ds_read_b128 v[42:45], v2 offset:7168
    v_mov_b32 v0, -1
    s_mov_b64 exec, s[58:59]
    global_store_dword v10, v0, s[34:35]
    global_store_dword v10, v0, s[36:37] sc1
    s_mov_b64 exec, -1
    s_waitcnt lgkmcnt(2)
    v_smfmac_f32_16x16x64_bf16 v[14:17], v[46:49], a[80:87], v1
    s_xor_b32 s17, s20, 149504
    v_smfmac_f32_16x16x64_bf16 v[18:21], v[46:49], a[88:95], v1
    s_add_u32 m0, s17, s21
    v_smfmac_f32_16x16x64_bf16 v[22:25], v[46:49], a[240:247], v1
    global_load_lds_dwordx4 v3, s[38:39]
    v_smfmac_f32_16x16x64_bf16 v[26:29], v[46:49], a[248:255], v1
    ds_read_b128 v[46:49], v2 offset:8192
    s_waitcnt lgkmcnt(2)
    v_smfmac_f32_16x16x64_bf16 v[14:17], v[38:41], a[96:103], v1
    s_add_u32 m0, m0, 0x1000
    v_smfmac_f32_16x16x64_bf16 v[18:21], v[38:41], a[104:111], v1
    s_add_u32 s38, s38, 0x1000
    s_addc_u32 s39, s39, 0
    v_smfmac_f32_16x16x64_bf16 v[22:25], v[38:41], v[72:79], v1
    global_load_lds_dwordx4 v3, s[38:39]
    v_smfmac_f32_16x16x64_bf16 v[26:29], v[38:41], v[80:87], v1
    ds_read_b128 v[38:41], v2 offset:9216
    s_waitcnt lgkmcnt(2)
    v_smfmac_f32_16x16x64_bf16 v[14:17], v[42:45], a[112:119], v1
    ds_read_b128 v[58:61], v5 offset:16384
    v_smfmac_f32_16x16x64_bf16 v[18:21], v[42:45], a[120:127], v1
    ds_read_b128 v[62:65], v5 offset:20480
    v_smfmac_f32_16x16x64_bf16 v[22:25], v[42:45], v[88:95], v1
    ds_read_b128 v[50:53], v5 offset:8192
    v_smfmac_f32_16x16x64_bf16 v[26:29], v[42:45], v[96:103], v1
    ds_read_b128 v[54:57], v5 offset:12288
    s_waitcnt lgkmcnt(5)
    v_smfmac_f32_16x16x64_bf16 v[14:17], v[46:49], a[128:135], v1
    v_add_u32 v0, s20, v2
    v_smfmac_f32_16x16x64_bf16 v[18:21], v[46:49], a[136:143], v1
    s_xor_b32 s20, s20, 149504
    v_smfmac_f32_16x16x64_bf16 v[22:25], v[46:49], v[104:111], v1
    v_smfmac_f32_16x16x64_bf16 v[26:29], v[46:49], v[112:119], v1
    s_waitcnt lgkmcnt(4)
    v_smfmac_f32_16x16x64_bf16 v[14:17], v[38:41], a[144:151], v1
    v_smfmac_f32_16x16x64_bf16 v[18:21], v[38:41], a[152:159], v1
    v_smfmac_f32_16x16x64_bf16 v[22:25], v[38:41], v[120:127], v1
    v_smfmac_f32_16x16x64_bf16 v[26:29], v[38:41], v[128:135], v1
    v_smfmac_f32_16x16x64_bf16 v[34:37], v[38:41], v[248:255], v1
    s_waitcnt lgkmcnt(2)
    v_smfmac_f32_16x16x64_bf16 v[30:33], v[38:41], v[58:65], v1
    ds_read_b128 v[58:61], v5 offset:0
    ds_read_b128 v[62:65], v5 offset:4096
    v_pk_add_f32 v[14:15], v[14:15], v[16:17]
    v_pk_add_f32 v[18:19], v[18:19], v[20:21]
    v_pk_mul_f32 v[14:15], v[14:15], s[44:45]
    v_pk_mul_f32 v[18:19], v[18:19], s[44:45]
    v_cvt_pk_bf16_f32 v16, v14, v18
    v_cvt_pk_bf16_f32 v17, v15, v19
    ds_write2_b32 v11, v16, v17 offset0:0 offset1:72
    v_pk_add_f32 v[22:23], v[22:23], v[24:25]
    v_pk_add_f32 v[26:27], v[26:27], v[28:29]
    v_cvt_pk_bf16_f32 v28, v22, v26
    v_cvt_pk_bf16_f32 v29, v23, v27
    v_add_u32 v71, 2304, v11
    ds_write2_b32 v71, v28, v29 offset0:0 offset1:72
    v_smfmac_f32_16x16x64_bf16 v[34:37], v[46:49], v[240:247], v1
    ds_read_b128 v[38:41], v2 offset:5120
    s_waitcnt lgkmcnt(5)
    v_smfmac_f32_16x16x64_bf16 v[30:33], v[46:49], v[50:57], v1
    ds_read_b128 v[50:53], v4 offset:57344
    ds_read_b128 v[54:57], v4 offset:61440
    v_smfmac_f32_16x16x64_bf16 v[34:37], v[42:45], v[232:239], v1
    ds_read_b128 v[46:49], v2 offset:6144
    s_waitcnt lgkmcnt(6)
    v_smfmac_f32_16x16x64_bf16 v[30:33], v[42:45], v[58:65], v1
    ds_read_b128 v[58:61], v4 offset:49152
    ds_read_b128 v[62:65], v4 offset:53248
    s_waitcnt lgkmcnt(6)
    s_barrier
    ds_read_b128 v[66:69], v0 offset:3072
    ds_read_b128 v[42:45], v0 offset:1024
    v_lshrrev_b32 v71, 1, v3
    s_waitcnt lgkmcnt(4)
    v_smfmac_f32_16x16x64_bf16 v[34:37], v[46:49], v[224:231], v1
    v_smfmac_f32_16x16x64_bf16 v[30:33], v[46:49], v[50:57], v1
    ds_read_b128 v[50:53], v12 offset:0
    ds_read_b128 v[54:57], v12 offset:64
    ds_read_b128 v[46:49], v0 offset:2048
    v_smfmac_f32_16x16x64_bf16 v[34:37], v[38:41], v[216:223], v1
    s_waitcnt lgkmcnt(5)
    v_smfmac_f32_16x16x64_bf16 v[30:33], v[38:41], v[58:65], v1
    ds_read_b128 v[58:61], v12 offset:128
    ds_read_b128 v[62:65], v12 offset:192
    ds_read_b128 v[38:41], v0 offset:0
    s_cmp_eq_u32 s14, 63
    s_cbranch_scc1 L_last_f1r
    s_waitcnt lgkmcnt(4)
    v_mfma_f32_16x16x32_bf16 v[14:17], v[42:45], v[54:57], 0
    ds_read_b128 v[42:45], v0 offset:5120
    s_waitcnt lgkmcnt(3)
    v_mfma_f32_16x16x32_bf16 v[14:17], v[46:49], v[58:61], v[14:17]
    ds_read_b128 v[46:49], v0 offset:6144
    v_pk_add_f32 v[30:31], v[30:31], v[32:33]
    v_pk_add_f32 v[34:35], v[34:35], v[36:37]
    s_waitcnt lgkmcnt(3)
    v_mfma_f32_16x16x32_bf16 v[14:17], v[66:69], v[62:65], v[14:17]
    ds_read_b128 v[66:69], v0 offset:7168
    v_cvt_pk_bf16_f32 v32, v30, v31
    v_cvt_pk_bf16_f32 v33, v34, v35
    s_waitcnt lgkmcnt(3)
    v_mfma_f32_16x16x32_bf16 v[14:17], v[38:41], v[50:53], v[14:17]
    ds_read_b128 v[38:41], v0 offset:4096
    global_store_dwordx2 v71, v[32:33], s[40:41] sc1
    v_mov_b32 v34, v33
    v_mov_b32 v35, 0
    s_waitcnt lgkmcnt(3)
    v_mfma_f32_16x16x32_bf16 v[18:21], v[42:45], v[54:57], 0
    ds_read_b128 v[42:45], v12 offset:2368
    s_waitcnt lgkmcnt(3)
    v_mfma_f32_16x16x32_bf16 v[18:21], v[46:49], v[58:61], v[18:21]
    ds_read_b128 v[46:49], v12 offset:2432
    s_waitcnt lgkmcnt(3)
    v_mfma_f32_16x16x32_bf16 v[18:21], v[66:69], v[62:65], v[18:21]
    ds_read_b128 v[66:69], v12 offset:2496
    s_waitcnt lgkmcnt(3)
    v_mfma_f32_16x16x32_bf16 v[18:21], v[38:41], v[50:53], v[18:21]
    ds_read_b128 v[38:41], v12 offset:2304
    v_exp_f32 v36, v14
    v_exp_f32 v37, v15
    v_exp_f32 v71, v16
    v_cvt_pk_bf16_f32 v26, v36, v37
    v_exp_f32 v36, v17
    s_nop 0
    v_cvt_pk_bf16_f32 v27, v71, v36
    s_waitcnt lgkmcnt(3)
    v_mfma_f32_16x16x32_bf16 v[22:25], v[42:45], v[54:57], 0
    ds_read_b128 v[42:45], v3 offset:18432
    s_waitcnt lgkmcnt(3)
    v_mfma_f32_16x16x32_bf16 v[22:25], v[46:49], v[58:61], v[22:25]
    ds_read_b128 v[46:49], v3 offset:22528
    v_exp_f32 v36, v18
    v_exp_f32 v37, v19
    s_waitcnt lgkmcnt(3)
    v_mfma_f32_16x16x32_bf16 v[22:25], v[66:69], v[62:65], v[22:25]
    v_exp_f32 v71, v20
    v_cvt_pk_bf16_f32 v28, v36, v37
    s_waitcnt lgkmcnt(2)
    v_mfma_f32_16x16x32_bf16 v[22:25], v[38:41], v[50:53], v[22:25]
    v_exp_f32 v36, v21
    s_nop 0
    v_cvt_pk_bf16_f32 v29, v71, v36
    v_mov_b64 v[66:67], s[62:63]
    v_mov_b64 v[68:69], s[62:63]
    s_waitcnt lgkmcnt(1)
    v_mfma_f32_16x16x32_bf16 v[54:57], v[42:45], v[26:29], 0
    s_nop 0
    v_exp_f32 v36, v22
    s_waitcnt lgkmcnt(0)
    v_mfma_f32_16x16x32_bf16 v[58:61], v[46:49], v[26:29], 0
    v_exp_f32 v37, v23
    v_mfma_f32_16x16x32_bf16 v[50:53], v[66:69], v[26:29], 0
    v_mov_b32 v31, 0
    v_cvt_pk_bf16_f32 v30, v36, v37
    s_add_u32 m0, s21, 18432
    s_nop 2
    v_mfma_f32_16x16x16_bf16 v[50:53], v[66:67], v[30:31], v[50:53]
    v_mfma_f32_16x16x16_bf16 v[54:57], v[32:33], v[30:31], v[54:57]
    v_mfma_f32_16x16x16_bf16 v[58:61], v[34:35], v[30:31], v[58:61]
    global_load_lds_dwordx4 v3, s[22:23]
    s_add_u32 m0, m0, 0x1000
    s_add_u32 s22, s22, 0x1000
    s_addc_u32 s23, s23, 0
    global_load_lds_dwordx4 v3, s[22:23]
    s_nop 0
    v_rcp_f32 v36, v50
    v_subrev_u32 v0, s54, v50
    v_cmp_lt_u32 vcc, s55, v0
    v_pk_mul_f32 v[54:55], v[54:55], v[36:37] op_sel_hi:[1,0]
    v_pk_mul_f32 v[58:59], v[58:59], v[36:37] op_sel_hi:[1,0]
    v_pk_mul_f32 v[56:57], v[56:57], v[36:37] op_sel_hi:[1,0]
    v_pk_mul_f32 v[60:61], v[60:61], v[36:37] op_sel_hi:[1,0]
    v_cvt_pk_bf16_f32 v62, v54, v58
    v_cvt_pk_bf16_f32 v63, v55, v59
    v_cvt_pk_bf16_f32 v64, v56, v60
    v_cvt_pk_bf16_f32 v65, v57, v61
    s_cbranch_vccnz L_fb_f1r
L_norm_f1r:
    s_mov_b64 exec, s[70:71]
    ds_write_b128 v13, v[62:65] offset:5120
    s_mov_b64 exec, -1
    v_mov_b64 v[14:15], 0
    v_mov_b64 v[16:17], 0
    v_mov_b64 v[18:19], 0
    v_mov_b64 v[20:21], 0
    v_mov_b64 v[22:23], 0
    v_mov_b64 v[24:25], 0
    v_mov_b64 v[26:27], 0
    v_mov_b64 v[28:29], 0
    v_mov_b64 v[30:31], 0
    v_mov_b64 v[32:33], 0
    s_waitcnt lgkmcnt(0)
    s_barrier
    ds_read_b128 v[38:41], v2 offset:5120
    ds_read_b128 v[42:45], v2 offset:6144
    ds_read_b128 v[46:49], v3 offset:26624
    s_add_u32 s14, s14, 1
    s_add_u32 s17, s14, 0
    s_and_b32 s17, s17, 3
    s_lshl_b32 s18, s17, 13
    s_add_u32 s28, s46, s18
    s_addc_u32 s29, s47, 0
    s_lshl_b32 s17, s17, 15
    s_add_u32 s18, s17, 16384
    s_add_u32 s30, s48, s18
    s_addc_u32 s31, s49, 0
    s_add_u32 s18, s17, 0
    s_add_u32 s32, s48, s18
    s_addc_u32 s33, s49, 0
    s_waitcnt lgkmcnt(2)
    v_smfmac_f32_16x16x64_bf16 v[14:17], v[38:41], v[136:143], v1
    s_waitcnt lgkmcnt(1)
    v_smfmac_f32_16x16x64_bf16 v[14:17], v[42:45], v[144:151], v1
    v_smfmac_f32_16x16x64_bf16 v[18:21], v[38:41], v[152:159], v1
    v_smfmac_f32_16x16x64_bf16 v[18:21], v[42:45], v[160:167], v1
    v_smfmac_f32_16x16x64_bf16 v[22:25], v[38:41], v[168:175], v1
    v_smfmac_f32_16x16x64_bf16 v[22:25], v[42:45], v[176:183], v1
    v_smfmac_f32_16x16x64_bf16 v[26:29], v[38:41], v[184:191], v1
    v_smfmac_f32_16x16x64_bf16 v[26:29], v[42:45], v[192:199], v1
    s_nop 1
    v_pk_add_f32 v[14:15], v[14:15], v[16:17]
    s_nop 0
    v_pk_add_f32 v[18:19], v[18:19], v[20:21]
    v_smfmac_f32_16x16x64_bf16 v[30:33], v[38:41], v[200:207], v1
    v_cvt_pk_bf16_f32 v16, v14, v18
    v_cvt_pk_bf16_f32 v17, v15, v19
    v_smfmac_f32_16x16x64_bf16 v[30:33], v[42:45], v[208:215], v1
    v_and_or_b32 v16, v16, -2, s15
    v_and_or_b32 v17, v17, -2, s15
    global_store_dwordx2 v7, v[16:17], s[24:25]
    v_pk_add_f32 v[22:23], v[22:23], v[24:25]
    v_pk_add_f32 v[26:27], v[26:27], v[28:29]
    v_cvt_pk_bf16_f32 v24, v22, v26
    v_cvt_pk_bf16_f32 v25, v23, v27
    v_and_or_b32 v24, v24, -2, s15
    v_and_or_b32 v25, v25, -2, s15
    global_store_dwordx2 v7, v[24:25], s[26:27]
    v_pk_add_f32 v[30:31], v[30:31], v[32:33]
    v_cvt_pk_bf16_f32 v32, v30, v31
    v_and_or_b32 v32, v32, -2, s15
    global_store_dword v8, v32, s[24:25]
    s_waitcnt lgkmcnt(0)
    s_waitcnt vmcnt(0)
L_pa2_f1r:
    global_load_dwordx4 v[38:41], v9, s[24:25] sc1
    global_load_dwordx4 v[42:45], v9, s[24:25] offset:1024 sc1
    s_waitcnt vmcnt(1)
    v_mfma_f32_16x16x32_bf16 v[50:53], v[38:41], v[46:49], 0
    v_bitop3_b32 v0, v38, v39, s15 bitop3:0x7e
    v_bitop3_b32 v71, v40, v41, s15 bitop3:0x7e
    s_waitcnt vmcnt(0)
    v_mfma_f32_16x16x32_bf16 v[50:53], v[42:45], v[46:49], v[50:53]
    v_bitop3_b32 v66, v42, v43, s15 bitop3:0x7e
    v_bitop3_b32 v67, v44, v45, s15 bitop3:0x7e
    v_or3_b32 v0, v0, v71, v66
    v_bitop3_b32 v0, v0, v67, 1 bitop3:0xa8
    v_cmp_ne_u32 vcc, 0, v0
    s_nop 2
    v_pk_add_f32 v[50:51], v[50:51], v[52:53]
    v_add_f32 v50, v50, v51
    s_cbranch_vccnz L_pa_f1r
    s_nop 0
    v_mov_b32_dpp v51, v50 quad_perm:[1,1,3,3] row_mask:0xf bank_mask:0xf
    v_cvt_pk_bf16_f32 v50, v50, v51
    v_min_u32 v50, -2, v50
    s_mov_b64 exec, s[58:59]
    global_store_dword v10, v50, s[28:29]
    global_store_dword v10, v50, s[30:31] sc1
    s_mov_b64 exec, -1
    s_waitcnt vmcnt(1)
    s_barrier
    global_load_dwordx4 v[46:49], v3, s[28:29] sc1
    global_load_dword v71, v6, s[28:29] sc1
    v_mov_b64 v[14:15], 0
    v_mov_b64 v[16:17], 0
    v_mov_b64 v[18:19], 0
    v_mov_b64 v[20:21], 0
    v_mov_b64 v[22:23], 0
    v_mov_b64 v[24:25], 0
    v_mov_b64 v[26:27], 0
    v_mov_b64 v[28:29], 0
    v_mov_b64 v[30:31], 0
    v_mov_b64 v[32:33], 0
    v_mov_b64 v[34:35], 0
    v_mov_b64 v[36:37], 0
    ds_read_b128 v[50:53], v3 offset:32768
    ds_read_b128 v[54:57], v3 offset:36864
    ds_read_b128 v[58:61], v3 offset:40960
    ds_read_b128 v[62:65], v3 offset:45056
    s_branch L_step_f1r
L_own_f1r:
    s_add_u32 s16, s16, 1
    s_cmp_gt_u32 s16, 1048576
    s_cbranch_scc1 L_bail5
    s_waitcnt lgkmcnt(0)
    global_load_dwordx4 v[46:49], v3, s[28:29] sc1
    global_load_dword v71, v6, s[28:29] sc1
    s_waitcnt vmcnt(0)
    s_branch L_own2_f1r
L_oth_f1r:
    s_add_u32 s16, s16, 1
    s_cmp_gt_u32 s16, 1048576
    s_cbranch_scc1 L_bail6
    s_waitcnt lgkmcnt(0)
    global_load_dwordx4 v[66:69], v3, s[32:33] sc1
    global_load_dword v70, v6, s[32:33] sc1
    s_waitcnt vmcnt(0)
    s_branch L_oth2_f1r
L_pa_f1r:
    s_add_u32 s16, s16, 1
    s_cmp_gt_u32 s16, 1048576
    s_cbranch_scc1 L_bail8
    s_branch L_pa2_f1r
L_fb_f1r:
    v_max3_f32 v0, v14, v15, v16
    v_max3_f32 v0, v0, v17, v18
    v_max3_f32 v0, v0, v19, v20
    v_max3_f32 v0, v0, v21, v22
    v_max3_f32 v0, v0, v23, v24
    v_max_f32 v0, v0, v25
    v_mov_b32 v36, v0
    s_nop 1
    v_permlane16_swap_b32 v0, v36
    v_max_f32 v0, v0, v36
    v_mov_b32 v36, v0
    s_nop 1
    v_permlane32_swap_b32 v0, v36
    v_max_f32 v0, v0, v36
    v_sub_f32 v14, v14, v0
    v_sub_f32 v15, v15, v0
    v_sub_f32 v16, v16, v0
    v_sub_f32 v17, v17, v0
    v_sub_f32 v18, v18, v0
    v_sub_f32 v19, v19, v0
    v_sub_f32 v20, v20, v0
    v_sub_f32 v21, v21, v0
    v_sub_f32 v22, v22, v0
    v_sub_f32 v23, v23, v0
    v_sub_f32 v24, v24, v0
    v_sub_f32 v25, v25, v0
    v_exp_f32 v36, v14
    v_exp_f32 v37, v15
    v_exp_f32 v71, v16
    v_cvt_pk_bf16_f32 v26, v36, v37
    v_exp_f32 v36, v17
    s_nop 0
    v_cvt_pk_bf16_f32 v27, v71, v36
    v_exp_f32 v36, v18
    v_exp_f32 v37, v19
    v_exp_f32 v71, v20
    v_cvt_pk_bf16_f32 v28, v36, v37
    v_exp_f32 v36, v21
    s_nop 0
    v_cvt_pk_bf16_f32 v29, v71, v36
    v_exp_f32 v36, v22
    v_exp_f32 v37, v23
    v_mov_b32 v31, 0
    v_cvt_pk_bf16_f32 v30, v36, v37
    v_mfma_f32_16x16x32_bf16 v[50:53], v[66:69], v[26:29], 0
    v_mfma_f32_16x16x32_bf16 v[54:57], v[42:45], v[26:29], 0
    v_mfma_f32_16x16x32_bf16 v[58:61], v[46:49], v[26:29], 0
    s_nop 3
    v_mfma_f32_16x16x16_bf16 v[50:53], v[66:67], v[30:31], v[50:53]
    v_mfma_f32_16x16x16_bf16 v[54:57], v[32:33], v[30:31], v[54:57]
    v_mfma_f32_16x16x16_bf16 v[58:61], v[34:35], v[30:31], v[58:61]
    s_nop 5
    v_rcp_f32 v36, v50
    s_nop 0
    v_pk_mul_f32 v[54:55], v[54:55], v[36:37] op_sel_hi:[1,0]
    v_pk_mul_f32 v[58:59], v[58:59], v[36:37] op_sel_hi:[1,0]
    v_pk_mul_f32 v[56:57], v[56:57], v[36:37] op_sel_hi:[1,0]
    v_pk_mul_f32 v[60:61], v[60:61], v[36:37] op_sel_hi:[1,0]
    v_cvt_pk_bf16_f32 v62, v54, v58
    v_cvt_pk_bf16_f32 v63, v55, v59
    v_cvt_pk_bf16_f32 v64, v56, v60
    v_cvt_pk_bf16_f32 v65, v57, v61
    s_branch L_norm_f1r
L_last_f1r:
    s_nop 2
    v_pk_add_f32 v[30:31], v[30:31], v[32:33]
    v_pk_add_f32 v[34:35], v[34:35], v[36:37]
    v_cvt_pk_bf16_f32 v32, v30, v31
    v_cvt_pk_bf16_f32 v33, v34, v35
    global_store_dwordx2 v71, v[32:33], s[40:41] sc1
    v_mov_b32 v34, v33
    v_mov_b32 v35, 0
    s_waitcnt vmcnt(0) lgkmcnt(0)
    s_barrier
    s_branch L_chain_end
L_var4:
    s_add_u32 s17, s14, 0
    s_and_b32 s17, s17, 3
    s_lshl_b32 s18, s17, 13
    s_add_u32 s28, s46, s18
    s_addc_u32 s29, s47, 0
    s_lshl_b32 s17, s17, 15
    s_add_u32 s18, s17, 0
    s_add_u32 s32, s48, s18
    s_addc_u32 s33, s49, 0
    global_load_dwordx4 v[46:49], v3, s[28:29] sc1
    global_load_dword v71, v6, s[28:29] sc1
    v_mov_b64 v[14:15], 0
    v_mov_b64 v[16:17], 0
    v_mov_b64 v[18:19], 0
    v_mov_b64 v[20:21], 0
    v_mov_b64 v[22:23], 0
    v_mov_b64 v[24:25], 0
    v_mov_b64 v[26:27], 0
    v_mov_b64 v[28:29], 0
    v_mov_b64 v[30:31], 0
    v_mov_b64 v[32:33], 0
    v_mov_b64 v[34:35], 0
    v_mov_b64 v[36:37], 0
    ds_read_b128 v[50:53], v3 offset:32768
    ds_read_b128 v[54:57], v3 offset:36864
    ds_read_b128 v[58:61], v3 offset:40960
    ds_read_b128 v[62:65], v3 offset:45056
L_step_f1i:
    s_waitcnt vmcnt(0)
L_own2_f1i:
    v_max3_u32 v0, v46, v47, v48
    v_max3_u32 v0, v0, v49, v71
    v_cmp_eq_u32 vcc, -1, v0
    ds_write_b128 v3, v[46:49] offset:0
    ds_write_b32 v6, v71 offset:0
    s_cbranch_vccnz L_own_f1i
    global_load_dwordx4 v[66:69], v3, s[32:33] sc1
    global_load_dword v70, v6, s[32:33] sc1
    s_waitcnt lgkmcnt(0)
    s_barrier
    ds_read_b128 v[38:41], v2 offset:0
    ds_read_b128 v[42:45], v2 offset:1024
    ds_read_b128 v[46:49], v2 offset:2048
    s_waitcnt lgkmcnt(2)
    v_smfmac_f32_16x16x64_bf16 v[14:17], v[38:41], a[0:7], v1
    s_lshr_b32 s17, s14, 2
    s_xor_b32 s17, s17, s5
    v_smfmac_f32_16x16x64_bf16 v[18:21], v[38:41], a[8:15], v1
    s_and_b32 s17, s17, 1
    s_lshl_b32 s17, s17, 13
    v_smfmac_f32_16x16x64_bf16 v[22:25], v[38:41], a[160:167], v1
    s_lshl_b32 s18, s14, 19
    s_add_u32 s17, s17, s18
    v_smfmac_f32_16x16x64_bf16 v[26:29], v[38:41], a[168:175], v1
    s_add_u32 s40, s100, s17
    s_addc_u32 s41, s101, 0
    s_add_u32 s17, s14, 1
    v_smfmac_f32_16x16x64_bf16 v[30:33], v[38:41], v[50:57], v1
    ds_read_b128 v[50:53], v3 offset:49152
    s_lshr_b32 s18, s17, 1
    v_smfmac_f32_16x16x64_bf16 v[34:37], v[38:41], v[58:65], v1
    ds_read_b128 v[54:57], v3 offset:53248
    s_xor_b32 s18, s18, s5
    s_waitcnt lgkmcnt(3)
    v_smfmac_f32_16x16x64_bf16 v[14:17], v[42:45], a[16:23], v1
    ds_read_b128 v[58:61], v3 offset:57344
    s_and_b32 s18, s18, 1
    v_smfmac_f32_16x16x64_bf16 v[18:21], v[42:45], a[24:31], v1
    ds_read_b128 v[62:65], v3 offset:61440
    s_lshl_b32 s18, s18, 13
    v_smfmac_f32_16x16x64_bf16 v[22:25], v[42:45], a[176:183], v1
    ds_read_b128 v[38:41], v2 offset:3072
    s_lshl_b32 s17, s17, 20
    v_smfmac_f32_16x16x64_bf16 v[26:29], v[42:45], a[184:191], v1
    s_add_u32 s17, s17, s18
    s_add_u32 s38, s50, s17
    s_addc_u32 s39, s51, 0
    s_waitcnt lgkmcnt(3)
    v_smfmac_f32_16x16x64_bf16 v[30:33], v[42:45], v[50:57], v1
    ds_read_b128 v[50:53], v4 offset:0
    s_add_u32 s22, s38, 0x4000
    s_addc_u32 s23, s39, 0
    s_waitcnt lgkmcnt(2)
    v_smfmac_f32_16x16x64_bf16 v[34:37], v[42:45], v[58:65], v1
    ds_read_b128 v[54:57], v4 offset:4096
    s_and_b32 s17, s14, 1
    v_smfmac_f32_16x16x64_bf16 v[14:17], v[46:49], a[32:39], v1
    ds_read_b128 v[58:61], v4 offset:8192
    s_mul_i32 s17, s17, 163840
    v_smfmac_f32_16x16x64_bf16 v[18:21], v[46:49], a[40:47], v1
    ds_read_b128 v[62:65], v4 offset:12288
    s_add_u32 s24, s52, s17
    s_addc_u32 s25, s53, 0
    v_smfmac_f32_16x16x64_bf16 v[22:25], v[46:49], a[192:199], v1
    ds_read_b128 v[42:45], v2 offset:4096
    s_add_u32 s26, s24, 16384
    s_addc_u32 s27, s25, 0
    v_smfmac_f32_16x16x64_bf16 v[26:29], v[46:49], a[200:207], v1
    s_bfe_u32 s15, s14, 0x10001
    s_waitcnt lgkmcnt(3)
    v_smfmac_f32_16x16x64_bf16 v[30:33], v[46:49], v[50:57], v1
    ds_read_b128 v[50:53], v4 offset:16384
    s_waitcnt lgkmcnt(2)
    v_smfmac_f32_16x16x64_bf16 v[34:37], v[46:49], v[58:65], v1
    ds_read_b128 v[54:57], v4 offset:20480
    v_smfmac_f32_16x16x64_bf16 v[14:17], v[38:41], a[48:55], v1
    ds_read_b128 v[58:61], v4 offset:24576
    v_smfmac_f32_16x16x64_bf16 v[18:21], v[38:41], a[56:63], v1
    ds_read_b128 v[62:65], v4 offset:28672
    v_smfmac_f32_16x16x64_bf16 v[22:25], v[38:41], a[208:215], v1
    v_smfmac_f32_16x16x64_bf16 v[26:29], v[38:41], a[216:223], v1
    s_waitcnt lgkmcnt(2)
    v_smfmac_f32_16x16x64_bf16 v[30:33], v[38:41], v[50:57], v1
    ds_read_b128 v[50:53], v4 offset:32768
    s_waitcnt lgkmcnt(1)
    v_smfmac_f32_16x16x64_bf16 v[34:37], v[38:41], v[58:65], v1
    ds_read_b128 v[54:57], v4 offset:36864
    s_waitcnt vmcnt(0)
L_oth2_f1i:
    v_max3_u32 v0, v66, v67, v68
    v_max3_u32 v0, v0, v69, v70
    v_cmp_eq_u32 vcc, -1, v0
    ds_write_b128 v3, v[66:69] offset:5120
    ds_write_b32 v6, v70 offset:5120
    s_cbranch_vccnz L_oth_f1i
    v_smfmac_f32_16x16x64_bf16 v[14:17], v[42:45], a[64:71], v1
    ds_read_b128 v[58:61], v4 offset:40960
    v_smfmac_f32_16x16x64_bf16 v[18:21], v[42:45], a[72:79], v1
    ds_read_b128 v[62:65], v4 offset:45056
    v_smfmac_f32_16x16x64_bf16 v[22:25], v[42:45], a[224:231], v1
    v_smfmac_f32_16x16x64_bf16 v[26:29], v[42:45], a[232:239], v1
    s_waitcnt lgkmcnt(4)
    v_smfmac_f32_16x16x64_bf16 v[30:33], v[42:45], v[50:57], v1
    s_waitcnt lgkmcnt(0)
    v_smfmac_f32_16x16x64_bf16 v[34:37], v[42:45], v[58:65], v1
    s_barrier
    ds_read_b128 v[46:49], v2 offset:5120
    ds_read_b128 v[38:41], v2 offset:6144
    ds_read_b128 v[42:45], v2 offset:7168
    s_waitcnt lgkmcnt(2)
    v_smfmac_f32_16x16x64_bf16 v[14:17], v[46:49], a[80:87], v1
    s_xor_b32 s17, s20, 149504
    v_smfmac_f32_16x16x64_bf16 v[18:21], v[46:49], a[88:95], v1
    s_add_u32 m0, s17, s21
    v_smfmac_f32_16x16x64_bf16 v[22:25], v[46:49], a[240:247], v1
    global_load_lds_dwordx4 v3, s[38:39]
    v_smfmac_f32_16x16x64_bf16 v[26:29], v[46:49], a[248:255], v1
    ds_read_b128 v[46:49], v2 offset:8192
    s_waitcnt lgkmcnt(2)
    v_smfmac_f32_16x16x64_bf16 v[14:17], v[38:41], a[96:103], v1
    s_add_u32 m0, m0, 0x1000
    v_smfmac_f32_16x16x64_bf16 v[18:21], v[38:41], a[104:111], v1
    s_add_u32 s38, s38, 0x1000
    s_addc_u32 s39, s39, 0
    v_smfmac_f32_16x16x64_bf16 v[22:25], v[38:41], v[72:79], v1
    global_load_lds_dwordx4 v3, s[38:39]
    v_smfmac_f32_16x16x64_bf16 v[26:29], v[38:41], v[80:87], v1
    ds_read_b128 v[38:41], v2 offset:9216
    s_waitcnt lgkmcnt(2)
    v_smfmac_f32_16x16x64_bf16 v[14:17], v[42:45], a[112:119], v1
    ds_read_b128 v[58:61], v5 offset:16384
    v_smfmac_f32_16x16x64_bf16 v[18:21], v[42:45], a[120:127], v1
    ds_read_b128 v[62:65], v5 offset:20480
    v_smfmac_f32_16x16x64_bf16 v[22:25], v[42:45], v[88:95], v1
    ds_read_b128 v[50:53], v5 offset:8192
    v_smfmac_f32_16x16x64_bf16 v[26:29], v[42:45], v[96:103], v1
    ds_read_b128 v[54:57], v5 offset:12288
    s_waitcnt lgkmcnt(5)
    v_smfmac_f32_16x16x64_bf16 v[14:17], v[46:49], a[128:135], v1
    v_add_u32 v0, s20, v2
    v_smfmac_f32_16x16x64_bf16 v[18:21], v[46:49], a[136:143], v1
    s_xor_b32 s20, s20, 149504
    v_smfmac_f32_16x16x64_bf16 v[22:25], v[46:49], v[104:111], v1
    v_smfmac_f32_16x16x64_bf16 v[26:29], v[46:49], v[112:119], v1
    s_waitcnt lgkmcnt(4)
    v_smfmac_f32_16x16x64_bf16 v[14:17], v[38:41], a[144:151], v1
    v_smfmac_f32_16x16x64_bf16 v[18:21], v[38:41], a[152:159], v1
    v_smfmac_f32_16x16x64_bf16 v[22:25], v[38:41], v[120:127], v1
    v_smfmac_f32_16x16x64_bf16 v[26:29], v[38:41], v[128:135], v1
    v_smfmac_f32_16x16x64_bf16 v[34:37], v[38:41], v[248:255], v1
    s_waitcnt lgkmcnt(2)
    v_smfmac_f32_16x16x64_bf16 v[30:33], v[38:41], v[58:65], v1
    ds_read_b128 v[58:61], v5 offset:0
    ds_read_b128 v[62:65], v5 offset:4096
    v_pk_add_f32 v[14:15], v[14:15], v[16:17]
    v_pk_add_f32 v[18:19], v[18:19], v[20:21]
    v_pk_mul_f32 v[14:15], v[14:15], s[44:45]
    v_pk_mul_f32 v[18:19], v[18:19], s[44:45]
    v_cvt_pk_bf16_f32 v16, v14, v18
    v_cvt_pk_bf16_f32 v17, v15, v19
    ds_write2_b32 v11, v16, v17 offset0:0 offset1:72
    v_pk_add_f32 v[22:23], v[22:23], v[24:25]
    v_pk_add_f32 v[26:27], v[26:27], v[28:29]
    v_cvt_pk_bf16_f32 v28, v22, v26
    v_cvt_pk_bf16_f32 v29, v23, v27
    v_add_u32 v71, 2304, v11
    ds_write2_b32 v71, v28, v29 offset0:0 offset1:72
    v_smfmac_f32_16x16x64_bf16 v[34:37], v[46:49], v[240:247], v1
    ds_read_b128 v[38:41], v2 offset:5120
    s_waitcnt lgkmcnt(5)
    v_smfmac_f32_16x16x64_bf16 v[30:33], v[46:49], v[50:57], v1
    ds_read_b128 v[50:53], v4 offset:57344
    ds_read_b128 v[54:57], v4 offset:61440
    v_smfmac_f32_16x16x64_bf16 v[34:37], v[42:45], v[232:239], v1
    ds_read_b128 v[46:49], v2 offset:6144
    s_waitcnt lgkmcnt(6)
    v_smfmac_f32_16x16x64_bf16 v[30:33], v[42:45], v[58:65], v1
    ds_read_b128 v[58:61], v4 offset:49152
    ds_read_b128 v[62:65], v4 offset:53248
    s_waitcnt lgkmcnt(6)
    s_barrier
    ds_read_b128 v[66:69], v0 offset:3072
    ds_read_b128 v[42:45], v0 offset:1024
    v_lshrrev_b32 v71, 1, v3
    s_waitcnt lgkmcnt(4)
    v_smfmac_f32_16x16x64_bf16 v[34:37], v[46:49], v[224:231], v1
    v_smfmac_f32_16x16x64_bf16 v[30:33], v[46:49], v[50:57], v1
    ds_read_b128 v[50:53], v12 offset:0
    ds_read_b128 v[54:57], v12 offset:64
    ds_read_b128 v[46:49], v0 offset:2048
    v_smfmac_f32_16x16x64_bf16 v[34:37], v[38:41], v[216:223], v1
    s_waitcnt lgkmcnt(5)
    v_smfmac_f32_16x16x64_bf16 v[30:33], v[38:41], v[58:65], v1
    ds_read_b128 v[58:61], v12 offset:128
    ds_read_b128 v[62:65], v12 offset:192
    ds_read_b128 v[38:41], v0 offset:0
    s_cmp_eq_u32 s14, 63
    s_cbranch_scc1 L_last_f1i
    s_waitcnt lgkmcnt(4)
    v_mfma_f32_16x16x32_bf16 v[14:17], v[42:45], v[54:57], 0
    ds_read_b128 v[42:45], v0 offset:5120
    s_waitcnt lgkmcnt(3)
    v_mfma_f32_16x16x32_bf16 v[14:17], v[46:49], v[58:61], v[14:17]
    ds_read_b128 v[46:49], v0 offset:6144
    v_pk_add_f32 v[30:31], v[30:31], v[32:33]
    v_pk_add_f32 v[34:35], v[34:35], v[36:37]
    s_waitcnt lgkmcnt(3)
    v_mfma_f32_16x16x32_bf16 v[14:17], v[66:69], v[62:65], v[14:17]
    ds_read_b128 v[66:69], v0 offset:7168
    v_cvt_pk_bf16_f32 v32, v30, v31
    v_cvt_pk_bf16_f32 v33, v34, v35
    s_waitcnt lgkmcnt(3)
    v_mfma_f32_16x16x32_bf16 v[14:17], v[38:41], v[50:53], v[14:17]
    ds_read_b128 v[38:41], v0 offset:4096
    global_store_dwordx2 v71, v[32:33], s[40:41] sc1
    v_mov_b32 v34, v33
    v_mov_b32 v35, 0
    s_waitcnt lgkmcnt(3)
    v_mfma_f32_16x16x32_bf16 v[18:21], v[42:45], v[54:57], 0
    ds_read_b128 v[42:45], v12 offset:2368
    s_waitcnt lgkmcnt(3)
    v_mfma_f32_16x16x32_bf16 v[18:21], v[46:49], v[58:61], v[18:21]
    ds_read_b128 v[46:49], v12 offset:2432
    s_waitcnt lgkmcnt(3)
    v_mfma_f32_16x16x32_bf16 v[18:21], v[66:69], v[62:65], v[18:21]
    ds_read_b128 v[66:69], v12 offset:2496
    s_waitcnt lgkmcnt(3)
    v_mfma_f32_16x16x32_bf16 v[18:21], v[38:41], v[50:53], v[18:21]
    ds_read_b128 v[38:41], v12 offset:2304
    v_exp_f32 v36, v14
    v_exp_f32 v37, v15
    v_exp_f32 v71, v16
    v_cvt_pk_bf16_f32 v26, v36, v37
    v_exp_f32 v36, v17
    s_nop 0
    v_cvt_pk_bf16_f32 v27, v71, v36
    s_waitcnt lgkmcnt(3)
    v_mfma_f32_16x16x32_bf16 v[22:25], v[42:45], v[54:57], 0
    ds_read_b128 v[42:45], v3 offset:18432
    s_waitcnt lgkmcnt(3)
    v_mfma_f32_16x16x32_bf16 v[22:25], v[46:49], v[58:61], v[22:25]
    ds_read_b128 v[46:49], v3 offset:22528
    v_exp_f32 v36, v18
    v_exp_f32 v37, v19
    s_waitcnt lgkmcnt(3)
    v_mfma_f32_16x16x32_bf16 v[22:25], v[66:69], v[62:65], v[22:25]
    v_exp_f32 v71, v20
    v_cvt_pk_bf16_f32 v28, v36, v37
    s_waitcnt lgkmcnt(2)
    v_mfma_f32_16x16x32_bf16 v[22:25], v[38:41], v[50:53], v[22:25]
    v_exp_f32 v36, v21
    s_nop 0
    v_cvt_pk_bf16_f32 v29, v71, v36
    v_mov_b64 v[66:67], s[62:63]
    v_mov_b64 v[68:69], s[62:63]
    s_waitcnt lgkmcnt(1)
    v_mfma_f32_16x16x32_bf16 v[54:57], v[42:45], v[26:29], 0
    s_nop 0
    v_exp_f32 v36, v22
    s_waitcnt lgkmcnt(0)
    v_mfma_f32_16x16x32_bf16 v[58:61], v[46:49], v[26:29], 0
    v_exp_f32 v37, v23
    v_mfma_f32_16x16x32_bf16 v[50:53], v[66:69], v[26:29], 0
    v_mov_b32 v31, 0
    v_cvt_pk_bf16_f32 v30, v36, v37
    s_add_u32 m0, s21, 18432
    s_nop 2
    v_mfma_f32_16x16x16_bf16 v[50:53], v[66:67], v[30:31], v[50:53]
    v_mfma_f32_16x16x16_bf16 v[54:57], v[32:33], v[30:31], v[54:57]
    v_mfma_f32_16x16x16_bf16 v[58:61], v[34:35], v[30:31], v[58:61]
    global_load_lds_dwordx4 v3, s[22:23]
    s_add_u32 m0, m0, 0x1000
    s_add_u32 s22, s22, 0x1000
    s_addc_u32 s23, s23, 0
    global_load_lds_dwordx4 v3, s[22:23]
    s_nop 0
    v_rcp_f32 v36, v50
    v_subrev_u32 v0, s54, v50
    v_cmp_lt_u32 vcc, s55, v0
    v_pk_mul_f32 v[54:55], v[54:55], v[36:37] op_sel_hi:[1,0]
    v_pk_mul_f32 v[58:59], v[58:59], v[36:37] op_sel_hi:[1,0]
    v_pk_mul_f32 v[56:57], v[56:57], v[36:37] op_sel_hi:[1,0]
    v_pk_mul_f32 v[60:61], v[60:61], v[36:37] op_sel_hi:[1,0]
    v_cvt_pk_bf16_f32 v62, v54, v58
    v_cvt_pk_bf16_f32 v63, v55, v59
    v_cvt_pk_bf16_f32 v64, v56, v60
    v_cvt_pk_bf16_f32 v65, v57, v61
    s_cbranch_vccnz L_fb_f1i
L_norm_f1i:
    s_mov_b64 exec, s[70:71]
    ds_write_b128 v13, v[62:65] offset:5120
    s_mov_b64 exec, -1
    v_mov_b64 v[14:15], 0
    v_mov_b64 v[16:17], 0
    v_mov_b64 v[18:19], 0
    v_mov_b64 v[20:21], 0
    v_mov_b64 v[22:23], 0
    v_mov_b64 v[24:25], 0
    v_mov_b64 v[26:27], 0
    v_mov_b64 v[28:29], 0
    v_mov_b64 v[30:31], 0
    v_mov_b64 v[32:33], 0
    s_waitcnt lgkmcnt(0)
    s_barrier
    ds_read_b128 v[38:41], v2 offset:5120
    ds_read_b128 v[42:45], v2 offset:6144
    s_add_u32 s14, s14, 1
    s_add_u32 s17, s14, 0
    s_and_b32 s17, s17, 3
    s_lshl_b32 s18, s17, 13
    s_add_u32 s28, s46, s18
    s_addc_u32 s29, s47, 0
    s_lshl_b32 s17, s17, 15
    s_add_u32 s18, s17, 0
    s_add_u32 s32, s48, s18
    s_addc_u32 s33, s49, 0
    s_waitcnt lgkmcnt(1)
    v_smfmac_f32_16x16x64_bf16 v[14:17], v[38:41], v[136:143], v1
    s_waitcnt lgkmcnt(0)
    v_smfmac_f32_16x16x64_bf16 v[14:17], v[42:45], v[144:151], v1
    v_smfmac_f32_16x16x64_bf16 v[18:21], v[38:41], v[152:159], v1
    v_smfmac_f32_16x16x64_bf16 v[18:21], v[42:45], v[160:167], v1
    v_smfmac_f32_16x16x64_bf16 v[22:25], v[38:41], v[168:175], v1
    v_smfmac_f32_16x16x64_bf16 v[22:25], v[42:45], v[176:183], v1
    v_smfmac_f32_16x16x64_bf16 v[26:29], v[38:41], v[184:191], v1
    v_smfmac_f32_16x16x64_bf16 v[26:29], v[42:45], v[192:199], v1
    s_nop 1
    v_pk_add_f32 v[14:15], v[14:15], v[16:17]
    s_nop 0
    v_pk_add_f32 v[18:19], v[18:19], v[20:21]
    v_smfmac_f32_16x16x64_bf16 v[30:33], v[38:41], v[200:207], v1
    v_cvt_pk_bf16_f32 v16, v14, v18
    v_cvt_pk_bf16_f32 v17, v15, v19
    v_smfmac_f32_16x16x64_bf16 v[30:33], v[42:45], v[208:215], v1
    v_and_or_b32 v16, v16, -2, s15
    v_and_or_b32 v17, v17, -2, s15
    global_store_dwordx2 v7, v[16:17], s[24:25]
    v_pk_add_f32 v[22:23], v[22:23], v[24:25]
    v_pk_add_f32 v[26:27], v[26:27], v[28:29]
    v_cvt_pk_bf16_f32 v24, v22, v26
    v_cvt_pk_bf16_f32 v25, v23, v27
    v_and_or_b32 v24, v24, -2, s15
    v_and_or_b32 v25, v25, -2, s15
    global_store_dwordx2 v7, v[24:25], s[26:27]
    v_pk_add_f32 v[30:31], v[30:31], v[32:33]
    v_cvt_pk_bf16_f32 v32, v30, v31
    v_and_or_b32 v32, v32, -2, s15
    global_store_dword v8, v32, s[24:25]
    s_waitcnt lgkmcnt(0)
    s_barrier
    global_load_dwordx4 v[46:49], v3, s[28:29] sc1
    global_load_dword v71, v6, s[28:29] sc1
    v_mov_b64 v[14:15], 0
    v_mov_b64 v[16:17], 0
    v_mov_b64 v[18:19], 0
    v_mov_b64 v[20:21], 0
    v_mov_b64 v[22:23], 0
    v_mov_b64 v[24:25], 0
    v_mov_b64 v[26:27], 0
    v_mov_b64 v[28:29], 0
    v_mov_b64 v[30:31], 0
    v_mov_b64 v[32:33], 0
    v_mov_b64 v[34:35], 0
    v_mov_b64 v[36:37], 0
    ds_read_b128 v[50:53], v3 offset:32768
    ds_read_b128 v[54:57], v3 offset:36864
    ds_read_b128 v[58:61], v3 offset:40960
    ds_read_b128 v[62:65], v3 offset:45056
    s_branch L_step_f1i
L_own_f1i:
    s_add_u32 s16, s16, 1
    s_cmp_gt_u32 s16, 1048576
    s_cbranch_scc1 L_bail5
    s_waitcnt lgkmcnt(0)
    global_load_dwordx4 v[46:49], v3, s[28:29] sc1
    global_load_dword v71, v6, s[28:29] sc1
    s_waitcnt vmcnt(0)
    s_branch L_own2_f1i
L_oth_f1i:
    s_add_u32 s16, s16, 1
    s_cmp_gt_u32 s16, 1048576
    s_cbranch_scc1 L_bail6
    s_waitcnt lgkmcnt(0)
    global_load_dwordx4 v[66:69], v3, s[32:33] sc1
    global_load_dword v70, v6, s[32:33] sc1
    s_waitcnt vmcnt(0)
    s_branch L_oth2_f1i
L_fb_f1i:
    v_max3_f32 v0, v14, v15, v16
    v_max3_f32 v0, v0, v17, v18
    v_max3_f32 v0, v0, v19, v20
    v_max3_f32 v0, v0, v21, v22
    v_max3_f32 v0, v0, v23, v24
    v_max_f32 v0, v0, v25
    v_mov_b32 v36, v0
    s_nop 1
    v_permlane16_swap_b32 v0, v36
    v_max_f32 v0, v0, v36
    v_mov_b32 v36, v0
    s_nop 1
    v_permlane32_swap_b32 v0, v36
    v_max_f32 v0, v0, v36
    v_sub_f32 v14, v14, v0
    v_sub_f32 v15, v15, v0
    v_sub_f32 v16, v16, v0
    v_sub_f32 v17, v17, v0
    v_sub_f32 v18, v18, v0
    v_sub_f32 v19, v19, v0
    v_sub_f32 v20, v20, v0
    v_sub_f32 v21, v21, v0
    v_sub_f32 v22, v22, v0
    v_sub_f32 v23, v23, v0
    v_sub_f32 v24, v24, v0
    v_sub_f32 v25, v25, v0
    v_exp_f32 v36, v14
    v_exp_f32 v37, v15
    v_exp_f32 v71, v16
    v_cvt_pk_bf16_f32 v26, v36, v37
    v_exp_f32 v36, v17
    s_nop 0
    v_cvt_pk_bf16_f32 v27, v71, v36
    v_exp_f32 v36, v18
    v_exp_f32 v37, v19
    v_exp_f32 v71, v20
    v_cvt_pk_bf16_f32 v28, v36, v37
    v_exp_f32 v36, v21
    s_nop 0
    v_cvt_pk_bf16_f32 v29, v71, v36
    v_exp_f32 v36, v22
    v_exp_f32 v37, v23
    v_mov_b32 v31, 0
    v_cvt_pk_bf16_f32 v30, v36, v37
    v_mfma_f32_16x16x32_bf16 v[50:53], v[66:69], v[26:29], 0
    v_mfma_f32_16x16x32_bf16 v[54:57], v[42:45], v[26:29], 0
    v_mfma_f32_16x16x32_bf16 v[58:61], v[46:49], v[26:29], 0
    s_nop 3
    v_mfma_f32_16x16x16_bf16 v[50:53], v[66:67], v[30:31], v[50:53]
    v_mfma_f32_16x16x16_bf16 v[54:57], v[32:33], v[30:31], v[54:57]
    v_mfma_f32_16x16x16_bf16 v[58:61], v[34:35], v[30:31], v[58:61]
    s_nop 5
    v_rcp_f32 v36, v50
    s_nop 0
    v_pk_mul_f32 v[54:55], v[54:55], v[36:37] op_sel_hi:[1,0]
    v_pk_mul_f32 v[58:59], v[58:59], v[36:37] op_sel_hi:[1,0]
    v_pk_mul_f32 v[56:57], v[56:57], v[36:37] op_sel_hi:[1,0]
    v_pk_mul_f32 v[60:61], v[60:61], v[36:37] op_sel_hi:[1,0]
    v_cvt_pk_bf16_f32 v62, v54, v58
    v_cvt_pk_bf16_f32 v63, v55, v59
    v_cvt_pk_bf16_f32 v64, v56, v60
    v_cvt_pk_bf16_f32 v65, v57, v61
    s_branch L_norm_f1i
L_last_f1i:
    s_nop 2
    v_pk_add_f32 v[30:31], v[30:31], v[32:33]
    v_pk_add_f32 v[34:35], v[34:35], v[36:37]
    v_cvt_pk_bf16_f32 v32, v30, v31
    v_cvt_pk_bf16_f32 v33, v34, v35
    global_store_dwordx2 v71, v[32:33], s[40:41] sc1
    v_mov_b32 v34, v33
    v_mov_b32 v35, 0
    s_waitcnt vmcnt(0) lgkmcnt(0)
    s_barrier
    s_branch L_chain_end
L_var5:
    s_add_u32 s17, s14, 0
    s_and_b32 s17, s17, 3
    s_lshl_b32 s18, s17, 13
    s_add_u32 s28, s46, s18
    s_addc_u32 s29, s47, 0
    s_lshl_b32 s17, s17, 15
    s_add_u32 s18, s17, 0
    s_add_u32 s32, s48, s18
    s_addc_u32 s33, s49, 0
    global_load_dwordx4 v[46:49], v3, s[28:29] sc1
    global_load_dword v71, v6, s[28:29] sc1
    v_mov_b64 v[14:15], 0
    v_mov_b64 v[16:17], 0
    v_mov_b64 v[18:19], 0
    v_mov_b64 v[20:21], 0
    v_mov_b64 v[22:23], 0
    v_mov_b64 v[24:25], 0
    v_mov_b64 v[26:27], 0
    v_mov_b64 v[28:29], 0
    v_mov_b64 v[30:31], 0
    v_mov_b64 v[32:33], 0
    v_mov_b64 v[34:35], 0
    v_mov_b64 v[36:37], 0
    ds_read_b128 v[50:53], v3 offset:32768
    ds_read_b128 v[54:57], v3 offset:36864
    ds_read_b128 v[58:61], v3 offset:40960
    ds_read_b128 v[62:65], v3 offset:45056
L_step_f1g:
    s_waitcnt vmcnt(0)
L_own2_f1g:
    v_max3_u32 v0, v46, v47, v48
    v_max3_u32 v0, v0, v49, v71
    v_cmp_eq_u32 vcc, -1, v0
    ds_write_b128 v3, v[46:49] offset:0
    ds_write_b32 v6, v71 offset:0
    s_cbranch_vccnz L_own_f1g
    global_load_dwordx4 v[66:69], v3, s[32:33] sc1
    global_load_dword v70, v6, s[32:33] sc1
    s_waitcnt lgkmcnt(0)
    s_barrier
    ds_read_b128 v[38:41], v2 offset:0
    ds_read_b128 v[42:45], v2 offset:1024
    ds_read_b128 v[46:49], v2 offset:2048
    s_waitcnt lgkmcnt(2)
    v_smfmac_f32_16x16x64_bf16 v[14:17], v[38:41], a[0:7], v1
    s_lshr_b32 s17, s14, 2
    s_xor_b32 s17, s17, s5
    v_smfmac_f32_16x16x64_bf16 v[18:21], v[38:41], a[8:15], v1
    s_and_b32 s17, s17, 1
    s_lshl_b32 s17, s17, 13
    v_smfmac_f32_16x16x64_bf16 v[22:25], v[38:41], a[160:167], v1
    s_lshl_b32 s18, s14, 19
    s_add_u32 s17, s17, s18
    v_smfmac_f32_16x16x64_bf16 v[26:29], v[38:41], a[168:175], v1
    s_add_u32 s40, s100, s17
    s_addc_u32 s41, s101, 0
    s_add_u32 s17, s14, 1
    v_smfmac_f32_16x16x64_bf16 v[30:33], v[38:41], v[50:57], v1
    ds_read_b128 v[50:53], v3 offset:49152
    s_lshr_b32 s18, s17, 1
    v_smfmac_f32_16x16x64_bf16 v[34:37], v[38:41], v[58:65], v1
    ds_read_b128 v[54:57], v3 offset:53248
    s_xor_b32 s18, s18, s5
    s_waitcnt lgkmcnt(3)
    v_smfmac_f32_16x16x64_bf16 v[14:17], v[42:45], a[16:23], v1
    ds_read_b128 v[58:61], v3 offset:57344
    s_and_b32 s18, s18, 1
    v_smfmac_f32_16x16x64_bf16 v[18:21], v[42:45], a[24:31], v1
    ds_read_b128 v[62:65], v3 offset:61440
    s_lshl_b32 s18, s18, 13
    v_smfmac_f32_16x16x64_bf16 v[22:25], v[42:45], a[176:183], v1
    ds_read_b128 v[38:41], v2 offset:3072
    s_lshl_b32 s17, s17, 20
    v_smfmac_f32_16x16x64_bf16 v[26:29], v[42:45], a[184:191], v1
    s_add_u32 s17, s17, s18
    s_add_u32 s38, s50, s17
    s_addc_u32 s39, s51, 0
    s_waitcnt lgkmcnt(3)
    v_smfmac_f32_16x16x64_bf16 v[30:33], v[42:45], v[50:57], v1
    ds_read_b128 v[50:53], v4 offset:0
    s_add_u32 s22, s38, 0x4000
    s_addc_u32 s23, s39, 0
    s_waitcnt lgkmcnt(2)
    v_smfmac_f32_16x16x64_bf16 v[34:37], v[42:45], v[58:65], v1
    ds_read_b128 v[54:57], v4 offset:4096
    s_and_b32 s17, s14, 1
    v_smfmac_f32_16x16x64_bf16 v[14:17], v[46:49], a[32:39], v1
    ds_read_b128 v[58:61], v4 offset:8192
    s_mul_i32 s17, s17, 163840
    v_smfmac_f32_16x16x64_bf16 v[18:21], v[46:49], a[40:47], v1
    ds_read_b128 v[62:65], v4 offset:12288
    s_add_u32 s24, s52, s17
    s_addc_u32 s25, s53, 0
    v_smfmac_f32_16x16x64_bf16 v[22:25], v[46:49], a[192:199], v1
    ds_read_b128 v[42:45], v2 offset:4096
    s_add_u32 s26, s24, 16384
    s_addc_u32 s27, s25, 0
    v_smfmac_f32_16x16x64_bf16 v[26:29], v[46:49], a[200:207], v1
    s_bfe_u32 s15, s14, 0x10001
    s_add_u32 s60, s14, 3
    s_waitcnt lgkmcnt(3)
    v_smfmac_f32_16x16x64_bf16 v[30:33], v[46:49], v[50:57], v1
    ds_read_b128 v[50:53], v4 offset:16384
    s_min_u32 s60, s60, 64
    s_waitcnt lgkmcnt(2)
    v_smfmac_f32_16x16x64_bf16 v[34:37], v[46:49], v[58:65], v1
    ds_read_b128 v[54:57], v4 offset:20480
    v_smfmac_f32_16x16x64_bf16 v[14:17], v[38:41], a[48:55], v1
    ds_read_b128 v[58:61], v4 offset:24576
    v_smfmac_f32_16x16x64_bf16 v[18:21], v[38:41], a[56:63], v1
    ds_read_b128 v[62:65], v4 offset:28672
    v_smfmac_f32_16x16x64_bf16 v[22:25], v[38:41], a[208:215], v1
    v_smfmac_f32_16x16x64_bf16 v[26:29], v[38:41], a[216:223], v1
    s_waitcnt lgkmcnt(2)
    v_smfmac_f32_16x16x64_bf16 v[30:33], v[38:41], v[50:57], v1
    ds_read_b128 v[50:53], v4 offset:32768
    s_waitcnt lgkmcnt(1)
    v_smfmac_f32_16x16x64_bf16 v[34:37], v[38:41], v[58:65], v1
    ds_read_b128 v[54:57], v4 offset:36864
    s_waitcnt vmcnt(0)
L_oth2_f1g:
    v_max3_u32 v0, v66, v67, v68
    v_max3_u32 v0, v0, v69, v70
    v_cmp_eq_u32 vcc, -1, v0
    ds_write_b128 v3, v[66:69] offset:5120
    ds_write_b32 v6, v70 offset:5120
    s_cbranch_vccnz L_oth_f1g
    v_smfmac_f32_16x16x64_bf16 v[14:17], v[42:45], a[64:71], v1
    ds_read_b128 v[58:61], v4 offset:40960
    v_smfmac_f32_16x16x64_bf16 v[18:21], v[42:45], a[72:79], v1
    ds_read_b128 v[62:65], v4 offset:45056
    v_smfmac_f32_16x16x64_bf16 v[22:25], v[42:45], a[224:231], v1
    v_smfmac_f32_16x16x64_bf16 v[26:29], v[42:45], a[232:239], v1
    s_waitcnt lgkmcnt(4)
    v_smfmac_f32_16x16x64_bf16 v[30:33], v[42:45], v[50:57], v1
    s_waitcnt lgkmcnt(0)
    v_smfmac_f32_16x16x64_bf16 v[34:37], v[42:45], v[58:65], v1
    s_barrier
    ds_read_b128 v[46:49], v2 offset:5120
    ds_read_b128 v[38:41], v2 offset:6144
    ds_read_b128 v[42:45], v2 offset:7168
    s_mov_b64 exec, 3
    v_lshlrev_b32 v0, 8, v2
    global_load_dword v70, v0, s[56:57] sc1
    s_mov_b64 exec, 1
    v_mov_b32 v71, s14
    global_store_dword v2, v71, s[42:43] sc1
    s_mov_b64 exec, -1
    s_waitcnt lgkmcnt(2)
    v_smfmac_f32_16x16x64_bf16 v[14:17], v[46:49], a[80:87], v1
    s_xor_b32 s17, s20, 149504
    v_smfmac_f32_16x16x64_bf16 v[18:21], v[46:49], a[88:95], v1
    s_add_u32 m0, s17, s21
    v_smfmac_f32_16x16x64_bf16 v[22:25], v[46:49], a[240:247], v1
    global_load_lds_dwordx4 v3, s[38:39]
    v_smfmac_f32_16x16x64_bf16 v[26:29], v[46:49], a[248:255], v1
    ds_read_b128 v[46:49], v2 offset:8192
    s_waitcnt lgkmcnt(2)
    v_smfmac_f32_16x16x64_bf16 v[14:17], v[38:41], a[96:103], v1
    s_add_u32 m0, m0, 0x1000
    v_smfmac_f32_16x16x64_bf16 v[18:21], v[38:41], a[104:111], v1
    s_add_u32 s38, s38, 0x1000
    s_addc_u32 s39, s39, 0
    v_smfmac_f32_16x16x64_bf16 v[22:25], v[38:41], v[72:79], v1
    global_load_lds_dwordx4 v3, s[38:39]
    v_smfmac_f32_16x16x64_bf16 v[26:29], v[38:41], v[80:87], v1
    ds_read_b128 v[38:41], v2 offset:9216
    s_waitcnt lgkmcnt(2)
    v_smfmac_f32_16x16x64_bf16 v[14:17], v[42:45], a[112:119], v1
    ds_read_b128 v[58:61], v5 offset:16384
    v_smfmac_f32_16x16x64_bf16 v[18:21], v[42:45], a[120:127], v1
    ds_read_b128 v[62:65], v5 offset:20480
    v_smfmac_f32_16x16x64_bf16 v[22:25], v[42:45], v[88:95], v1
    ds_read_b128 v[50:53], v5 offset:8192
    v_smfmac_f32_16x16x64_bf16 v[26:29], v[42:45], v[96:103], v1
    ds_read_b128 v[54:57], v5 offset:12288
    s_waitcnt lgkmcnt(5)
    v_smfmac_f32_16x16x64_bf16 v[14:17], v[46:49], a[128:135], v1
    v_add_u32 v0, s20, v2
    v_smfmac_f32_16x16x64_bf16 v[18:21], v[46:49], a[136:143], v1
    s_xor_b32 s20, s20, 149504
    v_smfmac_f32_16x16x64_bf16 v[22:25], v[46:49], v[104:111], v1
    v_smfmac_f32_16x16x64_bf16 v[26:29], v[46:49], v[112:119], v1
    s_waitcnt lgkmcnt(4)
    v_smfmac_f32_16x16x64_bf16 v[14:17], v[38:41], a[144:151], v1
    v_smfmac_f32_16x16x64_bf16 v[18:21], v[38:41], a[152:159], v1
    v_smfmac_f32_16x16x64_bf16 v[22:25], v[38:41], v[120:127], v1
    v_smfmac_f32_16x16x64_bf16 v[26:29], v[38:41], v[128:135], v1
    v_smfmac_f32_16x16x64_bf16 v[34:37], v[38:41], v[248:255], v1
    s_waitcnt lgkmcnt(2)
    v_smfmac_f32_16x16x64_bf16 v[30:33], v[38:41], v[58:65], v1
    ds_read_b128 v[58:61], v5 offset:0
    ds_read_b128 v[62:65], v5 offset:4096
    v_pk_add_f32 v[14:15], v[14:15], v[16:17]
    v_pk_add_f32 v[18:19], v[18:19], v[20:21]
    v_pk_mul_f32 v[14:15], v[14:15], s[44:45]
    v_pk_mul_f32 v[18:19], v[18:19], s[44:45]
    v_cvt_pk_bf16_f32 v16, v14, v18
    v_cvt_pk_bf16_f32 v17, v15, v19
    ds_write2_b32 v11, v16, v17 offset0:0 offset1:72
    v_pk_add_f32 v[22:23], v[22:23], v[24:25]
    v_pk_add_f32 v[26:27], v[26:27], v[28:29]
    v_cvt_pk_bf16_f32 v28, v22, v26
    v_cvt_pk_bf16_f32 v29, v23, v27
    v_add_u32 v71, 2304, v11
    ds_write2_b32 v71, v28, v29 offset0:0 offset1:72
    v_smfmac_f32_16x16x64_bf16 v[34:37], v[46:49], v[240:247], v1
    ds_read_b128 v[38:41], v2 offset:5120
    s_waitcnt lgkmcnt(5)
    v_smfmac_f32_16x16x64_bf16 v[30:33], v[46:49], v[50:57], v1
    ds_read_b128 v[50:53], v4 offset:57344
    ds_read_b128 v[54:57], v4 offset:61440
    v_smfmac_f32_16x16x64_bf16 v[34:37], v[42:45], v[232:239], v1
    ds_read_b128 v[46:49], v2 offset:6144
    s_waitcnt lgkmcnt(6)
    v_smfmac_f32_16x16x64_bf16 v[30:33], v[42:45], v[58:65], v1
    ds_read_b128 v[58:61], v4 offset:49152
    ds_read_b128 v[62:65], v4 offset:53248
    s_waitcnt lgkmcnt(6)
    s_barrier
    ds_read_b128 v[66:69], v0 offset:3072
    ds_read_b128 v[42:45], v0 offset:1024
    v_lshrrev_b32 v71, 1, v3
    s_waitcnt lgkmcnt(4)
    v_smfmac_f32_16x16x64_bf16 v[34:37], v[46:49], v[224:231], v1
    v_smfmac_f32_16x16x64_bf16 v[30:33], v[46:49], v[50:57], v1
    ds_read_b128 v[50:53], v12 offset:0
    ds_read_b128 v[54:57], v12 offset:64
    ds_read_b128 v[46:49], v0 offset:2048
    v_smfmac_f32_16x16x64_bf16 v[34:37], v[38:41], v[216:223], v1
    s_waitcnt lgkmcnt(5)
    v_smfmac_f32_16x16x64_bf16 v[30:33], v[38:41], v[58:65], v1
    ds_read_b128 v[58:61], v12 offset:128
    ds_read_b128 v[62:65], v12 offset:192
    ds_read_b128 v[38:41], v0 offset:0
    s_cmp_eq_u32 s14, 63
    s_cbranch_scc1 L_last_f1g
    s_waitcnt lgkmcnt(4)
    v_mfma_f32_16x16x32_bf16 v[14:17], v[42:45], v[54:57], 0
    ds_read_b128 v[42:45], v0 offset:5120
    s_waitcnt lgkmcnt(3)
    v_mfma_f32_16x16x32_bf16 v[14:17], v[46:49], v[58:61], v[14:17]
    ds_read_b128 v[46:49], v0 offset:6144
    v_pk_add_f32 v[30:31], v[30:31], v[32:33]
    v_pk_add_f32 v[34:35], v[34:35], v[36:37]
    s_waitcnt lgkmcnt(3)
    v_mfma_f32_16x16x32_bf16 v[14:17], v[66:69], v[62:65], v[14:17]
    ds_read_b128 v[66:69], v0 offset:7168
    v_cvt_pk_bf16_f32 v32, v30, v31
    v_cvt_pk_bf16_f32 v33, v34, v35
    s_waitcnt lgkmcnt(3)
    v_mfma_f32_16x16x32_bf16 v[14:17], v[38:41], v[50:53], v[14:17]
    ds_read_b128 v[38:41], v0 offset:4096
    global_store_dwordx2 v71, v[32:33], s[40:41] sc1
    v_mov_b32 v34, v33
    v_mov_b32 v35, 0
    s_waitcnt lgkmcnt(3)
    v_mfma_f32_16x16x32_bf16 v[18:21], v[42:45], v[54:57], 0
    ds_read_b128 v[42:45], v12 offset:2368
    s_waitcnt lgkmcnt(3)
    v_mfma_f32_16x16x32_bf16 v[18:21], v[46:49], v[58:61], v[18:21]
    ds_read_b128 v[46:49], v12 offset:2432
    s_waitcnt lgkmcnt(3)
    v_mfma_f32_16x16x32_bf16 v[18:21], v[66:69], v[62:65], v[18:21]
    ds_read_b128 v[66:69], v12 offset:2496
    s_waitcnt lgkmcnt(3)
    v_mfma_f32_16x16x32_bf16 v[18:21], v[38:41], v[50:53], v[18:21]
    ds_read_b128 v[38:41], v12 offset:2304
    v_exp_f32 v36, v14
    v_exp_f32 v37, v15
    v_exp_f32 v71, v16
    v_cvt_pk_bf16_f32 v26, v36, v37
    v_exp_f32 v36, v17
    s_nop 0
    v_cvt_pk_bf16_f32 v27, v71, v36
    s_waitcnt lgkmcnt(3)
    v_mfma_f32_16x16x32_bf16 v[22:25], v[42:45], v[54:57], 0
    ds_read_b128 v[42:45], v3 offset:18432
    s_waitcnt lgkmcnt(3)
    v_mfma_f32_16x16x32_bf16 v[22:25], v[46:49], v[58:61], v[22:25]
    ds_read_b128 v[46:49], v3 offset:22528
    v_exp_f32 v36, v18
    v_exp_f32 v37, v19
    s_waitcnt lgkmcnt(3)
    v_mfma_f32_16x16x32_bf16 v[22:25], v[66:69], v[62:65], v[22:25]
    v_exp_f32 v71, v20
    v_cvt_pk_bf16_f32 v28, v36, v37
    s_waitcnt lgkmcnt(2)
    v_mfma_f32_16x16x32_bf16 v[22:25], v[38:41], v[50:53], v[22:25]
    v_exp_f32 v36, v21
    s_nop 0
    v_cvt_pk_bf16_f32 v29, v71, v36
    v_mov_b64 v[66:67], s[62:63]
    v_mov_b64 v[68:69], s[62:63]
    s_waitcnt lgkmcnt(1)
    v_mfma_f32_16x16x32_bf16 v[54:57], v[42:45], v[26:29], 0
    s_nop 0
    v_exp_f32 v36, v22
    s_waitcnt lgkmcnt(0)
    v_mfma_f32_16x16x32_bf16 v[58:61], v[46:49], v[26:29], 0
    v_exp_f32 v37, v23
    v_mfma_f32_16x16x32_bf16 v[50:53], v[66:69], v[26:29], 0
    v_mov_b32 v31, 0
    v_cvt_pk_bf16_f32 v30, v36, v37
    s_add_u32 m0, s21, 18432
    s_nop 2
    v_mfma_f32_16x16x16_bf16 v[50:53], v[66:67], v[30:31], v[50:53]
    v_mfma_f32_16x16x16_bf16 v[54:57], v[32:33], v[30:31], v[54:57]
    v_mfma_f32_16x16x16_bf16 v[58:61], v[34:35], v[30:31], v[58:61]
    global_load_lds_dwordx4 v3, s[22:23]
    s_add_u32 m0, m0, 0x1000
    s_add_u32 s22, s22, 0x1000
    s_addc_u32 s23, s23, 0
    global_load_lds_dwordx4 v3, s[22:23]
    s_nop 0
    v_rcp_f32 v36, v50
    v_subrev_u32 v0, s54, v50
    v_cmp_lt_u32 vcc, s55, v0
    v_pk_mul_f32 v[54:55], v[54:55], v[36:37] op_sel_hi:[1,0]
    v_pk_mul_f32 v[58:59], v[58:59], v[36:37] op_sel_hi:[1,0]
    v_pk_mul_f32 v[56:57], v[56:57], v[36:37] op_sel_hi:[1,0]
    v_pk_mul_f32 v[60:61], v[60:61], v[36:37] op_sel_hi:[1,0]
    v_cvt_pk_bf16_f32 v62, v54, v58
    v_cvt_pk_bf16_f32 v63, v55, v59
    v_cvt_pk_bf16_f32 v64, v56, v60
    v_cvt_pk_bf16_f32 v65, v57, v61
    s_cbranch_vccnz L_fb_f1g
L_norm_f1g:
    s_mov_b64 exec, s[70:71]
    ds_write_b128 v13, v[62:65] offset:5120
    s_mov_b64 exec, -1
    v_mov_b64 v[14:15], 0
    v_mov_b64 v[16:17], 0
    v_mov_b64 v[18:19], 0
    v_mov_b64 v[20:21], 0
    v_mov_b64 v[22:23], 0
    v_mov_b64 v[24:25], 0
    v_mov_b64 v[26:27], 0
    v_mov_b64 v[28:29], 0
    v_mov_b64 v[30:31], 0
    v_mov_b64 v[32:33], 0
    s_mov_b64 exec, 3
    s_waitcnt vmcnt(6)
L_kv2_f1g:
    v_cmp_gt_u32 vcc, s60, v70
    s_nop 0
    s_cbranch_vccnz L_kv_f1g
    s_mov_b64 exec, -1
    s_waitcnt lgkmcnt(0)
    s_barrier
    ds_read_b128 v[38:41], v2 offset:5120
    ds_read_b128 v[42:45], v2 offset:6144
    s_add_u32 s14, s14, 1
    s_add_u32 s17, s14, 0
    s_and_b32 s17, s17, 3
    s_lshl_b32 s18, s17, 13
    s_add_u32 s28, s46, s18
    s_addc_u32 s29, s47, 0
    s_lshl_b32 s17, s17, 15
    s_add_u32 s18, s17, 0
    s_add_u32 s32, s48, s18
    s_addc_u32 s33, s49, 0
    s_waitcnt lgkmcnt(1)
    v_smfmac_f32_16x16x64_bf16 v[14:17], v[38:41], v[136:143], v1
    s_waitcnt lgkmcnt(0)
    v_smfmac_f32_16x16x64_bf16 v[14:17], v[42:45], v[144:151], v1
    v_smfmac_f32_16x16x64_bf16 v[18:21], v[38:41], v[152:159], v1
    v_smfmac_f32_16x16x64_bf16 v[18:21], v[42:45], v[160:167], v1
    v_smfmac_f32_16x16x64_bf16 v[22:25], v[38:41], v[168:175], v1
    v_smfmac_f32_16x16x64_bf16 v[22:25], v[42:45], v[176:183], v1
    v_smfmac_f32_16x16x64_bf16 v[26:29], v[38:41], v[184:191], v1
    v_smfmac_f32_16x16x64_bf16 v[26:29], v[42:45], v[192:199], v1
    s_nop 1
    v_pk_add_f32 v[14:15], v[14:15], v[16:17]
    s_nop 0
    v_pk_add_f32 v[18:19], v[18:19], v[20:21]
    v_smfmac_f32_16x16x64_bf16 v[30:33], v[38:41], v[200:207], v1
    v_cvt_pk_bf16_f32 v16, v14, v18
    v_cvt_pk_bf16_f32 v17, v15, v19
    v_smfmac_f32_16x16x64_bf16 v[30:33], v[42:45], v[208:215], v1
    v_and_or_b32 v16, v16, -2, s15
    v_and_or_b32 v17, v17, -2, s15
    global_store_dwordx2 v7, v[16:17], s[24:25]
    v_pk_add_f32 v[22:23], v[22:23], v[24:25]
    v_pk_add_f32 v[26:27], v[26:27], v[28:29]
    v_cvt_pk_bf16_f32 v24, v22, v26
    v_cvt_pk_bf16_f32 v25, v23, v27
    v_and_or_b32 v24, v24, -2, s15
    v_and_or_b32 v25, v25, -2, s15
    global_store_dwordx2 v7, v[24:25], s[26:27]
    v_pk_add_f32 v[30:31], v[30:31], v[32:33]
    v_cvt_pk_bf16_f32 v32, v30, v31
    v_and_or_b32 v32, v32, -2, s15
    global_store_dword v8, v32, s[24:25]
    s_waitcnt lgkmcnt(0)
    s_barrier
    global_load_dwordx4 v[46:49], v3, s[28:29] sc1
    global_load_dword v71, v6, s[28:29] sc1
    v_mov_b64 v[14:15], 0
    v_mov_b64 v[16:17], 0
    v_mov_b64 v[18:19], 0
    v_mov_b64 v[20:21], 0
    v_mov_b64 v[22:23], 0
    v_mov_b64 v[24:25], 0
    v_mov_b64 v[26:27], 0
    v_mov_b64 v[28:29], 0
    v_mov_b64 v[30:31], 0
    v_mov_b64 v[32:33], 0
    v_mov_b64 v[34:35], 0
    v_mov_b64 v[36:37], 0
    ds_read_b128 v[50:53], v3 offset:32768
    ds_read_b128 v[54:57], v3 offset:36864
    ds_read_b128 v[58:61], v3 offset:40960
    ds_read_b128 v[62:65], v3 offset:45056
    s_branch L_step_f1g
L_own_f1g:
    s_add_u32 s16, s16, 1
    s_cmp_gt_u32 s16, 1048576
    s_cbranch_scc1 L_bail5
    s_waitcnt lgkmcnt(0)
    global_load_dwordx4 v[46:49], v3, s[28:29] sc1
    global_load_dword v71, v6, s[28:29] sc1
    s_waitcnt vmcnt(0)
    s_branch L_own2_f1g
L_oth_f1g:
    s_add_u32 s16, s16, 1
    s_cmp_gt_u32 s16, 1048576
    s_cbranch_scc1 L_bail6
    s_waitcnt lgkmcnt(0)
    global_load_dwordx4 v[66:69], v3, s[32:33] sc1
    global_load_dword v70, v6, s[32:33] sc1
    s_waitcnt vmcnt(0)
    s_branch L_oth2_f1g
L_kv_f1g:
    s_add_u32 s16, s16, 1
    s_cmp_gt_u32 s16, 1048576
    s_cbranch_scc1 L_bail7
    v_lshlrev_b32 v0, 8, v2
    global_load_dword v70, v0, s[56:57] sc1
    s_waitcnt vmcnt(0)
    s_branch L_kv2_f1g
L_fb_f1g:
    v_max3_f32 v0, v14, v15, v16
    v_max3_f32 v0, v0, v17, v18
    v_max3_f32 v0, v0, v19, v20
    v_max3_f32 v0, v0, v21, v22
    v_max3_f32 v0, v0, v23, v24
    v_max_f32 v0, v0, v25
    v_mov_b32 v36, v0
    s_nop 1
    v_permlane16_swap_b32 v0, v36
    v_max_f32 v0, v0, v36
    v_mov_b32 v36, v0
    s_nop 1
    v_permlane32_swap_b32 v0, v36
    v_max_f32 v0, v0, v36
    v_sub_f32 v14, v14, v0
    v_sub_f32 v15, v15, v0
    v_sub_f32 v16, v16, v0
    v_sub_f32 v17, v17, v0
    v_sub_f32 v18, v18, v0
    v_sub_f32 v19, v19, v0
    v_sub_f32 v20, v20, v0
    v_sub_f32 v21, v21, v0
    v_sub_f32 v22, v22, v0
    v_sub_f32 v23, v23, v0
    v_sub_f32 v24, v24, v0
    v_sub_f32 v25, v25, v0
    v_exp_f32 v36, v14
    v_exp_f32 v37, v15
    v_exp_f32 v71, v16
    v_cvt_pk_bf16_f32 v26, v36, v37
    v_exp_f32 v36, v17
    s_nop 0
    v_cvt_pk_bf16_f32 v27, v71, v36
    v_exp_f32 v36, v18
    v_exp_f32 v37, v19
    v_exp_f32 v71, v20
    v_cvt_pk_bf16_f32 v28, v36, v37
    v_exp_f32 v36, v21
    s_nop 0
    v_cvt_pk_bf16_f32 v29, v71, v36
    v_exp_f32 v36, v22
    v_exp_f32 v37, v23
    v_mov_b32 v31, 0
    v_cvt_pk_bf16_f32 v30, v36, v37
    v_mfma_f32_16x16x32_bf16 v[50:53], v[66:69], v[26:29], 0
    v_mfma_f32_16x16x32_bf16 v[54:57], v[42:45], v[26:29], 0
    v_mfma_f32_16x16x32_bf16 v[58:61], v[46:49], v[26:29], 0
    s_nop 3
    v_mfma_f32_16x16x16_bf16 v[50:53], v[66:67], v[30:31], v[50:53]
    v_mfma_f32_16x16x16_bf16 v[54:57], v[32:33], v[30:31], v[54:57]
    v_mfma_f32_16x16x16_bf16 v[58:61], v[34:35], v[30:31], v[58:61]
    s_nop 5
    v_rcp_f32 v36, v50
    s_nop 0
    v_pk_mul_f32 v[54:55], v[54:55], v[36:37] op_sel_hi:[1,0]
    v_pk_mul_f32 v[58:59], v[58:59], v[36:37] op_sel_hi:[1,0]
    v_pk_mul_f32 v[56:57], v[56:57], v[36:37] op_sel_hi:[1,0]
    v_pk_mul_f32 v[60:61], v[60:61], v[36:37] op_sel_hi:[1,0]
    v_cvt_pk_bf16_f32 v62, v54, v58
    v_cvt_pk_bf16_f32 v63, v55, v59
    v_cvt_pk_bf16_f32 v64, v56, v60
    v_cvt_pk_bf16_f32 v65, v57, v61
    s_branch L_norm_f1g
L_last_f1g:
    s_nop 2
    v_pk_add_f32 v[30:31], v[30:31], v[32:33]
    v_pk_add_f32 v[34:35], v[34:35], v[36:37]
    v_cvt_pk_bf16_f32 v32, v30, v31
    v_cvt_pk_bf16_f32 v33, v34, v35
    global_store_dwordx2 v71, v[32:33], s[40:41] sc1
    v_mov_b32 v34, v33
    v_mov_b32 v35, 0
    s_waitcnt vmcnt(0) lgkmcnt(0)
    s_barrier
    s_mov_b64 exec, 1
    v_mov_b32 v0, 0
    v_mov_b32 v1, 64
    global_store_dword v0, v1, s[42:43] sc1
    s_waitcnt vmcnt(0)
    s_mov_b64 exec, -1
    s_branch L_chain_end
L_var6:
    s_add_u32 s17, s14, 0
    s_and_b32 s17, s17, 3
    s_lshl_b32 s18, s17, 13
    s_add_u32 s28, s46, s18
    s_addc_u32 s29, s47, 0
    s_lshl_b32 s17, s17, 15
    s_add_u32 s18, s17, 16384
    s_add_u32 s32, s48, s18
    s_addc_u32 s33, s49, 0
    global_load_dwordx4 v[46:49], v3, s[28:29] sc1
    global_load_dword v71, v6, s[28:29] sc1
    v_mov_b64 v[14:15], 0
    v_mov_b64 v[16:17], 0
    v_mov_b64 v[18:19], 0
    v_mov_b64 v[20:21], 0
    v_mov_b64 v[22:23], 0
    v_mov_b64 v[24:25], 0
    v_mov_b64 v[26:27], 0
    v_mov_b64 v[28:29], 0
    v_mov_b64 v[30:31], 0
    v_mov_b64 v[32:33], 0
    v_mov_b64 v[34:35], 0
    v_mov_b64 v[36:37], 0
    ds_read_b128 v[50:53], v3 offset:32768
    ds_read_b128 v[54:57], v3 offset:36864
    ds_read_b128 v[58:61], v3 offset:40960
    ds_read_b128 v[62:65], v3 offset:45056
L_step_s0r:
    s_waitcnt vmcnt(0)
L_own2_s0r:
    v_max3_u32 v0, v46, v47, v48
    v_max3_u32 v0, v0, v49, v71
    v_cmp_eq_u32 vcc, -1, v0
    ds_write_b128 v3, v[46:49] offset:0
    ds_write_b32 v6, v71 offset:0
    s_cbranch_vccnz L_own_s0r
    global_load_dwordx4 v[66:69], v3, s[32:33] sc1
    global_load_dword v70, v6, s[32:33] sc1
    s_waitcnt lgkmcnt(0)
    s_barrier
    ds_read_b128 v[38:41], v2 offset:0
    ds_read_b128 v[42:45], v2 offset:1024
    ds_read_b128 v[46:49], v2 offset:2048
    s_waitcnt lgkmcnt(2)
    v_smfmac_f32_16x16x64_bf16 v[14:17], v[38:41], a[0:7], v1
    s_lshr_b32 s17, s14, 2
    s_xor_b32 s17, s17, s5
    v_smfmac_f32_16x16x64_bf16 v[18:21], v[38:41], a[8:15], v1
    s_and_b32 s17, s17, 1
    s_lshl_b32 s17, s17, 13
    v_smfmac_f32_16x16x64_bf16 v[22:25], v[38:41], a[160:167], v1
    s_lshl_b32 s18, s14, 19
    s_add_u32 s17, s17, s18
    v_smfmac_f32_16x16x64_bf16 v[26:29], v[38:41], a[168:175], v1
    s_add_u32 s40, s100, s17
    s_addc_u32 s41, s101, 0
    s_add_u32 s17, s14, 1
    v_smfmac_f32_16x16x64_bf16 v[30:33], v[38:41], v[50:57], v1
    ds_read_b128 v[50:53], v3 offset:49152
    s_lshr_b32 s18, s17, 1
    v_smfmac_f32_16x16x64_bf16 v[34:37], v[38:41], v[58:65], v1
    ds_read_b128 v[54:57], v3 offset:53248
    s_xor_b32 s18, s18, s5
    s_waitcnt lgkmcnt(3)
    v_smfmac_f32_16x16x64_bf16 v[14:17], v[42:45], a[16:23], v1
    ds_read_b128 v[58:61], v3 offset:57344
    s_and_b32 s18, s18, 1
    v_smfmac_f32_16x16x64_bf16 v[18:21], v[42:45], a[24:31], v1
    ds_read_b128 v[62:65], v3 offset:61440
    s_lshl_b32 s18, s18, 13
    v_smfmac_f32_16x16x64_bf16 v[22:25], v[42:45], a[176:183], v1
    ds_read_b128 v[38:41], v2 offset:3072
    s_lshl_b32 s17, s17, 20
    v_smfmac_f32_16x16x64_bf16 v[26:29], v[42:45], a[184:191], v1
    s_add_u32 s17, s17, s18
    s_add_u32 s38, s50, s17
    s_addc_u32 s39, s51, 0
    s_waitcnt lgkmcnt(3)
    v_smfmac_f32_16x16x64_bf16 v[30:33], v[42:45], v[50:57], v1
    ds_read_b128 v[50:53], v4 offset:0
    s_add_u32 s22, s38, 0x4000
    s_addc_u32 s23, s39, 0
    s_waitcnt lgkmcnt(2)
    v_smfmac_f32_16x16x64_bf16 v[34:37], v[42:45], v[58:65], v1
    ds_read_b128 v[54:57], v4 offset:4096
    s_add_u32 s17, s14, 3
    v_smfmac_f32_16x16x64_bf16 v[14:17], v[46:49], a[32:39], v1
    ds_read_b128 v[58:61], v4 offset:8192
    s_and_b32 s17, s17, 3
    v_smfmac_f32_16x16x64_bf16 v[18:21], v[46:49], a[40:47], v1
    ds_read_b128 v[62:65], v4 offset:12288
    s_lshl_b32 s18, s17, 13
    v_smfmac_f32_16x16x64_bf16 v[22:25], v[46:49], a[192:199], v1
    ds_read_b128 v[42:45], v2 offset:4096
    s_add_u32 s34, s46, s18
    s_addc_u32 s35, s47, 0
    v_smfmac_f32_16x16x64_bf16 v[26:29], v[46:49], a[200:207], v1
    s_lshl_b32 s17, s17, 15
    s_add_u32 s18, s17, 0
    s_waitcnt lgkmcnt(3)
    v_smfmac_f32_16x16x64_bf16 v[30:33], v[46:49], v[50:57], v1
    ds_read_b128 v[50:53], v4 offset:16384
    s_add_u32 s36, s48, s18
    s_addc_u32 s37, s49, 0
    s_waitcnt lgkmcnt(2)
    v_smfmac_f32_16x16x64_bf16 v[34:37], v[46:49], v[58:65], v1
    ds_read_b128 v[54:57], v4 offset:20480
    s_and_b32 s17, s14, 1
    v_smfmac_f32_16x16x64_bf16 v[14:17], v[38:41], a[48:55], v1
    ds_read_b128 v[58:61], v4 offset:24576
    s_mul_i32 s17, s17, 163840
    v_smfmac_f32_16x16x64_bf16 v[18:21], v[38:41], a[56:63], v1
    ds_read_b128 v[62:65], v4 offset:28672
    s_add_u32 s24, s52, s17
    s_addc_u32 s25, s53, 0
    v_smfmac_f32_16x16x64_bf16 v[22:25], v[38:41], a[208:215], v1
    s_add_u32 s26, s24, 16384
    s_addc_u32 s27, s25, 0
    s_bfe_u32 s15, s14, 0x10001
    v_smfmac_f32_16x16x64_bf16 v[26:29], v[38:41], a[216:223], v1
    s_waitcnt lgkmcnt(2)
    v_smfmac_f32_16x16x64_bf16 v[30:33], v[38:41], v[50:57], v1
    ds_read_b128 v[50:53], v4 offset:32768
    s_waitcnt lgkmcnt(1)
    v_smfmac_f32_16x16x64_bf16 v[34:37], v[38:41], v[58:65], v1
    ds_read_b128 v[54:57], v4 offset:36864
    s_waitcnt vmcnt(0)
L_oth2_s0r:
    v_max3_u32 v0, v66, v67, v68
    v_max3_u32 v0, v0, v69, v70
    v_cmp_eq_u32 vcc, -1, v0
    ds_write_b128 v3, v[66:69] offset:5120
    ds_write_b32 v6, v70 offset:5120
    s_cbranch_vccnz L_oth_s0r
    v_smfmac_f32_16x16x64_bf16 v[14:17], v[42:45], a[64:71], v1
    ds_read_b128 v[58:61], v4 offset:40960
    v_smfmac_f32_16x16x64_bf16 v[18:21], v[42:45], a[72:79], v1
    ds_read_b128 v[62:65], v4 offset:45056
    v_smfmac_f32_16x16x64_bf16 v[22:25], v[42:45], a[224:231], v1
    v_smfmac_f32_16x16x64_bf16 v[26:29], v[42:45], a[232:239], v1
    s_waitcnt lgkmcnt(4)
    v_smfmac_f32_16x16x64_bf16 v[30:33], v[42:45], v[50:57], v1
    s_waitcnt lgkmcnt(0)
    v_smfmac_f32_16x16x64_bf16 v[34:37], v[42:45], v[58:65], v1
    s_barrier
    ds_read_b128 v[46:49], v2 offset:5120
    ds_read_b128 v[38:41], v2 offset:6144
    ds_read_b128 v[42:45], v2 offset:7168
    v_mov_b32 v0, -1
    s_mov_b64 exec, s[58:59]
    global_store_dword v10, v0, s[34:35] sc1
    global_store_dword v10, v0, s[36:37] sc1
    s_mov_b64 exec, -1
    s_waitcnt lgkmcnt(2)
    v_smfmac_f32_16x16x64_bf16 v[14:17], v[46:49], a[80:87], v1
    s_xor_b32 s17, s20, 149504
    v_smfmac_f32_16x16x64_bf16 v[18:21], v[46:49], a[88:95], v1
    s_add_u32 m0, s17, s21
    v_smfmac_f32_16x16x64_bf16 v[22:25], v[46:49], a[240:247], v1
    global_load_lds_dwordx4 v3, s[38:39]
    v_smfmac_f32_16x16x64_bf16 v[26:29], v[46:49], a[248:255], v1
    ds_read_b128 v[46:49], v2 offset:8192
    s_waitcnt lgkmcnt(2)
    v_smfmac_f32_16x16x64_bf16 v[14:17], v[38:41], a[96:103], v1
    s_add_u32 m0, m0, 0x1000
    v_smfmac_f32_16x16x64_bf16 v[18:21], v[38:41], a[104:111], v1
    s_add_u32 s38, s38, 0x1000
    s_addc_u32 s39, s39, 0
    v_smfmac_f32_16x16x64_bf16 v[22:25], v[38:41], v[72:79], v1
    global_load_lds_dwordx4 v3, s[38:39]
    v_smfmac_f32_16x16x64_bf16 v[26:29], v[38:41], v[80:87], v1
    ds_read_b128 v[38:41], v2 offset:9216
    s_waitcnt lgkmcnt(2)
    v_smfmac_f32_16x16x64_bf16 v[14:17], v[42:45], a[112:119], v1
    ds_read_b128 v[58:61], v5 offset:16384
    v_smfmac_f32_16x16x64_bf16 v[18:21], v[42:45], a[120:127], v1
    ds_read_b128 v[62:65], v5 offset:20480
    v_smfmac_f32_16x16x64_bf16 v[22:25], v[42:45], v[88:95], v1
    ds_read_b128 v[50:53], v5 offset:8192
    v_smfmac_f32_16x16x64_bf16 v[26:29], v[42:45], v[96:103], v1
    ds_read_b128 v[54:57], v5 offset:12288
    s_waitcnt lgkmcnt(5)
    v_smfmac_f32_16x16x64_bf16 v[14:17], v[46:49], a[128:135], v1
    v_add_u32 v0, s20, v2
    v_smfmac_f32_16x16x64_bf16 v[18:21], v[46:49], a[136:143], v1
    s_xor_b32 s20, s20, 149504
    v_smfmac_f32_16x16x64_bf16 v[22:25], v[46:49], v[104:111], v1
    v_smfmac_f32_16x16x64_bf16 v[26:29], v[46:49], v[112:119], v1
    s_waitcnt lgkmcnt(4)
    v_smfmac_f32_16x16x64_bf16 v[14:17], v[38:41], a[144:151], v1
    v_smfmac_f32_16x16x64_bf16 v[18:21], v[38:41], a[152:159], v1
    v_smfmac_f32_16x16x64_bf16 v[22:25], v[38:41], v[120:127], v1
    v_smfmac_f32_16x16x64_bf16 v[26:29], v[38:41], v[128:135], v1
    v_smfmac_f32_16x16x64_bf16 v[34:37], v[38:41], v[248:255], v1
    s_waitcnt lgkmcnt(2)
    v_smfmac_f32_16x16x64_bf16 v[30:33], v[38:41], v[58:65], v1
    ds_read_b128 v[58:61], v5 offset:0
    ds_read_b128 v[62:65], v5 offset:4096
    v_pk_add_f32 v[14:15], v[14:15], v[16:17]
    v_pk_add_f32 v[18:19], v[18:19], v[20:21]
    v_pk_mul_f32 v[14:15], v[14:15], s[44:45]
    v_pk_mul_f32 v[18:19], v[18:19], s[44:45]
    v_cvt_pk_bf16_f32 v16, v14, v18
    v_cvt_pk_bf16_f32 v17, v15, v19
    ds_write2_b32 v11, v16, v17 offset0:0 offset1:72
    v_pk_add_f32 v[22:23], v[22:23], v[24:25]
    v_pk_add_f32 v[26:27], v[26:27], v[28:29]
    v_cvt_pk_bf16_f32 v28, v22, v26
    v_cvt_pk_bf16_f32 v29, v23, v27
    v_add_u32 v71, 2304, v11
    ds_write2_b32 v71, v28, v29 offset0:0 offset1:72
    v_smfmac_f32_16x16x64_bf16 v[34:37], v[46:49], v[240:247], v1
    ds_read_b128 v[38:41], v2 offset:5120
    s_waitcnt lgkmcnt(5)
    v_smfmac_f32_16x16x64_bf16 v[30:33], v[46:49], v[50:57], v1
    ds_read_b128 v[50:53], v4 offset:57344
    ds_read_b128 v[54:57], v4 offset:61440
    v_smfmac_f32_16x16x64_bf16 v[34:37], v[42:45], v[232:239], v1
    ds_read_b128 v[46:49], v2 offset:6144
    s_waitcnt lgkmcnt(6)
    v_smfmac_f32_16x16x64_bf16 v[30:33], v[42:45], v[58:65], v1
    ds_read_b128 v[58:61], v4 offset:49152
    ds_read_b128 v[62:65], v4 offset:53248
    s_waitcnt lgkmcnt(6)
    s_barrier
    ds_read_b128 v[66:69], v0 offset:3072
    ds_read_b128 v[42:45], v0 offset:1024
    global_store_dword v11, v28, s[40:41] sc1
    global_store_dword v11, v29, s[40:41] offset:288 sc1
    s_waitcnt lgkmcnt(4)
    v_smfmac_f32_16x16x64_bf16 v[34:37], v[46:49], v[224:231], v1
    v_smfmac_f32_16x16x64_bf16 v[30:33], v[46:49], v[50:57], v1
    ds_read_b128 v[50:53], v12 offset:0
    ds_read_b128 v[54:57], v12 offset:64
    ds_read_b128 v[46:49], v0 offset:2048
    v_smfmac_f32_16x16x64_bf16 v[34:37], v[38:41], v[216:223], v1
    s_waitcnt lgkmcnt(5)
    v_smfmac_f32_16x16x64_bf16 v[30:33], v[38:41], v[58:65], v1
    ds_read_b128 v[58:61], v12 offset:128
    ds_read_b128 v[62:65], v12 offset:192
    ds_read_b128 v[38:41], v0 offset:0
    s_cmp_eq_u32 s14, 63
    s_cbranch_scc1 L_last_s0r
    s_waitcnt lgkmcnt(4)
    v_mfma_f32_16x16x32_bf16 v[14:17], v[42:45], v[54:57], 0
    ds_read_b128 v[42:45], v0 offset:5120
    s_waitcnt lgkmcnt(3)
    v_mfma_f32_16x16x32_bf16 v[14:17], v[46:49], v[58:61], v[14:17]
    ds_read_b128 v[46:49], v0 offset:6144
    v_pk_add_f32 v[30:31], v[30:31], v[32:33]
    v_pk_add_f32 v[34:35], v[34:35], v[36:37]
    s_waitcnt lgkmcnt(3)
    v_mfma_f32_16x16x32_bf16 v[14:17], v[66:69], v[62:65], v[14:17]
    ds_read_b128 v[66:69], v0 offset:7168
    v_cvt_pk_bf16_f32 v32, v30, v31
    v_cvt_pk_bf16_f32 v33, v34, v35
    s_waitcnt lgkmcnt(3)
    v_mfma_f32_16x16x32_bf16 v[14:17], v[38:41], v[50:53], v[14:17]
    ds_read_b128 v[38:41], v0 offset:4096
    v_mov_b32 v34, v33
    v_mov_b32 v35, 0
    s_waitcnt lgkmcnt(3)
    v_mfma_f32_16x16x32_bf16 v[18:21], v[42:45], v[54:57], 0
    ds_read_b128 v[42:45], v12 offset:2368
    s_waitcnt lgkmcnt(3)
    v_mfma_f32_16x16x32_bf16 v[18:21], v[46:49], v[58:61], v[18:21]
    ds_read_b128 v[46:49], v12 offset:2432
    s_waitcnt lgkmcnt(3)
    v_mfma_f32_16x16x32_bf16 v[18:21], v[66:69], v[62:65], v[18:21]
    ds_read_b128 v[66:69], v12 offset:2496
    s_waitcnt lgkmcnt(3)
    v_mfma_f32_16x16x32_bf16 v[18:21], v[38:41], v[50:53], v[18:21]
    ds_read_b128 v[38:41], v12 offset:2304
    v_exp_f32 v36, v14
    v_exp_f32 v37, v15
    v_exp_f32 v71, v16
    v_cvt_pk_bf16_f32 v26, v36, v37
    v_exp_f32 v36, v17
    s_nop 0
    v_cvt_pk_bf16_f32 v27, v71, v36
    s_waitcnt lgkmcnt(3)
    v_mfma_f32_16x16x32_bf16 v[22:25], v[42:45], v[54:57], 0
    ds_read_b128 v[42:45], v3 offset:18432
    s_waitcnt lgkmcnt(3)
    v_mfma_f32_16x16x32_bf16 v[22:25], v[46:49], v[58:61], v[22:25]
    ds_read_b128 v[46:49], v3 offset:22528
    v_exp_f32 v36, v18
    v_exp_f32 v37, v19
    s_waitcnt lgkmcnt(3)
    v_mfma_f32_16x16x32_bf16 v[22:25], v[66:69], v[62:65], v[22:25]
    v_exp_f32 v71, v20
    v_cvt_pk_bf16_f32 v28, v36, v37
    s_waitcnt lgkmcnt(2)
    v_mfma_f32_16x16x32_bf16 v[22:25], v[38:41], v[50:53], v[22:25]
    v_exp_f32 v36, v21
    s_nop 0
    v_cvt_pk_bf16_f32 v29, v71, v36
    v_mov_b64 v[66:67], s[62:63]
    v_mov_b64 v[68:69], s[62:63]
    s_waitcnt lgkmcnt(1)
    v_mfma_f32_16x16x32_bf16 v[54:57], v[42:45], v[26:29], 0
    s_nop 0
    v_exp_f32 v36, v22
    s_waitcnt lgkmcnt(0)
    v_mfma_f32_16x16x32_bf16 v[58:61], v[46:49], v[26:29], 0
    v_exp_f32 v37, v23
    v_mfma_f32_16x16x32_bf16 v[50:53], v[66:69], v[26:29], 0
    v_mov_b32 v31, 0
    v_cvt_pk_bf16_f32 v30, v36, v37
    s_add_u32 m0, s21, 18432
    s_nop 2
    v_mfma_f32_16x16x16_bf16 v[50:53], v[66:67], v[30:31], v[50:53]
    v_mfma_f32_16x16x16_bf16 v[54:57], v[32:33], v[30:31], v[54:57]
    v_mfma_f32_16x16x16_bf16 v[58:61], v[34:35], v[30:31], v[58:61]
    global_load_lds_dwordx4 v3, s[22:23]
    s_add_u32 m0, m0, 0x1000
    s_add_u32 s22, s22, 0x1000
    s_addc_u32 s23, s23, 0
    global_load_lds_dwordx4 v3, s[22:23]
    s_nop 0
    v_rcp_f32 v36, v50
    v_subrev_u32 v0, s54, v50
    v_cmp_lt_u32 vcc, s55, v0
    v_pk_mul_f32 v[54:55], v[54:55], v[36:37] op_sel_hi:[1,0]
    v_pk_mul_f32 v[58:59], v[58:59], v[36:37] op_sel_hi:[1,0]
    v_pk_mul_f32 v[56:57], v[56:57], v[36:37] op_sel_hi:[1,0]
    v_pk_mul_f32 v[60:61], v[60:61], v[36:37] op_sel_hi:[1,0]
    v_cvt_pk_bf16_f32 v62, v54, v58
    v_cvt_pk_bf16_f32 v63, v55, v59
    v_cvt_pk_bf16_f32 v64, v56, v60
    v_cvt_pk_bf16_f32 v65, v57, v61
    s_cbranch_vccnz L_fb_s0r
L_norm_s0r:
    s_mov_b64 exec, s[70:71]
    ds_write_b128 v13, v[62:65] offset:5120
    s_mov_b64 exec, -1
    v_mov_b64 v[14:15], 0
    v_mov_b64 v[16:17], 0
    v_mov_b64 v[18:19], 0
    v_mov_b64 v[20:21], 0
    v_mov_b64 v[22:23], 0
    v_mov_b64 v[24:25], 0
    v_mov_b64 v[26:27], 0
    v_mov_b64 v[28:29], 0
    v_mov_b64 v[30:31], 0
    v_mov_b64 v[32:33], 0
    s_waitcnt lgkmcnt(0)
    s_barrier
    ds_read_b128 v[38:41], v2 offset:5120
    ds_read_b128 v[42:45], v2 offset:6144
    ds_read_b128 v[46:49], v3 offset:26624
    s_add_u32 s14, s14, 1
    s_add_u32 s17, s14, 0
    s_and_b32 s17, s17, 3
    s_lshl_b32 s18, s17, 13
    s_add_u32 s28, s46, s18
    s_addc_u32 s29, s47, 0
    s_lshl_b32 s17, s17, 15
    s_add_u32 s18, s17, 0
    s_add_u32 s30, s48, s18
    s_addc_u32 s31, s49, 0
    s_add_u32 s18, s17, 16384
    s_add_u32 s32, s48, s18
    s_addc_u32 s33, s49, 0
    s_waitcnt lgkmcnt(2)
    v_smfmac_f32_16x16x64_bf16 v[14:17], v[38:41], v[136:143], v1
    s_waitcnt lgkmcnt(1)
    v_smfmac_f32_16x16x64_bf16 v[14:17], v[42:45], v[144:151], v1
    v_smfmac_f32_16x16x64_bf16 v[18:21], v[38:41], v[152:159], v1
    v_smfmac_f32_16x16x64_bf16 v[18:21], v[42:45], v[160:167], v1
    v_smfmac_f32_16x16x64_bf16 v[22:25], v[38:41], v[168:175], v1
    v_smfmac_f32_16x16x64_bf16 v[22:25], v[42:45], v[176:183], v1
    v_smfmac_f32_16x16x64_bf16 v[26:29], v[38:41], v[184:191], v1
    v_smfmac_f32_16x16x64_bf16 v[26:29], v[42:45], v[192:199], v1
    s_nop 1
    v_pk_add_f32 v[14:15], v[14:15], v[16:17]
    s_nop 0
    v_pk_add_f32 v[18:19], v[18:19], v[20:21]
    v_smfmac_f32_16x16x64_bf16 v[30:33], v[38:41], v[200:207], v1
    v_cvt_pk_bf16_f32 v16, v14, v18
    v_cvt_pk_bf16_f32 v17, v15, v19
    v_smfmac_f32_16x16x64_bf16 v[30:33], v[42:45], v[208:215], v1
    v_and_or_b32 v16, v16, -2, s15
    v_and_or_b32 v17, v17, -2, s15
    global_store_dwordx2 v7, v[16:17], s[24:25] sc1
    v_pk_add_f32 v[22:23], v[22:23], v[24:25]
    v_pk_add_f32 v[26:27], v[26:27], v[28:29]
    v_cvt_pk_bf16_f32 v24, v22, v26
    v_cvt_pk_bf16_f32 v25, v23, v27
    v_and_or_b32 v24, v24, -2, s15
    v_and_or_b32 v25, v25, -2, s15
    global_store_dwordx2 v7, v[24:25], s[26:27] sc1
    v_pk_add_f32 v[30:31], v[30:31], v[32:33]
    v_cvt_pk_bf16_f32 v32, v30, v31
    v_and_or_b32 v32, v32, -2, s15
    global_store_dword v8, v32, s[24:25] sc1
    s_waitcnt lgkmcnt(0)
    s_waitcnt vmcnt(0)
L_pa2_s0r:
    global_load_dwordx4 v[38:41], v9, s[24:25] sc1
    global_load_dwordx4 v[42:45], v9, s[24:25] offset:1024 sc1
    s_waitcnt vmcnt(1)
    v_mfma_f32_16x16x32_bf16 v[50:53], v[38:41], v[46:49], 0
    v_bitop3_b32 v0, v38, v39, s15 bitop3:0x7e
    v_bitop3_b32 v71, v40, v41, s15 bitop3:0x7e
    s_waitcnt vmcnt(0)
    v_mfma_f32_16x16x32_bf16 v[50:53], v[42:45], v[46:49], v[50:53]
    v_bitop3_b32 v66, v42, v43, s15 bitop3:0x7e
    v_bitop3_b32 v67, v44, v45, s15 bitop3:0x7e
    v_or3_b32 v0, v0, v71, v66
    v_bitop3_b32 v0, v0, v67, 1 bitop3:0xa8
    v_cmp_ne_u32 vcc, 0, v0
    s_nop 2
    v_pk_add_f32 v[50:51], v[50:51], v[52:53]
    v_add_f32 v50, v50, v51
    s_cbranch_vccnz L_pa_s0r
    s_nop 0
    v_mov_b32_dpp v51, v50 quad_perm:[1,1,3,3] row_mask:0xf bank_mask:0xf
    v_cvt_pk_bf16_f32 v50, v50, v51
    v_min_u32 v50, -2, v50
    s_mov_b64 exec, s[58:59]
    global_store_dword v10, v50, s[28:29] sc1
    global_store_dword v10, v50, s[30:31] sc1
    s_mov_b64 exec, -1
    s_waitcnt vmcnt(1)
    s_barrier
    global_load_dwordx4 v[46:49], v3, s[28:29] sc1
    global_load_dword v71, v6, s[28:29] sc1
    v_mov_b64 v[14:15], 0
    v_mov_b64 v[16:17], 0
    v_mov_b64 v[18:19], 0
    v_mov_b64 v[20:21], 0
    v_mov_b64 v[22:23], 0
    v_mov_b64 v[24:25], 0
    v_mov_b64 v[26:27], 0
    v_mov_b64 v[28:29], 0
    v_mov_b64 v[30:31], 0
    v_mov_b64 v[32:33], 0
    v_mov_b64 v[34:35], 0
    v_mov_b64 v[36:37], 0
    ds_read_b128 v[50:53], v3 offset:32768
    ds_read_b128 v[54:57], v3 offset:36864
    ds_read_b128 v[58:61], v3 offset:40960
    ds_read_b128 v[62:65], v3 offset:45056
    s_branch L_step_s0r
L_own_s0r:
    s_add_u32 s16, s16, 1
    s_cmp_gt_u32 s16, 1048576
    s_cbranch_scc1 L_bail5
    s_waitcnt lgkmcnt(0)
    global_load_dwordx4 v[46:49], v3, s[28:29] sc1
    global_load_dword v71, v6, s[28:29] sc1
    s_waitcnt vmcnt(0)
    s_branch L_own2_s0r
L_oth_s0r:
    s_add_u32 s16, s16, 1
    s_cmp_gt_u32 s16, 1048576
    s_cbranch_scc1 L_bail6
    s_waitcnt lgkmcnt(0)
    global_load_dwordx4 v[66:69], v3, s[32:33] sc1
    global_load_dword v70, v6, s[32:33] sc1
    s_waitcnt vmcnt(0)
    s_branch L_oth2_s0r
L_pa_s0r:
    s_add_u32 s16, s16, 1
    s_cmp_gt_u32 s16, 1048576
    s_cbranch_scc1 L_bail8
    s_branch L_pa2_s0r
L_fb_s0r:
    v_max3_f32 v0, v14, v15, v16
    v_max3_f32 v0, v0, v17, v18
    v_max3_f32 v0, v0, v19, v20
    v_max3_f32 v0, v0, v21, v22
    v_max3_f32 v0, v0, v23, v24
    v_max_f32 v0, v0, v25
    v_mov_b32 v36, v0
    s_nop 1
    v_permlane16_swap_b32 v0, v36
    v_max_f32 v0, v0, v36
    v_mov_b32 v36, v0
    s_nop 1
    v_permlane32_swap_b32 v0, v36
    v_max_f32 v0, v0, v36
    v_sub_f32 v14, v14, v0
    v_sub_f32 v15, v15, v0
    v_sub_f32 v16, v16, v0
    v_sub_f32 v17, v17, v0
    v_sub_f32 v18, v18, v0
    v_sub_f32 v19, v19, v0
    v_sub_f32 v20, v20, v0
    v_sub_f32 v21, v21, v0
    v_sub_f32 v22, v22, v0
    v_sub_f32 v23, v23, v0
    v_sub_f32 v24, v24, v0
    v_sub_f32 v25, v25, v0
    v_exp_f32 v36, v14
    v_exp_f32 v37, v15
    v_exp_f32 v71, v16
    v_cvt_pk_bf16_f32 v26, v36, v37
    v_exp_f32 v36, v17
    s_nop 0
    v_cvt_pk_bf16_f32 v27, v71, v36
    v_exp_f32 v36, v18
    v_exp_f32 v37, v19
    v_exp_f32 v71, v20
    v_cvt_pk_bf16_f32 v28, v36, v37
    v_exp_f32 v36, v21
    s_nop 0
    v_cvt_pk_bf16_f32 v29, v71, v36
    v_exp_f32 v36, v22
    v_exp_f32 v37, v23
    v_mov_b32 v31, 0
    v_cvt_pk_bf16_f32 v30, v36, v37
    v_mfma_f32_16x16x32_bf16 v[50:53], v[66:69], v[26:29], 0
    v_mfma_f32_16x16x32_bf16 v[54:57], v[42:45], v[26:29], 0
    v_mfma_f32_16x16x32_bf16 v[58:61], v[46:49], v[26:29], 0
    s_nop 3
    v_mfma_f32_16x16x16_bf16 v[50:53], v[66:67], v[30:31], v[50:53]
    v_mfma_f32_16x16x16_bf16 v[54:57], v[32:33], v[30:31], v[54:57]
    v_mfma_f32_16x16x16_bf16 v[58:61], v[34:35], v[30:31], v[58:61]
    s_nop 5
    v_rcp_f32 v36, v50
    s_nop 0
    v_pk_mul_f32 v[54:55], v[54:55], v[36:37] op_sel_hi:[1,0]
    v_pk_mul_f32 v[58:59], v[58:59], v[36:37] op_sel_hi:[1,0]
    v_pk_mul_f32 v[56:57], v[56:57], v[36:37] op_sel_hi:[1,0]
    v_pk_mul_f32 v[60:61], v[60:61], v[36:37] op_sel_hi:[1,0]
    v_cvt_pk_bf16_f32 v62, v54, v58
    v_cvt_pk_bf16_f32 v63, v55, v59
    v_cvt_pk_bf16_f32 v64, v56, v60
    v_cvt_pk_bf16_f32 v65, v57, v61
    s_branch L_norm_s0r
L_last_s0r:
    s_nop 2
    v_pk_add_f32 v[30:31], v[30:31], v[32:33]
    v_pk_add_f32 v[34:35], v[34:35], v[36:37]
    v_cvt_pk_bf16_f32 v32, v30, v31
    v_cvt_pk_bf16_f32 v33, v34, v35
    v_mov_b32 v34, v33
    v_mov_b32 v35, 0
    s_waitcnt vmcnt(0) lgkmcnt(0)
    s_barrier
    s_branch L_chain_end
L_var7:
    s_add_u32 s17, s14, 0
    s_and_b32 s17, s17, 3
    s_lshl_b32 s18, s17, 13
    s_add_u32 s28, s46, s18
    s_addc_u32 s29, s47, 0
    s_lshl_b32 s17, s17, 15
    s_add_u32 s18, s17, 16384
    s_add_u32 s32, s48, s18
    s_addc_u32 s33, s49, 0
    global_load_dwordx4 v[46:49], v3, s[28:29] sc1
    global_load_dword v71, v6, s[28:29] sc1
    v_mov_b64 v[14:15], 0
    v_mov_b64 v[16:17], 0
    v_mov_b64 v[18:19], 0
    v_mov_b64 v[20:21], 0
    v_mov_b64 v[22:23], 0
    v_mov_b64 v[24:25], 0
    v_mov_b64 v[26:27], 0
    v_mov_b64 v[28:29], 0
    v_mov_b64 v[30:31], 0
    v_mov_b64 v[32:33], 0
    v_mov_b64 v[34:35], 0
    v_mov_b64 v[36:37], 0
    ds_read_b128 v[50:53], v3 offset:32768
    ds_read_b128 v[54:57], v3 offset:36864
    ds_read_b128 v[58:61], v3 offset:40960
    ds_read_b128 v[62:65], v3 offset:45056
L_step_s0i:
    s_waitcnt vmcnt(0)
L_own2_s0i:
    v_max3_u32 v0, v46, v47, v48
    v_max3_u32 v0, v0, v49, v71
    v_cmp_eq_u32 vcc, -1, v0
    ds_write_b128 v3, v[46:49] offset:0
    ds_write_b32 v6, v71 offset:0
    s_cbranch_vccnz L_own_s0i
    global_load_dwordx4 v[66:69], v3, s[32:33] sc1
    global_load_dword v70, v6, s[32:33] sc1
    s_waitcnt lgkmcnt(0)
    s_barrier
    ds_read_b128 v[38:41], v2 offset:0
    ds_read_b128 v[42:45], v2 offset:1024
    ds_read_b128 v[46:49], v2 offset:2048
    s_waitcnt lgkmcnt(2)
    v_smfmac_f32_16x16x64_bf16 v[14:17], v[38:41], a[0:7], v1
    s_lshr_b32 s17, s14, 2
    s_xor_b32 s17, s17, s5
    v_smfmac_f32_16x16x64_bf16 v[18:21], v[38:41], a[8:15], v1
    s_and_b32 s17, s17, 1
    s_lshl_b32 s17, s17, 13
    v_smfmac_f32_16x16x64_bf16 v[22:25], v[38:41], a[160:167], v1
    s_lshl_b32 s18, s14, 19
    s_add_u32 s17, s17, s18
    v_smfmac_f32_16x16x64_bf16 v[26:29], v[38:41], a[168:175], v1
    s_add_u32 s40, s100, s17
    s_addc_u32 s41, s101, 0
    s_add_u32 s17, s14, 1
    v_smfmac_f32_16x16x64_bf16 v[30:33], v[38:41], v[50:57], v1
    ds_read_b128 v[50:53], v3 offset:49152
    s_lshr_b32 s18, s17, 1
    v_smfmac_f32_16x16x64_bf16 v[34:37], v[38:41], v[58:65], v1
    ds_read_b128 v[54:57], v3 offset:53248
    s_xor_b32 s18, s18, s5
    s_waitcnt lgkmcnt(3)
    v_smfmac_f32_16x16x64_bf16 v[14:17], v[42:45], a[16:23], v1
    ds_read_b128 v[58:61], v3 offset:57344
    s_and_b32 s18, s18, 1
    v_smfmac_f32_16x16x64_bf16 v[18:21], v[42:45], a[24:31], v1
    ds_read_b128 v[62:65], v3 offset:61440
    s_lshl_b32 s18, s18, 13
    v_smfmac_f32_16x16x64_bf16 v[22:25], v[42:45], a[176:183], v1
    ds_read_b128 v[38:41], v2 offset:3072
    s_lshl_b32 s17, s17, 20
    v_smfmac_f32_16x16x64_bf16 v[26:29], v[42:45], a[184:191], v1
    s_add_u32 s17, s17, s18
    s_add_u32 s38, s50, s17
    s_addc_u32 s39, s51, 0
    s_waitcnt lgkmcnt(3)
    v_smfmac_f32_16x16x64_bf16 v[30:33], v[42:45], v[50:57], v1
    ds_read_b128 v[50:53], v4 offset:0
    s_add_u32 s22, s38, 0x4000
    s_addc_u32 s23, s39, 0
    s_waitcnt lgkmcnt(2)
    v_smfmac_f32_16x16x64_bf16 v[34:37], v[42:45], v[58:65], v1
    ds_read_b128 v[54:57], v4 offset:4096
    s_and_b32 s17, s14, 1
    v_smfmac_f32_16x16x64_bf16 v[14:17], v[46:49], a[32:39], v1
    ds_read_b128 v[58:61], v4 offset:8192
    s_mul_i32 s17, s17, 163840
    v_smfmac_f32_16x16x64_bf16 v[18:21], v[46:49], a[40:47], v1
    ds_read_b128 v[62:65], v4 offset:12288
    s_add_u32 s24, s52, s17
    s_addc_u32 s25, s53, 0
    v_smfmac_f32_16x16x64_bf16 v[22:25], v[46:49], a[192:199], v1
    ds_read_b128 v[42:45], v2 offset:4096
    s_add_u32 s26, s24, 16384
    s_addc_u32 s27, s25, 0
    v_smfmac_f32_16x16x64_bf16 v[26:29], v[46:49], a[200:207], v1
    s_bfe_u32 s15, s14, 0x10001
    s_waitcnt lgkmcnt(3)
    v_smfmac_f32_16x16x64_bf16 v[30:33], v[46:49], v[50:57], v1
    ds_read_b128 v[50:53], v4 offset:16384
    s_waitcnt lgkmcnt(2)
    v_smfmac_f32_16x16x64_bf16 v[34:37], v[46:49], v[58:65], v1
    ds_read_b128 v[54:57], v4 offset:20480
    v_smfmac_f32_16x16x64_bf16 v[14:17], v[38:41], a[48:55], v1
    ds_read_b128 v[58:61], v4 offset:24576
    v_smfmac_f32_16x16x64_bf16 v[18:21], v[38:41], a[56:63], v1
    ds_read_b128 v[62:65], v4 offset:28672
    v_smfmac_f32_16x16x64_bf16 v[22:25], v[38:41], a[208:215], v1
    v_smfmac_f32_16x16x64_bf16 v[26:29], v[38:41], a[216:223], v1
    s_waitcnt lgkmcnt(2)
    v_smfmac_f32_16x16x64_bf16 v[30:33], v[38:41], v[50:57], v1
    ds_read_b128 v[50:53], v4 offset:32768
    s_waitcnt lgkmcnt(1)
    v_smfmac_f32_16x16x64_bf16 v[34:37], v[38:41], v[58:65], v1
    ds_read_b128 v[54:57], v4 offset:36864
    s_waitcnt vmcnt(0)
L_oth2_s0i:
    v_max3_u32 v0, v66, v67, v68
    v_max3_u32 v0, v0, v69, v70
    v_cmp_eq_u32 vcc, -1, v0
    ds_write_b128 v3, v[66:69] offset:5120
    ds_write_b32 v6, v70 offset:5120
    s_cbranch_vccnz L_oth_s0i
    v_smfmac_f32_16x16x64_bf16 v[14:17], v[42:45], a[64:71], v1
    ds_read_b128 v[58:61], v4 offset:40960
    v_smfmac_f32_16x16x64_bf16 v[18:21], v[42:45], a[72:79], v1
    ds_read_b128 v[62:65], v4 offset:45056
    v_smfmac_f32_16x16x64_bf16 v[22:25], v[42:45], a[224:231], v1
    v_smfmac_f32_16x16x64_bf16 v[26:29], v[42:45], a[232:239], v1
    s_waitcnt lgkmcnt(4)
    v_smfmac_f32_16x16x64_bf16 v[30:33], v[42:45], v[50:57], v1
    s_waitcnt lgkmcnt(0)
    v_smfmac_f32_16x16x64_bf16 v[34:37], v[42:45], v[58:65], v1
    s_barrier
    ds_read_b128 v[46:49], v2 offset:5120
    ds_read_b128 v[38:41], v2 offset:6144
    ds_read_b128 v[42:45], v2 offset:7168
    s_waitcnt lgkmcnt(2)
    v_smfmac_f32_16x16x64_bf16 v[14:17], v[46:49], a[80:87], v1
    s_xor_b32 s17, s20, 149504
    v_smfmac_f32_16x16x64_bf16 v[18:21], v[46:49], a[88:95], v1
    s_add_u32 m0, s17, s21
    v_smfmac_f32_16x16x64_bf16 v[22:25], v[46:49], a[240:247], v1
    global_load_lds_dwordx4 v3, s[38:39]
    v_smfmac_f32_16x16x64_bf16 v[26:29], v[46:49], a[248:255], v1
    ds_read_b128 v[46:49], v2 offset:8192
    s_waitcnt lgkmcnt(2)
    v_smfmac_f32_16x16x64_bf16 v[14:17], v[38:41], a[96:103], v1
    s_add_u32 m0, m0, 0x1000
    v_smfmac_f32_16x16x64_bf16 v[18:21], v[38:41], a[104:111], v1
    s_add_u32 s38, s38, 0x1000
    s_addc_u32 s39, s39, 0
    v_smfmac_f32_16x16x64_bf16 v[22:25], v[38:41], v[72:79], v1
    global_load_lds_dwordx4 v3, s[38:39]
    v_smfmac_f32_16x16x64_bf16 v[26:29], v[38:41], v[80:87], v1
    ds_read_b128 v[38:41], v2 offset:9216
    s_waitcnt lgkmcnt(2)
    v_smfmac_f32_16x16x64_bf16 v[14:17], v[42:45], a[112:119], v1
    ds_read_b128 v[58:61], v5 offset:16384
    v_smfmac_f32_16x16x64_bf16 v[18:21], v[42:45], a[120:127], v1
    ds_read_b128 v[62:65], v5 offset:20480
    v_smfmac_f32_16x16x64_bf16 v[22:25], v[42:45], v[88:95], v1
    ds_read_b128 v[50:53], v5 offset:8192
    v_smfmac_f32_16x16x64_bf16 v[26:29], v[42:45], v[96:103], v1
    ds_read_b128 v[54:57], v5 offset:12288
    s_waitcnt lgkmcnt(5)
    v_smfmac_f32_16x16x64_bf16 v[14:17], v[46:49], a[128:135], v1
    v_add_u32 v0, s20, v2
    v_smfmac_f32_16x16x64_bf16 v[18:21], v[46:49], a[136:143], v1
    s_xor_b32 s20, s20, 149504
    v_smfmac_f32_16x16x64_bf16 v[22:25], v[46:49], v[104:111], v1
    v_smfmac_f32_16x16x64_bf16 v[26:29], v[46:49], v[112:119], v1
    s_waitcnt lgkmcnt(4)
    v_smfmac_f32_16x16x64_bf16 v[14:17], v[38:41], a[144:151], v1
    v_smfmac_f32_16x16x64_bf16 v[18:21], v[38:41], a[152:159], v1
    v_smfmac_f32_16x16x64_bf16 v[22:25], v[38:41], v[120:127], v1
    v_smfmac_f32_16x16x64_bf16 v[26:29], v[38:41], v[128:135], v1
    v_smfmac_f32_16x16x64_bf16 v[34:37], v[38:41], v[248:255], v1
    s_waitcnt lgkmcnt(2)
    v_smfmac_f32_16x16x64_bf16 v[30:33], v[38:41], v[58:65], v1
    ds_read_b128 v[58:61], v5 offset:0
    ds_read_b128 v[62:65], v5 offset:4096
    v_pk_add_f32 v[14:15], v[14:15], v[16:17]
    v_pk_add_f32 v[18:19], v[18:19], v[20:21]
    v_pk_mul_f32 v[14:15], v[14:15], s[44:45]
    v_pk_mul_f32 v[18:19], v[18:19], s[44:45]
    v_cvt_pk_bf16_f32 v16, v14, v18
    v_cvt_pk_bf16_f32 v17, v15, v19
    ds_write2_b32 v11, v16, v17 offset0:0 offset1:72
    v_pk_add_f32 v[22:23], v[22:23], v[24:25]
    v_pk_add_f32 v[26:27], v[26:27], v[28:29]
    v_cvt_pk_bf16_f32 v28, v22, v26
    v_cvt_pk_bf16_f32 v29, v23, v27
    v_add_u32 v71, 2304, v11
    ds_write2_b32 v71, v28, v29 offset0:0 offset1:72
    v_smfmac_f32_16x16x64_bf16 v[34:37], v[46:49], v[240:247], v1
    ds_read_b128 v[38:41], v2 offset:5120
    s_waitcnt lgkmcnt(5)
    v_smfmac_f32_16x16x64_bf16 v[30:33], v[46:49], v[50:57], v1
    ds_read_b128 v[50:53], v4 offset:57344
    ds_read_b128 v[54:57], v4 offset:61440
    v_smfmac_f32_16x16x64_bf16 v[34:37], v[42:45], v[232:239], v1
    ds_read_b128 v[46:49], v2 offset:6144
    s_waitcnt lgkmcnt(6)
    v_smfmac_f32_16x16x64_bf16 v[30:33], v[42:45], v[58:65], v1
    ds_read_b128 v[58:61], v4 offset:49152
    ds_read_b128 v[62:65], v4 offset:53248
    s_waitcnt lgkmcnt(6)
    s_barrier
    ds_read_b128 v[66:69], v0 offset:3072
    ds_read_b128 v[42:45], v0 offset:1024
    global_store_dword v11, v28, s[40:41] sc1
    global_store_dword v11, v29, s[40:41] offset:288 sc1
    s_waitcnt lgkmcnt(4)
    v_smfmac_f32_16x16x64_bf16 v[34:37], v[46:49], v[224:231], v1
    v_smfmac_f32_16x16x64_bf16 v[30:33], v[46:49], v[50:57], v1
    ds_read_b128 v[50:53], v12 offset:0
    ds_read_b128 v[54:57], v12 offset:64
    ds_read_b128 v[46:49], v0 offset:2048
    v_smfmac_f32_16x16x64_bf16 v[34:37], v[38:41], v[216:223], v1
    s_waitcnt lgkmcnt(5)
    v_smfmac_f32_16x16x64_bf16 v[30:33], v[38:41], v[58:65], v1
    ds_read_b128 v[58:61], v12 offset:128
    ds_read_b128 v[62:65], v12 offset:192
    ds_read_b128 v[38:41], v0 offset:0
    s_cmp_eq_u32 s14, 63
    s_cbranch_scc1 L_last_s0i
    s_waitcnt lgkmcnt(4)
    v_mfma_f32_16x16x32_bf16 v[14:17], v[42:45], v[54:57], 0
    ds_read_b128 v[42:45], v0 offset:5120
    s_waitcnt lgkmcnt(3)
    v_mfma_f32_16x16x32_bf16 v[14:17], v[46:49], v[58:61], v[14:17]
    ds_read_b128 v[46:49], v0 offset:6144
    v_pk_add_f32 v[30:31], v[30:31], v[32:33]
    v_pk_add_f32 v[34:35], v[34:35], v[36:37]
    s_waitcnt lgkmcnt(3)
    v_mfma_f32_16x16x32_bf16 v[14:17], v[66:69], v[62:65], v[14:17]
    ds_read_b128 v[66:69], v0 offset:7168
    v_cvt_pk_bf16_f32 v32, v30, v31
    v_cvt_pk_bf16_f32 v33, v34, v35
    s_waitcnt lgkmcnt(3)
    v_mfma_f32_16x16x32_bf16 v[14:17], v[38:41], v[50:53], v[14:17]
    ds_read_b128 v[38:41], v0 offset:4096
    v_mov_b32 v34, v33
    v_mov_b32 v35, 0
    s_waitcnt lgkmcnt(3)
    v_mfma_f32_16x16x32_bf16 v[18:21], v[42:45], v[54:57], 0
    ds_read_b128 v[42:45], v12 offset:2368
    s_waitcnt lgkmcnt(3)
    v_mfma_f32_16x16x32_bf16 v[18:21], v[46:49], v[58:61], v[18:21]
    ds_read_b128 v[46:49], v12 offset:2432
    s_waitcnt lgkmcnt(3)
    v_mfma_f32_16x16x32_bf16 v[18:21], v[66:69], v[62:65], v[18:21]
    ds_read_b128 v[66:69], v12 offset:2496
    s_waitcnt lgkmcnt(3)
    v_mfma_f32_16x16x32_bf16 v[18:21], v[38:41], v[50:53], v[18:21]
    ds_read_b128 v[38:41], v12 offset:2304
    v_exp_f32 v36, v14
    v_exp_f32 v37, v15
    v_exp_f32 v71, v16
    v_cvt_pk_bf16_f32 v26, v36, v37
    v_exp_f32 v36, v17
    s_nop 0
    v_cvt_pk_bf16_f32 v27, v71, v36
    s_waitcnt lgkmcnt(3)
    v_mfma_f32_16x16x32_bf16 v[22:25], v[42:45], v[54:57], 0
    ds_read_b128 v[42:45], v3 offset:18432
    s_waitcnt lgkmcnt(3)
    v_mfma_f32_16x16x32_bf16 v[22:25], v[46:49], v[58:61], v[22:25]
    ds_read_b128 v[46:49], v3 offset:22528
    v_exp_f32 v36, v18
    v_exp_f32 v37, v19
    s_waitcnt lgkmcnt(3)
    v_mfma_f32_16x16x32_bf16 v[22:25], v[66:69], v[62:65], v[22:25]
    v_exp_f32 v71, v20
    v_cvt_pk_bf16_f32 v28, v36, v37
    s_waitcnt lgkmcnt(2)
    v_mfma_f32_16x16x32_bf16 v[22:25], v[38:41], v[50:53], v[22:25]
    v_exp_f32 v36, v21
    s_nop 0
    v_cvt_pk_bf16_f32 v29, v71, v36
    v_mov_b64 v[66:67], s[62:63]
    v_mov_b64 v[68:69], s[62:63]
    s_waitcnt lgkmcnt(1)
    v_mfma_f32_16x16x32_bf16 v[54:57], v[42:45], v[26:29], 0
    s_nop 0
    v_exp_f32 v36, v22
    s_waitcnt lgkmcnt(0)
    v_mfma_f32_16x16x32_bf16 v[58:61], v[46:49], v[26:29], 0
    v_exp_f32 v37, v23
    v_mfma_f32_16x16x32_bf16 v[50:53], v[66:69], v[26:29], 0
    v_mov_b32 v31, 0
    v_cvt_pk_bf16_f32 v30, v36, v37
    s_add_u32 m0, s21, 18432
    s_nop 2
    v_mfma_f32_16x16x16_bf16 v[50:53], v[66:67], v[30:31], v[50:53]
    v_mfma_f32_16x16x16_bf16 v[54:57], v[32:33], v[30:31], v[54:57]
    v_mfma_f32_16x16x16_bf16 v[58:61], v[34:35], v[30:31], v[58:61]
    global_load_lds_dwordx4 v3, s[22:23]
    s_add_u32 m0, m0, 0x1000
    s_add_u32 s22, s22, 0x1000
    s_addc_u32 s23, s23, 0
    global_load_lds_dwordx4 v3, s[22:23]
    s_nop 0
    v_rcp_f32 v36, v50
    v_subrev_u32 v0, s54, v50
    v_cmp_lt_u32 vcc, s55, v0
    v_pk_mul_f32 v[54:55], v[54:55], v[36:37] op_sel_hi:[1,0]
    v_pk_mul_f32 v[58:59], v[58:59], v[36:37] op_sel_hi:[1,0]
    v_pk_mul_f32 v[56:57], v[56:57], v[36:37] op_sel_hi:[1,0]
    v_pk_mul_f32 v[60:61], v[60:61], v[36:37] op_sel_hi:[1,0]
    v_cvt_pk_bf16_f32 v62, v54, v58
    v_cvt_pk_bf16_f32 v63, v55, v59
    v_cvt_pk_bf16_f32 v64, v56, v60
    v_cvt_pk_bf16_f32 v65, v57, v61
    s_cbranch_vccnz L_fb_s0i
L_norm_s0i:
    s_mov_b64 exec, s[70:71]
    ds_write_b128 v13, v[62:65] offset:5120
    s_mov_b64 exec, -1
    v_mov_b64 v[14:15], 0
    v_mov_b64 v[16:17], 0
    v_mov_b64 v[18:19], 0
    v_mov_b64 v[20:21], 0
    v_mov_b64 v[22:23], 0
    v_mov_b64 v[24:25], 0
    v_mov_b64 v[26:27], 0
    v_mov_b64 v[28:29], 0
    v_mov_b64 v[30:31], 0
    v_mov_b64 v[32:33], 0
    s_waitcnt lgkmcnt(0)
    s_barrier
    ds_read_b128 v[38:41], v2 offset:5120
    ds_read_b128 v[42:45], v2 offset:6144
    s_add_u32 s14, s14, 1
    s_add_u32 s17, s14, 0
    s_and_b32 s17, s17, 3
    s_lshl_b32 s18, s17, 13
    s_add_u32 s28, s46, s18
    s_addc_u32 s29, s47, 0
    s_lshl_b32 s17, s17, 15
    s_add_u32 s18, s17, 16384
    s_add_u32 s32, s48, s18
    s_addc_u32 s33, s49, 0
    s_waitcnt lgkmcnt(1)
    v_smfmac_f32_16x16x64_bf16 v[14:17], v[38:41], v[136:143], v1
    s_waitcnt lgkmcnt(0)
    v_smfmac_f32_16x16x64_bf16 v[14:17], v[42:45], v[144:151], v1
    v_smfmac_f32_16x16x64_bf16 v[18:21], v[38:41], v[152:159], v1
    v_smfmac_f32_16x16x64_bf16 v[18:21], v[42:45], v[160:167], v1
    v_smfmac_f32_16x16x64_bf16 v[22:25], v[38:41], v[168:175], v1
    v_smfmac_f32_16x16x64_bf16 v[22:25], v[42:45], v[176:183], v1
    v_smfmac_f32_16x16x64_bf16 v[26:29], v[38:41], v[184:191], v1
    v_smfmac_f32_16x16x64_bf16 v[26:29], v[42:45], v[192:199], v1
    s_nop 1
    v_pk_add_f32 v[14:15], v[14:15], v[16:17]
    s_nop 0
    v_pk_add_f32 v[18:19], v[18:19], v[20:21]
    v_smfmac_f32_16x16x64_bf16 v[30:33], v[38:41], v[200:207], v1
    v_cvt_pk_bf16_f32 v16, v14, v18
    v_cvt_pk_bf16_f32 v17, v15, v19
    v_smfmac_f32_16x16x64_bf16 v[30:33], v[42:45], v[208:215], v1
    v_and_or_b32 v16, v16, -2, s15
    v_and_or_b32 v17, v17, -2, s15
    global_store_dwordx2 v7, v[16:17], s[24:25] sc1
    v_pk_add_f32 v[22:23], v[22:23], v[24:25]
    v_pk_add_f32 v[26:27], v[26:27], v[28:29]
    v_cvt_pk_bf16_f32 v24, v22, v26
    v_cvt_pk_bf16_f32 v25, v23, v27
    v_and_or_b32 v24, v24, -2, s15
    v_and_or_b32 v25, v25, -2, s15
    global_store_dwordx2 v7, v[24:25], s[26:27] sc1
    v_pk_add_f32 v[30:31], v[30:31], v[32:33]
    v_cvt_pk_bf16_f32 v32, v30, v31
    v_and_or_b32 v32, v32, -2, s15
    global_store_dword v8, v32, s[24:25] sc1
    s_waitcnt lgkmcnt(0)
    s_barrier
    global_load_dwordx4 v[46:49], v3, s[28:29] sc1
    global_load_dword v71, v6, s[28:29] sc1
    v_mov_b64 v[14:15], 0
    v_mov_b64 v[16:17], 0
    v_mov_b64 v[18:19], 0
    v_mov_b64 v[20:21], 0
    v_mov_b64 v[22:23], 0
    v_mov_b64 v[24:25], 0
    v_mov_b64 v[26:27], 0
    v_mov_b64 v[28:29], 0
    v_mov_b64 v[30:31], 0
    v_mov_b64 v[32:33], 0
    v_mov_b64 v[34:35], 0
    v_mov_b64 v[36:37], 0
    ds_read_b128 v[50:53], v3 offset:32768
    ds_read_b128 v[54:57], v3 offset:36864
    ds_read_b128 v[58:61], v3 offset:40960
    ds_read_b128 v[62:65], v3 offset:45056
    s_branch L_step_s0i
L_own_s0i:
    s_add_u32 s16, s16, 1
    s_cmp_gt_u32 s16, 1048576
    s_cbranch_scc1 L_bail5
    s_waitcnt lgkmcnt(0)
    global_load_dwordx4 v[46:49], v3, s[28:29] sc1
    global_load_dword v71, v6, s[28:29] sc1
    s_waitcnt vmcnt(0)
    s_branch L_own2_s0i
L_oth_s0i:
    s_add_u32 s16, s16, 1
    s_cmp_gt_u32 s16, 1048576
    s_cbranch_scc1 L_bail6
    s_waitcnt lgkmcnt(0)
    global_load_dwordx4 v[66:69], v3, s[32:33] sc1
    global_load_dword v70, v6, s[32:33] sc1
    s_waitcnt vmcnt(0)
    s_branch L_oth2_s0i
L_fb_s0i:
    v_max3_f32 v0, v14, v15, v16
    v_max3_f32 v0, v0, v17, v18
    v_max3_f32 v0, v0, v19, v20
    v_max3_f32 v0, v0, v21, v22
    v_max3_f32 v0, v0, v23, v24
    v_max_f32 v0, v0, v25
    v_mov_b32 v36, v0
    s_nop 1
    v_permlane16_swap_b32 v0, v36
    v_max_f32 v0, v0, v36
    v_mov_b32 v36, v0
    s_nop 1
    v_permlane32_swap_b32 v0, v36
    v_max_f32 v0, v0, v36
    v_sub_f32 v14, v14, v0
    v_sub_f32 v15, v15, v0
    v_sub_f32 v16, v16, v0
    v_sub_f32 v17, v17, v0
    v_sub_f32 v18, v18, v0
    v_sub_f32 v19, v19, v0
    v_sub_f32 v20, v20, v0
    v_sub_f32 v21, v21, v0
    v_sub_f32 v22, v22, v0
    v_sub_f32 v23, v23, v0
    v_sub_f32 v24, v24, v0
    v_sub_f32 v25, v25, v0
    v_exp_f32 v36, v14
    v_exp_f32 v37, v15
    v_exp_f32 v71, v16
    v_cvt_pk_bf16_f32 v26, v36, v37
    v_exp_f32 v36, v17
    s_nop 0
    v_cvt_pk_bf16_f32 v27, v71, v36
    v_exp_f32 v36, v18
    v_exp_f32 v37, v19
    v_exp_f32 v71, v20
    v_cvt_pk_bf16_f32 v28, v36, v37
    v_exp_f32 v36, v21
    s_nop 0
    v_cvt_pk_bf16_f32 v29, v71, v36
    v_exp_f32 v36, v22
    v_exp_f32 v37, v23
    v_mov_b32 v31, 0
    v_cvt_pk_bf16_f32 v30, v36, v37
    v_mfma_f32_16x16x32_bf16 v[50:53], v[66:69], v[26:29], 0
    v_mfma_f32_16x16x32_bf16 v[54:57], v[42:45], v[26:29], 0
    v_mfma_f32_16x16x32_bf16 v[58:61], v[46:49], v[26:29], 0
    s_nop 3
    v_mfma_f32_16x16x16_bf16 v[50:53], v[66:67], v[30:31], v[50:53]
    v_mfma_f32_16x16x16_bf16 v[54:57], v[32:33], v[30:31], v[54:57]
    v_mfma_f32_16x16x16_bf16 v[58:61], v[34:35], v[30:31], v[58:61]
    s_nop 5
    v_rcp_f32 v36, v50
    s_nop 0
    v_pk_mul_f32 v[54:55], v[54:55], v[36:37] op_sel_hi:[1,0]
    v_pk_mul_f32 v[58:59], v[58:59], v[36:37] op_sel_hi:[1,0]
    v_pk_mul_f32 v[56:57], v[56:57], v[36:37] op_sel_hi:[1,0]
    v_pk_mul_f32 v[60:61], v[60:61], v[36:37] op_sel_hi:[1,0]
    v_cvt_pk_bf16_f32 v62, v54, v58
    v_cvt_pk_bf16_f32 v63, v55, v59
    v_cvt_pk_bf16_f32 v64, v56, v60
    v_cvt_pk_bf16_f32 v65, v57, v61
    s_branch L_norm_s0i
L_last_s0i:
    s_nop 2
    v_pk_add_f32 v[30:31], v[30:31], v[32:33]
    v_pk_add_f32 v[34:35], v[34:35], v[36:37]
    v_cvt_pk_bf16_f32 v32, v30, v31
    v_cvt_pk_bf16_f32 v33, v34, v35
    v_mov_b32 v34, v33
    v_mov_b32 v35, 0
    s_waitcnt vmcnt(0) lgkmcnt(0)
    s_barrier
    s_branch L_chain_end
L_var8:
    s_add_u32 s17, s14, 0
    s_and_b32 s17, s17, 3
    s_lshl_b32 s18, s17, 13
    s_add_u32 s28, s46, s18
    s_addc_u32 s29, s47, 0
    s_lshl_b32 s17, s17, 15
    s_add_u32 s18, s17, 16384
    s_add_u32 s32, s48, s18
    s_addc_u32 s33, s49, 0
    global_load_dwordx4 v[46:49], v3, s[28:29] sc1
    global_load_dword v71, v6, s[28:29] sc1
    v_mov_b64 v[14:15], 0
    v_mov_b64 v[16:17], 0
    v_mov_b64 v[18:19], 0
    v_mov_b64 v[20:21], 0
    v_mov_b64 v[22:23], 0
    v_mov_b64 v[24:25], 0
    v_mov_b64 v[26:27], 0
    v_mov_b64 v[28:29], 0
    v_mov_b64 v[30:31], 0
    v_mov_b64 v[32:33], 0
    v_mov_b64 v[34:35], 0
    v_mov_b64 v[36:37], 0
    ds_read_b128 v[50:53], v3 offset:32768
    ds_read_b128 v[54:57], v3 offset:36864
    ds_read_b128 v[58:61], v3 offset:40960
    ds_read_b128 v[62:65], v3 offset:45056
L_step_s0g:
    s_waitcnt vmcnt(0)
L_own2_s0g:
    v_max3_u32 v0, v46, v47, v48
    v_max3_u32 v0, v0, v49, v71
    v_cmp_eq_u32 vcc, -1, v0
    ds_write_b128 v3, v[46:49] offset:0
    ds_write_b32 v6, v71 offset:0
    s_cbranch_vccnz L_own_s0g
    global_load_dwordx4 v[66:69], v3, s[32:33] sc1
    global_load_dword v70, v6, s[32:33] sc1
    s_waitcnt lgkmcnt(0)
    s_barrier
    ds_read_b128 v[38:41], v2 offset:0
    ds_read_b128 v[42:45], v2 offset:1024
    ds_read_b128 v[46:49], v2 offset:2048
    s_waitcnt lgkmcnt(2)
    v_smfmac_f32_16x16x64_bf16 v[14:17], v[38:41], a[0:7], v1
    s_lshr_b32 s17, s14, 2
    s_xor_b32 s17, s17, s5
    v_smfmac_f32_16x16x64_bf16 v[18:21], v[38:41], a[8:15], v1
    s_and_b32 s17, s17, 1
    s_lshl_b32 s17, s17, 13
    v_smfmac_f32_16x16x64_bf16 v[22:25], v[38:41], a[160:167], v1
    s_lshl_b32 s18, s14, 19
    s_add_u32 s17, s17, s18
    v_smfmac_f32_16x16x64_bf16 v[26:29], v[38:41], a[168:175], v1
    s_add_u32 s40, s100, s17
    s_addc_u32 s41, s101, 0
    s_add_u32 s17, s14, 1
    v_smfmac_f32_16x16x64_bf16 v[30:33], v[38:41], v[50:57], v1
    ds_read_b128 v[50:53], v3 offset:49152
    s_lshr_b32 s18, s17, 1
    v_smfmac_f32_16x16x64_bf16 v[34:37], v[38:41], v[58:65], v1
    ds_read_b128 v[54:57], v3 offset:53248
    s_xor_b32 s18, s18, s5
    s_waitcnt lgkmcnt(3)
    v_smfmac_f32_16x16x64_bf16 v[14:17], v[42:45], a[16:23], v1
    ds_read_b128 v[58:61], v3 offset:57344
    s_and_b32 s18, s18, 1
    v_smfmac_f32_16x16x64_bf16 v[18:21], v[42:45], a[24:31], v1
    ds_read_b128 v[62:65], v3 offset:61440
    s_lshl_b32 s18, s18, 13
    v_smfmac_f32_16x16x64_bf16 v[22:25], v[42:45], a[176:183], v1
    ds_read_b128 v[38:41], v2 offset:3072
    s_lshl_b32 s17, s17, 20
    v_smfmac_f32_16x16x64_bf16 v[26:29], v[42:45], a[184:191], v1
    s_add_u32 s17, s17, s18
    s_add_u32 s38, s50, s17
    s_addc_u32 s39, s51, 0
    s_waitcnt lgkmcnt(3)
    v_smfmac_f32_16x16x64_bf16 v[30:33], v[42:45], v[50:57], v1
    ds_read_b128 v[50:53], v4 offset:0
    s_add_u32 s22, s38, 0x4000
    s_addc_u32 s23, s39, 0
    s_waitcnt lgkmcnt(2)
    v_smfmac_f32_16x16x64_bf16 v[34:37], v[42:45], v[58:65], v1
    ds_read_b128 v[54:57], v4 offset:4096
    s_and_b32 s17, s14, 1
    v_smfmac_f32_16x16x64_bf16 v[14:17], v[46:49], a[32:39], v1
    ds_read_b128 v[58:61], v4 offset:8192
    s_mul_i32 s17, s17, 163840
    v_smfmac_f32_16x16x64_bf16 v[18:21], v[46:49], a[40:47], v1
    ds_read_b128 v[62:65], v4 offset:12288
    s_add_u32 s24, s52, s17
    s_addc_u32 s25, s53, 0
    v_smfmac_f32_16x16x64_bf16 v[22:25], v[46:49], a[192:199], v1
    ds_read_b128 v[42:45], v2 offset:4096
    s_add_u32 s26, s24, 16384
    s_addc_u32 s27, s25, 0
    v_smfmac_f32_16x16x64_bf16 v[26:29], v[46:49], a[200:207], v1
    s_bfe_u32 s15, s14, 0x10001
    s_add_u32 s60, s14, 3
    s_waitcnt lgkmcnt(3)
    v_smfmac_f32_16x16x64_bf16 v[30:33], v[46:49], v[50:57], v1
    ds_read_b128 v[50:53], v4 offset:16384
    s_min_u32 s60, s60, 64
    s_waitcnt lgkmcnt(2)
    v_smfmac_f32_16x16x64_bf16 v[34:37], v[46:49], v[58:65], v1
    ds_read_b128 v[54:57], v4 offset:20480
    v_smfmac_f32_16x16x64_bf16 v[14:17], v[38:41], a[48:55], v1
    ds_read_b128 v[58:61], v4 offset:24576
    v_smfmac_f32_16x16x64_bf16 v[18:21], v[38:41], a[56:63], v1
    ds_read_b128 v[62:65], v4 offset:28672
    v_smfmac_f32_16x16x64_bf16 v[22:25], v[38:41], a[208:215], v1
    v_smfmac_f32_16x16x64_bf16 v[26:29], v[38:41], a[216:223], v1
    s_waitcnt lgkmcnt(2)
    v_smfmac_f32_16x16x64_bf16 v[30:33], v[38:41], v[50:57], v1
    ds_read_b128 v[50:53], v4 offset:32768
    s_waitcnt lgkmcnt(1)
    v_smfmac_f32_16x16x64_bf16 v[34:37], v[38:41], v[58:65], v1
    ds_read_b128 v[54:57], v4 offset:36864
    s_waitcnt vmcnt(0)
L_oth2_s0g:
    v_max3_u32 v0, v66, v67, v68
    v_max3_u32 v0, v0, v69, v70
    v_cmp_eq_u32 vcc, -1, v0
    ds_write_b128 v3, v[66:69] offset:5120
    ds_write_b32 v6, v70 offset:5120
    s_cbranch_vccnz L_oth_s0g
    v_smfmac_f32_16x16x64_bf16 v[14:17], v[42:45], a[64:71], v1
    ds_read_b128 v[58:61], v4 offset:40960
    v_smfmac_f32_16x16x64_bf16 v[18:21], v[42:45], a[72:79], v1
    ds_read_b128 v[62:65], v4 offset:45056
    v_smfmac_f32_16x16x64_bf16 v[22:25], v[42:45], a[224:231], v1
    v_smfmac_f32_16x16x64_bf16 v[26:29], v[42:45], a[232:239], v1
    s_waitcnt lgkmcnt(4)
    v_smfmac_f32_16x16x64_bf16 v[30:33], v[42:45], v[50:57], v1
    s_waitcnt lgkmcnt(0)
    v_smfmac_f32_16x16x64_bf16 v[34:37], v[42:45], v[58:65], v1
    s_barrier
    ds_read_b128 v[46:49], v2 offset:5120
    ds_read_b128 v[38:41], v2 offset:6144
    ds_read_b128 v[42:45], v2 offset:7168
    s_mov_b64 exec, 3
    v_lshlrev_b32 v0, 8, v2
    global_load_dword v70, v0, s[56:57] sc1
    s_mov_b64 exec, 1
    v_mov_b32 v71, s14
    global_store_dword v2, v71, s[42:43] sc1
    s_mov_b64 exec, -1
    s_waitcnt lgkmcnt(2)
    v_smfmac_f32_16x16x64_bf16 v[14:17], v[46:49], a[80:87], v1
    s_xor_b32 s17, s20, 149504
    v_smfmac_f32_16x16x64_bf16 v[18:21], v[46:49], a[88:95], v1
    s_add_u32 m0, s17, s21
    v_smfmac_f32_16x16x64_bf16 v[22:25], v[46:49], a[240:247], v1
    global_load_lds_dwordx4 v3, s[38:39]
    v_smfmac_f32_16x16x64_bf16 v[26:29], v[46:49], a[248:255], v1
    ds_read_b128 v[46:49], v2 offset:8192
    s_waitcnt lgkmcnt(2)
    v_smfmac_f32_16x16x64_bf16 v[14:17], v[38:41], a[96:103], v1
    s_add_u32 m0, m0, 0x1000
    v_smfmac_f32_16x16x64_bf16 v[18:21], v[38:41], a[104:111], v1
    s_add_u32 s38, s38, 0x1000
    s_addc_u32 s39, s39, 0
    v_smfmac_f32_16x16x64_bf16 v[22:25], v[38:41], v[72:79], v1
    global_load_lds_dwordx4 v3, s[38:39]
    v_smfmac_f32_16x16x64_bf16 v[26:29], v[38:41], v[80:87], v1
    ds_read_b128 v[38:41], v2 offset:9216
    s_waitcnt lgkmcnt(2)
    v_smfmac_f32_16x16x64_bf16 v[14:17], v[42:45], a[112:119], v1
    ds_read_b128 v[58:61], v5 offset:16384
    v_smfmac_f32_16x16x64_bf16 v[18:21], v[42:45], a[120:127], v1
    ds_read_b128 v[62:65], v5 offset:20480
    v_smfmac_f32_16x16x64_bf16 v[22:25], v[42:45], v[88:95], v1
    ds_read_b128 v[50:53], v5 offset:8192
    v_smfmac_f32_16x16x64_bf16 v[26:29], v[42:45], v[96:103], v1
    ds_read_b128 v[54:57], v5 offset:12288
    s_waitcnt lgkmcnt(5)
    v_smfmac_f32_16x16x64_bf16 v[14:17], v[46:49], a[128:135], v1
    v_add_u32 v0, s20, v2
    v_smfmac_f32_16x16x64_bf16 v[18:21], v[46:49], a[136:143], v1
    s_xor_b32 s20, s20, 149504
    v_smfmac_f32_16x16x64_bf16 v[22:25], v[46:49], v[104:111], v1
    v_smfmac_f32_16x16x64_bf16 v[26:29], v[46:49], v[112:119], v1
    s_waitcnt lgkmcnt(4)
    v_smfmac_f32_16x16x64_bf16 v[14:17], v[38:41], a[144:151], v1
    v_smfmac_f32_16x16x64_bf16 v[18:21], v[38:41], a[152:159], v1
    v_smfmac_f32_16x16x64_bf16 v[22:25], v[38:41], v[120:127], v1
    v_smfmac_f32_16x16x64_bf16 v[26:29], v[38:41], v[128:135], v1
    v_smfmac_f32_16x16x64_bf16 v[34:37], v[38:41], v[248:255], v1
    s_waitcnt lgkmcnt(2)
    v_smfmac_f32_16x16x64_bf16 v[30:33], v[38:41], v[58:65], v1
    ds_read_b128 v[58:61], v5 offset:0
    ds_read_b128 v[62:65], v5 offset:4096
    v_pk_add_f32 v[14:15], v[14:15], v[16:17]
    v_pk_add_f32 v[18:19], v[18:19], v[20:21]
    v_pk_mul_f32 v[14:15], v[14:15], s[44:45]
    v_pk_mul_f32 v[18:19], v[18:19], s[44:45]
    v_cvt_pk_bf16_f32 v16, v14, v18
    v_cvt_pk_bf16_f32 v17, v15, v19
    ds_write2_b32 v11, v16, v17 offset0:0 offset1:72
    v_pk_add_f32 v[22:23], v[22:23], v[24:25]
    v_pk_add_f32 v[26:27], v[26:27], v[28:29]
    v_cvt_pk_bf16_f32 v28, v22, v26
    v_cvt_pk_bf16_f32 v29, v23, v27
    v_add_u32 v71, 2304, v11
    ds_write2_b32 v71, v28, v29 offset0:0 offset1:72
    v_smfmac_f32_16x16x64_bf16 v[34:37], v[46:49], v[240:247], v1
    ds_read_b128 v[38:41], v2 offset:5120
    s_waitcnt lgkmcnt(5)
    v_smfmac_f32_16x16x64_bf16 v[30:33], v[46:49], v[50:57], v1
    ds_read_b128 v[50:53], v4 offset:57344
    ds_read_b128 v[54:57], v4 offset:61440
    v_smfmac_f32_16x16x64_bf16 v[34:37], v[42:45], v[232:239], v1
    ds_read_b128 v[46:49], v2 offset:6144
    s_waitcnt lgkmcnt(6)
    v_smfmac_f32_16x16x64_bf16 v[30:33], v[42:45], v[58:65], v1
    ds_read_b128 v[58:61], v4 offset:49152
    ds_read_b128 v[62:65], v4 offset:53248
    s_waitcnt lgkmcnt(6)
    s_barrier
    ds_read_b128 v[66:69], v0 offset:3072
    ds_read_b128 v[42:45], v0 offset:1024
    global_store_dword v11, v28, s[40:41] sc1
    global_store_dword v11, v29, s[40:41] offset:288 sc1
    s_waitcnt lgkmcnt(4)
    v_smfmac_f32_16x16x64_bf16 v[34:37], v[46:49], v[224:231], v1
    v_smfmac_f32_16x16x64_bf16 v[30:33], v[46:49], v[50:57], v1
    ds_read_b128 v[50:53], v12 offset:0
    ds_read_b128 v[54:57], v12 offset:64
    ds_read_b128 v[46:49], v0 offset:2048
    v_smfmac_f32_16x16x64_bf16 v[34:37], v[38:41], v[216:223], v1
    s_waitcnt lgkmcnt(5)
    v_smfmac_f32_16x16x64_bf16 v[30:33], v[38:41], v[58:65], v1
    ds_read_b128 v[58:61], v12 offset:128
    ds_read_b128 v[62:65], v12 offset:192
    ds_read_b128 v[38:41], v0 offset:0
    s_cmp_eq_u32 s14, 63
    s_cbranch_scc1 L_last_s0g
    s_waitcnt lgkmcnt(4)
    v_mfma_f32_16x16x32_bf16 v[14:17], v[42:45], v[54:57], 0
    ds_read_b128 v[42:45], v0 offset:5120
    s_waitcnt lgkmcnt(3)
    v_mfma_f32_16x16x32_bf16 v[14:17], v[46:49], v[58:61], v[14:17]
    ds_read_b128 v[46:49], v0 offset:6144
    v_pk_add_f32 v[30:31], v[30:31], v[32:33]
    v_pk_add_f32 v[34:35], v[34:35], v[36:37]
    s_waitcnt lgkmcnt(3)
    v_mfma_f32_16x16x32_bf16 v[14:17], v[66:69], v[62:65], v[14:17]
    ds_read_b128 v[66:69], v0 offset:7168
    v_cvt_pk_bf16_f32 v32, v30, v31
    v_cvt_pk_bf16_f32 v33, v34, v35
    s_waitcnt lgkmcnt(3)
    v_mfma_f32_16x16x32_bf16 v[14:17], v[38:41], v[50:53], v[14:17]
    ds_read_b128 v[38:41], v0 offset:4096
    v_mov_b32 v34, v33
    v_mov_b32 v35, 0
    s_waitcnt lgkmcnt(3)
    v_mfma_f32_16x16x32_bf16 v[18:21], v[42:45], v[54:57], 0
    ds_read_b128 v[42:45], v12 offset:2368
    s_waitcnt lgkmcnt(3)
    v_mfma_f32_16x16x32_bf16 v[18:21], v[46:49], v[58:61], v[18:21]
    ds_read_b128 v[46:49], v12 offset:2432
    s_waitcnt lgkmcnt(3)
    v_mfma_f32_16x16x32_bf16 v[18:21], v[66:69], v[62:65], v[18:21]
    ds_read_b128 v[66:69], v12 offset:2496
    s_waitcnt lgkmcnt(3)
    v_mfma_f32_16x16x32_bf16 v[18:21], v[38:41], v[50:53], v[18:21]
    ds_read_b128 v[38:41], v12 offset:2304
    v_exp_f32 v36, v14
    v_exp_f32 v37, v15
    v_exp_f32 v71, v16
    v_cvt_pk_bf16_f32 v26, v36, v37
    v_exp_f32 v36, v17
    s_nop 0
    v_cvt_pk_bf16_f32 v27, v71, v36
    s_waitcnt lgkmcnt(3)
    v_mfma_f32_16x16x32_bf16 v[22:25], v[42:45], v[54:57], 0
    ds_read_b128 v[42:45], v3 offset:18432
    s_waitcnt lgkmcnt(3)
    v_mfma_f32_16x16x32_bf16 v[22:25], v[46:49], v[58:61], v[22:25]
    ds_read_b128 v[46:49], v3 offset:22528
    v_exp_f32 v36, v18
    v_exp_f32 v37, v19
    s_waitcnt lgkmcnt(3)
    v_mfma_f32_16x16x32_bf16 v[22:25], v[66:69], v[62:65], v[22:25]
    v_exp_f32 v71, v20
    v_cvt_pk_bf16_f32 v28, v36, v37
    s_waitcnt lgkmcnt(2)
    v_mfma_f32_16x16x32_bf16 v[22:25], v[38:41], v[50:53], v[22:25]
    v_exp_f32 v36, v21
    s_nop 0
    v_cvt_pk_bf16_f32 v29, v71, v36
    v_mov_b64 v[66:67], s[62:63]
    v_mov_b64 v[68:69], s[62:63]
    s_waitcnt lgkmcnt(1)
    v_mfma_f32_16x16x32_bf16 v[54:57], v[42:45], v[26:29], 0
    s_nop 0
    v_exp_f32 v36, v22
    s_waitcnt lgkmcnt(0)
    v_mfma_f32_16x16x32_bf16 v[58:61], v[46:49], v[26:29], 0
    v_exp_f32 v37, v23
    v_mfma_f32_16x16x32_bf16 v[50:53], v[66:69], v[26:29], 0
    v_mov_b32 v31, 0
    v_cvt_pk_bf16_f32 v30, v36, v37
    s_add_u32 m0, s21, 18432
    s_nop 2
    v_mfma_f32_16x16x16_bf16 v[50:53], v[66:67], v[30:31], v[50:53]
    v_mfma_f32_16x16x16_bf16 v[54:57], v[32:33], v[30:31], v[54:57]
    v_mfma_f32_16x16x16_bf16 v[58:61], v[34:35], v[30:31], v[58:61]
    global_load_lds_dwordx4 v3, s[22:23]
    s_add_u32 m0, m0, 0x1000
    s_add_u32 s22, s22, 0x1000
    s_addc_u32 s23, s23, 0
    global_load_lds_dwordx4 v3, s[22:23]
    s_nop 0
    v_rcp_f32 v36, v50
    v_subrev_u32 v0, s54, v50
    v_cmp_lt_u32 vcc, s55, v0
    v_pk_mul_f32 v[54:55], v[54:55], v[36:37] op_sel_hi:[1,0]
    v_pk_mul_f32 v[58:59], v[58:59], v[36:37] op_sel_hi:[1,0]
    v_pk_mul_f32 v[56:57], v[56:57], v[36:37] op_sel_hi:[1,0]
    v_pk_mul_f32 v[60:61], v[60:61], v[36:37] op_sel_hi:[1,0]
    v_cvt_pk_bf16_f32 v62, v54, v58
    v_cvt_pk_bf16_f32 v63, v55, v59
    v_cvt_pk_bf16_f32 v64, v56, v60
    v_cvt_pk_bf16_f32 v65, v57, v61
    s_cbranch_vccnz L_fb_s0g
L_norm_s0g:
    s_mov_b64 exec, s[70:71]
    ds_write_b128 v13, v[62:65] offset:5120
    s_mov_b64 exec, -1
    v_mov_b64 v[14:15], 0
    v_mov_b64 v[16:17], 0
    v_mov_b64 v[18:19], 0
    v_mov_b64 v[20:21], 0
    v_mov_b64 v[22:23], 0
    v_mov_b64 v[24:25], 0
    v_mov_b64 v[26:27], 0
    v_mov_b64 v[28:29], 0
    v_mov_b64 v[30:31], 0
    v_mov_b64 v[32:33], 0
    s_mov_b64 exec, 3
    s_waitcnt vmcnt(7)
L_kv2_s0g:
    v_cmp_gt_u32 vcc, s60, v70
    s_nop 0
    s_cbranch_vccnz L_kv_s0g
    s_mov_b64 exec, -1
    s_waitcnt lgkmcnt(0)
    s_barrier
    ds_read_b128 v[38:41], v2 offset:5120
    ds_read_b128 v[42:45], v2 offset:6144
    s_add_u32 s14, s14, 1
    s_add_u32 s17, s14, 0
    s_and_b32 s17, s17, 3
    s_lshl_b32 s18, s17, 13
    s_add_u32 s28, s46, s18
    s_addc_u32 s29, s47, 0
    s_lshl_b32 s17, s17, 15
    s_add_u32 s18, s17, 16384
    s_add_u32 s32, s48, s18
    s_addc_u32 s33, s49, 0
    s_waitcnt lgkmcnt(1)
    v_smfmac_f32_16x16x64_bf16 v[14:17], v[38:41], v[136:143], v1
    s_waitcnt lgkmcnt(0)
    v_smfmac_f32_16x16x64_bf16 v[14:17], v[42:45], v[144:151], v1
    v_smfmac_f32_16x16x64_bf16 v[18:21], v[38:41], v[152:159], v1
    v_smfmac_f32_16x16x64_bf16 v[18:21], v[42:45], v[160:167], v1
    v_smfmac_f32_16x16x64_bf16 v[22:25], v[38:41], v[168:175], v1
    v_smfmac_f32_16x16x64_bf16 v[22:25], v[42:45], v[176:183], v1
    v_smfmac_f32_16x16x64_bf16 v[26:29], v[38:41], v[184:191], v1
    v_smfmac_f32_16x16x64_bf16 v[26:29], v[42:45], v[192:199], v1
    s_nop 1
    v_pk_add_f32 v[14:15], v[14:15], v[16:17]
    s_nop 0
    v_pk_add_f32 v[18:19], v[18:19], v[20:21]
    v_smfmac_f32_16x16x64_bf16 v[30:33], v[38:41], v[200:207], v1
    v_cvt_pk_bf16_f32 v16, v14, v18
    v_cvt_pk_bf16_f32 v17, v15, v19
    v_smfmac_f32_16x16x64_bf16 v[30:33], v[42:45], v[208:215], v1
    v_and_or_b32 v16, v16, -2, s15
    v_and_or_b32 v17, v17, -2, s15
    global_store_dwordx2 v7, v[16:17], s[24:25] sc1
    v_pk_add_f32 v[22:23], v[22:23], v[24:25]
    v_pk_add_f32 v[26:27], v[26:27], v[28:29]
    v_cvt_pk_bf16_f32 v24, v22, v26
    v_cvt_pk_bf16_f32 v25, v23, v27
    v_and_or_b32 v24, v24, -2, s15
    v_and_or_b32 v25, v25, -2, s15
    global_store_dwordx2 v7, v[24:25], s[26:27] sc1
    v_pk_add_f32 v[30:31], v[30:31], v[32:33]
    v_cvt_pk_bf16_f32 v32, v30, v31
    v_and_or_b32 v32, v32, -2, s15
    global_store_dword v8, v32, s[24:25] sc1
    s_waitcnt lgkmcnt(0)
    s_barrier
    global_load_dwordx4 v[46:49], v3, s[28:29] sc1
    global_load_dword v71, v6, s[28:29] sc1
    v_mov_b64 v[14:15], 0
    v_mov_b64 v[16:17], 0
    v_mov_b64 v[18:19], 0
    v_mov_b64 v[20:21], 0
    v_mov_b64 v[22:23], 0
    v_mov_b64 v[24:25], 0
    v_mov_b64 v[26:27], 0
    v_mov_b64 v[28:29], 0
    v_mov_b64 v[30:31], 0
    v_mov_b64 v[32:33], 0
    v_mov_b64 v[34:35], 0
    v_mov_b64 v[36:37], 0
    ds_read_b128 v[50:53], v3 offset:32768
    ds_read_b128 v[54:57], v3 offset:36864
    ds_read_b128 v[58:61], v3 offset:40960
    ds_read_b128 v[62:65], v3 offset:45056
    s_branch L_step_s0g
L_own_s0g:
    s_add_u32 s16, s16, 1
    s_cmp_gt_u32 s16, 1048576
    s_cbranch_scc1 L_bail5
    s_waitcnt lgkmcnt(0)
    global_load_dwordx4 v[46:49], v3, s[28:29] sc1
    global_load_dword v71, v6, s[28:29] sc1
    s_waitcnt vmcnt(0)
    s_branch L_own2_s0g
L_oth_s0g:
    s_add_u32 s16, s16, 1
    s_cmp_gt_u32 s16, 1048576
    s_cbranch_scc1 L_bail6
    s_waitcnt lgkmcnt(0)
    global_load_dwordx4 v[66:69], v3, s[32:33] sc1
    global_load_dword v70, v6, s[32:33] sc1
    s_waitcnt vmcnt(0)
    s_branch L_oth2_s0g
L_kv_s0g:
    s_add_u32 s16, s16, 1
    s_cmp_gt_u32 s16, 1048576
    s_cbranch_scc1 L_bail7
    v_lshlrev_b32 v0, 8, v2
    global_load_dword v70, v0, s[56:57] sc1
    s_waitcnt vmcnt(0)
    s_branch L_kv2_s0g
L_fb_s0g:
    v_max3_f32 v0, v14, v15, v16
    v_max3_f32 v0, v0, v17, v18
    v_max3_f32 v0, v0, v19, v20
    v_max3_f32 v0, v0, v21, v22
    v_max3_f32 v0, v0, v23, v24
    v_max_f32 v0, v0, v25
    v_mov_b32 v36, v0
    s_nop 1
    v_permlane16_swap_b32 v0, v36
    v_max_f32 v0, v0, v36
    v_mov_b32 v36, v0
    s_nop 1
    v_permlane32_swap_b32 v0, v36
    v_max_f32 v0, v0, v36
    v_sub_f32 v14, v14, v0
    v_sub_f32 v15, v15, v0
    v_sub_f32 v16, v16, v0
    v_sub_f32 v17, v17, v0
    v_sub_f32 v18, v18, v0
    v_sub_f32 v19, v19, v0
    v_sub_f32 v20, v20, v0
    v_sub_f32 v21, v21, v0
    v_sub_f32 v22, v22, v0
    v_sub_f32 v23, v23, v0
    v_sub_f32 v24, v24, v0
    v_sub_f32 v25, v25, v0
    v_exp_f32 v36, v14
    v_exp_f32 v37, v15
    v_exp_f32 v71, v16
    v_cvt_pk_bf16_f32 v26, v36, v37
    v_exp_f32 v36, v17
    s_nop 0
    v_cvt_pk_bf16_f32 v27, v71, v36
    v_exp_f32 v36, v18
    v_exp_f32 v37, v19
    v_exp_f32 v71, v20
    v_cvt_pk_bf16_f32 v28, v36, v37
    v_exp_f32 v36, v21
    s_nop 0
    v_cvt_pk_bf16_f32 v29, v71, v36
    v_exp_f32 v36, v22
    v_exp_f32 v37, v23
    v_mov_b32 v31, 0
    v_cvt_pk_bf16_f32 v30, v36, v37
    v_mfma_f32_16x16x32_bf16 v[50:53], v[66:69], v[26:29], 0
    v_mfma_f32_16x16x32_bf16 v[54:57], v[42:45], v[26:29], 0
    v_mfma_f32_16x16x32_bf16 v[58:61], v[46:49], v[26:29], 0
    s_nop 3
    v_mfma_f32_16x16x16_bf16 v[50:53], v[66:67], v[30:31], v[50:53]
    v_mfma_f32_16x16x16_bf16 v[54:57], v[32:33], v[30:31], v[54:57]
    v_mfma_f32_16x16x16_bf16 v[58:61], v[34:35], v[30:31], v[58:61]
    s_nop 5
    v_rcp_f32 v36, v50
    s_nop 0
    v_pk_mul_f32 v[54:55], v[54:55], v[36:37] op_sel_hi:[1,0]
    v_pk_mul_f32 v[58:59], v[58:59], v[36:37] op_sel_hi:[1,0]
    v_pk_mul_f32 v[56:57], v[56:57], v[36:37] op_sel_hi:[1,0]
    v_pk_mul_f32 v[60:61], v[60:61], v[36:37] op_sel_hi:[1,0]
    v_cvt_pk_bf16_f32 v62, v54, v58
    v_cvt_pk_bf16_f32 v63, v55, v59
    v_cvt_pk_bf16_f32 v64, v56, v60
    v_cvt_pk_bf16_f32 v65, v57, v61
    s_branch L_norm_s0g
L_last_s0g:
    s_nop 2
    v_pk_add_f32 v[30:31], v[30:31], v[32:33]
    v_pk_add_f32 v[34:35], v[34:35], v[36:37]
    v_cvt_pk_bf16_f32 v32, v30, v31
    v_cvt_pk_bf16_f32 v33, v34, v35
    v_mov_b32 v34, v33
    v_mov_b32 v35, 0
    s_waitcnt vmcnt(0) lgkmcnt(0)
    s_barrier
    s_mov_b64 exec, 1
    v_mov_b32 v0, 0
    v_mov_b32 v1, 64
    global_store_dword v0, v1, s[42:43] sc1
    s_waitcnt vmcnt(0)
    s_mov_b64 exec, -1
    s_branch L_chain_end
L_var9:
    s_add_u32 s17, s14, 0
    s_and_b32 s17, s17, 3
    s_lshl_b32 s18, s17, 13
    s_add_u32 s28, s46, s18
    s_addc_u32 s29, s47, 0
    s_lshl_b32 s17, s17, 15
    s_add_u32 s18, s17, 0
    s_add_u32 s32, s48, s18
    s_addc_u32 s33, s49, 0
    global_load_dwordx4 v[46:49], v3, s[28:29] sc1
    global_load_dword v71, v6, s[28:29] sc1
    v_mov_b64 v[14:15], 0
    v_mov_b64 v[16:17], 0
    v_mov_b64 v[18:19], 0
    v_mov_b64 v[20:21], 0
    v_mov_b64 v[22:23], 0
    v_mov_b64 v[24:25], 0
    v_mov_b64 v[26:27], 0
    v_mov_b64 v[28:29], 0
    v_mov_b64 v[30:31], 0
    v_mov_b64 v[32:33], 0
    v_mov_b64 v[34:35], 0
    v_mov_b64 v[36:37], 0
    ds_read_b128 v[50:53], v3 offset:32768
    ds_read_b128 v[54:57], v3 offset:36864
    ds_read_b128 v[58:61], v3 offset:40960
    ds_read_b128 v[62:65], v3 offset:45056
L_step_s1r:
    s_waitcnt vmcnt(0)
L_own2_s1r:
    v_max3_u32 v0, v46, v47, v48
    v_max3_u32 v0, v0, v49, v71
    v_cmp_eq_u32 vcc, -1, v0
    ds_write_b128 v3, v[46:49] offset:0
    ds_write_b32 v6, v71 offset:0
    s_cbranch_vccnz L_own_s1r
    global_load_dwordx4 v[66:69], v3, s[32:33] sc1
    global_load_dword v70, v6, s[32:33] sc1
    s_waitcnt lgkmcnt(0)
    s_barrier
    ds_read_b128 v[38:41], v2 offset:0
    ds_read_b128 v[42:45], v2 offset:1024
    ds_read_b128 v[46:49], v2 offset:2048
    s_waitcnt lgkmcnt(2)
    v_smfmac_f32_16x16x64_bf16 v[14:17], v[38:41], a[0:7], v1
    s_lshr_b32 s17, s14, 2
    s_xor_b32 s17, s17, s5
    v_smfmac_f32_16x16x64_bf16 v[18:21], v[38:41], a[8:15], v1
    s_and_b32 s17, s17, 1
    s_lshl_b32 s17, s17, 13
    v_smfmac_f32_16x16x64_bf16 v[22:25], v[38:41], a[160:167], v1
    s_lshl_b32 s18, s14, 19
    s_add_u32 s17, s17, s18
    v_smfmac_f32_16x16x64_bf16 v[26:29], v[38:41], a[168:175], v1
    s_add_u32 s40, s100, s17
    s_addc_u32 s41, s101, 0
    s_add_u32 s17, s14, 1
    v_smfmac_f32_16x16x64_bf16 v[30:33], v[38:41], v[50:57], v1
    ds_read_b128 v[50:53], v3 offset:49152
    s_lshr_b32 s18, s17, 1
    v_smfmac_f32_16x16x64_bf16 v[34:37], v[38:41], v[58:65], v1
    ds_read_b128 v[54:57], v3 offset:53248
    s_xor_b32 s18, s18, s5
    s_waitcnt lgkmcnt(3)
    v_smfmac_f32_16x16x64_bf16 v[14:17], v[42:45], a[16:23], v1
    ds_read_b128 v[58:61], v3 offset:57344
    s_and_b32 s18, s18, 1
    v_smfmac_f32_16x16x64_bf16 v[18:21], v[42:45], a[24:31], v1
    ds_read_b128 v[62:65], v3 offset:61440
    s_lshl_b32 s18, s18, 13
    v_smfmac_f32_16x16x64_bf16 v[22:25], v[42:45], a[176:183], v1
    ds_read_b128 v[38:41], v2 offset:3072
    s_lshl_b32 s17, s17, 20
    v_smfmac_f32_16x16x64_bf16 v[26:29], v[42:45], a[184:191], v1
    s_add_u32 s17, s17, s18
    s_add_u32 s38, s50, s17
    s_addc_u32 s39, s51, 0
    s_waitcnt lgkmcnt(3)
    v_smfmac_f32_16x16x64_bf16 v[30:33], v[42:45], v[50:57], v1
    ds_read_b128 v[50:53], v4 offset:0
    s_add_u32 s22, s38, 0x4000
    s_addc_u32 s23, s39, 0
    s_waitcnt lgkmcnt(2)
    v_smfmac_f32_16x16x64_bf16 v[34:37], v[42:45], v[58:65], v1
    ds_read_b128 v[54:57], v4 offset:4096
    s_add_u32 s17, s14, 3
    v_smfmac_f32_16x16x64_bf16 v[14:17], v[46:49], a[32:39], v1
    ds_read_b128 v[58:61], v4 offset:8192
    s_and_b32 s17, s17, 3
    v_smfmac_f32_16x16x64_bf16 v[18:21], v[46:49], a[40:47], v1
    ds_read_b128 v[62:65], v4 offset:12288
    s_lshl_b32 s18, s17, 13
    v_smfmac_f32_16x16x64_bf16 v[22:25], v[46:49], a[192:199], v1
    ds_read_b128 v[42:45], v2 offset:4096
    s_add_u32 s34, s46, s18
    s_addc_u32 s35, s47, 0
    v_smfmac_f32_16x16x64_bf16 v[26:29], v[46:49], a[200:207], v1
    s_lshl_b32 s17, s17, 15
    s_add_u32 s18, s17, 16384
    s_waitcnt lgkmcnt(3)
    v_smfmac_f32_16x16x64_bf16 v[30:33], v[46:49], v[50:57], v1
    ds_read_b128 v[50:53], v4 offset:16384
    s_add_u32 s36, s48, s18
    s_addc_u32 s37, s49, 0
    s_waitcnt lgkmcnt(2)
    v_smfmac_f32_16x16x64_bf16 v[34:37], v[46:49], v[58:65], v1
    ds_read_b128 v[54:57], v4 offset:20480
    s_and_b32 s17, s14, 1
    v_smfmac_f32_16x16x64_bf16 v[14:17], v[38:41], a[48:55], v1
    ds_read_b128 v[58:61], v4 offset:24576
    s_mul_i32 s17, s17, 163840
    v_smfmac_f32_16x16x64_bf16 v[18:21], v[38:41], a[56:63], v1
    ds_read_b128 v[62:65], v4 offset:28672
    s_add_u32 s24, s52, s17
    s_addc_u32 s25, s53, 0
    v_smfmac_f32_16x16x64_bf16 v[22:25], v[38:41], a[208:215], v1
    s_add_u32 s26, s24, 16384
    s_addc_u32 s27, s25, 0
    s_bfe_u32 s15, s14, 0x10001
    v_smfmac_f32_16x16x64_bf16 v[26:29], v[38:41], a[216:223], v1
    s_waitcnt lgkmcnt(2)
    v_smfmac_f32_16x16x64_bf16 v[30:33], v[38:41], v[50:57], v1
    ds_read_b128 v[50:53], v4 offset:32768
    s_waitcnt lgkmcnt(1)
    v_smfmac_f32_16x16x64_bf16 v[34:37], v[38:41], v[58:65], v1
    ds_read_b128 v[54:57], v4 offset:36864
    s_waitcnt vmcnt(0)
L_oth2_s1r:
    v_max3_u32 v0, v66, v67, v68
    v_max3_u32 v0, v0, v69, v70
    v_cmp_eq_u32 vcc, -1, v0
    ds_write_b128 v3, v[66:69] offset:5120
    ds_write_b32 v6, v70 offset:5120
    s_cbranch_vccnz L_oth_s1r
    v_smfmac_f32_16x16x64_bf16 v[14:17], v[42:45], a[64:71], v1
    ds_read_b128 v[58:61], v4 offset:40960
    v_smfmac_f32_16x16x64_bf16 v[18:21], v[42:45], a[72:79], v1
    ds_read_b128 v[62:65], v4 offset:45056
    v_smfmac_f32_16x16x64_bf16 v[22:25], v[42:45], a[224:231], v1
    v_smfmac_f32_16x16x64_bf16 v[26:29], v[42:45], a[232:239], v1
    s_waitcnt lgkmcnt(4)
    v_smfmac_f32_16x16x64_bf16 v[30:33], v[42:45], v[50:57], v1
    s_waitcnt lgkmcnt(0)
    v_smfmac_f32_16x16x64_bf16 v[34:37], v[42:45], v[58:65], v1
    s_barrier
    ds_read_b128 v[46:49], v2 offset:5120
    ds_read_b128 v[38:41], v2 offset:6144
    ds_read_b128 v[42:45], v2 offset:7168
    v_mov_b32 v0, -1
    s_mov_b64 exec, s[58:59]
    global_store_dword v10, v0, s[34:35] sc1
    global_store_dword v10, v0, s[36:37] sc1
    s_mov_b64 exec, -1
    s_waitcnt lgkmcnt(2)
    v_smfmac_f32_16x16x64_bf16 v[14:17], v[46:49], a[80:87], v1
    s_xor_b32 s17, s20, 149504
    v_smfmac_f32_16x16x64_bf16 v[18:21], v[46:49], a[88:95], v1
    s_add_u32 m0, s17, s21
    v_smfmac_f32_16x16x64_bf16 v[22:25], v[46:49], a[240:247], v1
    global_load_lds_dwordx4 v3, s[38:39]
    v_smfmac_f32_16x16x64_bf16 v[26:29], v[46:49], a[248:255], v1
    ds_read_b128 v[46:49], v2 offset:8192
    s_waitcnt lgkmcnt(2)
    v_smfmac_f32_16x16x64_bf16 v[14:17], v[38:41], a[96:103], v1
    s_add_u32 m0, m0, 0x1000
    v_smfmac_f32_16x16x64_bf16 v[18:21], v[38:41], a[104:111], v1
    s_add_u32 s38, s38, 0x1000
    s_addc_u32 s39, s39, 0
    v_smfmac_f32_16x16x64_bf16 v[22:25], v[38:41], v[72:79], v1
    global_load_lds_dwordx4 v3, s[38:39]
    v_smfmac_f32_16x16x64_bf16 v[26:29], v[38:41], v[80:87], v1
    ds_read_b128 v[38:41], v2 offset:9216
    s_waitcnt lgkmcnt(2)
    v_smfmac_f32_16x16x64_bf16 v[14:17], v[42:45], a[112:119], v1
    ds_read_b128 v[58:61], v5 offset:16384
    v_smfmac_f32_16x16x64_bf16 v[18:21], v[42:45], a[120:127], v1
    ds_read_b128 v[62:65], v5 offset:20480
    v_smfmac_f32_16x16x64_bf16 v[22:25], v[42:45], v[88:95], v1
    ds_read_b128 v[50:53], v5 offset:8192
    v_smfmac_f32_16x16x64_bf16 v[26:29], v[42:45], v[96:103], v1
    ds_read_b128 v[54:57], v5 offset:12288
    s_waitcnt lgkmcnt(5)
    v_smfmac_f32_16x16x64_bf16 v[14:17], v[46:49], a[128:135], v1
    v_add_u32 v0, s20, v2
    v_smfmac_f32_16x16x64_bf16 v[18:21], v[46:49], a[136:143], v1
    s_xor_b32 s20, s20, 149504
    v_smfmac_f32_16x16x64_bf16 v[22:25], v[46:49], v[104:111], v1
    v_smfmac_f32_16x16x64_bf16 v[26:29], v[46:49], v[112:119], v1
    s_waitcnt lgkmcnt(4)
    v_smfmac_f32_16x16x64_bf16 v[14:17], v[38:41], a[144:151], v1
    v_smfmac_f32_16x16x64_bf16 v[18:21], v[38:41], a[152:159], v1
    v_smfmac_f32_16x16x64_bf16 v[22:25], v[38:41], v[120:127], v1
    v_smfmac_f32_16x16x64_bf16 v[26:29], v[38:41], v[128:135], v1
    v_smfmac_f32_16x16x64_bf16 v[34:37], v[38:41], v[248:255], v1
    s_waitcnt lgkmcnt(2)
    v_smfmac_f32_16x16x64_bf16 v[30:33], v[38:41], v[58:65], v1
    ds_read_b128 v[58:61], v5 offset:0
    ds_read_b128 v[62:65], v5 offset:4096
    v_pk_add_f32 v[14:15], v[14:15], v[16:17]
    v_pk_add_f32 v[18:19], v[18:19], v[20:21]
    v_pk_mul_f32 v[14:15], v[14:15], s[44:45]
    v_pk_mul_f32 v[18:19], v[18:19], s[44:45]
    v_cvt_pk_bf16_f32 v16, v14, v18
    v_cvt_pk_bf16_f32 v17, v15, v19
    ds_write2_b32 v11, v16, v17 offset0:0 offset1:72
    v_pk_add_f32 v[22:23], v[22:23], v[24:25]
    v_pk_add_f32 v[26:27], v[26:27], v[28:29]
    v_cvt_pk_bf16_f32 v28, v22, v26
    v_cvt_pk_bf16_f32 v29, v23, v27
    v_add_u32 v71, 2304, v11
    ds_write2_b32 v71, v28, v29 offset0:0 offset1:72
    v_smfmac_f32_16x16x64_bf16 v[34:37], v[46:49], v[240:247], v1
    ds_read_b128 v[38:41], v2 offset:5120
    s_waitcnt lgkmcnt(5)
    v_smfmac_f32_16x16x64_bf16 v[30:33], v[46:49], v[50:57], v1
    ds_read_b128 v[50:53], v4 offset:57344
    ds_read_b128 v[54:57], v4 offset:61440
    v_smfmac_f32_16x16x64_bf16 v[34:37], v[42:45], v[232:239], v1
    ds_read_b128 v[46:49], v2 offset:6144
    s_waitcnt lgkmcnt(6)
    v_smfmac_f32_16x16x64_bf16 v[30:33], v[42:45], v[58:65], v1
    ds_read_b128 v[58:61], v4 offset:49152
    ds_read_b128 v[62:65], v4 offset:53248
    s_waitcnt lgkmcnt(6)
    s_barrier
    ds_read_b128 v[66:69], v0 offset:3072
    ds_read_b128 v[42:45], v0 offset:1024
    v_lshrrev_b32 v71, 1, v3
    s_waitcnt lgkmcnt(4)
    v_smfmac_f32_16x16x64_bf16 v[34:37], v[46:49], v[224:231], v1
    v_smfmac_f32_16x16x64_bf16 v[30:33], v[46:49], v[50:57], v1
    ds_read_b128 v[50:53], v12 offset:0
    ds_read_b128 v[54:57], v12 offset:64
    ds_read_b128 v[46:49], v0 offset:2048
    v_smfmac_f32_16x16x64_bf16 v[34:37], v[38:41], v[216:223], v1
    s_waitcnt lgkmcnt(5)
    v_smfmac_f32_16x16x64_bf16 v[30:33], v[38:41], v[58:65], v1
    ds_read_b128 v[58:61], v12 offset:128
    ds_read_b128 v[62:65], v12 offset:192
    ds_read_b128 v[38:41], v0 offset:0
    s_cmp_eq_u32 s14, 63
    s_cbranch_scc1 L_last_s1r
    s_waitcnt lgkmcnt(4)
    v_mfma_f32_16x16x32_bf16 v[14:17], v[42:45], v[54:57], 0
    ds_read_b128 v[42:45], v0 offset:5120
    s_waitcnt lgkmcnt(3)
    v_mfma_f32_16x16x32_bf16 v[14:17], v[46:49], v[58:61], v[14:17]
    ds_read_b128 v[46:49], v0 offset:6144
    v_pk_add_f32 v[30:31], v[30:31], v[32:33]
    v_pk_add_f32 v[34:35], v[34:35], v[36:37]
    s_waitcnt lgkmcnt(3)
    v_mfma_f32_16x16x32_bf16 v[14:17], v[66:69], v[62:65], v[14:17]
    ds_read_b128 v[66:69], v0 offset:7168
    v_cvt_pk_bf16_f32 v32, v30, v31
    v_cvt_pk_bf16_f32 v33, v34, v35
    s_waitcnt lgkmcnt(3)
    v_mfma_f32_16x16x32_bf16 v[14:17], v[38:41], v[50:53], v[14:17]
    ds_read_b128 v[38:41], v0 offset:4096
    global_store_dwordx2 v71, v[32:33], s[40:41] sc1
    v_mov_b32 v34, v33
    v_mov_b32 v35, 0
    s_waitcnt lgkmcnt(3)
    v_mfma_f32_16x16x32_bf16 v[18:21], v[42:45], v[54:57], 0
    ds_read_b128 v[42:45], v12 offset:2368
    s_waitcnt lgkmcnt(3)
    v_mfma_f32_16x16x32_bf16 v[18:21], v[46:49], v[58:61], v[18:21]
    ds_read_b128 v[46:49], v12 offset:2432
    s_waitcnt lgkmcnt(3)
    v_mfma_f32_16x16x32_bf16 v[18:21], v[66:69], v[62:65], v[18:21]
    ds_read_b128 v[66:69], v12 offset:2496
    s_waitcnt lgkmcnt(3)
    v_mfma_f32_16x16x32_bf16 v[18:21], v[38:41], v[50:53], v[18:21]
    ds_read_b128 v[38:41], v12 offset:2304
    v_exp_f32 v36, v14
    v_exp_f32 v37, v15
    v_exp_f32 v71, v16
    v_cvt_pk_bf16_f32 v26, v36, v37
    v_exp_f32 v36, v17
    s_nop 0
    v_cvt_pk_bf16_f32 v27, v71, v36
    s_waitcnt lgkmcnt(3)
    v_mfma_f32_16x16x32_bf16 v[22:25], v[42:45], v[54:57], 0
    ds_read_b128 v[42:45], v3 offset:18432
    s_waitcnt lgkmcnt(3)
    v_mfma_f32_16x16x32_bf16 v[22:25], v[46:49], v[58:61], v[22:25]
    ds_read_b128 v[46:49], v3 offset:22528
    v_exp_f32 v36, v18
    v_exp_f32 v37, v19
    s_waitcnt lgkmcnt(3)
    v_mfma_f32_16x16x32_bf16 v[22:25], v[66:69], v[62:65], v[22:25]
    v_exp_f32 v71, v20
    v_cvt_pk_bf16_f32 v28, v36, v37
    s_waitcnt lgkmcnt(2)
    v_mfma_f32_16x16x32_bf16 v[22:25], v[38:41], v[50:53], v[22:25]
    v_exp_f32 v36, v21
    s_nop 0
    v_cvt_pk_bf16_f32 v29, v71, v36
    v_mov_b64 v[66:67], s[62:63]
    v_mov_b64 v[68:69], s[62:63]
    s_waitcnt lgkmcnt(1)
    v_mfma_f32_16x16x32_bf16 v[54:57], v[42:45], v[26:29], 0
    s_nop 0
    v_exp_f32 v36, v22
    s_waitcnt lgkmcnt(0)
    v_mfma_f32_16x16x32_bf16 v[58:61], v[46:49], v[26:29], 0
    v_exp_f32 v37, v23
    v_mfma_f32_16x16x32_bf16 v[50:53], v[66:69], v[26:29], 0
    v_mov_b32 v31, 0
    v_cvt_pk_bf16_f32 v30, v36, v37
    s_add_u32 m0, s21, 18432
    s_nop 2
    v_mfma_f32_16x16x16_bf16 v[50:53], v[66:67], v[30:31], v[50:53]
    v_mfma_f32_16x16x16_bf16 v[54:57], v[32:33], v[30:31], v[54:57]
    v_mfma_f32_16x16x16_bf16 v[58:61], v[34:35], v[30:31], v[58:61]
    global_load_lds_dwordx4 v3, s[22:23]
    s_add_u32 m0, m0, 0x1000
    s_add_u32 s22, s22, 0x1000
    s_addc_u32 s23, s23, 0
    global_load_lds_dwordx4 v3, s[22:23]
    s_nop 0
    v_rcp_f32 v36, v50
    v_subrev_u32 v0, s54, v50
    v_cmp_lt_u32 vcc, s55, v0
    v_pk_mul_f32 v[54:55], v[54:55], v[36:37] op_sel_hi:[1,0]
    v_pk_mul_f32 v[58:59], v[58:59], v[36:37] op_sel_hi:[1,0]
    v_pk_mul_f32 v[56:57], v[56:57], v[36:37] op_sel_hi:[1,0]
    v_pk_mul_f32 v[60:61], v[60:61], v[36:37] op_sel_hi:[1,0]
    v_cvt_pk_bf16_f32 v62, v54, v58
    v_cvt_pk_bf16_f32 v63, v55, v59
    v_cvt_pk_bf16_f32 v64, v56, v60
    v_cvt_pk_bf16_f32 v65, v57, v61
    s_cbranch_vccnz L_fb_s1r
L_norm_s1r:
    s_mov_b64 exec, s[70:71]
    ds_write_b128 v13, v[62:65] offset:5120
    s_mov_b64 exec, -1
    v_mov_b64 v[14:15], 0
    v_mov_b64 v[16:17], 0
    v_mov_b64 v[18:19], 0
    v_mov_b64 v[20:21], 0
    v_mov_b64 v[22:23], 0
    v_mov_b64 v[24:25], 0
    v_mov_b64 v[26:27], 0
    v_mov_b64 v[28:29], 0
    v_mov_b64 v[30:31], 0
    v_mov_b64 v[32:33], 0
    s_waitcnt lgkmcnt(0)
    s_barrier
    ds_read_b128 v[38:41], v2 offset:5120
    ds_read_b128 v[42:45], v2 offset:6144
    ds_read_b128 v[46:49], v3 offset:26624
    s_add_u32 s14, s14, 1
    s_add_u32 s17, s14, 0
    s_and_b32 s17, s17, 3
    s_lshl_b32 s18, s17, 13
    s_add_u32 s28, s46, s18
    s_addc_u32 s29, s47, 0
    s_lshl_b32 s17, s17, 15
    s_add_u32 s18, s17, 16384
    s_add_u32 s30, s48, s18
    s_addc_u32 s31, s49, 0
    s_add_u32 s18, s17, 0
    s_add_u32 s32, s48, s18
    s_addc_u32 s33, s49, 0
    s_waitcnt lgkmcnt(2)
    v_smfmac_f32_16x16x64_bf16 v[14:17], v[38:41], v[136:143], v1
    s_waitcnt lgkmcnt(1)
    v_smfmac_f32_16x16x64_bf16 v[14:17], v[42:45], v[144:151], v1
    v_smfmac_f32_16x16x64_bf16 v[18:21], v[38:41], v[152:159], v1
    v_smfmac_f32_16x16x64_bf16 v[18:21], v[42:45], v[160:167], v1
    v_smfmac_f32_16x16x64_bf16 v[22:25], v[38:41], v[168:175], v1
    v_smfmac_f32_16x16x64_bf16 v[22:25], v[42:45], v[176:183], v1
    v_smfmac_f32_16x16x64_bf16 v[26:29], v[38:41], v[184:191], v1
    v_smfmac_f32_16x16x64_bf16 v[26:29], v[42:45], v[192:199], v1
    s_nop 1
    v_pk_add_f32 v[14:15], v[14:15], v[16:17]
    s_nop 0
    v_pk_add_f32 v[18:19], v[18:19], v[20:21]
    v_smfmac_f32_16x16x64_bf16 v[30:33], v[38:41], v[200:207], v1
    v_cvt_pk_bf16_f32 v16, v14, v18
    v_cvt_pk_bf16_f32 v17, v15, v19
    v_smfmac_f32_16x16x64_bf16 v[30:33], v[42:45], v[208:215], v1
    v_and_or_b32 v16, v16, -2, s15
    v_and_or_b32 v17, v17, -2, s15
    global_store_dwordx2 v7, v[16:17], s[24:25] sc1
    v_pk_add_f32 v[22:23], v[22:23], v[24:25]
    v_pk_add_f32 v[26:27], v[26:27], v[28:29]
    v_cvt_pk_bf16_f32 v24, v22, v26
    v_cvt_pk_bf16_f32 v25, v23, v27
    v_and_or_b32 v24, v24, -2, s15
    v_and_or_b32 v25, v25, -2, s15
    global_store_dwordx2 v7, v[24:25], s[26:27] sc1
    v_pk_add_f32 v[30:31], v[30:31], v[32:33]
    v_cvt_pk_bf16_f32 v32, v30, v31
    v_and_or_b32 v32, v32, -2, s15
    global_store_dword v8, v32, s[24:25] sc1
    s_waitcnt lgkmcnt(0)
    s_waitcnt vmcnt(0)
L_pa2_s1r:
    global_load_dwordx4 v[38:41], v9, s[24:25] sc1
    global_load_dwordx4 v[42:45], v9, s[24:25] offset:1024 sc1
    s_waitcnt vmcnt(1)
    v_mfma_f32_16x16x32_bf16 v[50:53], v[38:41], v[46:49], 0
    v_bitop3_b32 v0, v38, v39, s15 bitop3:0x7e
    v_bitop3_b32 v71, v40, v41, s15 bitop3:0x7e
    s_waitcnt vmcnt(0)
    v_mfma_f32_16x16x32_bf16 v[50:53], v[42:45], v[46:49], v[50:53]
    v_bitop3_b32 v66, v42, v43, s15 bitop3:0x7e
    v_bitop3_b32 v67, v44, v45, s15 bitop3:0x7e
    v_or3_b32 v0, v0, v71, v66
    v_bitop3_b32 v0, v0, v67, 1 bitop3:0xa8
    v_cmp_ne_u32 vcc, 0, v0
    s_nop 2
    v_pk_add_f32 v[50:51], v[50:51], v[52:53]
    v_add_f32 v50, v50, v51
    s_cbranch_vccnz L_pa_s1r
    s_nop 0
    v_mov_b32_dpp v51, v50 quad_perm:[1,1,3,3] row_mask:0xf bank_mask:0xf
    v_cvt_pk_bf16_f32 v50, v50, v51
    v_min_u32 v50, -2, v50
    s_mov_b64 exec, s[58:59]
    global_store_dword v10, v50, s[28:29] sc1
    global_store_dword v10, v50, s[30:31] sc1
    s_mov_b64 exec, -1
    s_waitcnt vmcnt(1)
    s_barrier
    global_load_dwordx4 v[46:49], v3, s[28:29] sc1
    global_load_dword v71, v6, s[28:29] sc1
    v_mov_b64 v[14:15], 0
    v_mov_b64 v[16:17], 0
    v_mov_b64 v[18:19], 0
    v_mov_b64 v[20:21], 0
    v_mov_b64 v[22:23], 0
    v_mov_b64 v[24:25], 0
    v_mov_b64 v[26:27], 0
    v_mov_b64 v[28:29], 0
    v_mov_b64 v[30:31], 0
    v_mov_b64 v[32:33], 0
    v_mov_b64 v[34:35], 0
    v_mov_b64 v[36:37], 0
    ds_read_b128 v[50:53], v3 offset:32768
    ds_read_b128 v[54:57], v3 offset:36864
    ds_read_b128 v[58:61], v3 offset:40960
    ds_read_b128 v[62:65], v3 offset:45056
    s_branch L_step_s1r
L_own_s1r:
    s_add_u32 s16, s16, 1
    s_cmp_gt_u32 s16, 1048576
    s_cbranch_scc1 L_bail5
    s_waitcnt lgkmcnt(0)
    global_load_dwordx4 v[46:49], v3, s[28:29] sc1
    global_load_dword v71, v6, s[28:29] sc1
    s_waitcnt vmcnt(0)
    s_branch L_own2_s1r
L_oth_s1r:
    s_add_u32 s16, s16, 1
    s_cmp_gt_u32 s16, 1048576
    s_cbranch_scc1 L_bail6
    s_waitcnt lgkmcnt(0)
    global_load_dwordx4 v[66:69], v3, s[32:33] sc1
    global_load_dword v70, v6, s[32:33] sc1
    s_waitcnt vmcnt(0)
    s_branch L_oth2_s1r
L_pa_s1r:
    s_add_u32 s16, s16, 1
    s_cmp_gt_u32 s16, 1048576
    s_cbranch_scc1 L_bail8
    s_branch L_pa2_s1r
L_fb_s1r:
    v_max3_f32 v0, v14, v15, v16
    v_max3_f32 v0, v0, v17, v18
    v_max3_f32 v0, v0, v19, v20
    v_max3_f32 v0, v0, v21, v22
    v_max3_f32 v0, v0, v23, v24
    v_max_f32 v0, v0, v25
    v_mov_b32 v36, v0
    s_nop 1
    v_permlane16_swap_b32 v0, v36
    v_max_f32 v0, v0, v36
    v_mov_b32 v36, v0
    s_nop 1
    v_permlane32_swap_b32 v0, v36
    v_max_f32 v0, v0, v36
    v_sub_f32 v14, v14, v0
    v_sub_f32 v15, v15, v0
    v_sub_f32 v16, v16, v0
    v_sub_f32 v17, v17, v0
    v_sub_f32 v18, v18, v0
    v_sub_f32 v19, v19, v0
    v_sub_f32 v20, v20, v0
    v_sub_f32 v21, v21, v0
    v_sub_f32 v22, v22, v0
    v_sub_f32 v23, v23, v0
    v_sub_f32 v24, v24, v0
    v_sub_f32 v25, v25, v0
    v_exp_f32 v36, v14
    v_exp_f32 v37, v15
    v_exp_f32 v71, v16
    v_cvt_pk_bf16_f32 v26, v36, v37
    v_exp_f32 v36, v17
    s_nop 0
    v_cvt_pk_bf16_f32 v27, v71, v36
    v_exp_f32 v36, v18
    v_exp_f32 v37, v19
    v_exp_f32 v71, v20
    v_cvt_pk_bf16_f32 v28, v36, v37
    v_exp_f32 v36, v21
    s_nop 0
    v_cvt_pk_bf16_f32 v29, v71, v36
    v_exp_f32 v36, v22
    v_exp_f32 v37, v23
    v_mov_b32 v31, 0
    v_cvt_pk_bf16_f32 v30, v36, v37
    v_mfma_f32_16x16x32_bf16 v[50:53], v[66:69], v[26:29], 0
    v_mfma_f32_16x16x32_bf16 v[54:57], v[42:45], v[26:29], 0
    v_mfma_f32_16x16x32_bf16 v[58:61], v[46:49], v[26:29], 0
    s_nop 3
    v_mfma_f32_16x16x16_bf16 v[50:53], v[66:67], v[30:31], v[50:53]
    v_mfma_f32_16x16x16_bf16 v[54:57], v[32:33], v[30:31], v[54:57]
    v_mfma_f32_16x16x16_bf16 v[58:61], v[34:35], v[30:31], v[58:61]
    s_nop 5
    v_rcp_f32 v36, v50
    s_nop 0
    v_pk_mul_f32 v[54:55], v[54:55], v[36:37] op_sel_hi:[1,0]
    v_pk_mul_f32 v[58:59], v[58:59], v[36:37] op_sel_hi:[1,0]
    v_pk_mul_f32 v[56:57], v[56:57], v[36:37] op_sel_hi:[1,0]
    v_pk_mul_f32 v[60:61], v[60:61], v[36:37] op_sel_hi:[1,0]
    v_cvt_pk_bf16_f32 v62, v54, v58
    v_cvt_pk_bf16_f32 v63, v55, v59
    v_cvt_pk_bf16_f32 v64, v56, v60
    v_cvt_pk_bf16_f32 v65, v57, v61
    s_branch L_norm_s1r
L_last_s1r:
    s_nop 2
    v_pk_add_f32 v[30:31], v[30:31], v[32:33]
    v_pk_add_f32 v[34:35], v[34:35], v[36:37]
    v_cvt_pk_bf16_f32 v32, v30, v31
    v_cvt_pk_bf16_f32 v33, v34, v35
    global_store_dwordx2 v71, v[32:33], s[40:41] sc1
    v_mov_b32 v34, v33
    v_mov_b32 v35, 0
    s_waitcnt vmcnt(0) lgkmcnt(0)
    s_barrier
    s_branch L_chain_end
L_var10:
    s_add_u32 s17, s14, 0
    s_and_b32 s17, s17, 3
    s_lshl_b32 s18, s17, 13
    s_add_u32 s28, s46, s18
    s_addc_u32 s29, s47, 0
    s_lshl_b32 s17, s17, 15
    s_add_u32 s18, s17, 0
    s_add_u32 s32, s48, s18
    s_addc_u32 s33, s49, 0
    global_load_dwordx4 v[46:49], v3, s[28:29] sc1
    global_load_dword v71, v6, s[28:29] sc1
    v_mov_b64 v[14:15], 0
    v_mov_b64 v[16:17], 0
    v_mov_b64 v[18:19], 0
    v_mov_b64 v[20:21], 0
    v_mov_b64 v[22:23], 0
    v_mov_b64 v[24:25], 0
    v_mov_b64 v[26:27], 0
    v_mov_b64 v[28:29], 0
    v_mov_b64 v[30:31], 0
    v_mov_b64 v[32:33], 0
    v_mov_b64 v[34:35], 0
    v_mov_b64 v[36:37], 0
    ds_read_b128 v[50:53], v3 offset:32768
    ds_read_b128 v[54:57], v3 offset:36864
    ds_read_b128 v[58:61], v3 offset:40960
    ds_read_b128 v[62:65], v3 offset:45056
L_step_s1i:
    s_waitcnt vmcnt(0)
L_own2_s1i:
    v_max3_u32 v0, v46, v47, v48
    v_max3_u32 v0, v0, v49, v71
    v_cmp_eq_u32 vcc, -1, v0
    ds_write_b128 v3, v[46:49] offset:0
    ds_write_b32 v6, v71 offset:0
    s_cbranch_vccnz L_own_s1i
    global_load_dwordx4 v[66:69], v3, s[32:33] sc1
    global_load_dword v70, v6, s[32:33] sc1
    s_waitcnt lgkmcnt(0)
    s_barrier
    ds_read_b128 v[38:41], v2 offset:0
    ds_read_b128 v[42:45], v2 offset:1024
    ds_read_b128 v[46:49], v2 offset:2048
    s_waitcnt lgkmcnt(2)
    v_smfmac_f32_16x16x64_bf16 v[14:17], v[38:41], a[0:7], v1
    s_lshr_b32 s17, s14, 2
    s_xor_b32 s17, s17, s5
    v_smfmac_f32_16x16x64_bf16 v[18:21], v[38:41], a[8:15], v1
    s_and_b32 s17, s17, 1
    s_lshl_b32 s17, s17, 13
    v_smfmac_f32_16x16x64_bf16 v[22:25], v[38:41], a[160:167], v1
    s_lshl_b32 s18, s14, 19
    s_add_u32 s17, s17, s18
    v_smfmac_f32_16x16x64_bf16 v[26:29], v[38:41], a[168:175], v1
    s_add_u32 s40, s100, s17
    s_addc_u32 s41, s101, 0
    s_add_u32 s17, s14, 1
    v_smfmac_f32_16x16x64_bf16 v[30:33], v[38:41], v[50:57], v1
    ds_read_b128 v[50:53], v3 offset:49152
    s_lshr_b32 s18, s17, 1
    v_smfmac_f32_16x16x64_bf16 v[34:37], v[38:41], v[58:65], v1
    ds_read_b128 v[54:57], v3 offset:53248
    s_xor_b32 s18, s18, s5
    s_waitcnt lgkmcnt(3)
    v_smfmac_f32_16x16x64_bf16 v[14:17], v[42:45], a[16:23], v1
    ds_read_b128 v[58:61], v3 offset:57344
    s_and_b32 s18, s18, 1
    v_smfmac_f32_16x16x64_bf16 v[18:21], v[42:45], a[24:31], v1
    ds_read_b128 v[62:65], v3 offset:61440
    s_lshl_b32 s18, s18, 13
    v_smfmac_f32_16x16x64_bf16 v[22:25], v[42:45], a[176:183], v1
    ds_read_b128 v[38:41], v2 offset:3072
    s_lshl_b32 s17, s17, 20
    v_smfmac_f32_16x16x64_bf16 v[26:29], v[42:45], a[184:191], v1
    s_add_u32 s17, s17, s18
    s_add_u32 s38, s50, s17
    s_addc_u32 s39, s51, 0
    s_waitcnt lgkmcnt(3)
    v_smfmac_f32_16x16x64_bf16 v[30:33], v[42:45], v[50:57], v1
    ds_read_b128 v[50:53], v4 offset:0
    s_add_u32 s22, s38, 0x4000
    s_addc_u32 s23, s39, 0
    s_waitcnt lgkmcnt(2)
    v_smfmac_f32_16x16x64_bf16 v[34:37], v[42:45], v[58:65], v1
    ds_read_b128 v[54:57], v4 offset:4096
    s_and_b32 s17, s14, 1
    v_smfmac_f32_16x16x64_bf16 v[14:17], v[46:49], a[32:39], v1
    ds_read_b128 v[58:61], v4 offset:8192
    s_mul_i32 s17, s17, 163840
    v_smfmac_f32_16x16x64_bf16 v[18:21], v[46:49], a[40:47], v1
    ds_read_b128 v[62:65], v4 offset:12288
    s_add_u32 s24, s52, s17
    s_addc_u32 s25, s53, 0
    v_smfmac_f32_16x16x64_bf16 v[22:25], v[46:49], a[192:199], v1
    ds_read_b128 v[42:45], v2 offset:4096
    s_add_u32 s26, s24, 16384
    s_addc_u32 s27, s25, 0
    v_smfmac_f32_16x16x64_bf16 v[26:29], v[46:49], a[200:207], v1
    s_bfe_u32 s15, s14, 0x10001
    s_waitcnt lgkmcnt(3)
    v_smfmac_f32_16x16x64_bf16 v[30:33], v[46:49], v[50:57], v1
    ds_read_b128 v[50:53], v4 offset:16384
    s_waitcnt lgkmcnt(2)
    v_smfmac_f32_16x16x64_bf16 v[34:37], v[46:49], v[58:65], v1
    ds_read_b128 v[54:57], v4 offset:20480
    v_smfmac_f32_16x16x64_bf16 v[14:17], v[38:41], a[48:55], v1
    ds_read_b128 v[58:61], v4 offset:24576
    v_smfmac_f32_16x16x64_bf16 v[18:21], v[38:41], a[56:63], v1
    ds_read_b128 v[62:65], v4 offset:28672
    v_smfmac_f32_16x16x64_bf16 v[22:25], v[38:41], a[208:215], v1
    v_smfmac_f32_16x16x64_bf16 v[26:29], v[38:41], a[216:223], v1
    s_waitcnt lgkmcnt(2)
    v_smfmac_f32_16x16x64_bf16 v[30:33], v[38:41], v[50:57], v1
    ds_read_b128 v[50:53], v4 offset:32768
    s_waitcnt lgkmcnt(1)
    v_smfmac_f32_16x16x64_bf16 v[34:37], v[38:41], v[58:65], v1
    ds_read_b128 v[54:57], v4 offset:36864
    s_waitcnt vmcnt(0)
L_oth2_s1i:
    v_max3_u32 v0, v66, v67, v68
    v_max3_u32 v0, v0, v69, v70
    v_cmp_eq_u32 vcc, -1, v0
    ds_write_b128 v3, v[66:69] offset:5120
    ds_write_b32 v6, v70 offset:5120
    s_cbranch_vccnz L_oth_s1i
    v_smfmac_f32_16x16x64_bf16 v[14:17], v[42:45], a[64:71], v1
    ds_read_b128 v[58:61], v4 offset:40960
    v_smfmac_f32_16x16x64_bf16 v[18:21], v[42:45], a[72:79], v1
    ds_read_b128 v[62:65], v4 offset:45056
    v_smfmac_f32_16x16x64_bf16 v[22:25], v[42:45], a[224:231], v1
    v_smfmac_f32_16x16x64_bf16 v[26:29], v[42:45], a[232:239], v1
    s_waitcnt lgkmcnt(4)
    v_smfmac_f32_16x16x64_bf16 v[30:33], v[42:45], v[50:57], v1
    s_waitcnt lgkmcnt(0)
    v_smfmac_f32_16x16x64_bf16 v[34:37], v[42:45], v[58:65], v1
    s_barrier
    ds_read_b128 v[46:49], v2 offset:5120
    ds_read_b128 v[38:41], v2 offset:6144
    ds_read_b128 v[42:45], v2 offset:7168
    s_waitcnt lgkmcnt(2)
    v_smfmac_f32_16x16x64_bf16 v[14:17], v[46:49], a[80:87], v1
    s_xor_b32 s17, s20, 149504
    v_smfmac_f32_16x16x64_bf16 v[18:21], v[46:49], a[88:95], v1
    s_add_u32 m0, s17, s21
    v_smfmac_f32_16x16x64_bf16 v[22:25], v[46:49], a[240:247], v1
    global_load_lds_dwordx4 v3, s[38:39]
    v_smfmac_f32_16x16x64_bf16 v[26:29], v[46:49], a[248:255], v1
    ds_read_b128 v[46:49], v2 offset:8192
    s_waitcnt lgkmcnt(2)
    v_smfmac_f32_16x16x64_bf16 v[14:17], v[38:41], a[96:103], v1
    s_add_u32 m0, m0, 0x1000
    v_smfmac_f32_16x16x64_bf16 v[18:21], v[38:41], a[104:111], v1
    s_add_u32 s38, s38, 0x1000
    s_addc_u32 s39, s39, 0
    v_smfmac_f32_16x16x64_bf16 v[22:25], v[38:41], v[72:79], v1
    global_load_lds_dwordx4 v3, s[38:39]
    v_smfmac_f32_16x16x64_bf16 v[26:29], v[38:41], v[80:87], v1
    ds_read_b128 v[38:41], v2 offset:9216
    s_waitcnt lgkmcnt(2)
    v_smfmac_f32_16x16x64_bf16 v[14:17], v[42:45], a[112:119], v1
    ds_read_b128 v[58:61], v5 offset:16384
    v_smfmac_f32_16x16x64_bf16 v[18:21], v[42:45], a[120:127], v1
    ds_read_b128 v[62:65], v5 offset:20480
    v_smfmac_f32_16x16x64_bf16 v[22:25], v[42:45], v[88:95], v1
    ds_read_b128 v[50:53], v5 offset:8192
    v_smfmac_f32_16x16x64_bf16 v[26:29], v[42:45], v[96:103], v1
    ds_read_b128 v[54:57], v5 offset:12288
    s_waitcnt lgkmcnt(5)
    v_smfmac_f32_16x16x64_bf16 v[14:17], v[46:49], a[128:135], v1
    v_add_u32 v0, s20, v2
    v_smfmac_f32_16x16x64_bf16 v[18:21], v[46:49], a[136:143], v1
    s_xor_b32 s20, s20, 149504
    v_smfmac_f32_16x16x64_bf16 v[22:25], v[46:49], v[104:111], v1
    v_smfmac_f32_16x16x64_bf16 v[26:29], v[46:49], v[112:119], v1
    s_waitcnt lgkmcnt(4)
    v_smfmac_f32_16x16x64_bf16 v[14:17], v[38:41], a[144:151], v1
    v_smfmac_f32_16x16x64_bf16 v[18:21], v[38:41], a[152:159], v1
    v_smfmac_f32_16x16x64_bf16 v[22:25], v[38:41], v[120:127], v1
    v_smfmac_f32_16x16x64_bf16 v[26:29], v[38:41], v[128:135], v1
    v_smfmac_f32_16x16x64_bf16 v[34:37], v[38:41], v[248:255], v1
    s_waitcnt lgkmcnt(2)
    v_smfmac_f32_16x16x64_bf16 v[30:33], v[38:41], v[58:65], v1
    ds_read_b128 v[58:61], v5 offset:0
    ds_read_b128 v[62:65], v5 offset:4096
    v_pk_add_f32 v[14:15], v[14:15], v[16:17]
    v_pk_add_f32 v[18:19], v[18:19], v[20:21]
    v_pk_mul_f32 v[14:15], v[14:15], s[44:45]
    v_pk_mul_f32 v[18:19], v[18:19], s[44:45]
    v_cvt_pk_bf16_f32 v16, v14, v18
    v_cvt_pk_bf16_f32 v17, v15, v19
    ds_write2_b32 v11, v16, v17 offset0:0 offset1:72
    v_pk_add_f32 v[22:23], v[22:23], v[24:25]
    v_pk_add_f32 v[26:27], v[26:27], v[28:29]
    v_cvt_pk_bf16_f32 v28, v22, v26
    v_cvt_pk_bf16_f32 v29, v23, v27
    v_add_u32 v71, 2304, v11
    ds_write2_b32 v71, v28, v29 offset0:0 offset1:72
    v_smfmac_f32_16x16x64_bf16 v[34:37], v[46:49], v[240:247], v1
    ds_read_b128 v[38:41], v2 offset:5120
    s_waitcnt lgkmcnt(5)
    v_smfmac_f32_16x16x64_bf16 v[30:33], v[46:49], v[50:57], v1
    ds_read_b128 v[50:53], v4 offset:57344
    ds_read_b128 v[54:57], v4 offset:61440
    v_smfmac_f32_16x16x64_bf16 v[34:37], v[42:45], v[232:239], v1
    ds_read_b128 v[46:49], v2 offset:6144
    s_waitcnt lgkmcnt(6)
    v_smfmac_f32_16x16x64_bf16 v[30:33], v[42:45], v[58:65], v1
    ds_read_b128 v[58:61], v4 offset:49152
    ds_read_b128 v[62:65], v4 offset:53248
    s_waitcnt lgkmcnt(6)
    s_barrier
    ds_read_b128 v[66:69], v0 offset:3072
    ds_read_b128 v[42:45], v0 offset:1024
    v_lshrrev_b32 v71, 1, v3
    s_waitcnt lgkmcnt(4)
    v_smfmac_f32_16x16x64_bf16 v[34:37], v[46:49], v[224:231], v1
    v_smfmac_f32_16x16x64_bf16 v[30:33], v[46:49], v[50:57], v1
    ds_read_b128 v[50:53], v12 offset:0
    ds_read_b128 v[54:57], v12 offset:64
    ds_read_b128 v[46:49], v0 offset:2048
    v_smfmac_f32_16x16x64_bf16 v[34:37], v[38:41], v[216:223], v1
    s_waitcnt lgkmcnt(5)
    v_smfmac_f32_16x16x64_bf16 v[30:33], v[38:41], v[58:65], v1
    ds_read_b128 v[58:61], v12 offset:128
    ds_read_b128 v[62:65], v12 offset:192
    ds_read_b128 v[38:41], v0 offset:0
    s_cmp_eq_u32 s14, 63
    s_cbranch_scc1 L_last_s1i
    s_waitcnt lgkmcnt(4)
    v_mfma_f32_16x16x32_bf16 v[14:17], v[42:45], v[54:57], 0
    ds_read_b128 v[42:45], v0 offset:5120
    s_waitcnt lgkmcnt(3)
    v_mfma_f32_16x16x32_bf16 v[14:17], v[46:49], v[58:61], v[14:17]
    ds_read_b128 v[46:49], v0 offset:6144
    v_pk_add_f32 v[30:31], v[30:31], v[32:33]
    v_pk_add_f32 v[34:35], v[34:35], v[36:37]
    s_waitcnt lgkmcnt(3)
    v_mfma_f32_16x16x32_bf16 v[14:17], v[66:69], v[62:65], v[14:17]
    ds_read_b128 v[66:69], v0 offset:7168
    v_cvt_pk_bf16_f32 v32, v30, v31
    v_cvt_pk_bf16_f32 v33, v34, v35
    s_waitcnt lgkmcnt(3)
    v_mfma_f32_16x16x32_bf16 v[14:17], v[38:41], v[50:53], v[14:17]
    ds_read_b128 v[38:41], v0 offset:4096
    global_store_dwordx2 v71, v[32:33], s[40:41] sc1
    v_mov_b32 v34, v33
    v_mov_b32 v35, 0
    s_waitcnt lgkmcnt(3)
    v_mfma_f32_16x16x32_bf16 v[18:21], v[42:45], v[54:57], 0
    ds_read_b128 v[42:45], v12 offset:2368
    s_waitcnt lgkmcnt(3)
    v_mfma_f32_16x16x32_bf16 v[18:21], v[46:49], v[58:61], v[18:21]
    ds_read_b128 v[46:49], v12 offset:2432
    s_waitcnt lgkmcnt(3)
    v_mfma_f32_16x16x32_bf16 v[18:21], v[66:69], v[62:65], v[18:21]
    ds_read_b128 v[66:69], v12 offset:2496
    s_waitcnt lgkmcnt(3)
    v_mfma_f32_16x16x32_bf16 v[18:21], v[38:41], v[50:53], v[18:21]
    ds_read_b128 v[38:41], v12 offset:2304
    v_exp_f32 v36, v14
    v_exp_f32 v37, v15
    v_exp_f32 v71, v16
    v_cvt_pk_bf16_f32 v26, v36, v37
    v_exp_f32 v36, v17
    s_nop 0
    v_cvt_pk_bf16_f32 v27, v71, v36
    s_waitcnt lgkmcnt(3)
    v_mfma_f32_16x16x32_bf16 v[22:25], v[42:45], v[54:57], 0
    ds_read_b128 v[42:45], v3 offset:18432
    s_waitcnt lgkmcnt(3)
    v_mfma_f32_16x16x32_bf16 v[22:25], v[46:49], v[58:61], v[22:25]
    ds_read_b128 v[46:49], v3 offset:22528
    v_exp_f32 v36, v18
    v_exp_f32 v37, v19
    s_waitcnt lgkmcnt(3)
    v_mfma_f32_16x16x32_bf16 v[22:25], v[66:69], v[62:65], v[22:25]
    v_exp_f32 v71, v20
    v_cvt_pk_bf16_f32 v28, v36, v37
    s_waitcnt lgkmcnt(2)
    v_mfma_f32_16x16x32_bf16 v[22:25], v[38:41], v[50:53], v[22:25]
    v_exp_f32 v36, v21
    s_nop 0
    v_cvt_pk_bf16_f32 v29, v71, v36
    v_mov_b64 v[66:67], s[62:63]
    v_mov_b64 v[68:69], s[62:63]
    s_waitcnt lgkmcnt(1)
    v_mfma_f32_16x16x32_bf16 v[54:57], v[42:45], v[26:29], 0
    s_nop 0
    v_exp_f32 v36, v22
    s_waitcnt lgkmcnt(0)
    v_mfma_f32_16x16x32_bf16 v[58:61], v[46:49], v[26:29], 0
    v_exp_f32 v37, v23
    v_mfma_f32_16x16x32_bf16 v[50:53], v[66:69], v[26:29], 0
    v_mov_b32 v31, 0
    v_cvt_pk_bf16_f32 v30, v36, v37
    s_add_u32 m0, s21, 18432
    s_nop 2
    v_mfma_f32_16x16x16_bf16 v[50:53], v[66:67], v[30:31], v[50:53]
    v_mfma_f32_16x16x16_bf16 v[54:57], v[32:33], v[30:31], v[54:57]
    v_mfma_f32_16x16x16_bf16 v[58:61], v[34:35], v[30:31], v[58:61]
    global_load_lds_dwordx4 v3, s[22:23]
    s_add_u32 m0, m0, 0x1000
    s_add_u32 s22, s22, 0x1000
    s_addc_u32 s23, s23, 0
    global_load_lds_dwordx4 v3, s[22:23]
    s_nop 0
    v_rcp_f32 v36, v50
    v_subrev_u32 v0, s54, v50
    v_cmp_lt_u32 vcc, s55, v0
    v_pk_mul_f32 v[54:55], v[54:55], v[36:37] op_sel_hi:[1,0]
    v_pk_mul_f32 v[58:59], v[58:59], v[36:37] op_sel_hi:[1,0]
    v_pk_mul_f32 v[56:57], v[56:57], v[36:37] op_sel_hi:[1,0]
    v_pk_mul_f32 v[60:61], v[60:61], v[36:37] op_sel_hi:[1,0]
    v_cvt_pk_bf16_f32 v62, v54, v58
    v_cvt_pk_bf16_f32 v63, v55, v59
    v_cvt_pk_bf16_f32 v64, v56, v60
    v_cvt_pk_bf16_f32 v65, v57, v61
    s_cbranch_vccnz L_fb_s1i
L_norm_s1i:
    s_mov_b64 exec, s[70:71]
    ds_write_b128 v13, v[62:65] offset:5120
    s_mov_b64 exec, -1
    v_mov_b64 v[14:15], 0
    v_mov_b64 v[16:17], 0
    v_mov_b64 v[18:19], 0
    v_mov_b64 v[20:21], 0
    v_mov_b64 v[22:23], 0
    v_mov_b64 v[24:25], 0
    v_mov_b64 v[26:27], 0
    v_mov_b64 v[28:29], 0
    v_mov_b64 v[30:31], 0
    v_mov_b64 v[32:33], 0
    s_waitcnt lgkmcnt(0)
    s_barrier
    ds_read_b128 v[38:41], v2 offset:5120
    ds_read_b128 v[42:45], v2 offset:6144
    s_add_u32 s14, s14, 1
    s_add_u32 s17, s14, 0
    s_and_b32 s17, s17, 3
    s_lshl_b32 s18, s17, 13
    s_add_u32 s28, s46, s18
    s_addc_u32 s29, s47, 0
    s_lshl_b32 s17, s17, 15
    s_add_u32 s18, s17, 0
    s_add_u32 s32, s48, s18
    s_addc_u32 s33, s49, 0
    s_waitcnt lgkmcnt(1)
    v_smfmac_f32_16x16x64_bf16 v[14:17], v[38:41], v[136:143], v1
    s_waitcnt lgkmcnt(0)
    v_smfmac_f32_16x16x64_bf16 v[14:17], v[42:45], v[144:151], v1
    v_smfmac_f32_16x16x64_bf16 v[18:21], v[38:41], v[152:159], v1
    v_smfmac_f32_16x16x64_bf16 v[18:21], v[42:45], v[160:167], v1
    v_smfmac_f32_16x16x64_bf16 v[22:25], v[38:41], v[168:175], v1
    v_smfmac_f32_16x16x64_bf16 v[22:25], v[42:45], v[176:183], v1
    v_smfmac_f32_16x16x64_bf16 v[26:29], v[38:41], v[184:191], v1
    v_smfmac_f32_16x16x64_bf16 v[26:29], v[42:45], v[192:199], v1
    s_nop 1
    v_pk_add_f32 v[14:15], v[14:15], v[16:17]
    s_nop 0
    v_pk_add_f32 v[18:19], v[18:19], v[20:21]
    v_smfmac_f32_16x16x64_bf16 v[30:33], v[38:41], v[200:207], v1
    v_cvt_pk_bf16_f32 v16, v14, v18
    v_cvt_pk_bf16_f32 v17, v15, v19
    v_smfmac_f32_16x16x64_bf16 v[30:33], v[42:45], v[208:215], v1
    v_and_or_b32 v16, v16, -2, s15
    v_and_or_b32 v17, v17, -2, s15
    global_store_dwordx2 v7, v[16:17], s[24:25] sc1
    v_pk_add_f32 v[22:23], v[22:23], v[24:25]
    v_pk_add_f32 v[26:27], v[26:27], v[28:29]
    v_cvt_pk_bf16_f32 v24, v22, v26
    v_cvt_pk_bf16_f32 v25, v23, v27
    v_and_or_b32 v24, v24, -2, s15
    v_and_or_b32 v25, v25, -2, s15
    global_store_dwordx2 v7, v[24:25], s[26:27] sc1
    v_pk_add_f32 v[30:31], v[30:31], v[32:33]
    v_cvt_pk_bf16_f32 v32, v30, v31
    v_and_or_b32 v32, v32, -2, s15
    global_store_dword v8, v32, s[24:25] sc1
    s_waitcnt lgkmcnt(0)
    s_barrier
    global_load_dwordx4 v[46:49], v3, s[28:29] sc1
    global_load_dword v71, v6, s[28:29] sc1
    v_mov_b64 v[14:15], 0
    v_mov_b64 v[16:17], 0
    v_mov_b64 v[18:19], 0
    v_mov_b64 v[20:21], 0
    v_mov_b64 v[22:23], 0
    v_mov_b64 v[24:25], 0
    v_mov_b64 v[26:27], 0
    v_mov_b64 v[28:29], 0
    v_mov_b64 v[30:31], 0
    v_mov_b64 v[32:33], 0
    v_mov_b64 v[34:35], 0
    v_mov_b64 v[36:37], 0
    ds_read_b128 v[50:53], v3 offset:32768
    ds_read_b128 v[54:57], v3 offset:36864
    ds_read_b128 v[58:61], v3 offset:40960
    ds_read_b128 v[62:65], v3 offset:45056
    s_branch L_step_s1i
L_own_s1i:
    s_add_u32 s16, s16, 1
    s_cmp_gt_u32 s16, 1048576
    s_cbranch_scc1 L_bail5
    s_waitcnt lgkmcnt(0)
    global_load_dwordx4 v[46:49], v3, s[28:29] sc1
    global_load_dword v71, v6, s[28:29] sc1
    s_waitcnt vmcnt(0)
    s_branch L_own2_s1i
L_oth_s1i:
    s_add_u32 s16, s16, 1
    s_cmp_gt_u32 s16, 1048576
    s_cbranch_scc1 L_bail6
    s_waitcnt lgkmcnt(0)
    global_load_dwordx4 v[66:69], v3, s[32:33] sc1
    global_load_dword v70, v6, s[32:33] sc1
    s_waitcnt vmcnt(0)
    s_branch L_oth2_s1i
L_fb_s1i:
    v_max3_f32 v0, v14, v15, v16
    v_max3_f32 v0, v0, v17, v18
    v_max3_f32 v0, v0, v19, v20
    v_max3_f32 v0, v0, v21, v22
    v_max3_f32 v0, v0, v23, v24
    v_max_f32 v0, v0, v25
    v_mov_b32 v36, v0
    s_nop 1
    v_permlane16_swap_b32 v0, v36
    v_max_f32 v0, v0, v36
    v_mov_b32 v36, v0
    s_nop 1
    v_permlane32_swap_b32 v0, v36
    v_max_f32 v0, v0, v36
    v_sub_f32 v14, v14, v0
    v_sub_f32 v15, v15, v0
    v_sub_f32 v16, v16, v0
    v_sub_f32 v17, v17, v0
    v_sub_f32 v18, v18, v0
    v_sub_f32 v19, v19, v0
    v_sub_f32 v20, v20, v0
    v_sub_f32 v21, v21, v0
    v_sub_f32 v22, v22, v0
    v_sub_f32 v23, v23, v0
    v_sub_f32 v24, v24, v0
    v_sub_f32 v25, v25, v0
    v_exp_f32 v36, v14
    v_exp_f32 v37, v15
    v_exp_f32 v71, v16
    v_cvt_pk_bf16_f32 v26, v36, v37
    v_exp_f32 v36, v17
    s_nop 0
    v_cvt_pk_bf16_f32 v27, v71, v36
    v_exp_f32 v36, v18
    v_exp_f32 v37, v19
    v_exp_f32 v71, v20
    v_cvt_pk_bf16_f32 v28, v36, v37
    v_exp_f32 v36, v21
    s_nop 0
    v_cvt_pk_bf16_f32 v29, v71, v36
    v_exp_f32 v36, v22
    v_exp_f32 v37, v23
    v_mov_b32 v31, 0
    v_cvt_pk_bf16_f32 v30, v36, v37
    v_mfma_f32_16x16x32_bf16 v[50:53], v[66:69], v[26:29], 0
    v_mfma_f32_16x16x32_bf16 v[54:57], v[42:45], v[26:29], 0
    v_mfma_f32_16x16x32_bf16 v[58:61], v[46:49], v[26:29], 0
    s_nop 3
    v_mfma_f32_16x16x16_bf16 v[50:53], v[66:67], v[30:31], v[50:53]
    v_mfma_f32_16x16x16_bf16 v[54:57], v[32:33], v[30:31], v[54:57]
    v_mfma_f32_16x16x16_bf16 v[58:61], v[34:35], v[30:31], v[58:61]
    s_nop 5
    v_rcp_f32 v36, v50
    s_nop 0
    v_pk_mul_f32 v[54:55], v[54:55], v[36:37] op_sel_hi:[1,0]
    v_pk_mul_f32 v[58:59], v[58:59], v[36:37] op_sel_hi:[1,0]
    v_pk_mul_f32 v[56:57], v[56:57], v[36:37] op_sel_hi:[1,0]
    v_pk_mul_f32 v[60:61], v[60:61], v[36:37] op_sel_hi:[1,0]
    v_cvt_pk_bf16_f32 v62, v54, v58
    v_cvt_pk_bf16_f32 v63, v55, v59
    v_cvt_pk_bf16_f32 v64, v56, v60
    v_cvt_pk_bf16_f32 v65, v57, v61
    s_branch L_norm_s1i
L_last_s1i:
    s_nop 2
    v_pk_add_f32 v[30:31], v[30:31], v[32:33]
    v_pk_add_f32 v[34:35], v[34:35], v[36:37]
    v_cvt_pk_bf16_f32 v32, v30, v31
    v_cvt_pk_bf16_f32 v33, v34, v35
    global_store_dwordx2 v71, v[32:33], s[40:41] sc1
    v_mov_b32 v34, v33
    v_mov_b32 v35, 0
    s_waitcnt vmcnt(0) lgkmcnt(0)
    s_barrier
    s_branch L_chain_end
L_var11:
    s_add_u32 s17, s14, 0
    s_and_b32 s17, s17, 3
    s_lshl_b32 s18, s17, 13
    s_add_u32 s28, s46, s18
    s_addc_u32 s29, s47, 0
    s_lshl_b32 s17, s17, 15
    s_add_u32 s18, s17, 0
    s_add_u32 s32, s48, s18
    s_addc_u32 s33, s49, 0
    global_load_dwordx4 v[46:49], v3, s[28:29] sc1
    global_load_dword v71, v6, s[28:29] sc1
    v_mov_b64 v[14:15], 0
    v_mov_b64 v[16:17], 0
    v_mov_b64 v[18:19], 0
    v_mov_b64 v[20:21], 0
    v_mov_b64 v[22:23], 0
    v_mov_b64 v[24:25], 0
    v_mov_b64 v[26:27], 0
    v_mov_b64 v[28:29], 0
    v_mov_b64 v[30:31], 0
    v_mov_b64 v[32:33], 0
    v_mov_b64 v[34:35], 0
    v_mov_b64 v[36:37], 0
    ds_read_b128 v[50:53], v3 offset:32768
    ds_read_b128 v[54:57], v3 offset:36864
    ds_read_b128 v[58:61], v3 offset:40960
    ds_read_b128 v[62:65], v3 offset:45056
L_step_s1g:
    s_waitcnt vmcnt(0)
L_own2_s1g:
    v_max3_u32 v0, v46, v47, v48
    v_max3_u32 v0, v0, v49, v71
    v_cmp_eq_u32 vcc, -1, v0
    ds_write_b128 v3, v[46:49] offset:0
    ds_write_b32 v6, v71 offset:0
    s_cbranch_vccnz L_own_s1g
    global_load_dwordx4 v[66:69], v3, s[32:33] sc1
    global_load_dword v70, v6, s[32:33] sc1
    s_waitcnt lgkmcnt(0)
    s_barrier
    ds_read_b128 v[38:41], v2 offset:0
    ds_read_b128 v[42:45], v2 offset:1024
    ds_read_b128 v[46:49], v2 offset:2048
    s_waitcnt lgkmcnt(2)
    v_smfmac_f32_16x16x64_bf16 v[14:17], v[38:41], a[0:7], v1
    s_lshr_b32 s17, s14, 2
    s_xor_b32 s17, s17, s5
    v_smfmac_f32_16x16x64_bf16 v[18:21], v[38:41], a[8:15], v1
    s_and_b32 s17, s17, 1
    s_lshl_b32 s17, s17, 13
    v_smfmac_f32_16x16x64_bf16 v[22:25], v[38:41], a[160:167], v1
    s_lshl_b32 s18, s14, 19
    s_add_u32 s17, s17, s18
    v_smfmac_f32_16x16x64_bf16 v[26:29], v[38:41], a[168:175], v1
    s_add_u32 s40, s100, s17
    s_addc_u32 s41, s101, 0
    s_add_u32 s17, s14, 1
    v_smfmac_f32_16x16x64_bf16 v[30:33], v[38:41], v[50:57], v1
    ds_read_b128 v[50:53], v3 offset:49152
    s_lshr_b32 s18, s17, 1
    v_smfmac_f32_16x16x64_bf16 v[34:37], v[38:41], v[58:65], v1
    ds_read_b128 v[54:57], v3 offset:53248
    s_xor_b32 s18, s18, s5
    s_waitcnt lgkmcnt(3)
    v_smfmac_f32_16x16x64_bf16 v[14:17], v[42:45], a[16:23], v1
    ds_read_b128 v[58:61], v3 offset:57344
    s_and_b32 s18, s18, 1
    v_smfmac_f32_16x16x64_bf16 v[18:21], v[42:45], a[24:31], v1
    ds_read_b128 v[62:65], v3 offset:61440
    s_lshl_b32 s18, s18, 13
    v_smfmac_f32_16x16x64_bf16 v[22:25], v[42:45], a[176:183], v1
    ds_read_b128 v[38:41], v2 offset:3072
    s_lshl_b32 s17, s17, 20
    v_smfmac_f32_16x16x64_bf16 v[26:29], v[42:45], a[184:191], v1
    s_add_u32 s17, s17, s18
    s_add_u32 s38, s50, s17
    s_addc_u32 s39, s51, 0
    s_waitcnt lgkmcnt(3)
    v_smfmac_f32_16x16x64_bf16 v[30:33], v[42:45], v[50:57], v1
    ds_read_b128 v[50:53], v4 offset:0
    s_add_u32 s22, s38, 0x4000
    s_addc_u32 s23, s39, 0
    s_waitcnt lgkmcnt(2)
    v_smfmac_f32_16x16x64_bf16 v[34:37], v[42:45], v[58:65], v1
    ds_read_b128 v[54:57], v4 offset:4096
    s_and_b32 s17, s14, 1
    v_smfmac_f32_16x16x64_bf16 v[14:17], v[46:49], a[32:39], v1
    ds_read_b128 v[58:61], v4 offset:8192
    s_mul_i32 s17, s17, 163840
    v_smfmac_f32_16x16x64_bf16 v[18:21], v[46:49], a[40:47], v1
    ds_read_b128 v[62:65], v4 offset:12288
    s_add_u32 s24, s52, s17
    s_addc_u32 s25, s53, 0
    v_smfmac_f32_16x16x64_bf16 v[22:25], v[46:49], a[192:199], v1
    ds_read_b128 v[42:45], v2 offset:4096
    s_add_u32 s26, s24, 16384
    s_addc_u32 s27, s25, 0
    v_smfmac_f32_16x16x64_bf16 v[26:29], v[46:49], a[200:207], v1
    s_bfe_u32 s15, s14, 0x10001
    s_add_u32 s60, s14, 3
    s_waitcnt lgkmcnt(3)
    v_smfmac_f32_16x16x64_bf16 v[30:33], v[46:49], v[50:57], v1
    ds_read_b128 v[50:53], v4 offset:16384
    s_min_u32 s60, s60, 64
    s_waitcnt lgkmcnt(2)
    v_smfmac_f32_16x16x64_bf16 v[34:37], v[46:49], v[58:65], v1
    ds_read_b128 v[54:57], v4 offset:20480
    v_smfmac_f32_16x16x64_bf16 v[14:17], v[38:41], a[48:55], v1
    ds_read_b128 v[58:61], v4 offset:24576
    v_smfmac_f32_16x16x64_bf16 v[18:21], v[38:41], a[56:63], v1
    ds_read_b128 v[62:65], v4 offset:28672
    v_smfmac_f32_16x16x64_bf16 v[22:25], v[38:41], a[208:215], v1
    v_smfmac_f32_16x16x64_bf16 v[26:29], v[38:41], a[216:223], v1
    s_waitcnt lgkmcnt(2)
    v_smfmac_f32_16x16x64_bf16 v[30:33], v[38:41], v[50:57], v1
    ds_read_b128 v[50:53], v4 offset:32768
    s_waitcnt lgkmcnt(1)
    v_smfmac_f32_16x16x64_bf16 v[34:37], v[38:41], v[58:65], v1
    ds_read_b128 v[54:57], v4 offset:36864
    s_waitcnt vmcnt(0)
L_oth2_s1g:
    v_max3_u32 v0, v66, v67, v68
    v_max3_u32 v0, v0, v69, v70
    v_cmp_eq_u32 vcc, -1, v0
    ds_write_b128 v3, v[66:69] offset:5120
    ds_write_b32 v6, v70 offset:5120
    s_cbranch_vccnz L_oth_s1g
    v_smfmac_f32_16x16x64_bf16 v[14:17], v[42:45], a[64:71], v1
    ds_read_b128 v[58:61], v4 offset:40960
    v_smfmac_f32_16x16x64_bf16 v[18:21], v[42:45], a[72:79], v1
    ds_read_b128 v[62:65], v4 offset:45056
    v_smfmac_f32_16x16x64_bf16 v[22:25], v[42:45], a[224:231], v1
    v_smfmac_f32_16x16x64_bf16 v[26:29], v[42:45], a[232:239], v1
    s_waitcnt lgkmcnt(4)
    v_smfmac_f32_16x16x64_bf16 v[30:33], v[42:45], v[50:57], v1
    s_waitcnt lgkmcnt(0)
    v_smfmac_f32_16x16x64_bf16 v[34:37], v[42:45], v[58:65], v1
    s_barrier
    ds_read_b128 v[46:49], v2 offset:5120
    ds_read_b128 v[38:41], v2 offset:6144
    ds_read_b128 v[42:45], v2 offset:7168
    s_mov_b64 exec, 3
    v_lshlrev_b32 v0, 8, v2
    global_load_dword v70, v0, s[56:57] sc1
    s_mov_b64 exec, 1
    v_mov_b32 v71, s14
    global_store_dword v2, v71, s[42:43] sc1
    s_mov_b64 exec, -1
    s_waitcnt lgkmcnt(2)
    v_smfmac_f32_16x16x64_bf16 v[14:17], v[46:49], a[80:87], v1
    s_xor_b32 s17, s20, 149504
    v_smfmac_f32_16x16x64_bf16 v[18:21], v[46:49], a[88:95], v1
    s_add_u32 m0, s17, s21
    v_smfmac_f32_16x16x64_bf16 v[22:25], v[46:49], a[240:247], v1
    global_load_lds_dwordx4 v3, s[38:39]
    v_smfmac_f32_16x16x64_bf16 v[26:29], v[46:49], a[248:255], v1
    ds_read_b128 v[46:49], v2 offset:8192
    s_waitcnt lgkmcnt(2)
    v_smfmac_f32_16x16x64_bf16 v[14:17], v[38:41], a[96:103], v1
    s_add_u32 m0, m0, 0x1000
    v_smfmac_f32_16x16x64_bf16 v[18:21], v[38:41], a[104:111], v1
    s_add_u32 s38, s38, 0x1000
    s_addc_u32 s39, s39, 0
    v_smfmac_f32_16x16x64_bf16 v[22:25], v[38:41], v[72:79], v1
    global_load_lds_dwordx4 v3, s[38:39]
    v_smfmac_f32_16x16x64_bf16 v[26:29], v[38:41], v[80:87], v1
    ds_read_b128 v[38:41], v2 offset:9216
    s_waitcnt lgkmcnt(2)
    v_smfmac_f32_16x16x64_bf16 v[14:17], v[42:45], a[112:119], v1
    ds_read_b128 v[58:61], v5 offset:16384
    v_smfmac_f32_16x16x64_bf16 v[18:21], v[42:45], a[120:127], v1
    ds_read_b128 v[62:65], v5 offset:20480
    v_smfmac_f32_16x16x64_bf16 v[22:25], v[42:45], v[88:95], v1
    ds_read_b128 v[50:53], v5 offset:8192
    v_smfmac_f32_16x16x64_bf16 v[26:29], v[42:45], v[96:103], v1
    ds_read_b128 v[54:57], v5 offset:12288
    s_waitcnt lgkmcnt(5)
    v_smfmac_f32_16x16x64_bf16 v[14:17], v[46:49], a[128:135], v1
    v_add_u32 v0, s20, v2
    v_smfmac_f32_16x16x64_bf16 v[18:21], v[46:49], a[136:143], v1
    s_xor_b32 s20, s20, 149504
    v_smfmac_f32_16x16x64_bf16 v[22:25], v[46:49], v[104:111], v1
    v_smfmac_f32_16x16x64_bf16 v[26:29], v[46:49], v[112:119], v1
    s_waitcnt lgkmcnt(4)
    v_smfmac_f32_16x16x64_bf16 v[14:17], v[38:41], a[144:151], v1
    v_smfmac_f32_16x16x64_bf16 v[18:21], v[38:41], a[152:159], v1
    v_smfmac_f32_16x16x64_bf16 v[22:25], v[38:41], v[120:127], v1
    v_smfmac_f32_16x16x64_bf16 v[26:29], v[38:41], v[128:135], v1
    v_smfmac_f32_16x16x64_bf16 v[34:37], v[38:41], v[248:255], v1
    s_waitcnt lgkmcnt(2)
    v_smfmac_f32_16x16x64_bf16 v[30:33], v[38:41], v[58:65], v1
    ds_read_b128 v[58:61], v5 offset:0
    ds_read_b128 v[62:65], v5 offset:4096
    v_pk_add_f32 v[14:15], v[14:15], v[16:17]
    v_pk_add_f32 v[18:19], v[18:19], v[20:21]
    v_pk_mul_f32 v[14:15], v[14:15], s[44:45]
    v_pk_mul_f32 v[18:19], v[18:19], s[44:45]
    v_cvt_pk_bf16_f32 v16, v14, v18
    v_cvt_pk_bf16_f32 v17, v15, v19
    ds_write2_b32 v11, v16, v17 offset0:0 offset1:72
    v_pk_add_f32 v[22:23], v[22:23], v[24:25]
    v_pk_add_f32 v[26:27], v[26:27], v[28:29]
    v_cvt_pk_bf16_f32 v28, v22, v26
    v_cvt_pk_bf16_f32 v29, v23, v27
    v_add_u32 v71, 2304, v11
    ds_write2_b32 v71, v28, v29 offset0:0 offset1:72
    v_smfmac_f32_16x16x64_bf16 v[34:37], v[46:49], v[240:247], v1
    ds_read_b128 v[38:41], v2 offset:5120
    s_waitcnt lgkmcnt(5)
    v_smfmac_f32_16x16x64_bf16 v[30:33], v[46:49], v[50:57], v1
    ds_read_b128 v[50:53], v4 offset:57344
    ds_read_b128 v[54:57], v4 offset:61440
    v_smfmac_f32_16x16x64_bf16 v[34:37], v[42:45], v[232:239], v1
    ds_read_b128 v[46:49], v2 offset:6144
    s_waitcnt lgkmcnt(6)
    v_smfmac_f32_16x16x64_bf16 v[30:33], v[42:45], v[58:65], v1
    ds_read_b128 v[58:61], v4 offset:49152
    ds_read_b128 v[62:65], v4 offset:53248
    s_waitcnt lgkmcnt(6)
    s_barrier
    ds_read_b128 v[66:69], v0 offset:3072
    ds_read_b128 v[42:45], v0 offset:1024
    v_lshrrev_b32 v71, 1, v3
    s_waitcnt lgkmcnt(4)
    v_smfmac_f32_16x16x64_bf16 v[34:37], v[46:49], v[224:231], v1
    v_smfmac_f32_16x16x64_bf16 v[30:33], v[46:49], v[50:57], v1
    ds_read_b128 v[50:53], v12 offset:0
    ds_read_b128 v[54:57], v12 offset:64
    ds_read_b128 v[46:49], v0 offset:2048
    v_smfmac_f32_16x16x64_bf16 v[34:37], v[38:41], v[216:223], v1
    s_waitcnt lgkmcnt(5)
    v_smfmac_f32_16x16x64_bf16 v[30:33], v[38:41], v[58:65], v1
    ds_read_b128 v[58:61], v12 offset:128
    ds_read_b128 v[62:65], v12 offset:192
    ds_read_b128 v[38:41], v0 offset:0
    s_cmp_eq_u32 s14, 63
    s_cbranch_scc1 L_last_s1g
    s_waitcnt lgkmcnt(4)
    v_mfma_f32_16x16x32_bf16 v[14:17], v[42:45], v[54:57], 0
    ds_read_b128 v[42:45], v0 offset:5120
    s_waitcnt lgkmcnt(3)
    v_mfma_f32_16x16x32_bf16 v[14:17], v[46:49], v[58:61], v[14:17]
    ds_read_b128 v[46:49], v0 offset:6144
    v_pk_add_f32 v[30:31], v[30:31], v[32:33]
    v_pk_add_f32 v[34:35], v[34:35], v[36:37]
    s_waitcnt lgkmcnt(3)
    v_mfma_f32_16x16x32_bf16 v[14:17], v[66:69], v[62:65], v[14:17]
    ds_read_b128 v[66:69], v0 offset:7168
    v_cvt_pk_bf16_f32 v32, v30, v31
    v_cvt_pk_bf16_f32 v33, v34, v35
    s_waitcnt lgkmcnt(3)
    v_mfma_f32_16x16x32_bf16 v[14:17], v[38:41], v[50:53], v[14:17]
    ds_read_b128 v[38:41], v0 offset:4096
    global_store_dwordx2 v71, v[32:33], s[40:41] sc1
    v_mov_b32 v34, v33
    v_mov_b32 v35, 0
    s_waitcnt lgkmcnt(3)
    v_mfma_f32_16x16x32_bf16 v[18:21], v[42:45], v[54:57], 0
    ds_read_b128 v[42:45], v12 offset:2368
    s_waitcnt lgkmcnt(3)
    v_mfma_f32_16x16x32_bf16 v[18:21], v[46:49], v[58:61], v[18:21]
    ds_read_b128 v[46:49], v12 offset:2432
    s_waitcnt lgkmcnt(3)
    v_mfma_f32_16x16x32_bf16 v[18:21], v[66:69], v[62:65], v[18:21]
    ds_read_b128 v[66:69], v12 offset:2496
    s_waitcnt lgkmcnt(3)
    v_mfma_f32_16x16x32_bf16 v[18:21], v[38:41], v[50:53], v[18:21]
    ds_read_b128 v[38:41], v12 offset:2304
    v_exp_f32 v36, v14
    v_exp_f32 v37, v15
    v_exp_f32 v71, v16
    v_cvt_pk_bf16_f32 v26, v36, v37
    v_exp_f32 v36, v17
    s_nop 0
    v_cvt_pk_bf16_f32 v27, v71, v36
    s_waitcnt lgkmcnt(3)
    v_mfma_f32_16x16x32_bf16 v[22:25], v[42:45], v[54:57], 0
    ds_read_b128 v[42:45], v3 offset:18432
    s_waitcnt lgkmcnt(3)
    v_mfma_f32_16x16x32_bf16 v[22:25], v[46:49], v[58:61], v[22:25]
    ds_read_b128 v[46:49], v3 offset:22528
    v_exp_f32 v36, v18
    v_exp_f32 v37, v19
    s_waitcnt lgkmcnt(3)
    v_mfma_f32_16x16x32_bf16 v[22:25], v[66:69], v[62:65], v[22:25]
    v_exp_f32 v71, v20
    v_cvt_pk_bf16_f32 v28, v36, v37
    s_waitcnt lgkmcnt(2)
    v_mfma_f32_16x16x32_bf16 v[22:25], v[38:41], v[50:53], v[22:25]
    v_exp_f32 v36, v21
    s_nop 0
    v_cvt_pk_bf16_f32 v29, v71, v36
    v_mov_b64 v[66:67], s[62:63]
    v_mov_b64 v[68:69], s[62:63]
    s_waitcnt lgkmcnt(1)
    v_mfma_f32_16x16x32_bf16 v[54:57], v[42:45], v[26:29], 0
    s_nop 0
    v_exp_f32 v36, v22
    s_waitcnt lgkmcnt(0)
    v_mfma_f32_16x16x32_bf16 v[58:61], v[46:49], v[26:29], 0
    v_exp_f32 v37, v23
    v_mfma_f32_16x16x32_bf16 v[50:53], v[66:69], v[26:29], 0
    v_mov_b32 v31, 0
    v_cvt_pk_bf16_f32 v30, v36, v37
    s_add_u32 m0, s21, 18432
    s_nop 2
    v_mfma_f32_16x16x16_bf16 v[50:53], v[66:67], v[30:31], v[50:53]
    v_mfma_f32_16x16x16_bf16 v[54:57], v[32:33], v[30:31], v[54:57]
    v_mfma_f32_16x16x16_bf16 v[58:61], v[34:35], v[30:31], v[58:61]
    global_load_lds_dwordx4 v3, s[22:23]
    s_add_u32 m0, m0, 0x1000
    s_add_u32 s22, s22, 0x1000
    s_addc_u32 s23, s23, 0
    global_load_lds_dwordx4 v3, s[22:23]
    s_nop 0
    v_rcp_f32 v36, v50
    v_subrev_u32 v0, s54, v50
    v_cmp_lt_u32 vcc, s55, v0
    v_pk_mul_f32 v[54:55], v[54:55], v[36:37] op_sel_hi:[1,0]
    v_pk_mul_f32 v[58:59], v[58:59], v[36:37] op_sel_hi:[1,0]
    v_pk_mul_f32 v[56:57], v[56:57], v[36:37] op_sel_hi:[1,0]
    v_pk_mul_f32 v[60:61], v[60:61], v[36:37] op_sel_hi:[1,0]
    v_cvt_pk_bf16_f32 v62, v54, v58
    v_cvt_pk_bf16_f32 v63, v55, v59
    v_cvt_pk_bf16_f32 v64, v56, v60
    v_cvt_pk_bf16_f32 v65, v57, v61
    s_cbranch_vccnz L_fb_s1g
L_norm_s1g:
    s_mov_b64 exec, s[70:71]
    ds_write_b128 v13, v[62:65] offset:5120
    s_mov_b64 exec, -1
    v_mov_b64 v[14:15], 0
    v_mov_b64 v[16:17], 0
    v_mov_b64 v[18:19], 0
    v_mov_b64 v[20:21], 0
    v_mov_b64 v[22:23], 0
    v_mov_b64 v[24:25], 0
    v_mov_b64 v[26:27], 0
    v_mov_b64 v[28:29], 0
    v_mov_b64 v[30:31], 0
    v_mov_b64 v[32:33], 0
    s_mov_b64 exec, 3
    s_waitcnt vmcnt(6)
L_kv2_s1g:
    v_cmp_gt_u32 vcc, s60, v70
    s_nop 0
    s_cbranch_vccnz L_kv_s1g
    s_mov_b64 exec, -1
    s_waitcnt lgkmcnt(0)
    s_barrier
    ds_read_b128 v[38:41], v2 offset:5120
    ds_read_b128 v[42:45], v2 offset:6144
    s_add_u32 s14, s14, 1
    s_add_u32 s17, s14, 0
    s_and_b32 s17, s17, 3
    s_lshl_b32 s18, s17, 13
    s_add_u32 s28, s46, s18
    s_addc_u32 s29, s47, 0
    s_lshl_b32 s17, s17, 15
    s_add_u32 s18, s17, 0
    s_add_u32 s32, s48, s18
    s_addc_u32 s33, s49, 0
    s_waitcnt lgkmcnt(1)
    v_smfmac_f32_16x16x64_bf16 v[14:17], v[38:41], v[136:143], v1
    s_waitcnt lgkmcnt(0)
    v_smfmac_f32_16x16x64_bf16 v[14:17], v[42:45], v[144:151], v1
    v_smfmac_f32_16x16x64_bf16 v[18:21], v[38:41], v[152:159], v1
    v_smfmac_f32_16x16x64_bf16 v[18:21], v[42:45], v[160:167], v1
    v_smfmac_f32_16x16x64_bf16 v[22:25], v[38:41], v[168:175], v1
    v_smfmac_f32_16x16x64_bf16 v[22:25], v[42:45], v[176:183], v1
    v_smfmac_f32_16x16x64_bf16 v[26:29], v[38:41], v[184:191], v1
    v_smfmac_f32_16x16x64_bf16 v[26:29], v[42:45], v[192:199], v1
    s_nop 1
    v_pk_add_f32 v[14:15], v[14:15], v[16:17]
    s_nop 0
    v_pk_add_f32 v[18:19], v[18:19], v[20:21]
    v_smfmac_f32_16x16x64_bf16 v[30:33], v[38:41], v[200:207], v1
    v_cvt_pk_bf16_f32 v16, v14, v18
    v_cvt_pk_bf16_f32 v17, v15, v19
    v_smfmac_f32_16x16x64_bf16 v[30:33], v[42:45], v[208:215], v1
    v_and_or_b32 v16, v16, -2, s15
    v_and_or_b32 v17, v17, -2, s15
    global_store_dwordx2 v7, v[16:17], s[24:25] sc1
    v_pk_add_f32 v[22:23], v[22:23], v[24:25]
    v_pk_add_f32 v[26:27], v[26:27], v[28:29]
    v_cvt_pk_bf16_f32 v24, v22, v26
    v_cvt_pk_bf16_f32 v25, v23, v27
    v_and_or_b32 v24, v24, -2, s15
    v_and_or_b32 v25, v25, -2, s15
    global_store_dwordx2 v7, v[24:25], s[26:27] sc1
    v_pk_add_f32 v[30:31], v[30:31], v[32:33]
    v_cvt_pk_bf16_f32 v32, v30, v31
    v_and_or_b32 v32, v32, -2, s15
    global_store_dword v8, v32, s[24:25] sc1
    s_waitcnt lgkmcnt(0)
    s_barrier
    global_load_dwordx4 v[46:49], v3, s[28:29] sc1
    global_load_dword v71, v6, s[28:29] sc1
    v_mov_b64 v[14:15], 0
    v_mov_b64 v[16:17], 0
    v_mov_b64 v[18:19], 0
    v_mov_b64 v[20:21], 0
    v_mov_b64 v[22:23], 0
    v_mov_b64 v[24:25], 0
    v_mov_b64 v[26:27], 0
    v_mov_b64 v[28:29], 0
    v_mov_b64 v[30:31], 0
    v_mov_b64 v[32:33], 0
    v_mov_b64 v[34:35], 0
    v_mov_b64 v[36:37], 0
    ds_read_b128 v[50:53], v3 offset:32768
    ds_read_b128 v[54:57], v3 offset:36864
    ds_read_b128 v[58:61], v3 offset:40960
    ds_read_b128 v[62:65], v3 offset:45056
    s_branch L_step_s1g
L_own_s1g:
    s_add_u32 s16, s16, 1
    s_cmp_gt_u32 s16, 1048576
    s_cbranch_scc1 L_bail5
    s_waitcnt lgkmcnt(0)
    global_load_dwordx4 v[46:49], v3, s[28:29] sc1
    global_load_dword v71, v6, s[28:29] sc1
    s_waitcnt vmcnt(0)
    s_branch L_own2_s1g
L_oth_s1g:
    s_add_u32 s16, s16, 1
    s_cmp_gt_u32 s16, 1048576
    s_cbranch_scc1 L_bail6
    s_waitcnt lgkmcnt(0)
    global_load_dwordx4 v[66:69], v3, s[32:33] sc1
    global_load_dword v70, v6, s[32:33] sc1
    s_waitcnt vmcnt(0)
    s_branch L_oth2_s1g
L_kv_s1g:
    s_add_u32 s16, s16, 1
    s_cmp_gt_u32 s16, 1048576
    s_cbranch_scc1 L_bail7
    v_lshlrev_b32 v0, 8, v2
    global_load_dword v70, v0, s[56:57] sc1
    s_waitcnt vmcnt(0)
    s_branch L_kv2_s1g
L_fb_s1g:
    v_max3_f32 v0, v14, v15, v16
    v_max3_f32 v0, v0, v17, v18
    v_max3_f32 v0, v0, v19, v20
    v_max3_f32 v0, v0, v21, v22
    v_max3_f32 v0, v0, v23, v24
    v_max_f32 v0, v0, v25
    v_mov_b32 v36, v0
    s_nop 1
    v_permlane16_swap_b32 v0, v36
    v_max_f32 v0, v0, v36
    v_mov_b32 v36, v0
    s_nop 1
    v_permlane32_swap_b32 v0, v36
    v_max_f32 v0, v0, v36
    v_sub_f32 v14, v14, v0
    v_sub_f32 v15, v15, v0
    v_sub_f32 v16, v16, v0
    v_sub_f32 v17, v17, v0
    v_sub_f32 v18, v18, v0
    v_sub_f32 v19, v19, v0
    v_sub_f32 v20, v20, v0
    v_sub_f32 v21, v21, v0
    v_sub_f32 v22, v22, v0
    v_sub_f32 v23, v23, v0
    v_sub_f32 v24, v24, v0
    v_sub_f32 v25, v25, v0
    v_exp_f32 v36, v14
    v_exp_f32 v37, v15
    v_exp_f32 v71, v16
    v_cvt_pk_bf16_f32 v26, v36, v37
    v_exp_f32 v36, v17
    s_nop 0
    v_cvt_pk_bf16_f32 v27, v71, v36
    v_exp_f32 v36, v18
    v_exp_f32 v37, v19
    v_exp_f32 v71, v20
    v_cvt_pk_bf16_f32 v28, v36, v37
    v_exp_f32 v36, v21
    s_nop 0
    v_cvt_pk_bf16_f32 v29, v71, v36
    v_exp_f32 v36, v22
    v_exp_f32 v37, v23
    v_mov_b32 v31, 0
    v_cvt_pk_bf16_f32 v30, v36, v37
    v_mfma_f32_16x16x32_bf16 v[50:53], v[66:69], v[26:29], 0
    v_mfma_f32_16x16x32_bf16 v[54:57], v[42:45], v[26:29], 0
    v_mfma_f32_16x16x32_bf16 v[58:61], v[46:49], v[26:29], 0
    s_nop 3
    v_mfma_f32_16x16x16_bf16 v[50:53], v[66:67], v[30:31], v[50:53]
    v_mfma_f32_16x16x16_bf16 v[54:57], v[32:33], v[30:31], v[54:57]
    v_mfma_f32_16x16x16_bf16 v[58:61], v[34:35], v[30:31], v[58:61]
    s_nop 5
    v_rcp_f32 v36, v50
    s_nop 0
    v_pk_mul_f32 v[54:55], v[54:55], v[36:37] op_sel_hi:[1,0]
    v_pk_mul_f32 v[58:59], v[58:59], v[36:37] op_sel_hi:[1,0]
    v_pk_mul_f32 v[56:57], v[56:57], v[36:37] op_sel_hi:[1,0]
    v_pk_mul_f32 v[60:61], v[60:61], v[36:37] op_sel_hi:[1,0]
    v_cvt_pk_bf16_f32 v62, v54, v58
    v_cvt_pk_bf16_f32 v63, v55, v59
    v_cvt_pk_bf16_f32 v64, v56, v60
    v_cvt_pk_bf16_f32 v65, v57, v61
    s_branch L_norm_s1g
L_last_s1g:
    s_nop 2
    v_pk_add_f32 v[30:31], v[30:31], v[32:33]
    v_pk_add_f32 v[34:35], v[34:35], v[36:37]
    v_cvt_pk_bf16_f32 v32, v30, v31
    v_cvt_pk_bf16_f32 v33, v34, v35
    global_store_dwordx2 v71, v[32:33], s[40:41] sc1
    v_mov_b32 v34, v33
    v_mov_b32 v35, 0
    s_waitcnt vmcnt(0) lgkmcnt(0)
    s_barrier
    s_mov_b64 exec, 1
    v_mov_b32 v0, 0
    v_mov_b32 v1, 64
    global_store_dword v0, v1, s[42:43] sc1
    s_waitcnt vmcnt(0)
    s_mov_b64 exec, -1
    s_branch L_chain_end
L_chain_end:
    s_branch L_end
.section .rodata,"a"
.p2align 6
.amdhsa_kernel concat_heads__grouped_kv_mqa__memory_aug_recurrent_mem_tr__prompt_kernel
  .amdhsa_next_free_vgpr 512
  .amdhsa_next_free_sgpr 102
  .amdhsa_accum_offset 256
  .amdhsa_group_segment_fixed_size 0
  .amdhsa_kernarg_size 120
  .amdhsa_user_sgpr_count 2
  .amdhsa_user_sgpr_kernarg_segment_ptr 1
  .amdhsa_system_sgpr_workgroup_id_x 1
.end_amdhsa_kernel
```
